```python
import torch

def _softmax(x, axis=-1):
    return torch.softmax(x, dim=axis)
def _gelu(x):
    return torch.nn.functional.gelu(x, approximate="tanh")
def _silu(x):
    return torch.nn.functional.silu(x)
def _sigmoid(x):
    return torch.sigmoid(x)
def _layernorm(x, axis=-1, eps=1e-5):
    m = x.mean(dim=axis, keepdim=True)
    v = x.var(dim=axis, keepdim=True, unbiased=False)
    return (x - m) / torch.sqrt(v + eps)
def _scatter_add(tgt, idx, src, axis=0):
    return tgt.clone().index_add_(axis, idx, src)
def _segment_sum(src, seg, n):
    out = torch.zeros((n,) + src.shape[1:], dtype=src.dtype)
    return out.index_add_(0, seg, src)
def _pad(x, pw):
    flat = tuple(v for pair in reversed(pw) for v in pair)
    return torch.nn.functional.pad(x, flat)

kernel_name = 'concat_heads__sliding_local_dilated__compressed_kv_cla__prompt'

def setup_inputs():

    _w = (lambda a: (lambda t: t.to(torch.bfloat16) if t.is_floating_point() else t)(torch.as_tensor(a)))
    def _A_setup():
        B, S, D = 1, 2048, 512
        return {
            "x": _w((lambda *s: torch.randn(*s, dtype=torch.bfloat16) * 0.4)(B, S, D)),
            "wqkv": _w((lambda *s: torch.randn(*s, dtype=torch.bfloat16) * 0.4)(D, 3 * D)),
            "wo": _w((lambda *s: torch.randn(*s, dtype=torch.bfloat16) * 0.05)(D, D)),
        }
    _A_in = _A_setup()

    def _B_setup():
        B, H, Sq, Sk, D, M = 1, 32, 2048, 2048, 128, 512
        Dc = 4 * D
        return {
            "x": _w((lambda *s: torch.randn(*s, dtype=torch.bfloat16) * 0.2)(B, Sq, M)),
            "c_kv": _w((lambda *s: torch.randn(*s, dtype=torch.bfloat16) * 1.6)(B, Sk, Dc)),
            "w_q": _w((lambda *s: torch.randn(*s, dtype=torch.bfloat16) * 3.2)(M, H, D) * (M ** -0.5)),
            "w_uk": _w((lambda *s: torch.randn(*s, dtype=torch.bfloat16) * 3.2)(Dc, H, D) * (Dc ** -0.5)),
            "w_uv": _w((lambda *s: torch.randn(*s, dtype=torch.bfloat16) * 1.6)(Dc, H, D) * (Dc ** -0.5)),
            "w_o": _w((lambda *s: torch.randn(*s, dtype=torch.bfloat16) * 1.6)(H, D, M) * ((H * D) ** -0.5)),
        }
    _B_in = _B_setup()

    return {
        "A_x": _A_in["x"],
        "A_wqkv": _A_in["wqkv"],
        "A_wo": _A_in["wo"],
        "B_x": _B_in["x"],
        "B_c_kv": _B_in["c_kv"],
        "B_w_q": _B_in["w_q"],
        "B_w_uk": _B_in["w_uk"],
        "B_w_uv": _B_in["w_uv"],
        "B_w_o": _B_in["w_o"],
    }

def reference(A_x, A_wqkv, A_wo, B_x, B_c_kv, B_w_q, B_w_uk, B_w_uv, B_w_o):
    def _A_ref(x, wqkv, wo):
        B, S, D = x.shape
        H = 32; Dh = D // H
        W, dil = 8, 2
        qkv = (lambda x, *d: x.permute(*d))((x @ wqkv).reshape(B, S, 3, H, Dh), 2, 0, 3, 1, 4)
        q, k, v = qkv[0], qkv[1], qkv[2]
        scale = Dh ** -0.5
        pos = torch.arange(S)
        off = torch.arange(W) * dil
        idx = pos[:, None] - off[None, :]
        mask = idx >= 0
        idx_c = torch.where(mask, idx, 0).reshape(-1)
        kg = k[:, :, idx_c, :].reshape(B, H, S, W, Dh)
        vg = v[:, :, idx_c, :].reshape(B, H, S, W, Dh)
        logits = torch.einsum("bhsd,bhswd->bhsw", q, kg) * scale
        logits = torch.where(mask[None, None, :, :], logits, -1e9)
        attn = _softmax(logits, axis=-1)
        o = torch.einsum("bhsw,bhswd->bhsd", attn, vg)
        return (lambda x, *d: x.permute(*d))(o, 0, 2, 1, 3).reshape(B, S, D) @ wo

    def _B_ref(x, c_kv, w_q, w_uk, w_uv, w_o):
        B, Sq, M = x.shape[0], x.shape[1], x.shape[2]
        Sk = c_kv.shape[1]
        H, D = w_q.shape[1], w_q.shape[2]
        q = torch.einsum("bqm,mhd->bhqd", x, w_q)
        k = torch.einsum("bkc,chd->bhkd", c_kv, w_uk)
        v = torch.einsum("bkc,chd->bhkd", c_kv, w_uv)
        scores = torch.einsum("bhqd,bhkd->bhqk", q, k) * (D ** -0.5)
        off = Sk - Sq
        qi = torch.arange(Sq)[:, None]
        kj = torch.arange(Sk)[None, :]
        cmask = kj <= (qi + off)
        scores = torch.where(cmask[None, None], scores, -1e9)
        p = _softmax(scores, axis=-1)
        ctx = torch.einsum("bhqk,bhkd->bhqd", p, v)
        return torch.einsum("bhqd,hdm->bqm", ctx, w_o)

    a = _A_ref(A_x, A_wqkv, A_wo)
    b = _B_ref(B_x, B_c_kv, B_w_q, B_w_uk, B_w_uv, B_w_o)
    return torch.concatenate([a, b], axis=-1)
```

```asm
; @launch grid=(256,1,1) block=(256,1,1) lds=163840
.amdgcn_target "amdgcn-amd-amdhsa--gfx950"
.text
.globl concat_heads__sliding_local_dilated__compressed_kv_cla__prompt_kernel
.p2align 8
.type concat_heads__sliding_local_dilated__compressed_kv_cla__prompt_kernel,@function
concat_heads__sliding_local_dilated__compressed_kv_cla__prompt_kernel:
    s_cmp_ge_u32 s2, 256
    s_cbranch_scc1 L_end
    s_load_dwordx16 s[4:19], s[0:1], 0
    s_load_dwordx8 s[20:27], s[0:1], 64
    s_getpc_b64 s[64:65]
L_pc0:
    v_lshrrev_b32 v27, 3, v0
    s_lshr_b32 s66, s2, 3
    v_lshlrev_b32 v27, 7, v27
    s_lshl_b32 s66, s66, 12
    v_add_u32 v27, s66, v27
    v_min_u32 v27, L_end-L_pc0-4, v27
    global_load_dword a255, v27, s[64:65]
    v_lshrrev_b32 v26, 6, v0
    v_and_b32 v1, 63, v0
    v_readfirstlane_b32 s48, v26
    s_and_b32 s49, s2, 7
    s_lshl_b32 s49, s49, 2
    s_lshr_b32 s51, s2, 3
    s_and_b32 s51, s51, 3
    s_add_u32 s49, s49, s51
    s_lshr_b32 s50, s2, 5
    v_lshlrev_b32 v2, 4, v1
    v_lshrrev_b32 v3, 4, v1
    v_and_b32 v4, 15, v1
    v_lshrrev_b32 v26, 3, v1
    v_and_b32 v27, 7, v1
    v_xor_b32 v27, v27, v26
    v_lshlrev_b32 v27, 4, v27
    v_lshl_add_u32 v8, v26, 10, v27
    v_add_u32 v9, 7168, v8
    v_add_u32 v10, 14336, v8
    v_add_u32 v11, 21504, v8
    v_lshrrev_b32 v26, 1, v4
    v_xor_b32 v26, v26, v3
    v_and_b32 v27, 1, v4
    v_lshl_add_u32 v26, v26, 1, v27
    v_lshlrev_b32 v26, 4, v26
    v_lshl_add_u32 v12, v3, 13, v26
    v_add_u32 v13, 31744, v12
    v_xor_b32 v28, 128, v12
    v_add_u32 v14, 63488, v28
    v_add_u32 v15, 95232, v28
    s_lshl_b32 s96, s48, 13
    s_and_b32 s51, s48, 1
    s_lshl_b32 s55, s51, 18
    s_lshl_b32 s54, s48, 15
    s_lshl_b32 s3, s48, 12
    s_sub_u32 s51, 7, s50
    s_lshl_b32 s51, s51, 18
    s_lshl_b32 s52, s49, 8
    s_waitcnt lgkmcnt(0)
    s_cmp_lt_u32 s48, 2
    s_cselect_b32 s32, s16, s18
    s_cselect_b32 s33, s17, s19
    s_add_u32 s32, s32, s52
    s_addc_u32 s33, s33, 0
    s_sub_u32 s34, 4194304, s52
    s_mov_b32 s35, 0x20000
    s_add_u32 s28, s12, s51
    s_addc_u32 s29, s13, 0
    s_mov_b32 s30, 262144
    s_mov_b32 s31, 0x20000
    s_add_u32 m0, s96, 0
    s_add_u32 s51, s55, 0
    buffer_load_dwordx4 v12, s[32:35], s51 offen offset:0 nt lds
    s_lshr_b32 s52, s48, 1
    s_lshl_b32 s52, s52, 14
    v_and_b32 v26, 7, v1
    v_xor_b32 v26, v26, v3
    v_lshlrev_b32 v26, 4, v26
    buffer_load_dwordx4 v13, s[32:35], s51 offen offset:1024 nt lds
    v_lshl_add_u32 v26, v4, 7, v26
    v_add_u32 v16, 0x8000, v26
    v_xor_b32 v17, 64, v16
    v_lshrrev_b32 v26, 2, v4
    v_lshl_add_u32 v27, v3, 3, v26
    buffer_load_dwordx4 v14, s[32:35], s51 offen offset:2048 nt lds
    v_lshlrev_b32 v27, 8, v27
    v_and_b32 v28, 1, v3
    v_lshl_add_u32 v26, v28, 2, v26
    v_lshl_add_u32 v27, v26, 5, v27
    v_and_b32 v28, 3, v4
    buffer_load_dwordx4 v15, s[32:35], s51 offen offset:3072 nt lds
    v_lshl_add_u32 v27, v28, 3, v27
    v_add_u32 v18, s52, v27
    v_xor_b32 v19, 32, v18
    v_xor_b32 v20, 64, v18
    v_xor_b32 v21, 96, v18
    s_add_u32 m0, s96, 4096
    s_add_u32 s51, s55, 131072
    buffer_load_dwordx4 v12, s[32:35], s51 offen offset:0 nt lds
    s_and_b32 s52, s48, 1
    s_lshl_b32 s52, s52, 7
    v_xor_b32 v18, s52, v18
    v_xor_b32 v19, s52, v19
    v_xor_b32 v20, s52, v20
    buffer_load_dwordx4 v13, s[32:35], s51 offen offset:1024 nt lds
    v_xor_b32 v21, s52, v21
    s_lshl_b32 s52, s2, 2
    s_add_u32 s52, s52, s48
    s_lshl_b32 s52, s52, 11
    v_lshlrev_b32 v29, 7, v4
    buffer_load_dwordx4 v14, s[32:35], s51 offen offset:2048 nt lds
    v_add_u32 v29, s52, v29
    s_lshr_b32 s53, s2, 3
    s_lshl_b32 s53, s53, 2
    s_add_u32 s53, s53, s48
    s_lshl_b32 s53, s53, 14
    buffer_load_dwordx4 v15, s[32:35], s51 offen offset:3072 nt lds
    s_and_b32 s52, s2, 7
    s_lshl_b32 s52, s52, 10
    s_add_u32 s53, s53, s52
    v_bfe_u32 v31, v1, 3, 1
    v_lshlrev_b32 v31, 13, v31
    s_lshr_b32 m0, s96, 1
    s_add_u32 m0, m0, 32768
    s_add_u32 s51, s54, 0
    buffer_load_dwordx4 v8, s[28:31], s51 offen offset:0 lds
    v_and_b32 v30, 7, v1
    v_lshl_add_u32 v31, v30, 7, v31
    v_add_u32 v31, s53, v31
    s_add_u32 s56, s26, 62980096
    s_addc_u32 s57, s27, 0
    s_load_dword s94, s[56:57], 0
    buffer_load_dwordx4 v9, s[28:31], s51 offen offset:1024 lds
    buffer_load_dwordx4 v10, s[28:31], s51 offen offset:2048 lds
    buffer_load_dwordx4 v11, s[28:31], s51 offen offset:3072 lds
    s_add_u32 m0, s96, 49152
    s_add_u32 s51, s55, 524288
    buffer_load_dwordx4 v12, s[32:35], s51 offen offset:0 nt lds
    buffer_load_dwordx4 v13, s[32:35], s51 offen offset:1024 nt lds
    buffer_load_dwordx4 v14, s[32:35], s51 offen offset:2048 nt lds
    buffer_load_dwordx4 v15, s[32:35], s51 offen offset:3072 nt lds
    s_add_u32 m0, s96, 53248
    s_add_u32 s51, s55, 655360
    buffer_load_dwordx4 v12, s[32:35], s51 offen offset:0 nt lds
    buffer_load_dwordx4 v13, s[32:35], s51 offen offset:1024 nt lds
    buffer_load_dwordx4 v14, s[32:35], s51 offen offset:2048 nt lds
    buffer_load_dwordx4 v15, s[32:35], s51 offen offset:3072 nt lds
    s_lshr_b32 m0, s96, 1
    s_add_u32 m0, m0, 81920
    s_add_u32 s51, s54, 128
    buffer_load_dwordx4 v8, s[28:31], s51 offen offset:0 lds
    buffer_load_dwordx4 v9, s[28:31], s51 offen offset:1024 lds
    buffer_load_dwordx4 v10, s[28:31], s51 offen offset:2048 lds
    buffer_load_dwordx4 v11, s[28:31], s51 offen offset:3072 lds
    s_waitcnt vmcnt(12)
    s_barrier
L_vmain:
    ds_read_b64_tr_b16 a[0:1], v18 offset:0
    ds_read_b64_tr_b16 a[2:3], v18 offset:1024
    ds_read_b64_tr_b16 a[16:17], v18 offset:8192
    ds_read_b64_tr_b16 a[18:19], v18 offset:9216
    ds_read_b64_tr_b16 a[4:5], v19 offset:0
    ds_read_b64_tr_b16 a[6:7], v19 offset:1024
    ds_read_b64_tr_b16 a[20:21], v19 offset:8192
    ds_read_b64_tr_b16 a[22:23], v19 offset:9216
    ds_read_b64_tr_b16 a[8:9], v20 offset:0
    ds_read_b64_tr_b16 a[10:11], v20 offset:1024
    ds_read_b64_tr_b16 a[24:25], v20 offset:8192
    ds_read_b64_tr_b16 a[26:27], v20 offset:9216
    ds_read_b64_tr_b16 a[12:13], v21 offset:0
    ds_read_b64_tr_b16 a[14:15], v21 offset:1024
    ds_read_b64_tr_b16 a[28:29], v21 offset:8192
    ds_read_b64_tr_b16 a[30:31], v21 offset:9216
    ds_read_b128 v[32:35], v16 offset:0
    ds_read_b128 v[36:39], v17 offset:0
    ds_read_b128 v[40:43], v16 offset:2048
    ds_read_b128 v[44:47], v17 offset:2048
    ds_read_b128 v[48:51], v16 offset:4096
    ds_read_b128 v[52:55], v17 offset:4096
    ds_read_b128 v[56:59], v16 offset:6144
    ds_read_b128 v[60:63], v17 offset:6144
    ds_read_b128 v[64:67], v16 offset:8192
    ds_read_b128 v[68:71], v17 offset:8192
    ds_read_b128 v[72:75], v16 offset:10240
    ds_read_b128 v[76:79], v17 offset:10240
    ds_read_b128 v[80:83], v16 offset:12288
    ds_read_b128 v[84:87], v17 offset:12288
    ds_read_b128 v[88:91], v16 offset:14336
    ds_read_b128 v[92:95], v17 offset:14336
    v_add_u32 v16, 0xc000, v16
    v_add_u32 v17, 0xc000, v17
    v_add_u32 v18, 0xc000, v18
    v_add_u32 v19, 0xc000, v19
    v_add_u32 v20, 0xc000, v20
    v_add_u32 v21, 0xc000, v21
    s_cmp_ge_u32 s48, 2
    s_cbranch_scc1 L_vpath
    s_waitcnt lgkmcnt(0)
    v_mfma_f32_16x16x32_bf16 v[128:131], a[0:3], v[32:35], 0
    s_add_u32 m0, s96, 98304
    s_add_u32 s51, s55, 1048576
    v_mfma_f32_16x16x32_bf16 v[128:131], a[16:19], v[36:39], v[128:131]
    buffer_load_dwordx4 v12, s[32:35], s51 offen offset:0 nt lds
    v_mfma_f32_16x16x32_bf16 v[132:135], a[4:7], v[32:35], 0
    v_mfma_f32_16x16x32_bf16 v[132:135], a[20:23], v[36:39], v[132:135]
    buffer_load_dwordx4 v13, s[32:35], s51 offen offset:1024 nt lds
    v_mfma_f32_16x16x32_bf16 v[136:139], a[8:11], v[32:35], 0
    v_mfma_f32_16x16x32_bf16 v[136:139], a[24:27], v[36:39], v[136:139]
    buffer_load_dwordx4 v14, s[32:35], s51 offen offset:2048 nt lds
    v_mfma_f32_16x16x32_bf16 v[140:143], a[12:15], v[32:35], 0
    v_mfma_f32_16x16x32_bf16 v[140:143], a[28:31], v[36:39], v[140:143]
    buffer_load_dwordx4 v15, s[32:35], s51 offen offset:3072 nt lds
    v_mfma_f32_16x16x32_bf16 v[144:147], a[0:3], v[40:43], 0
    s_add_u32 m0, s96, 102400
    s_add_u32 s51, s55, 1179648
    v_mfma_f32_16x16x32_bf16 v[144:147], a[16:19], v[44:47], v[144:147]
    buffer_load_dwordx4 v12, s[32:35], s51 offen offset:0 nt lds
    v_mfma_f32_16x16x32_bf16 v[148:151], a[4:7], v[40:43], 0
    v_mfma_f32_16x16x32_bf16 v[148:151], a[20:23], v[44:47], v[148:151]
    buffer_load_dwordx4 v13, s[32:35], s51 offen offset:1024 nt lds
    v_mfma_f32_16x16x32_bf16 v[152:155], a[8:11], v[40:43], 0
    v_mfma_f32_16x16x32_bf16 v[152:155], a[24:27], v[44:47], v[152:155]
    buffer_load_dwordx4 v14, s[32:35], s51 offen offset:2048 nt lds
    v_mfma_f32_16x16x32_bf16 v[156:159], a[12:15], v[40:43], 0
    v_mfma_f32_16x16x32_bf16 v[156:159], a[28:31], v[44:47], v[156:159]
    buffer_load_dwordx4 v15, s[32:35], s51 offen offset:3072 nt lds
    v_mfma_f32_16x16x32_bf16 v[160:163], a[0:3], v[48:51], 0
    s_lshr_b32 m0, s96, 1
    s_add_u32 m0, m0, 131072
    s_add_u32 s51, s54, 256
    v_mfma_f32_16x16x32_bf16 v[160:163], a[16:19], v[52:55], v[160:163]
    buffer_load_dwordx4 v8, s[28:31], s51 offen offset:0 lds
    v_mfma_f32_16x16x32_bf16 v[164:167], a[4:7], v[48:51], 0
    v_mfma_f32_16x16x32_bf16 v[164:167], a[20:23], v[52:55], v[164:167]
    buffer_load_dwordx4 v9, s[28:31], s51 offen offset:1024 lds
    v_mfma_f32_16x16x32_bf16 v[168:171], a[8:11], v[48:51], 0
    v_mfma_f32_16x16x32_bf16 v[168:171], a[24:27], v[52:55], v[168:171]
    buffer_load_dwordx4 v10, s[28:31], s51 offen offset:2048 lds
    v_mfma_f32_16x16x32_bf16 v[172:175], a[12:15], v[48:51], 0
    v_mfma_f32_16x16x32_bf16 v[172:175], a[28:31], v[52:55], v[172:175]
    buffer_load_dwordx4 v11, s[28:31], s51 offen offset:3072 lds
    s_waitcnt vmcnt(12) lgkmcnt(0)
    s_barrier
    v_mfma_f32_16x16x32_bf16 v[176:179], a[0:3], v[56:59], 0
    s_add_u32 m0, s96, 0
    s_add_u32 s51, s55, 1572864
    ds_read_b64_tr_b16 a[32:33], v18 offset:0
    v_mfma_f32_16x16x32_bf16 v[176:179], a[16:19], v[60:63], v[176:179]
    buffer_load_dwordx4 v12, s[32:35], s51 offen offset:0 nt lds
    v_mfma_f32_16x16x32_bf16 v[180:183], a[4:7], v[56:59], 0
    ds_read_b128 v[96:99], v16 offset:0
    ds_read_b128 v[100:103], v17 offset:0
    v_mfma_f32_16x16x32_bf16 v[180:183], a[20:23], v[60:63], v[180:183]
    ds_read_b64_tr_b16 a[34:35], v18 offset:1024
    ds_read_b64_tr_b16 a[48:49], v18 offset:8192
    v_mfma_f32_16x16x32_bf16 v[184:187], a[8:11], v[56:59], 0
    buffer_load_dwordx4 v13, s[32:35], s51 offen offset:1024 nt lds
    v_mfma_f32_16x16x32_bf16 v[184:187], a[24:27], v[60:63], v[184:187]
    ds_read_b128 v[104:107], v16 offset:2048
    v_mfma_f32_16x16x32_bf16 v[188:191], a[12:15], v[56:59], 0
    ds_read_b128 v[108:111], v17 offset:2048
    ds_read_b64_tr_b16 a[50:51], v18 offset:9216
    v_mfma_f32_16x16x32_bf16 v[188:191], a[28:31], v[60:63], v[188:191]
    ds_read_b64_tr_b16 a[36:37], v19 offset:0
    v_mfma_f32_16x16x32_bf16 v[192:195], a[0:3], v[64:67], 0
    buffer_load_dwordx4 v14, s[32:35], s51 offen offset:2048 nt lds
    v_mfma_f32_16x16x32_bf16 v[192:195], a[16:19], v[68:71], v[192:195]
    ds_read_b128 v[112:115], v16 offset:4096
    v_mfma_f32_16x16x32_bf16 v[196:199], a[4:7], v[64:67], 0
    ds_read_b128 v[116:119], v17 offset:4096
    ds_read_b64_tr_b16 a[38:39], v19 offset:1024
    v_mfma_f32_16x16x32_bf16 v[196:199], a[20:23], v[68:71], v[196:199]
    buffer_load_dwordx4 v15, s[32:35], s51 offen offset:3072 nt lds
    v_mfma_f32_16x16x32_bf16 v[200:203], a[8:11], v[64:67], 0
    ds_read_b128 v[120:123], v16 offset:6144
    ds_read_b64_tr_b16 a[52:53], v19 offset:8192
    v_mfma_f32_16x16x32_bf16 v[200:203], a[24:27], v[68:71], v[200:203]
    s_add_u32 m0, s96, 4096
    s_add_u32 s51, s55, 1703936
    v_mfma_f32_16x16x32_bf16 v[204:207], a[12:15], v[64:67], 0
    buffer_load_dwordx4 v12, s[32:35], s51 offen offset:0 nt lds
    v_mfma_f32_16x16x32_bf16 v[204:207], a[28:31], v[68:71], v[204:207]
    ds_read_b128 v[124:127], v17 offset:6144
    ds_read_b64_tr_b16 a[54:55], v19 offset:9216
    v_mfma_f32_16x16x32_bf16 v[208:211], a[0:3], v[72:75], 0
    ds_read_b128 v[32:35], v16 offset:8192
    ds_read_b64_tr_b16 a[40:41], v20 offset:0
    v_mfma_f32_16x16x32_bf16 v[208:211], a[16:19], v[76:79], v[208:211]
    buffer_load_dwordx4 v13, s[32:35], s51 offen offset:1024 nt lds
    v_mfma_f32_16x16x32_bf16 v[212:215], a[4:7], v[72:75], 0
    ds_read_b128 v[36:39], v17 offset:8192
    ds_read_b64_tr_b16 a[42:43], v20 offset:1024
    v_mfma_f32_16x16x32_bf16 v[212:215], a[20:23], v[76:79], v[212:215]
    v_mfma_f32_16x16x32_bf16 v[216:219], a[8:11], v[72:75], 0
    ds_read_b128 v[40:43], v16 offset:10240
    ds_read_b64_tr_b16 a[56:57], v20 offset:8192
    v_mfma_f32_16x16x32_bf16 v[216:219], a[24:27], v[76:79], v[216:219]
    buffer_load_dwordx4 v14, s[32:35], s51 offen offset:2048 nt lds
    v_mfma_f32_16x16x32_bf16 v[220:223], a[12:15], v[72:75], 0
    ds_read_b128 v[44:47], v17 offset:10240
    ds_read_b64_tr_b16 a[58:59], v20 offset:9216
    v_mfma_f32_16x16x32_bf16 v[220:223], a[28:31], v[76:79], v[220:223]
    ds_read_b64_tr_b16 a[44:45], v21 offset:0
    v_mfma_f32_16x16x32_bf16 v[224:227], a[0:3], v[80:83], 0
    buffer_load_dwordx4 v15, s[32:35], s51 offen offset:3072 nt lds
    v_mfma_f32_16x16x32_bf16 v[224:227], a[16:19], v[84:87], v[224:227]
    ds_read_b128 v[48:51], v16 offset:12288
    ds_read_b64_tr_b16 a[46:47], v21 offset:1024
    v_mfma_f32_16x16x32_bf16 v[228:231], a[4:7], v[80:83], 0
    s_lshr_b32 m0, s96, 1
    s_add_u32 m0, m0, 32768
    s_add_u32 s51, s54, 384
    v_mfma_f32_16x16x32_bf16 v[228:231], a[20:23], v[84:87], v[228:231]
    buffer_load_dwordx4 v8, s[28:31], s51 offen offset:0 lds
    v_mfma_f32_16x16x32_bf16 v[232:235], a[8:11], v[80:83], 0
    ds_read_b128 v[52:55], v17 offset:12288
    ds_read_b128 v[56:59], v16 offset:14336
    v_mfma_f32_16x16x32_bf16 v[232:235], a[24:27], v[84:87], v[232:235]
    ds_read_b64_tr_b16 a[60:61], v21 offset:8192
    ds_read_b64_tr_b16 a[62:63], v21 offset:9216
    v_mfma_f32_16x16x32_bf16 v[236:239], a[12:15], v[80:83], 0
    buffer_load_dwordx4 v9, s[28:31], s51 offen offset:1024 lds
    v_mfma_f32_16x16x32_bf16 v[236:239], a[28:31], v[84:87], v[236:239]
    ds_read_b128 v[60:63], v17 offset:14336
    v_mfma_f32_16x16x32_bf16 v[240:243], a[0:3], v[88:91], 0
    v_mfma_f32_16x16x32_bf16 v[240:243], a[16:19], v[92:95], v[240:243]
    v_mfma_f32_16x16x32_bf16 v[244:247], a[4:7], v[88:91], 0
    buffer_load_dwordx4 v10, s[28:31], s51 offen offset:2048 lds
    v_mfma_f32_16x16x32_bf16 v[244:247], a[20:23], v[92:95], v[244:247]
    v_add_u32 v16, 0xc000, v16
    v_mfma_f32_16x16x32_bf16 v[248:251], a[8:11], v[88:91], 0
    v_add_u32 v17, 0xc000, v17
    v_add_u32 v18, 0xc000, v18
    v_mfma_f32_16x16x32_bf16 v[248:251], a[24:27], v[92:95], v[248:251]
    buffer_load_dwordx4 v11, s[28:31], s51 offen offset:3072 lds
    v_mfma_f32_16x16x32_bf16 v[252:255], a[12:15], v[88:91], 0
    v_add_u32 v19, 0xc000, v19
    v_add_u32 v20, 0xc000, v20
    v_mfma_f32_16x16x32_bf16 v[252:255], a[28:31], v[92:95], v[252:255]
    v_add_u32 v21, 0xc000, v21
    s_waitcnt vmcnt(12) lgkmcnt(0)
    s_barrier
    v_mfma_f32_16x16x32_bf16 v[128:131], a[32:35], v[96:99], v[128:131]
    ds_read_b128 v[64:67], v16 offset:0
    ds_read_b64_tr_b16 a[64:65], v18 offset:0
    v_mfma_f32_16x16x32_bf16 v[128:131], a[48:51], v[100:103], v[128:131]
    s_add_u32 m0, s96, 49152
    s_add_u32 s51, s55, 2097152
    v_mfma_f32_16x16x32_bf16 v[132:135], a[36:39], v[96:99], v[132:135]
    buffer_load_dwordx4 v12, s[32:35], s51 offen offset:0 nt lds
    v_mfma_f32_16x16x32_bf16 v[132:135], a[52:55], v[100:103], v[132:135]
    ds_read_b128 v[68:71], v17 offset:0
    v_mfma_f32_16x16x32_bf16 v[136:139], a[40:43], v[96:99], v[136:139]
    v_mfma_f32_16x16x32_bf16 v[136:139], a[56:59], v[100:103], v[136:139]
    ds_read_b64_tr_b16 a[66:67], v18 offset:1024
    v_mfma_f32_16x16x32_bf16 v[140:143], a[44:47], v[96:99], v[140:143]
    ds_read_b128 v[72:75], v16 offset:2048
    v_mfma_f32_16x16x32_bf16 v[140:143], a[60:63], v[100:103], v[140:143]
    buffer_load_dwordx4 v13, s[32:35], s51 offen offset:1024 nt lds
    v_mfma_f32_16x16x32_bf16 v[144:147], a[32:35], v[104:107], v[144:147]
    ds_read_b64_tr_b16 a[80:81], v18 offset:8192
    v_mfma_f32_16x16x32_bf16 v[144:147], a[48:51], v[108:111], v[144:147]
    ds_read_b128 v[76:79], v17 offset:2048
    v_mfma_f32_16x16x32_bf16 v[148:151], a[36:39], v[104:107], v[148:151]
    v_mfma_f32_16x16x32_bf16 v[148:151], a[52:55], v[108:111], v[148:151]
    v_mfma_f32_16x16x32_bf16 v[152:155], a[40:43], v[104:107], v[152:155]
    ds_read_b128 v[80:83], v16 offset:4096
    ds_read_b64_tr_b16 a[82:83], v18 offset:9216
    v_mfma_f32_16x16x32_bf16 v[152:155], a[56:59], v[108:111], v[152:155]
    buffer_load_dwordx4 v14, s[32:35], s51 offen offset:2048 nt lds
    v_mfma_f32_16x16x32_bf16 v[156:159], a[44:47], v[104:107], v[156:159]
    v_mfma_f32_16x16x32_bf16 v[156:159], a[60:63], v[108:111], v[156:159]
    ds_read_b128 v[84:87], v17 offset:4096
    ds_read_b64_tr_b16 a[68:69], v19 offset:0
    v_mfma_f32_16x16x32_bf16 v[160:163], a[32:35], v[112:115], v[160:163]
    v_mfma_f32_16x16x32_bf16 v[160:163], a[48:51], v[116:119], v[160:163]
    ds_read_b64_tr_b16 a[70:71], v19 offset:1024
    v_mfma_f32_16x16x32_bf16 v[164:167], a[36:39], v[112:115], v[164:167]
    buffer_load_dwordx4 v15, s[32:35], s51 offen offset:3072 nt lds
    v_mfma_f32_16x16x32_bf16 v[164:167], a[52:55], v[116:119], v[164:167]
    ds_read_b128 v[88:91], v16 offset:6144
    v_mfma_f32_16x16x32_bf16 v[168:171], a[40:43], v[112:115], v[168:171]
    v_mfma_f32_16x16x32_bf16 v[168:171], a[56:59], v[116:119], v[168:171]
    ds_read_b128 v[92:95], v17 offset:6144
    ds_read_b64_tr_b16 a[84:85], v19 offset:8192
    v_mfma_f32_16x16x32_bf16 v[172:175], a[44:47], v[112:115], v[172:175]
    s_add_u32 m0, s96, 53248
    s_add_u32 s51, s55, 2228224
    v_mfma_f32_16x16x32_bf16 v[172:175], a[60:63], v[116:119], v[172:175]
    buffer_load_dwordx4 v12, s[32:35], s51 offen offset:0 nt lds
    v_mfma_f32_16x16x32_bf16 v[176:179], a[32:35], v[120:123], v[176:179]
    ds_read_b128 v[96:99], v16 offset:8192
    v_mfma_f32_16x16x32_bf16 v[176:179], a[48:51], v[124:127], v[176:179]
    ds_read_b64_tr_b16 a[86:87], v19 offset:9216
    v_mfma_f32_16x16x32_bf16 v[180:183], a[36:39], v[120:123], v[180:183]
    v_mfma_f32_16x16x32_bf16 v[180:183], a[52:55], v[124:127], v[180:183]
    ds_read_b128 v[100:103], v17 offset:8192
    v_mfma_f32_16x16x32_bf16 v[184:187], a[40:43], v[120:123], v[184:187]
    buffer_load_dwordx4 v13, s[32:35], s51 offen offset:1024 nt lds
    v_mfma_f32_16x16x32_bf16 v[184:187], a[56:59], v[124:127], v[184:187]
    ds_read_b64_tr_b16 a[72:73], v20 offset:0
    v_mfma_f32_16x16x32_bf16 v[188:191], a[44:47], v[120:123], v[188:191]
    ds_read_b128 v[104:107], v16 offset:10240
    v_mfma_f32_16x16x32_bf16 v[188:191], a[60:63], v[124:127], v[188:191]
    v_mfma_f32_16x16x32_bf16 v[192:195], a[32:35], v[32:35], v[192:195]
    ds_read_b64_tr_b16 a[74:75], v20 offset:1024
    v_mfma_f32_16x16x32_bf16 v[192:195], a[48:51], v[36:39], v[192:195]
    ds_read_b128 v[108:111], v17 offset:10240
    v_mfma_f32_16x16x32_bf16 v[196:199], a[36:39], v[32:35], v[196:199]
    buffer_load_dwordx4 v14, s[32:35], s51 offen offset:2048 nt lds
    v_mfma_f32_16x16x32_bf16 v[196:199], a[52:55], v[36:39], v[196:199]
    v_mfma_f32_16x16x32_bf16 v[200:203], a[40:43], v[32:35], v[200:203]
    ds_read_b128 v[112:115], v16 offset:12288
    ds_read_b64_tr_b16 a[88:89], v20 offset:8192
    v_mfma_f32_16x16x32_bf16 v[200:203], a[56:59], v[36:39], v[200:203]
    v_mfma_f32_16x16x32_bf16 v[204:207], a[44:47], v[32:35], v[204:207]
    ds_read_b64_tr_b16 a[90:91], v20 offset:9216
    v_mfma_f32_16x16x32_bf16 v[204:207], a[60:63], v[36:39], v[204:207]
    buffer_load_dwordx4 v15, s[32:35], s51 offen offset:3072 nt lds
    v_mfma_f32_16x16x32_bf16 v[208:211], a[32:35], v[40:43], v[208:211]
    ds_read_b128 v[116:119], v17 offset:12288
    v_mfma_f32_16x16x32_bf16 v[208:211], a[48:51], v[44:47], v[208:211]
    v_mfma_f32_16x16x32_bf16 v[212:215], a[36:39], v[40:43], v[212:215]
    ds_read_b128 v[120:123], v16 offset:14336
    ds_read_b64_tr_b16 a[76:77], v21 offset:0
    v_mfma_f32_16x16x32_bf16 v[212:215], a[52:55], v[44:47], v[212:215]
    s_lshr_b32 m0, s96, 1
    s_add_u32 m0, m0, 81920
    s_add_u32 s51, s54, 512
    v_mfma_f32_16x16x32_bf16 v[216:219], a[40:43], v[40:43], v[216:219]
    buffer_load_dwordx4 v8, s[28:31], s51 offen offset:0 lds
    v_mfma_f32_16x16x32_bf16 v[216:219], a[56:59], v[44:47], v[216:219]
    ds_read_b128 v[124:127], v17 offset:14336
    v_mfma_f32_16x16x32_bf16 v[220:223], a[44:47], v[40:43], v[220:223]
    ds_read_b64_tr_b16 a[78:79], v21 offset:1024
    v_mfma_f32_16x16x32_bf16 v[220:223], a[60:63], v[44:47], v[220:223]
    v_mfma_f32_16x16x32_bf16 v[224:227], a[32:35], v[48:51], v[224:227]
    ds_read_b64_tr_b16 a[92:93], v21 offset:8192
    v_mfma_f32_16x16x32_bf16 v[224:227], a[48:51], v[52:55], v[224:227]
    buffer_load_dwordx4 v9, s[28:31], s51 offen offset:1024 lds
    v_mfma_f32_16x16x32_bf16 v[228:231], a[36:39], v[48:51], v[228:231]
    v_mfma_f32_16x16x32_bf16 v[228:231], a[52:55], v[52:55], v[228:231]
    v_mfma_f32_16x16x32_bf16 v[232:235], a[40:43], v[48:51], v[232:235]
    v_mfma_f32_16x16x32_bf16 v[232:235], a[56:59], v[52:55], v[232:235]
    ds_read_b64_tr_b16 a[94:95], v21 offset:9216
    v_mfma_f32_16x16x32_bf16 v[236:239], a[44:47], v[48:51], v[236:239]
    v_mfma_f32_16x16x32_bf16 v[236:239], a[60:63], v[52:55], v[236:239]
    buffer_load_dwordx4 v10, s[28:31], s51 offen offset:2048 lds
    v_mfma_f32_16x16x32_bf16 v[240:243], a[32:35], v[56:59], v[240:243]
    v_mfma_f32_16x16x32_bf16 v[240:243], a[48:51], v[60:63], v[240:243]
    v_mfma_f32_16x16x32_bf16 v[244:247], a[36:39], v[56:59], v[244:247]
    v_mfma_f32_16x16x32_bf16 v[244:247], a[52:55], v[60:63], v[244:247]
    v_add_u32 v16, 0xfffe8000, v16
    v_add_u32 v17, 0xfffe8000, v17
    v_mfma_f32_16x16x32_bf16 v[248:251], a[40:43], v[56:59], v[248:251]
    buffer_load_dwordx4 v11, s[28:31], s51 offen offset:3072 lds
    v_mfma_f32_16x16x32_bf16 v[248:251], a[56:59], v[60:63], v[248:251]
    v_add_u32 v18, 0xfffe8000, v18
    v_add_u32 v19, 0xfffe8000, v19
    v_mfma_f32_16x16x32_bf16 v[252:255], a[44:47], v[56:59], v[252:255]
    v_add_u32 v20, 0xfffe8000, v20
    v_mfma_f32_16x16x32_bf16 v[252:255], a[60:63], v[60:63], v[252:255]
    v_add_u32 v21, 0xfffe8000, v21
    s_waitcnt vmcnt(12) lgkmcnt(0)
    s_barrier
    v_mfma_f32_16x16x32_bf16 v[128:131], a[64:67], v[64:67], v[128:131]
    ds_read_b128 v[32:35], v16 offset:0
    ds_read_b64_tr_b16 a[96:97], v18 offset:0
    s_lshr_b32 s53, s48, 1
    v_mfma_f32_16x16x32_bf16 v[128:131], a[80:83], v[68:71], v[128:131]
    s_add_u32 m0, s96, 98304
    s_add_u32 s51, s55, 2621440
    v_mfma_f32_16x16x32_bf16 v[132:135], a[68:71], v[64:67], v[132:135]
    buffer_load_dwordx4 v12, s[32:35], s51 offen offset:0 nt lds
    v_mfma_f32_16x16x32_bf16 v[132:135], a[84:87], v[68:71], v[132:135]
    ds_read_b128 v[36:39], v17 offset:0
    s_lshl_b32 s53, s53, 24
    v_mfma_f32_16x16x32_bf16 v[136:139], a[72:75], v[64:67], v[136:139]
    s_lshl_b32 s52, s49, 19
    s_add_u32 s53, s53, s52
    v_mfma_f32_16x16x32_bf16 v[136:139], a[88:91], v[68:71], v[136:139]
    ds_read_b64_tr_b16 a[98:99], v18 offset:1024
    v_mfma_f32_16x16x32_bf16 v[140:143], a[76:79], v[64:67], v[140:143]
    ds_read_b128 v[40:43], v16 offset:2048
    s_sub_u32 s52, 7, s50
    v_mfma_f32_16x16x32_bf16 v[140:143], a[92:95], v[68:71], v[140:143]
    buffer_load_dwordx4 v13, s[32:35], s51 offen offset:1024 nt lds
    v_mfma_f32_16x16x32_bf16 v[144:147], a[64:67], v[72:75], v[144:147]
    ds_read_b64_tr_b16 a[112:113], v18 offset:8192
    s_lshl_b32 s52, s52, 16
    v_mfma_f32_16x16x32_bf16 v[144:147], a[80:83], v[76:79], v[144:147]
    ds_read_b128 v[44:47], v17 offset:2048
    s_add_u32 s53, s53, s52
    v_mfma_f32_16x16x32_bf16 v[148:151], a[68:71], v[72:75], v[148:151]
    s_add_u32 s36, s26, s53
    s_addc_u32 s37, s27, 0
    v_mfma_f32_16x16x32_bf16 v[148:151], a[84:87], v[76:79], v[148:151]
    s_mov_b32 s38, 65536
    s_mov_b32 s39, 0x20000
    v_mfma_f32_16x16x32_bf16 v[152:155], a[72:75], v[72:75], v[152:155]
    ds_read_b128 v[48:51], v16 offset:4096
    ds_read_b64_tr_b16 a[114:115], v18 offset:9216
    v_mfma_f32_16x16x32_bf16 v[152:155], a[88:91], v[76:79], v[152:155]
    buffer_load_dwordx4 v14, s[32:35], s51 offen offset:2048 nt lds
    v_mfma_f32_16x16x32_bf16 v[156:159], a[76:79], v[72:75], v[156:159]
    s_add_u32 s76, s26, 62914560
    s_addc_u32 s77, s27, 0
    v_mfma_f32_16x16x32_bf16 v[156:159], a[92:95], v[76:79], v[156:159]
    ds_read_b128 v[52:55], v17 offset:4096
    ds_read_b64_tr_b16 a[100:101], v19 offset:0
    v_mfma_f32_16x16x32_bf16 v[160:163], a[64:67], v[80:83], v[160:163]
    s_mov_b32 s78, 65540
    v_mfma_f32_16x16x32_bf16 v[160:163], a[80:83], v[84:87], v[160:163]
    ds_read_b64_tr_b16 a[102:103], v19 offset:1024
    s_mov_b32 s79, 0x20000
    v_mfma_f32_16x16x32_bf16 v[164:167], a[68:71], v[80:83], v[164:167]
    buffer_load_dwordx4 v15, s[32:35], s51 offen offset:3072 nt lds
    v_mfma_f32_16x16x32_bf16 v[164:167], a[84:87], v[84:87], v[164:167]
    ds_read_b128 v[56:59], v16 offset:6144
    s_add_u32 s95, s94, 1
    v_mfma_f32_16x16x32_bf16 v[168:171], a[72:75], v[80:83], v[168:171]
    s_lshl_b32 s52, s48, 2
    v_xor_b32 v5, s52, v1
    v_mfma_f32_16x16x32_bf16 v[168:171], a[88:91], v[84:87], v[168:171]
    ds_read_b128 v[60:63], v17 offset:6144
    ds_read_b64_tr_b16 a[116:117], v19 offset:8192
    v_mfma_f32_16x16x32_bf16 v[172:175], a[76:79], v[80:83], v[172:175]
    s_add_u32 m0, s96, 102400
    s_add_u32 s51, s55, 2752512
    v_mfma_f32_16x16x32_bf16 v[172:175], a[92:95], v[84:87], v[172:175]
    buffer_load_dwordx4 v12, s[32:35], s51 offen offset:0 nt lds
    v_mfma_f32_16x16x32_bf16 v[176:179], a[64:67], v[88:91], v[176:179]
    ds_read_b128 v[64:67], v16 offset:8192
    v_xor_b32 v5, 0, v5
    v_mfma_f32_16x16x32_bf16 v[176:179], a[80:83], v[92:95], v[176:179]
    ds_read_b64_tr_b16 a[118:119], v19 offset:9216
    v_lshlrev_b32 v5, 4, v5
    v_mfma_f32_16x16x32_bf16 v[180:183], a[68:71], v[88:91], v[180:183]
    v_xor_b32 v6, s52, v1
    v_xor_b32 v6, 1, v6
    v_mfma_f32_16x16x32_bf16 v[180:183], a[84:87], v[92:95], v[180:183]
    ds_read_b128 v[68:71], v17 offset:8192
    v_lshlrev_b32 v6, 4, v6
    v_mfma_f32_16x16x32_bf16 v[184:187], a[72:75], v[88:91], v[184:187]
    buffer_load_dwordx4 v13, s[32:35], s51 offen offset:1024 nt lds
    v_mfma_f32_16x16x32_bf16 v[184:187], a[88:91], v[92:95], v[184:187]
    ds_read_b64_tr_b16 a[104:105], v20 offset:0
    v_xor_b32 v7, s52, v1
    v_mfma_f32_16x16x32_bf16 v[188:191], a[76:79], v[88:91], v[188:191]
    ds_read_b128 v[72:75], v16 offset:10240
    v_xor_b32 v7, 2, v7
    v_mfma_f32_16x16x32_bf16 v[188:191], a[92:95], v[92:95], v[188:191]
    v_mfma_f32_16x16x32_bf16 v[192:195], a[64:67], v[96:99], v[192:195]
    ds_read_b64_tr_b16 a[106:107], v20 offset:1024
    v_lshlrev_b32 v7, 4, v7
    v_mfma_f32_16x16x32_bf16 v[192:195], a[80:83], v[100:103], v[192:195]
    ds_read_b128 v[76:79], v17 offset:10240
    v_xor_b32 v28, s52, v1
    v_mfma_f32_16x16x32_bf16 v[196:199], a[68:71], v[96:99], v[196:199]
    buffer_load_dwordx4 v14, s[32:35], s51 offen offset:2048 nt lds
    v_mfma_f32_16x16x32_bf16 v[196:199], a[84:87], v[100:103], v[196:199]
    v_xor_b32 v28, 3, v28
    v_lshlrev_b32 v28, 4, v28
    v_mfma_f32_16x16x32_bf16 v[200:203], a[72:75], v[96:99], v[200:203]
    ds_read_b128 v[80:83], v16 offset:12288
    ds_read_b64_tr_b16 a[120:121], v20 offset:8192
    v_mfma_f32_16x16x32_bf16 v[200:203], a[88:91], v[100:103], v[200:203]
    v_add_u32 v22, 0, v3
    v_mfma_f32_16x16x32_bf16 v[204:207], a[76:79], v[96:99], v[204:207]
    ds_read_b64_tr_b16 a[122:123], v20 offset:9216
    v_xor_b32 v22, v22, v4
    v_mfma_f32_16x16x32_bf16 v[204:207], a[92:95], v[100:103], v[204:207]
    buffer_load_dwordx4 v15, s[32:35], s51 offen offset:3072 nt lds
    v_mfma_f32_16x16x32_bf16 v[208:211], a[64:67], v[104:107], v[208:211]
    ds_read_b128 v[84:87], v17 offset:12288
    v_lshlrev_b32 v22, 4, v22
    v_mfma_f32_16x16x32_bf16 v[208:211], a[80:83], v[108:111], v[208:211]
    v_lshl_add_u32 v22, v4, 10, v22
    v_add_u32 v22, 98304, v22
    v_mfma_f32_16x16x32_bf16 v[212:215], a[68:71], v[104:107], v[212:215]
    ds_read_b128 v[88:91], v16 offset:14336
    ds_read_b64_tr_b16 a[108:109], v21 offset:0
    v_mfma_f32_16x16x32_bf16 v[212:215], a[84:87], v[108:111], v[212:215]
    s_lshr_b32 m0, s96, 1
    s_add_u32 m0, m0, 131072
    s_add_u32 s51, s54, 640
    v_mfma_f32_16x16x32_bf16 v[216:219], a[72:75], v[104:107], v[216:219]
    buffer_load_dwordx4 v8, s[28:31], s51 offen offset:0 lds
    v_mfma_f32_16x16x32_bf16 v[216:219], a[88:91], v[108:111], v[216:219]
    ds_read_b128 v[92:95], v17 offset:14336
    v_add_u32 v23, 4, v3
    v_mfma_f32_16x16x32_bf16 v[220:223], a[76:79], v[104:107], v[220:223]
    ds_read_b64_tr_b16 a[110:111], v21 offset:1024
    v_xor_b32 v23, v23, v4
    v_mfma_f32_16x16x32_bf16 v[220:223], a[92:95], v[108:111], v[220:223]
    v_lshlrev_b32 v23, 4, v23
    v_mfma_f32_16x16x32_bf16 v[224:227], a[64:67], v[112:115], v[224:227]
    ds_read_b64_tr_b16 a[124:125], v21 offset:8192
    v_lshl_add_u32 v23, v4, 10, v23
    v_mfma_f32_16x16x32_bf16 v[224:227], a[80:83], v[116:119], v[224:227]
    buffer_load_dwordx4 v9, s[28:31], s51 offen offset:1024 lds
    v_mfma_f32_16x16x32_bf16 v[228:231], a[68:71], v[112:115], v[228:231]
    v_add_u32 v23, 98304, v23
    v_mfma_f32_16x16x32_bf16 v[228:231], a[84:87], v[116:119], v[228:231]
    v_add_u32 v24, 8, v3
    v_mfma_f32_16x16x32_bf16 v[232:235], a[72:75], v[112:115], v[232:235]
    v_xor_b32 v24, v24, v4
    v_mfma_f32_16x16x32_bf16 v[232:235], a[88:91], v[116:119], v[232:235]
    ds_read_b64_tr_b16 a[126:127], v21 offset:9216
    v_lshlrev_b32 v24, 4, v24
    v_mfma_f32_16x16x32_bf16 v[236:239], a[76:79], v[112:115], v[236:239]
    v_lshl_add_u32 v24, v4, 10, v24
    v_mfma_f32_16x16x32_bf16 v[236:239], a[92:95], v[116:119], v[236:239]
    buffer_load_dwordx4 v10, s[28:31], s51 offen offset:2048 lds
    v_mfma_f32_16x16x32_bf16 v[240:243], a[64:67], v[120:123], v[240:243]
    v_add_u32 v24, 98304, v24
    v_mfma_f32_16x16x32_bf16 v[240:243], a[80:83], v[124:127], v[240:243]
    v_add_u32 v25, 12, v3
    v_mfma_f32_16x16x32_bf16 v[244:247], a[68:71], v[120:123], v[244:247]
    v_xor_b32 v25, v25, v4
    v_lshlrev_b32 v25, 4, v25
    v_mfma_f32_16x16x32_bf16 v[244:247], a[84:87], v[124:127], v[244:247]
    v_add_u32 v16, 0xc000, v16
    v_add_u32 v17, 0xc000, v17
    v_mfma_f32_16x16x32_bf16 v[248:251], a[72:75], v[120:123], v[248:251]
    buffer_load_dwordx4 v11, s[28:31], s51 offen offset:3072 lds
    v_mfma_f32_16x16x32_bf16 v[248:251], a[88:91], v[124:127], v[248:251]
    v_add_u32 v18, 0xc000, v18
    v_add_u32 v19, 0xc000, v19
    v_mfma_f32_16x16x32_bf16 v[252:255], a[76:79], v[120:123], v[252:255]
    v_add_u32 v20, 0xc000, v20
    v_lshl_add_u32 v25, v4, 10, v25
    v_mfma_f32_16x16x32_bf16 v[252:255], a[92:95], v[124:127], v[252:255]
    v_add_u32 v21, 0xc000, v21
    v_add_u32 v25, 98304, v25
    s_waitcnt vmcnt(12) lgkmcnt(0)
    s_barrier
    v_mfma_f32_16x16x32_bf16 v[128:131], a[96:99], v[32:35], v[128:131]
    ds_read_b128 v[96:99], v16 offset:0
    ds_read_b64_tr_b16 a[128:129], v18 offset:0
    v_mfma_f32_16x16x32_bf16 v[128:131], a[112:115], v[36:39], v[128:131]
    s_add_u32 m0, s96, 0
    s_add_u32 s51, s55, 3145728
    v_mfma_f32_16x16x32_bf16 v[132:135], a[100:103], v[32:35], v[132:135]
    buffer_load_dwordx4 v12, s[32:35], s51 offen offset:0 nt lds
    v_mfma_f32_16x16x32_bf16 v[132:135], a[116:119], v[36:39], v[132:135]
    ds_read_b128 v[100:103], v17 offset:0
    v_mfma_f32_16x16x32_bf16 v[136:139], a[104:107], v[32:35], v[136:139]
    v_mfma_f32_16x16x32_bf16 v[136:139], a[120:123], v[36:39], v[136:139]
    ds_read_b64_tr_b16 a[130:131], v18 offset:1024
    v_mfma_f32_16x16x32_bf16 v[140:143], a[108:111], v[32:35], v[140:143]
    ds_read_b128 v[104:107], v16 offset:2048
    v_mfma_f32_16x16x32_bf16 v[140:143], a[124:127], v[36:39], v[140:143]
    buffer_load_dwordx4 v13, s[32:35], s51 offen offset:1024 nt lds
    v_mfma_f32_16x16x32_bf16 v[144:147], a[96:99], v[40:43], v[144:147]
    ds_read_b64_tr_b16 a[144:145], v18 offset:8192
    v_mfma_f32_16x16x32_bf16 v[144:147], a[112:115], v[44:47], v[144:147]
    ds_read_b128 v[108:111], v17 offset:2048
    v_mfma_f32_16x16x32_bf16 v[148:151], a[100:103], v[40:43], v[148:151]
    v_mfma_f32_16x16x32_bf16 v[148:151], a[116:119], v[44:47], v[148:151]
    v_mfma_f32_16x16x32_bf16 v[152:155], a[104:107], v[40:43], v[152:155]
    ds_read_b128 v[112:115], v16 offset:4096
    ds_read_b64_tr_b16 a[146:147], v18 offset:9216
    v_mfma_f32_16x16x32_bf16 v[152:155], a[120:123], v[44:47], v[152:155]
    buffer_load_dwordx4 v14, s[32:35], s51 offen offset:2048 nt lds
    v_mfma_f32_16x16x32_bf16 v[156:159], a[108:111], v[40:43], v[156:159]
    v_mfma_f32_16x16x32_bf16 v[156:159], a[124:127], v[44:47], v[156:159]
    ds_read_b128 v[116:119], v17 offset:4096
    ds_read_b64_tr_b16 a[132:133], v19 offset:0
    v_mfma_f32_16x16x32_bf16 v[160:163], a[96:99], v[48:51], v[160:163]
    v_mfma_f32_16x16x32_bf16 v[160:163], a[112:115], v[52:55], v[160:163]
    ds_read_b64_tr_b16 a[134:135], v19 offset:1024
    v_mfma_f32_16x16x32_bf16 v[164:167], a[100:103], v[48:51], v[164:167]
    buffer_load_dwordx4 v15, s[32:35], s51 offen offset:3072 nt lds
    v_mfma_f32_16x16x32_bf16 v[164:167], a[116:119], v[52:55], v[164:167]
    ds_read_b128 v[120:123], v16 offset:6144
    v_mfma_f32_16x16x32_bf16 v[168:171], a[104:107], v[48:51], v[168:171]
    v_mfma_f32_16x16x32_bf16 v[168:171], a[120:123], v[52:55], v[168:171]
    ds_read_b128 v[124:127], v17 offset:6144
    ds_read_b64_tr_b16 a[148:149], v19 offset:8192
    v_mfma_f32_16x16x32_bf16 v[172:175], a[108:111], v[48:51], v[172:175]
    s_add_u32 m0, s96, 4096
    s_add_u32 s51, s55, 3276800
    v_mfma_f32_16x16x32_bf16 v[172:175], a[124:127], v[52:55], v[172:175]
    buffer_load_dwordx4 v12, s[32:35], s51 offen offset:0 nt lds
    v_mfma_f32_16x16x32_bf16 v[176:179], a[96:99], v[56:59], v[176:179]
    ds_read_b128 v[32:35], v16 offset:8192
    v_mfma_f32_16x16x32_bf16 v[176:179], a[112:115], v[60:63], v[176:179]
    ds_read_b64_tr_b16 a[150:151], v19 offset:9216
    v_mfma_f32_16x16x32_bf16 v[180:183], a[100:103], v[56:59], v[180:183]
    v_mfma_f32_16x16x32_bf16 v[180:183], a[116:119], v[60:63], v[180:183]
    ds_read_b128 v[36:39], v17 offset:8192
    v_mfma_f32_16x16x32_bf16 v[184:187], a[104:107], v[56:59], v[184:187]
    buffer_load_dwordx4 v13, s[32:35], s51 offen offset:1024 nt lds
    v_mfma_f32_16x16x32_bf16 v[184:187], a[120:123], v[60:63], v[184:187]
    ds_read_b64_tr_b16 a[136:137], v20 offset:0
    v_mfma_f32_16x16x32_bf16 v[188:191], a[108:111], v[56:59], v[188:191]
    ds_read_b128 v[40:43], v16 offset:10240
    v_mfma_f32_16x16x32_bf16 v[188:191], a[124:127], v[60:63], v[188:191]
    v_mfma_f32_16x16x32_bf16 v[192:195], a[96:99], v[64:67], v[192:195]
    ds_read_b64_tr_b16 a[138:139], v20 offset:1024
    v_mfma_f32_16x16x32_bf16 v[192:195], a[112:115], v[68:71], v[192:195]
    ds_read_b128 v[44:47], v17 offset:10240
    v_mfma_f32_16x16x32_bf16 v[196:199], a[100:103], v[64:67], v[196:199]
    buffer_load_dwordx4 v14, s[32:35], s51 offen offset:2048 nt lds
    v_mfma_f32_16x16x32_bf16 v[196:199], a[116:119], v[68:71], v[196:199]
    v_mfma_f32_16x16x32_bf16 v[200:203], a[104:107], v[64:67], v[200:203]
    ds_read_b128 v[48:51], v16 offset:12288
    ds_read_b64_tr_b16 a[152:153], v20 offset:8192
    v_mfma_f32_16x16x32_bf16 v[200:203], a[120:123], v[68:71], v[200:203]
    v_mfma_f32_16x16x32_bf16 v[204:207], a[108:111], v[64:67], v[204:207]
    ds_read_b64_tr_b16 a[154:155], v20 offset:9216
    v_mfma_f32_16x16x32_bf16 v[204:207], a[124:127], v[68:71], v[204:207]
    buffer_load_dwordx4 v15, s[32:35], s51 offen offset:3072 nt lds
    v_mfma_f32_16x16x32_bf16 v[208:211], a[96:99], v[72:75], v[208:211]
    ds_read_b128 v[52:55], v17 offset:12288
    v_mfma_f32_16x16x32_bf16 v[208:211], a[112:115], v[76:79], v[208:211]
    v_mfma_f32_16x16x32_bf16 v[212:215], a[100:103], v[72:75], v[212:215]
    ds_read_b128 v[56:59], v16 offset:14336
    ds_read_b64_tr_b16 a[140:141], v21 offset:0
    v_mfma_f32_16x16x32_bf16 v[212:215], a[116:119], v[76:79], v[212:215]
    s_lshr_b32 m0, s96, 1
    s_add_u32 m0, m0, 32768
    s_add_u32 s51, s54, 768
    v_mfma_f32_16x16x32_bf16 v[216:219], a[104:107], v[72:75], v[216:219]
    buffer_load_dwordx4 v8, s[28:31], s51 offen offset:0 lds
    v_mfma_f32_16x16x32_bf16 v[216:219], a[120:123], v[76:79], v[216:219]
    ds_read_b128 v[60:63], v17 offset:14336
    v_mfma_f32_16x16x32_bf16 v[220:223], a[108:111], v[72:75], v[220:223]
    ds_read_b64_tr_b16 a[142:143], v21 offset:1024
    v_mfma_f32_16x16x32_bf16 v[220:223], a[124:127], v[76:79], v[220:223]
    v_mfma_f32_16x16x32_bf16 v[224:227], a[96:99], v[80:83], v[224:227]
    ds_read_b64_tr_b16 a[156:157], v21 offset:8192
    v_mfma_f32_16x16x32_bf16 v[224:227], a[112:115], v[84:87], v[224:227]
    buffer_load_dwordx4 v9, s[28:31], s51 offen offset:1024 lds
    v_mfma_f32_16x16x32_bf16 v[228:231], a[100:103], v[80:83], v[228:231]
    v_mfma_f32_16x16x32_bf16 v[228:231], a[116:119], v[84:87], v[228:231]
    v_mfma_f32_16x16x32_bf16 v[232:235], a[104:107], v[80:83], v[232:235]
    v_mfma_f32_16x16x32_bf16 v[232:235], a[120:123], v[84:87], v[232:235]
    ds_read_b64_tr_b16 a[158:159], v21 offset:9216
    v_mfma_f32_16x16x32_bf16 v[236:239], a[108:111], v[80:83], v[236:239]
    v_mfma_f32_16x16x32_bf16 v[236:239], a[124:127], v[84:87], v[236:239]
    buffer_load_dwordx4 v10, s[28:31], s51 offen offset:2048 lds
    v_mfma_f32_16x16x32_bf16 v[240:243], a[96:99], v[88:91], v[240:243]
    v_mfma_f32_16x16x32_bf16 v[240:243], a[112:115], v[92:95], v[240:243]
    v_mfma_f32_16x16x32_bf16 v[244:247], a[100:103], v[88:91], v[244:247]
    v_mfma_f32_16x16x32_bf16 v[244:247], a[116:119], v[92:95], v[244:247]
    v_add_u32 v16, 0xc000, v16
    v_add_u32 v17, 0xc000, v17
    v_mfma_f32_16x16x32_bf16 v[248:251], a[104:107], v[88:91], v[248:251]
    buffer_load_dwordx4 v11, s[28:31], s51 offen offset:3072 lds
    v_mfma_f32_16x16x32_bf16 v[248:251], a[120:123], v[92:95], v[248:251]
    v_add_u32 v18, 0xc000, v18
    v_add_u32 v19, 0xc000, v19
    v_mfma_f32_16x16x32_bf16 v[252:255], a[108:111], v[88:91], v[252:255]
    v_add_u32 v20, 0xc000, v20
    v_mfma_f32_16x16x32_bf16 v[252:255], a[124:127], v[92:95], v[252:255]
    v_add_u32 v21, 0xc000, v21
    s_waitcnt vmcnt(12) lgkmcnt(0)
    s_barrier
    v_mfma_f32_16x16x32_bf16 v[128:131], a[128:131], v[96:99], v[128:131]
    ds_read_b128 v[64:67], v16 offset:0
    ds_read_b64_tr_b16 a[160:161], v18 offset:0
    v_mfma_f32_16x16x32_bf16 v[128:131], a[144:147], v[100:103], v[128:131]
    s_add_u32 m0, s96, 49152
    s_add_u32 s51, s55, 3670016
    v_mfma_f32_16x16x32_bf16 v[132:135], a[132:135], v[96:99], v[132:135]
    buffer_load_dwordx4 v12, s[32:35], s51 offen offset:0 nt lds
    v_mfma_f32_16x16x32_bf16 v[132:135], a[148:151], v[100:103], v[132:135]
    ds_read_b128 v[68:71], v17 offset:0
    v_mfma_f32_16x16x32_bf16 v[136:139], a[136:139], v[96:99], v[136:139]
    v_mfma_f32_16x16x32_bf16 v[136:139], a[152:155], v[100:103], v[136:139]
    ds_read_b64_tr_b16 a[162:163], v18 offset:1024
    v_mfma_f32_16x16x32_bf16 v[140:143], a[140:143], v[96:99], v[140:143]
    buffer_load_dwordx4 v13, s[32:35], s51 offen offset:1024 nt lds
    v_mfma_f32_16x16x32_bf16 v[140:143], a[156:159], v[100:103], v[140:143]
    ds_read_b128 v[72:75], v16 offset:2048
    v_mfma_f32_16x16x32_bf16 v[144:147], a[128:131], v[104:107], v[144:147]
    ds_read_b64_tr_b16 a[176:177], v18 offset:8192
    v_mfma_f32_16x16x32_bf16 v[144:147], a[144:147], v[108:111], v[144:147]
    ds_read_b128 v[76:79], v17 offset:2048
    v_mfma_f32_16x16x32_bf16 v[148:151], a[132:135], v[104:107], v[148:151]
    buffer_load_dwordx4 v14, s[32:35], s51 offen offset:2048 nt lds
    v_mfma_f32_16x16x32_bf16 v[148:151], a[148:151], v[108:111], v[148:151]
    v_mfma_f32_16x16x32_bf16 v[152:155], a[136:139], v[104:107], v[152:155]
    ds_read_b128 v[80:83], v16 offset:4096
    ds_read_b64_tr_b16 a[178:179], v18 offset:9216
    v_mfma_f32_16x16x32_bf16 v[152:155], a[152:155], v[108:111], v[152:155]
    v_mfma_f32_16x16x32_bf16 v[156:159], a[140:143], v[104:107], v[156:159]
    buffer_load_dwordx4 v15, s[32:35], s51 offen offset:3072 nt lds
    v_mfma_f32_16x16x32_bf16 v[156:159], a[156:159], v[108:111], v[156:159]
    ds_read_b128 v[84:87], v17 offset:4096
    ds_read_b64_tr_b16 a[164:165], v19 offset:0
    v_mfma_f32_16x16x32_bf16 v[160:163], a[128:131], v[112:115], v[160:163]
    v_mfma_f32_16x16x32_bf16 v[160:163], a[144:147], v[116:119], v[160:163]
    s_add_u32 m0, s96, 53248
    s_add_u32 s51, s55, 3801088
    v_mfma_f32_16x16x32_bf16 v[164:167], a[132:135], v[112:115], v[164:167]
    buffer_load_dwordx4 v12, s[32:35], s51 offen offset:0 nt lds
    v_mfma_f32_16x16x32_bf16 v[164:167], a[148:151], v[116:119], v[164:167]
    ds_read_b128 v[88:91], v16 offset:6144
    ds_read_b64_tr_b16 a[166:167], v19 offset:1024
    v_mfma_f32_16x16x32_bf16 v[168:171], a[136:139], v[112:115], v[168:171]
    v_mfma_f32_16x16x32_bf16 v[168:171], a[152:155], v[116:119], v[168:171]
    ds_read_b128 v[92:95], v17 offset:6144
    v_mfma_f32_16x16x32_bf16 v[172:175], a[140:143], v[112:115], v[172:175]
    ds_read_b64_tr_b16 a[180:181], v19 offset:8192
    v_mfma_f32_16x16x32_bf16 v[172:175], a[156:159], v[116:119], v[172:175]
    buffer_load_dwordx4 v13, s[32:35], s51 offen offset:1024 nt lds
    v_mfma_f32_16x16x32_bf16 v[176:179], a[128:131], v[120:123], v[176:179]
    ds_read_b128 v[96:99], v16 offset:8192
    v_mfma_f32_16x16x32_bf16 v[176:179], a[144:147], v[124:127], v[176:179]
    ds_read_b64_tr_b16 a[182:183], v19 offset:9216
    v_mfma_f32_16x16x32_bf16 v[180:183], a[132:135], v[120:123], v[180:183]
    v_mfma_f32_16x16x32_bf16 v[180:183], a[148:151], v[124:127], v[180:183]
    buffer_load_dwordx4 v14, s[32:35], s51 offen offset:2048 nt lds
    v_mfma_f32_16x16x32_bf16 v[184:187], a[136:139], v[120:123], v[184:187]
    ds_read_b128 v[100:103], v17 offset:8192
    v_mfma_f32_16x16x32_bf16 v[184:187], a[152:155], v[124:127], v[184:187]
    ds_read_b64_tr_b16 a[168:169], v20 offset:0
    v_mfma_f32_16x16x32_bf16 v[188:191], a[140:143], v[120:123], v[188:191]
    ds_read_b128 v[104:107], v16 offset:10240
    v_mfma_f32_16x16x32_bf16 v[188:191], a[156:159], v[124:127], v[188:191]
    buffer_load_dwordx4 v15, s[32:35], s51 offen offset:3072 nt lds
    v_mfma_f32_16x16x32_bf16 v[192:195], a[128:131], v[32:35], v[192:195]
    ds_read_b64_tr_b16 a[170:171], v20 offset:1024
    v_mfma_f32_16x16x32_bf16 v[192:195], a[144:147], v[36:39], v[192:195]
    ds_read_b128 v[108:111], v17 offset:10240
    v_mfma_f32_16x16x32_bf16 v[196:199], a[132:135], v[32:35], v[196:199]
    s_lshr_b32 m0, s96, 1
    s_add_u32 m0, m0, 81920
    s_add_u32 s51, s54, 896
    v_mfma_f32_16x16x32_bf16 v[196:199], a[148:151], v[36:39], v[196:199]
    buffer_load_dwordx4 v8, s[28:31], s51 offen offset:0 lds
    v_mfma_f32_16x16x32_bf16 v[200:203], a[136:139], v[32:35], v[200:203]
    ds_read_b128 v[112:115], v16 offset:12288
    ds_read_b64_tr_b16 a[184:185], v20 offset:8192
    v_mfma_f32_16x16x32_bf16 v[200:203], a[152:155], v[36:39], v[200:203]
    v_mfma_f32_16x16x32_bf16 v[204:207], a[140:143], v[32:35], v[204:207]
    ds_read_b64_tr_b16 a[186:187], v20 offset:9216
    v_mfma_f32_16x16x32_bf16 v[204:207], a[156:159], v[36:39], v[204:207]
    buffer_load_dwordx4 v9, s[28:31], s51 offen offset:1024 lds
    v_mfma_f32_16x16x32_bf16 v[208:211], a[128:131], v[40:43], v[208:211]
    ds_read_b128 v[116:119], v17 offset:12288
    v_mfma_f32_16x16x32_bf16 v[208:211], a[144:147], v[44:47], v[208:211]
    v_mfma_f32_16x16x32_bf16 v[212:215], a[132:135], v[40:43], v[212:215]
    ds_read_b128 v[120:123], v16 offset:14336
    ds_read_b64_tr_b16 a[172:173], v21 offset:0
    v_mfma_f32_16x16x32_bf16 v[212:215], a[148:151], v[44:47], v[212:215]
    v_mfma_f32_16x16x32_bf16 v[216:219], a[136:139], v[40:43], v[216:219]
    buffer_load_dwordx4 v10, s[28:31], s51 offen offset:2048 lds
    v_mfma_f32_16x16x32_bf16 v[216:219], a[152:155], v[44:47], v[216:219]
    ds_read_b128 v[124:127], v17 offset:14336
    v_mfma_f32_16x16x32_bf16 v[220:223], a[140:143], v[40:43], v[220:223]
    ds_read_b64_tr_b16 a[174:175], v21 offset:1024
    v_mfma_f32_16x16x32_bf16 v[220:223], a[156:159], v[44:47], v[220:223]
    v_mfma_f32_16x16x32_bf16 v[224:227], a[128:131], v[48:51], v[224:227]
    buffer_load_dwordx4 v11, s[28:31], s51 offen offset:3072 lds
    v_mfma_f32_16x16x32_bf16 v[224:227], a[144:147], v[52:55], v[224:227]
    ds_read_b64_tr_b16 a[188:189], v21 offset:8192
    v_mfma_f32_16x16x32_bf16 v[228:231], a[132:135], v[48:51], v[228:231]
    v_mfma_f32_16x16x32_bf16 v[228:231], a[148:151], v[52:55], v[228:231]
    v_mfma_f32_16x16x32_bf16 v[232:235], a[136:139], v[48:51], v[232:235]
    s_mov_b32 s64, s12
    s_mov_b32 s65, s13
    v_mfma_f32_16x16x32_bf16 v[232:235], a[152:155], v[52:55], v[232:235]
    ds_read_b64_tr_b16 a[190:191], v21 offset:9216
    v_mfma_f32_16x16x32_bf16 v[236:239], a[140:143], v[48:51], v[236:239]
    v_mfma_f32_16x16x32_bf16 v[236:239], a[156:159], v[52:55], v[236:239]
    v_mfma_f32_16x16x32_bf16 v[240:243], a[128:131], v[56:59], v[240:243]
    s_mov_b32 s66, 2097152
    s_mov_b32 s67, 0x20000
    v_mfma_f32_16x16x32_bf16 v[240:243], a[144:147], v[60:63], v[240:243]
    v_mfma_f32_16x16x32_bf16 v[244:247], a[132:135], v[56:59], v[244:247]
    v_mfma_f32_16x16x32_bf16 v[244:247], a[148:151], v[60:63], v[244:247]
    s_mov_b32 s68, 0
    v_add_u32 v16, 0xfffe8000, v16
    v_mfma_f32_16x16x32_bf16 v[248:251], a[136:139], v[56:59], v[248:251]
    buffer_load_dword v0, v29, s[64:67], s68 offen
    v_mfma_f32_16x16x32_bf16 v[248:251], a[152:155], v[60:63], v[248:251]
    v_add_u32 v17, 0xfffe8000, v17
    v_add_u32 v18, 0xfffe8000, v18
    v_mfma_f32_16x16x32_bf16 v[252:255], a[140:143], v[56:59], v[252:255]
    v_add_u32 v19, 0xfffe8000, v19
    v_add_u32 v20, 0xfffe8000, v20
    v_mfma_f32_16x16x32_bf16 v[252:255], a[156:159], v[60:63], v[252:255]
    v_add_u32 v21, 0xfffe8000, v21
    s_waitcnt vmcnt(13) lgkmcnt(0)
    s_barrier
    v_mfma_f32_16x16x32_bf16 v[128:131], a[160:163], v[64:67], v[128:131]
    ds_read_b128 v[32:35], v16 offset:0
    ds_read_b64_tr_b16 a[192:193], v18 offset:0
    v_mfma_f32_16x16x32_bf16 v[128:131], a[176:179], v[68:71], v[128:131]
    s_lshr_b32 m0, s96, 1
    s_add_u32 m0, m0, 98304
    s_add_u32 s51, s3, 131072
    v_mfma_f32_16x16x32_bf16 v[132:135], a[164:167], v[64:67], v[132:135]
    buffer_load_dwordx4 v5, s[28:31], s51 offen offset:0 lds
    v_mfma_f32_16x16x32_bf16 v[132:135], a[180:183], v[68:71], v[132:135]
    ds_read_b128 v[36:39], v17 offset:0
    v_mfma_f32_16x16x32_bf16 v[136:139], a[168:171], v[64:67], v[136:139]
    v_mfma_f32_16x16x32_bf16 v[136:139], a[184:187], v[68:71], v[136:139]
    ds_read_b64_tr_b16 a[194:195], v18 offset:1024
    v_mfma_f32_16x16x32_bf16 v[140:143], a[172:175], v[64:67], v[140:143]
    ds_read_b128 v[40:43], v16 offset:2048
    v_mfma_f32_16x16x32_bf16 v[140:143], a[188:191], v[68:71], v[140:143]
    ds_read_b64_tr_b16 a[208:209], v18 offset:8192
    v_mfma_f32_16x16x32_bf16 v[144:147], a[160:163], v[72:75], v[144:147]
    buffer_load_dwordx4 v6, s[28:31], s51 offen offset:1024 lds
    v_mfma_f32_16x16x32_bf16 v[144:147], a[176:179], v[76:79], v[144:147]
    ds_read_b128 v[44:47], v17 offset:2048
    v_mfma_f32_16x16x32_bf16 v[148:151], a[164:167], v[72:75], v[148:151]
    v_mfma_f32_16x16x32_bf16 v[148:151], a[180:183], v[76:79], v[148:151]
    v_mfma_f32_16x16x32_bf16 v[152:155], a[168:171], v[72:75], v[152:155]
    ds_read_b128 v[48:51], v16 offset:4096
    ds_read_b64_tr_b16 a[210:211], v18 offset:9216
    v_mfma_f32_16x16x32_bf16 v[152:155], a[184:187], v[76:79], v[152:155]
    v_mfma_f32_16x16x32_bf16 v[156:159], a[172:175], v[72:75], v[156:159]
    buffer_load_dwordx4 v7, s[28:31], s51 offen offset:2048 lds
    v_mfma_f32_16x16x32_bf16 v[156:159], a[188:191], v[76:79], v[156:159]
    ds_read_b128 v[52:55], v17 offset:4096
    ds_read_b64_tr_b16 a[196:197], v19 offset:0
    v_mfma_f32_16x16x32_bf16 v[160:163], a[160:163], v[80:83], v[160:163]
    v_mfma_f32_16x16x32_bf16 v[160:163], a[176:179], v[84:87], v[160:163]
    v_mfma_f32_16x16x32_bf16 v[164:167], a[164:167], v[80:83], v[164:167]
    ds_read_b128 v[56:59], v16 offset:6144
    ds_read_b64_tr_b16 a[198:199], v19 offset:1024
    v_mfma_f32_16x16x32_bf16 v[164:167], a[180:183], v[84:87], v[164:167]
    v_mfma_f32_16x16x32_bf16 v[168:171], a[168:171], v[80:83], v[168:171]
    buffer_load_dwordx4 v28, s[28:31], s51 offen offset:3072 lds
    v_mfma_f32_16x16x32_bf16 v[168:171], a[184:187], v[84:87], v[168:171]
    ds_read_b128 v[60:63], v17 offset:6144
    v_mfma_f32_16x16x32_bf16 v[172:175], a[172:175], v[80:83], v[172:175]
    ds_read_b64_tr_b16 a[212:213], v19 offset:8192
    v_mfma_f32_16x16x32_bf16 v[172:175], a[188:191], v[84:87], v[172:175]
    v_mfma_f32_16x16x32_bf16 v[176:179], a[160:163], v[88:91], v[176:179]
    s_lshr_b32 m0, s96, 1
    s_add_u32 m0, m0, 114688
    s_add_u32 s51, s3, 147456
    v_mfma_f32_16x16x32_bf16 v[176:179], a[176:179], v[92:95], v[176:179]
    buffer_load_dwordx4 v5, s[28:31], s51 offen offset:0 lds
    v_mfma_f32_16x16x32_bf16 v[180:183], a[164:167], v[88:91], v[180:183]
    ds_read_b128 v[64:67], v16 offset:8192
    ds_read_b64_tr_b16 a[214:215], v19 offset:9216
    v_mfma_f32_16x16x32_bf16 v[180:183], a[180:183], v[92:95], v[180:183]
    ds_read_b128 v[68:71], v17 offset:8192
    v_mfma_f32_16x16x32_bf16 v[184:187], a[168:171], v[88:91], v[184:187]
    v_mfma_f32_16x16x32_bf16 v[184:187], a[184:187], v[92:95], v[184:187]
    ds_read_b64_tr_b16 a[200:201], v20 offset:0
    v_mfma_f32_16x16x32_bf16 v[188:191], a[172:175], v[88:91], v[188:191]
    ds_read_b128 v[72:75], v16 offset:10240
    v_mfma_f32_16x16x32_bf16 v[188:191], a[188:191], v[92:95], v[188:191]
    buffer_load_dwordx4 v6, s[28:31], s51 offen offset:1024 lds
    v_mfma_f32_16x16x32_bf16 v[192:195], a[160:163], v[96:99], v[192:195]
    ds_read_b64_tr_b16 a[202:203], v20 offset:1024
    v_mfma_f32_16x16x32_bf16 v[192:195], a[176:179], v[100:103], v[192:195]
    ds_read_b128 v[76:79], v17 offset:10240
    v_mfma_f32_16x16x32_bf16 v[196:199], a[164:167], v[96:99], v[196:199]
    v_mfma_f32_16x16x32_bf16 v[196:199], a[180:183], v[100:103], v[196:199]
    v_mfma_f32_16x16x32_bf16 v[200:203], a[168:171], v[96:99], v[200:203]
    ds_read_b128 v[80:83], v16 offset:12288
    ds_read_b64_tr_b16 a[216:217], v20 offset:8192
    v_mfma_f32_16x16x32_bf16 v[200:203], a[184:187], v[100:103], v[200:203]
    buffer_load_dwordx4 v7, s[28:31], s51 offen offset:2048 lds
    v_mfma_f32_16x16x32_bf16 v[204:207], a[172:175], v[96:99], v[204:207]
    v_mfma_f32_16x16x32_bf16 v[204:207], a[188:191], v[100:103], v[204:207]
    ds_read_b128 v[84:87], v17 offset:12288
    ds_read_b64_tr_b16 a[218:219], v20 offset:9216
    v_mfma_f32_16x16x32_bf16 v[208:211], a[160:163], v[104:107], v[208:211]
    v_mfma_f32_16x16x32_bf16 v[208:211], a[176:179], v[108:111], v[208:211]
    ds_read_b64_tr_b16 a[204:205], v21 offset:0
    v_mfma_f32_16x16x32_bf16 v[212:215], a[164:167], v[104:107], v[212:215]
    buffer_load_dwordx4 v28, s[28:31], s51 offen offset:3072 lds
    v_mfma_f32_16x16x32_bf16 v[212:215], a[180:183], v[108:111], v[212:215]
    ds_read_b128 v[88:91], v16 offset:14336
    v_mfma_f32_16x16x32_bf16 v[216:219], a[168:171], v[104:107], v[216:219]
    v_mfma_f32_16x16x32_bf16 v[216:219], a[184:187], v[108:111], v[216:219]
    ds_read_b128 v[92:95], v17 offset:14336
    v_mfma_f32_16x16x32_bf16 v[220:223], a[172:175], v[104:107], v[220:223]
    ds_read_b64_tr_b16 a[206:207], v21 offset:1024
    v_mfma_f32_16x16x32_bf16 v[220:223], a[188:191], v[108:111], v[220:223]
    v_mfma_f32_16x16x32_bf16 v[224:227], a[160:163], v[112:115], v[224:227]
    s_mov_b32 s64, s10
    s_mov_b32 s65, s11
    v_mfma_f32_16x16x32_bf16 v[224:227], a[176:179], v[116:119], v[224:227]
    ds_read_b64_tr_b16 a[220:221], v21 offset:8192
    v_mfma_f32_16x16x32_bf16 v[228:231], a[164:167], v[112:115], v[228:231]
    v_mfma_f32_16x16x32_bf16 v[228:231], a[180:183], v[116:119], v[228:231]
    v_mfma_f32_16x16x32_bf16 v[232:235], a[168:171], v[112:115], v[232:235]
    v_mfma_f32_16x16x32_bf16 v[232:235], a[184:187], v[116:119], v[232:235]
    ds_read_b64_tr_b16 a[222:223], v21 offset:9216
    v_mfma_f32_16x16x32_bf16 v[236:239], a[172:175], v[112:115], v[236:239]
    s_mov_b32 s66, 2097152
    s_mov_b32 s67, 0x20000
    v_mfma_f32_16x16x32_bf16 v[236:239], a[188:191], v[116:119], v[236:239]
    v_mfma_f32_16x16x32_bf16 v[240:243], a[160:163], v[120:123], v[240:243]
    v_mfma_f32_16x16x32_bf16 v[240:243], a[176:179], v[124:127], v[240:243]
    v_mfma_f32_16x16x32_bf16 v[244:247], a[164:167], v[120:123], v[244:247]
    v_mfma_f32_16x16x32_bf16 v[244:247], a[180:183], v[124:127], v[244:247]
    s_mov_b32 s68, 0
    v_add_u32 v16, 0xc000, v16
    v_mfma_f32_16x16x32_bf16 v[248:251], a[168:171], v[120:123], v[248:251]
    buffer_load_dword v0, v29, s[64:67], s68 offen
    v_mfma_f32_16x16x32_bf16 v[248:251], a[184:187], v[124:127], v[248:251]
    v_add_u32 v17, 0xc000, v17
    v_add_u32 v18, 0xc000, v18
    v_mfma_f32_16x16x32_bf16 v[252:255], a[172:175], v[120:123], v[252:255]
    v_add_u32 v19, 0xc000, v19
    v_add_u32 v20, 0xc000, v20
    v_mfma_f32_16x16x32_bf16 v[252:255], a[188:191], v[124:127], v[252:255]
    v_add_u32 v21, 0xc000, v21
    s_waitcnt vmcnt(10) lgkmcnt(0)
    s_barrier
    v_mfma_f32_16x16x32_bf16 v[128:131], a[192:195], v[32:35], v[128:131]
    ds_read_b128 v[96:99], v16 offset:0
    v_mfma_f32_16x16x32_bf16 v[128:131], a[208:211], v[36:39], v[128:131]
    ds_read_b64_tr_b16 a[224:225], v18 offset:0
    v_mfma_f32_16x16x32_bf16 v[132:135], a[196:199], v[32:35], v[132:135]
    s_lshr_b32 m0, s96, 1
    s_add_u32 m0, m0, 131072
    s_add_u32 s51, s3, 163840
    v_mfma_f32_16x16x32_bf16 v[132:135], a[212:215], v[36:39], v[132:135]
    buffer_load_dwordx4 v5, s[28:31], s51 offen offset:0 lds
    v_mfma_f32_16x16x32_bf16 v[136:139], a[200:203], v[32:35], v[136:139]
    ds_read_b128 v[100:103], v17 offset:0
    v_mfma_f32_16x16x32_bf16 v[136:139], a[216:219], v[36:39], v[136:139]
    ds_read_b64_tr_b16 a[226:227], v18 offset:1024
    v_mfma_f32_16x16x32_bf16 v[140:143], a[204:207], v[32:35], v[140:143]
    ds_read_b128 v[104:107], v16 offset:2048
    v_mfma_f32_16x16x32_bf16 v[140:143], a[220:223], v[36:39], v[140:143]
    v_mfma_f32_16x16x32_bf16 v[144:147], a[192:195], v[40:43], v[144:147]
    ds_read_b64_tr_b16 a[240:241], v18 offset:8192
    s_and_b32 s52, s48, 1
    v_mfma_f32_16x16x32_bf16 v[144:147], a[208:211], v[44:47], v[144:147]
    ds_read_b128 v[108:111], v17 offset:2048
    v_mfma_f32_16x16x32_bf16 v[148:151], a[196:199], v[40:43], v[148:151]
    v_mfma_f32_16x16x32_bf16 v[148:151], a[212:215], v[44:47], v[148:151]
    buffer_load_dwordx4 v6, s[28:31], s51 offen offset:1024 lds
    v_mfma_f32_16x16x32_bf16 v[152:155], a[200:203], v[40:43], v[152:155]
    ds_read_b128 v[112:115], v16 offset:4096
    ds_read_b64_tr_b16 a[242:243], v18 offset:9216
    v_mfma_f32_16x16x32_bf16 v[152:155], a[216:219], v[44:47], v[152:155]
    v_mfma_f32_16x16x32_bf16 v[156:159], a[204:207], v[40:43], v[156:159]
    v_mfma_f32_16x16x32_bf16 v[156:159], a[220:223], v[44:47], v[156:159]
    ds_read_b128 v[116:119], v17 offset:4096
    ds_read_b64_tr_b16 a[228:229], v19 offset:0
    v_mfma_f32_16x16x32_bf16 v[160:163], a[192:195], v[48:51], v[160:163]
    v_mfma_f32_16x16x32_bf16 v[160:163], a[208:211], v[52:55], v[160:163]
    v_mfma_f32_16x16x32_bf16 v[164:167], a[196:199], v[48:51], v[164:167]
    ds_read_b128 v[120:123], v16 offset:6144
    ds_read_b64_tr_b16 a[230:231], v19 offset:1024
    v_mfma_f32_16x16x32_bf16 v[164:167], a[212:215], v[52:55], v[164:167]
    buffer_load_dwordx4 v7, s[28:31], s51 offen offset:2048 lds
    v_mfma_f32_16x16x32_bf16 v[168:171], a[200:203], v[48:51], v[168:171]
    v_mfma_f32_16x16x32_bf16 v[168:171], a[216:219], v[52:55], v[168:171]
    ds_read_b128 v[124:127], v17 offset:6144
    v_mfma_f32_16x16x32_bf16 v[172:175], a[204:207], v[48:51], v[172:175]
    ds_read_b64_tr_b16 a[244:245], v19 offset:8192
    v_mfma_f32_16x16x32_bf16 v[172:175], a[220:223], v[52:55], v[172:175]
    v_mfma_f32_16x16x32_bf16 v[176:179], a[192:195], v[56:59], v[176:179]
    ds_read_b128 v[32:35], v16 offset:8192
    s_lshl_b32 s52, s52, 11
    v_mfma_f32_16x16x32_bf16 v[176:179], a[208:211], v[60:63], v[176:179]
    ds_read_b64_tr_b16 a[246:247], v19 offset:9216
    v_mfma_f32_16x16x32_bf16 v[180:183], a[196:199], v[56:59], v[180:183]
    v_mfma_f32_16x16x32_bf16 v[180:183], a[212:215], v[60:63], v[180:183]
    buffer_load_dwordx4 v28, s[28:31], s51 offen offset:3072 lds
    v_mfma_f32_16x16x32_bf16 v[184:187], a[200:203], v[56:59], v[184:187]
    ds_read_b128 v[36:39], v17 offset:8192
    v_mfma_f32_16x16x32_bf16 v[184:187], a[216:219], v[60:63], v[184:187]
    ds_read_b64_tr_b16 a[232:233], v20 offset:0
    v_mfma_f32_16x16x32_bf16 v[188:191], a[204:207], v[56:59], v[188:191]
    ds_read_b128 v[40:43], v16 offset:10240
    v_mfma_f32_16x16x32_bf16 v[188:191], a[220:223], v[60:63], v[188:191]
    v_mfma_f32_16x16x32_bf16 v[192:195], a[192:195], v[64:67], v[192:195]
    ds_read_b64_tr_b16 a[234:235], v20 offset:1024
    v_mfma_f32_16x16x32_bf16 v[192:195], a[208:211], v[68:71], v[192:195]
    ds_read_b128 v[44:47], v17 offset:10240
    v_mfma_f32_16x16x32_bf16 v[196:199], a[196:199], v[64:67], v[196:199]
    s_lshr_b32 m0, s96, 1
    s_add_u32 m0, m0, 147456
    s_add_u32 s51, s3, 180224
    v_mfma_f32_16x16x32_bf16 v[196:199], a[212:215], v[68:71], v[196:199]
    buffer_load_dwordx4 v5, s[28:31], s51 offen offset:0 lds
    v_mfma_f32_16x16x32_bf16 v[200:203], a[200:203], v[64:67], v[200:203]
    ds_read_b128 v[48:51], v16 offset:12288
    ds_read_b64_tr_b16 a[248:249], v20 offset:8192
    v_mfma_f32_16x16x32_bf16 v[200:203], a[216:219], v[68:71], v[200:203]
    v_mfma_f32_16x16x32_bf16 v[204:207], a[204:207], v[64:67], v[204:207]
    v_mfma_f32_16x16x32_bf16 v[204:207], a[220:223], v[68:71], v[204:207]
    ds_read_b128 v[52:55], v17 offset:12288
    ds_read_b64_tr_b16 a[250:251], v20 offset:9216
    v_mfma_f32_16x16x32_bf16 v[208:211], a[192:195], v[72:75], v[208:211]
    v_add_u32 v26, s52, v2
    v_mfma_f32_16x16x32_bf16 v[208:211], a[208:211], v[76:79], v[208:211]
    v_mfma_f32_16x16x32_bf16 v[212:215], a[196:199], v[72:75], v[212:215]
    ds_read_b128 v[56:59], v16 offset:14336
    ds_read_b64_tr_b16 a[236:237], v21 offset:0
    v_mfma_f32_16x16x32_bf16 v[212:215], a[212:215], v[76:79], v[212:215]
    buffer_load_dwordx4 v6, s[28:31], s51 offen offset:1024 lds
    v_mfma_f32_16x16x32_bf16 v[216:219], a[200:203], v[72:75], v[216:219]
    v_mfma_f32_16x16x32_bf16 v[216:219], a[216:219], v[76:79], v[216:219]
    ds_read_b128 v[60:63], v17 offset:14336
    v_mfma_f32_16x16x32_bf16 v[220:223], a[204:207], v[72:75], v[220:223]
    ds_read_b64_tr_b16 a[238:239], v21 offset:1024
    v_mfma_f32_16x16x32_bf16 v[220:223], a[220:223], v[76:79], v[220:223]
    v_mfma_f32_16x16x32_bf16 v[224:227], a[192:195], v[80:83], v[224:227]
    v_mfma_f32_16x16x32_bf16 v[224:227], a[208:211], v[84:87], v[224:227]
    ds_read_b64_tr_b16 a[252:253], v21 offset:8192
    v_mfma_f32_16x16x32_bf16 v[228:231], a[196:199], v[80:83], v[228:231]
    v_mfma_f32_16x16x32_bf16 v[228:231], a[212:215], v[84:87], v[228:231]
    buffer_load_dwordx4 v7, s[28:31], s51 offen offset:2048 lds
    v_mfma_f32_16x16x32_bf16 v[232:235], a[200:203], v[80:83], v[232:235]
    v_mfma_f32_16x16x32_bf16 v[232:235], a[216:219], v[84:87], v[232:235]
    ds_read_b64_tr_b16 a[254:255], v21 offset:9216
    v_mfma_f32_16x16x32_bf16 v[236:239], a[204:207], v[80:83], v[236:239]
    v_mfma_f32_16x16x32_bf16 v[236:239], a[220:223], v[84:87], v[236:239]
    v_mfma_f32_16x16x32_bf16 v[240:243], a[192:195], v[88:91], v[240:243]
    v_add_u32 v27, 4096, v26
    v_mfma_f32_16x16x32_bf16 v[240:243], a[208:211], v[92:95], v[240:243]
    v_mfma_f32_16x16x32_bf16 v[244:247], a[196:199], v[88:91], v[244:247]
    v_mfma_f32_16x16x32_bf16 v[244:247], a[212:215], v[92:95], v[244:247]
    buffer_load_dwordx4 v28, s[28:31], s51 offen offset:3072 lds
    v_mfma_f32_16x16x32_bf16 v[248:251], a[200:203], v[88:91], v[248:251]
    v_mfma_f32_16x16x32_bf16 v[248:251], a[216:219], v[92:95], v[248:251]
    v_mfma_f32_16x16x32_bf16 v[252:255], a[204:207], v[88:91], v[252:255]
    v_mfma_f32_16x16x32_bf16 v[252:255], a[220:223], v[92:95], v[252:255]
    s_waitcnt vmcnt(9) lgkmcnt(0)
    s_barrier
    v_mfma_f32_16x16x32_bf16 v[128:131], a[224:227], v[96:99], v[128:131]
    ds_read_b128 v[64:67], v22 offset:0
    v_mfma_f32_16x16x32_bf16 v[128:131], a[240:243], v[100:103], v[128:131]
    s_lshr_b32 m0, s96, 1
    s_add_u32 m0, m0, 0
    s_add_u32 s51, s3, 196608
    v_mfma_f32_16x16x32_bf16 v[132:135], a[228:231], v[96:99], v[132:135]
    buffer_load_dwordx4 v5, s[28:31], s51 offen offset:0 lds
    v_mfma_f32_16x16x32_bf16 v[132:135], a[244:247], v[100:103], v[132:135]
    ds_read_b128 v[68:71], v23 offset:0
    v_mfma_f32_16x16x32_bf16 v[136:139], a[232:235], v[96:99], v[136:139]
    v_mfma_f32_16x16x32_bf16 v[136:139], a[248:251], v[100:103], v[136:139]
    v_mfma_f32_16x16x32_bf16 v[140:143], a[236:239], v[96:99], v[140:143]
    ds_read_b128 v[72:75], v24 offset:0
    v_mfma_f32_16x16x32_bf16 v[140:143], a[252:255], v[100:103], v[140:143]
    v_mfma_f32_16x16x32_bf16 v[144:147], a[224:227], v[104:107], v[144:147]
    buffer_load_dwordx4 v6, s[28:31], s51 offen offset:1024 lds
    v_mfma_f32_16x16x32_bf16 v[144:147], a[240:243], v[108:111], v[144:147]
    ds_read_b128 v[76:79], v25 offset:0
    v_mfma_f32_16x16x32_bf16 v[148:151], a[228:231], v[104:107], v[148:151]
    v_mfma_f32_16x16x32_bf16 v[148:151], a[244:247], v[108:111], v[148:151]
    v_mfma_f32_16x16x32_bf16 v[152:155], a[232:235], v[104:107], v[152:155]
    ds_read_b128 v[80:83], v22 offset:256
    v_mfma_f32_16x16x32_bf16 v[152:155], a[248:251], v[108:111], v[152:155]
    v_mfma_f32_16x16x32_bf16 v[156:159], a[236:239], v[104:107], v[156:159]
    buffer_load_dwordx4 v7, s[28:31], s51 offen offset:2048 lds
    v_mfma_f32_16x16x32_bf16 v[156:159], a[252:255], v[108:111], v[156:159]
    ds_read_b128 v[84:87], v23 offset:256
    v_mfma_f32_16x16x32_bf16 v[160:163], a[224:227], v[112:115], v[160:163]
    v_mfma_f32_16x16x32_bf16 v[160:163], a[240:243], v[116:119], v[160:163]
    v_mfma_f32_16x16x32_bf16 v[164:167], a[228:231], v[112:115], v[164:167]
    ds_read_b128 v[88:91], v24 offset:256
    v_mfma_f32_16x16x32_bf16 v[164:167], a[244:247], v[116:119], v[164:167]
    v_mfma_f32_16x16x32_bf16 v[168:171], a[232:235], v[112:115], v[168:171]
    buffer_load_dwordx4 v28, s[28:31], s51 offen offset:3072 lds
    v_mfma_f32_16x16x32_bf16 v[168:171], a[248:251], v[116:119], v[168:171]
    ds_read_b128 v[92:95], v25 offset:256
    v_mfma_f32_16x16x32_bf16 v[172:175], a[236:239], v[112:115], v[172:175]
    v_mfma_f32_16x16x32_bf16 v[172:175], a[252:255], v[116:119], v[172:175]
    v_mfma_f32_16x16x32_bf16 v[176:179], a[224:227], v[120:123], v[176:179]
    s_lshr_b32 m0, s96, 1
    s_add_u32 m0, m0, 16384
    s_add_u32 s51, s3, 212992
    v_mfma_f32_16x16x32_bf16 v[176:179], a[240:243], v[124:127], v[176:179]
    buffer_load_dwordx4 v5, s[28:31], s51 offen offset:0 lds
    v_mfma_f32_16x16x32_bf16 v[180:183], a[228:231], v[120:123], v[180:183]
    ds_read_b128 v[96:99], v22 offset:512
    v_mfma_f32_16x16x32_bf16 v[180:183], a[244:247], v[124:127], v[180:183]
    ds_read_b128 v[100:103], v23 offset:512
    v_mfma_f32_16x16x32_bf16 v[184:187], a[232:235], v[120:123], v[184:187]
    v_mfma_f32_16x16x32_bf16 v[184:187], a[248:251], v[124:127], v[184:187]
    v_mfma_f32_16x16x32_bf16 v[188:191], a[236:239], v[120:123], v[188:191]
    ds_read_b128 v[104:107], v24 offset:512
    v_mfma_f32_16x16x32_bf16 v[188:191], a[252:255], v[124:127], v[188:191]
    buffer_load_dwordx4 v6, s[28:31], s51 offen offset:1024 lds
    v_mfma_f32_16x16x32_bf16 v[192:195], a[224:227], v[32:35], v[192:195]
    v_mfma_f32_16x16x32_bf16 v[192:195], a[240:243], v[36:39], v[192:195]
    ds_read_b128 v[108:111], v25 offset:512
    v_mfma_f32_16x16x32_bf16 v[196:199], a[228:231], v[32:35], v[196:199]
    v_mfma_f32_16x16x32_bf16 v[196:199], a[244:247], v[36:39], v[196:199]
    v_mfma_f32_16x16x32_bf16 v[200:203], a[232:235], v[32:35], v[200:203]
    ds_read_b128 v[112:115], v22 offset:768
    v_mfma_f32_16x16x32_bf16 v[200:203], a[248:251], v[36:39], v[200:203]
    buffer_load_dwordx4 v7, s[28:31], s51 offen offset:2048 lds
    v_mfma_f32_16x16x32_bf16 v[204:207], a[236:239], v[32:35], v[204:207]
    v_mfma_f32_16x16x32_bf16 v[204:207], a[252:255], v[36:39], v[204:207]
    ds_read_b128 v[116:119], v23 offset:768
    v_mfma_f32_16x16x32_bf16 v[208:211], a[224:227], v[40:43], v[208:211]
    v_mfma_f32_16x16x32_bf16 v[208:211], a[240:243], v[44:47], v[208:211]
    v_mfma_f32_16x16x32_bf16 v[212:215], a[228:231], v[40:43], v[212:215]
    buffer_load_dwordx4 v28, s[28:31], s51 offen offset:3072 lds
    v_mfma_f32_16x16x32_bf16 v[212:215], a[244:247], v[44:47], v[212:215]
    ds_read_b128 v[120:123], v24 offset:768
    v_mfma_f32_16x16x32_bf16 v[216:219], a[232:235], v[40:43], v[216:219]
    v_mfma_f32_16x16x32_bf16 v[216:219], a[248:251], v[44:47], v[216:219]
    ds_read_b128 v[124:127], v25 offset:768
    v_mfma_f32_16x16x32_bf16 v[220:223], a[236:239], v[40:43], v[220:223]
    v_mfma_f32_16x16x32_bf16 v[220:223], a[252:255], v[44:47], v[220:223]
    v_mfma_f32_16x16x32_bf16 v[224:227], a[224:227], v[48:51], v[224:227]
    s_mov_b32 s64, s14
    s_mov_b32 s65, s15
    v_mfma_f32_16x16x32_bf16 v[224:227], a[240:243], v[52:55], v[224:227]
    v_mfma_f32_16x16x32_bf16 v[228:231], a[228:231], v[48:51], v[228:231]
    v_mfma_f32_16x16x32_bf16 v[228:231], a[244:247], v[52:55], v[228:231]
    v_mfma_f32_16x16x32_bf16 v[232:235], a[232:235], v[48:51], v[232:235]
    v_mfma_f32_16x16x32_bf16 v[232:235], a[248:251], v[52:55], v[232:235]
    v_mfma_f32_16x16x32_bf16 v[236:239], a[236:239], v[48:51], v[236:239]
    s_mov_b32 s66, 4194304
    s_mov_b32 s67, 0x20000
    v_mfma_f32_16x16x32_bf16 v[236:239], a[252:255], v[52:55], v[236:239]
    v_mfma_f32_16x16x32_bf16 v[240:243], a[224:227], v[56:59], v[240:243]
    v_mfma_f32_16x16x32_bf16 v[240:243], a[240:243], v[60:63], v[240:243]
    v_mfma_f32_16x16x32_bf16 v[244:247], a[228:231], v[56:59], v[244:247]
    v_mfma_f32_16x16x32_bf16 v[244:247], a[244:247], v[60:63], v[244:247]
    s_mov_b32 s68, 0
    v_mfma_f32_16x16x32_bf16 v[248:251], a[232:235], v[56:59], v[248:251]
    buffer_load_dword v0, v31, s[64:67], s68 offen
    v_mfma_f32_16x16x32_bf16 v[248:251], a[248:251], v[60:63], v[248:251]
    v_mfma_f32_16x16x32_bf16 v[252:255], a[236:239], v[56:59], v[252:255]
    v_mfma_f32_16x16x32_bf16 v[252:255], a[252:255], v[60:63], v[252:255]
    v_cvt_pk_bf16_f32 v159, v158, v159
    v_cvt_pk_bf16_f32 v158, v156, v157
    v_cvt_pk_bf16_f32 v157, v154, v155
    v_cvt_pk_bf16_f32 v156, v152, v153
    v_cvt_pk_bf16_f32 v152, v144, v145
    v_cvt_pk_bf16_f32 v153, v146, v147
    v_cvt_pk_bf16_f32 v154, v148, v149
    v_cvt_pk_bf16_f32 v155, v150, v151
    v_cvt_pk_bf16_f32 v148, v136, v137
    v_cvt_pk_bf16_f32 v149, v138, v139
    v_cvt_pk_bf16_f32 v150, v140, v141
    v_cvt_pk_bf16_f32 v151, v142, v143
    v_cvt_pk_bf16_f32 v144, v128, v129
    v_cvt_pk_bf16_f32 v145, v130, v131
    v_cvt_pk_bf16_f32 v146, v132, v133
    v_cvt_pk_bf16_f32 v147, v134, v135
    s_waitcnt lgkmcnt(0)
    v_mfma_f32_16x16x32_bf16 v[128:131], a[0:3], v[64:67], 0
    ds_read_b128 v[32:35], v22 offset:16384
    v_mfma_f32_16x16x32_bf16 v[132:135], a[4:7], v[64:67], 0
    v_mfma_f32_16x16x32_bf16 v[136:139], a[8:11], v[64:67], 0
    v_mfma_f32_16x16x32_bf16 v[140:143], a[12:15], v[64:67], 0
    ds_read_b128 v[36:39], v23 offset:16384
    v_mfma_f32_16x16x32_bf16 v[128:131], a[16:19], v[68:71], v[128:131]
    v_mfma_f32_16x16x32_bf16 v[132:135], a[20:23], v[68:71], v[132:135]
    v_mfma_f32_16x16x32_bf16 v[136:139], a[24:27], v[68:71], v[136:139]
    ds_read_b128 v[40:43], v24 offset:16384
    v_mfma_f32_16x16x32_bf16 v[140:143], a[28:31], v[68:71], v[140:143]
    v_mfma_f32_16x16x32_bf16 v[128:131], a[32:35], v[72:75], v[128:131]
    v_mfma_f32_16x16x32_bf16 v[132:135], a[36:39], v[72:75], v[132:135]
    ds_read_b128 v[44:47], v25 offset:16384
    v_mfma_f32_16x16x32_bf16 v[136:139], a[40:43], v[72:75], v[136:139]
    s_mov_b32 s53, 0
    v_mfma_f32_16x16x32_bf16 v[140:143], a[44:47], v[72:75], v[140:143]
    buffer_store_dwordx4 v[144:147], v26, s[36:39], s53 offen offset:0 sc1
    v_mfma_f32_16x16x32_bf16 v[128:131], a[48:51], v[76:79], v[128:131]
    ds_read_b128 v[48:51], v22 offset:16640
    v_mfma_f32_16x16x32_bf16 v[132:135], a[52:55], v[76:79], v[132:135]
    v_mfma_f32_16x16x32_bf16 v[136:139], a[56:59], v[76:79], v[136:139]
    v_mfma_f32_16x16x32_bf16 v[140:143], a[60:63], v[76:79], v[140:143]
    ds_read_b128 v[52:55], v23 offset:16640
    v_mfma_f32_16x16x32_bf16 v[128:131], a[64:67], v[80:83], v[128:131]
    v_mfma_f32_16x16x32_bf16 v[132:135], a[68:71], v[80:83], v[132:135]
    v_mfma_f32_16x16x32_bf16 v[136:139], a[72:75], v[80:83], v[136:139]
    ds_read_b128 v[56:59], v24 offset:16640
    v_mfma_f32_16x16x32_bf16 v[140:143], a[76:79], v[80:83], v[140:143]
    v_mfma_f32_16x16x32_bf16 v[128:131], a[80:83], v[84:87], v[128:131]
    v_mfma_f32_16x16x32_bf16 v[132:135], a[84:87], v[84:87], v[132:135]
    ds_read_b128 v[60:63], v25 offset:16640
    v_mfma_f32_16x16x32_bf16 v[136:139], a[88:91], v[84:87], v[136:139]
    v_mfma_f32_16x16x32_bf16 v[140:143], a[92:95], v[84:87], v[140:143]
    v_mfma_f32_16x16x32_bf16 v[128:131], a[96:99], v[88:91], v[128:131]
    ds_read_b128 v[64:67], v22 offset:16896
    v_mfma_f32_16x16x32_bf16 v[132:135], a[100:103], v[88:91], v[132:135]
    buffer_store_dwordx4 v[148:151], v26, s[36:39], s53 offen offset:1024 sc1
    v_mfma_f32_16x16x32_bf16 v[136:139], a[104:107], v[88:91], v[136:139]
    v_mfma_f32_16x16x32_bf16 v[140:143], a[108:111], v[88:91], v[140:143]
    ds_read_b128 v[68:71], v23 offset:16896
    v_mfma_f32_16x16x32_bf16 v[128:131], a[112:115], v[92:95], v[128:131]
    v_mfma_f32_16x16x32_bf16 v[132:135], a[116:119], v[92:95], v[132:135]
    v_mfma_f32_16x16x32_bf16 v[136:139], a[120:123], v[92:95], v[136:139]
    ds_read_b128 v[72:75], v24 offset:16896
    v_mfma_f32_16x16x32_bf16 v[140:143], a[124:127], v[92:95], v[140:143]
    v_mfma_f32_16x16x32_bf16 v[128:131], a[128:131], v[96:99], v[128:131]
    v_mfma_f32_16x16x32_bf16 v[132:135], a[132:135], v[96:99], v[132:135]
    ds_read_b128 v[76:79], v25 offset:16896
    v_mfma_f32_16x16x32_bf16 v[136:139], a[136:139], v[96:99], v[136:139]
    v_mfma_f32_16x16x32_bf16 v[140:143], a[140:143], v[96:99], v[140:143]
    v_mfma_f32_16x16x32_bf16 v[128:131], a[144:147], v[100:103], v[128:131]
    ds_read_b128 v[80:83], v22 offset:17152
    v_mfma_f32_16x16x32_bf16 v[132:135], a[148:151], v[100:103], v[132:135]
    v_mfma_f32_16x16x32_bf16 v[136:139], a[152:155], v[100:103], v[136:139]
    buffer_store_dwordx4 v[152:155], v27, s[36:39], s53 offen offset:0 sc1
    v_mfma_f32_16x16x32_bf16 v[140:143], a[156:159], v[100:103], v[140:143]
    ds_read_b128 v[84:87], v23 offset:17152
    v_mfma_f32_16x16x32_bf16 v[128:131], a[160:163], v[104:107], v[128:131]
    v_mfma_f32_16x16x32_bf16 v[132:135], a[164:167], v[104:107], v[132:135]
    v_mfma_f32_16x16x32_bf16 v[136:139], a[168:171], v[104:107], v[136:139]
    ds_read_b128 v[88:91], v24 offset:17152
    v_mfma_f32_16x16x32_bf16 v[140:143], a[172:175], v[104:107], v[140:143]
    v_mfma_f32_16x16x32_bf16 v[128:131], a[176:179], v[108:111], v[128:131]
    v_mfma_f32_16x16x32_bf16 v[132:135], a[180:183], v[108:111], v[132:135]
    ds_read_b128 v[92:95], v25 offset:17152
    v_mfma_f32_16x16x32_bf16 v[136:139], a[184:187], v[108:111], v[136:139]
    v_mfma_f32_16x16x32_bf16 v[140:143], a[188:191], v[108:111], v[140:143]
    v_mfma_f32_16x16x32_bf16 v[128:131], a[192:195], v[112:115], v[128:131]
    v_mfma_f32_16x16x32_bf16 v[132:135], a[196:199], v[112:115], v[132:135]
    v_mfma_f32_16x16x32_bf16 v[136:139], a[200:203], v[112:115], v[136:139]
    v_mfma_f32_16x16x32_bf16 v[140:143], a[204:207], v[112:115], v[140:143]
    v_mfma_f32_16x16x32_bf16 v[128:131], a[208:211], v[116:119], v[128:131]
    v_mfma_f32_16x16x32_bf16 v[132:135], a[212:215], v[116:119], v[132:135]
    buffer_store_dwordx4 v[156:159], v27, s[36:39], s53 offen offset:1024 sc1
    v_mfma_f32_16x16x32_bf16 v[136:139], a[216:219], v[116:119], v[136:139]
    v_mfma_f32_16x16x32_bf16 v[140:143], a[220:223], v[116:119], v[140:143]
    v_mfma_f32_16x16x32_bf16 v[128:131], a[224:227], v[120:123], v[128:131]
    v_mfma_f32_16x16x32_bf16 v[132:135], a[228:231], v[120:123], v[132:135]
    v_mfma_f32_16x16x32_bf16 v[136:139], a[232:235], v[120:123], v[136:139]
    v_mfma_f32_16x16x32_bf16 v[140:143], a[236:239], v[120:123], v[140:143]
    v_mfma_f32_16x16x32_bf16 v[128:131], a[240:243], v[124:127], v[128:131]
    v_add_u32 v22, 0x8000, v22
    v_mfma_f32_16x16x32_bf16 v[132:135], a[244:247], v[124:127], v[132:135]
    v_add_u32 v23, 0x8000, v23
    v_mfma_f32_16x16x32_bf16 v[136:139], a[248:251], v[124:127], v[136:139]
    v_add_u32 v24, 0x8000, v24
    v_mfma_f32_16x16x32_bf16 v[140:143], a[252:255], v[124:127], v[140:143]
    v_add_u32 v25, 0x8000, v25
    s_waitcnt vmcnt(13) lgkmcnt(0)
    s_barrier
    v_mfma_f32_16x16x32_bf16 v[144:147], a[0:3], v[32:35], 0
    ds_read_b128 v[96:99], v22 offset:0
    v_mfma_f32_16x16x32_bf16 v[148:151], a[4:7], v[32:35], 0
    s_lshr_b32 m0, s96, 1
    s_add_u32 m0, m0, 98304
    s_add_u32 s51, s3, 229376
    v_mfma_f32_16x16x32_bf16 v[152:155], a[8:11], v[32:35], 0
    buffer_load_dwordx4 v5, s[28:31], s51 offen offset:0 lds
    v_mfma_f32_16x16x32_bf16 v[156:159], a[12:15], v[32:35], 0
    ds_read_b128 v[100:103], v23 offset:0
    v_mfma_f32_16x16x32_bf16 v[144:147], a[16:19], v[36:39], v[144:147]
    v_mfma_f32_16x16x32_bf16 v[148:151], a[20:23], v[36:39], v[148:151]
    v_cvt_pk_bf16_f32 v160, v160, v161
    v_mfma_f32_16x16x32_bf16 v[152:155], a[24:27], v[36:39], v[152:155]
    ds_read_b128 v[104:107], v24 offset:0
    v_mfma_f32_16x16x32_bf16 v[156:159], a[28:31], v[36:39], v[156:159]
    v_cvt_pk_bf16_f32 v161, v162, v163
    v_mfma_f32_16x16x32_bf16 v[144:147], a[32:35], v[40:43], v[144:147]
    buffer_load_dwordx4 v6, s[28:31], s51 offen offset:1024 lds
    v_mfma_f32_16x16x32_bf16 v[148:151], a[36:39], v[40:43], v[148:151]
    ds_read_b128 v[108:111], v25 offset:0
    v_mfma_f32_16x16x32_bf16 v[152:155], a[40:43], v[40:43], v[152:155]
    v_mfma_f32_16x16x32_bf16 v[156:159], a[44:47], v[40:43], v[156:159]
    v_cvt_pk_bf16_f32 v162, v164, v165
    v_mfma_f32_16x16x32_bf16 v[144:147], a[48:51], v[44:47], v[144:147]
    ds_read_b128 v[112:115], v22 offset:256
    v_cvt_pk_bf16_f32 v163, v166, v167
    v_mfma_f32_16x16x32_bf16 v[148:151], a[52:55], v[44:47], v[148:151]
    buffer_load_dwordx4 v7, s[28:31], s51 offen offset:2048 lds
    v_mfma_f32_16x16x32_bf16 v[152:155], a[56:59], v[44:47], v[152:155]
    v_mfma_f32_16x16x32_bf16 v[156:159], a[60:63], v[44:47], v[156:159]
    ds_read_b128 v[116:119], v23 offset:256
    s_mov_b32 s53, 8192
    v_mfma_f32_16x16x32_bf16 v[144:147], a[64:67], v[48:51], v[144:147]
    buffer_store_dwordx4 v[160:163], v26, s[36:39], s53 offen offset:0 sc1
    v_mfma_f32_16x16x32_bf16 v[148:151], a[68:71], v[48:51], v[148:151]
    v_mfma_f32_16x16x32_bf16 v[152:155], a[72:75], v[48:51], v[152:155]
    ds_read_b128 v[120:123], v24 offset:256
    v_cvt_pk_bf16_f32 v168, v168, v169
    v_mfma_f32_16x16x32_bf16 v[156:159], a[76:79], v[48:51], v[156:159]
    buffer_load_dwordx4 v28, s[28:31], s51 offen offset:3072 lds
    v_mfma_f32_16x16x32_bf16 v[144:147], a[80:83], v[52:55], v[144:147]
    v_mfma_f32_16x16x32_bf16 v[148:151], a[84:87], v[52:55], v[148:151]
    ds_read_b128 v[124:127], v25 offset:256
    v_mfma_f32_16x16x32_bf16 v[152:155], a[88:91], v[52:55], v[152:155]
    v_cvt_pk_bf16_f32 v169, v170, v171
    v_mfma_f32_16x16x32_bf16 v[156:159], a[92:95], v[52:55], v[156:159]
    s_lshr_b32 m0, s96, 1
    s_add_u32 m0, m0, 114688
    s_add_u32 s51, s3, 245760
    v_mfma_f32_16x16x32_bf16 v[144:147], a[96:99], v[56:59], v[144:147]
    buffer_load_dwordx4 v5, s[28:31], s51 offen offset:0 lds
    v_mfma_f32_16x16x32_bf16 v[148:151], a[100:103], v[56:59], v[148:151]
    ds_read_b128 v[32:35], v22 offset:512
    v_cvt_pk_bf16_f32 v170, v172, v173
    v_mfma_f32_16x16x32_bf16 v[152:155], a[104:107], v[56:59], v[152:155]
    v_mfma_f32_16x16x32_bf16 v[156:159], a[108:111], v[56:59], v[156:159]
    ds_read_b128 v[36:39], v23 offset:512
    v_mfma_f32_16x16x32_bf16 v[144:147], a[112:115], v[60:63], v[144:147]
    v_cvt_pk_bf16_f32 v171, v174, v175
    v_mfma_f32_16x16x32_bf16 v[148:151], a[116:119], v[60:63], v[148:151]
    v_mfma_f32_16x16x32_bf16 v[152:155], a[120:123], v[60:63], v[152:155]
    buffer_load_dwordx4 v6, s[28:31], s51 offen offset:1024 lds
    v_mfma_f32_16x16x32_bf16 v[156:159], a[124:127], v[60:63], v[156:159]
    ds_read_b128 v[40:43], v24 offset:512
    v_mfma_f32_16x16x32_bf16 v[144:147], a[128:131], v[64:67], v[144:147]
    buffer_store_dwordx4 v[168:171], v26, s[36:39], s53 offen offset:1024 sc1
    v_mfma_f32_16x16x32_bf16 v[148:151], a[132:135], v[64:67], v[148:151]
    ds_read_b128 v[44:47], v25 offset:512
    v_cvt_pk_bf16_f32 v176, v176, v177
    v_mfma_f32_16x16x32_bf16 v[152:155], a[136:139], v[64:67], v[152:155]
    v_mfma_f32_16x16x32_bf16 v[156:159], a[140:143], v[64:67], v[156:159]
    v_cvt_pk_bf16_f32 v177, v178, v179
    v_mfma_f32_16x16x32_bf16 v[144:147], a[144:147], v[68:71], v[144:147]
    buffer_load_dwordx4 v7, s[28:31], s51 offen offset:2048 lds
    v_mfma_f32_16x16x32_bf16 v[148:151], a[148:151], v[68:71], v[148:151]
    ds_read_b128 v[48:51], v22 offset:768
    v_mfma_f32_16x16x32_bf16 v[152:155], a[152:155], v[68:71], v[152:155]
    v_mfma_f32_16x16x32_bf16 v[156:159], a[156:159], v[68:71], v[156:159]
    ds_read_b128 v[52:55], v23 offset:768
    v_cvt_pk_bf16_f32 v178, v180, v181
    v_mfma_f32_16x16x32_bf16 v[144:147], a[160:163], v[72:75], v[144:147]
    v_mfma_f32_16x16x32_bf16 v[148:151], a[164:167], v[72:75], v[148:151]
    buffer_load_dwordx4 v28, s[28:31], s51 offen offset:3072 lds
    v_mfma_f32_16x16x32_bf16 v[152:155], a[168:171], v[72:75], v[152:155]
    ds_read_b128 v[56:59], v24 offset:768
    v_cvt_pk_bf16_f32 v179, v182, v183
    v_mfma_f32_16x16x32_bf16 v[156:159], a[172:175], v[72:75], v[156:159]
    v_mfma_f32_16x16x32_bf16 v[144:147], a[176:179], v[76:79], v[144:147]
    buffer_store_dwordx4 v[176:179], v27, s[36:39], s53 offen offset:0 sc1
    v_mfma_f32_16x16x32_bf16 v[148:151], a[180:183], v[76:79], v[148:151]
    ds_read_b128 v[60:63], v25 offset:768
    v_mfma_f32_16x16x32_bf16 v[152:155], a[184:187], v[76:79], v[152:155]
    v_mfma_f32_16x16x32_bf16 v[156:159], a[188:191], v[76:79], v[156:159]
    s_mov_b32 s64, s14
    s_mov_b32 s65, s15
    v_mfma_f32_16x16x32_bf16 v[144:147], a[192:195], v[80:83], v[144:147]
    v_cvt_pk_bf16_f32 v184, v184, v185
    v_mfma_f32_16x16x32_bf16 v[148:151], a[196:199], v[80:83], v[148:151]
    v_mfma_f32_16x16x32_bf16 v[152:155], a[200:203], v[80:83], v[152:155]
    v_mfma_f32_16x16x32_bf16 v[156:159], a[204:207], v[80:83], v[156:159]
    v_cvt_pk_bf16_f32 v185, v186, v187
    v_mfma_f32_16x16x32_bf16 v[144:147], a[208:211], v[84:87], v[144:147]
    s_mov_b32 s66, 4194304
    s_mov_b32 s67, 0x20000
    v_mfma_f32_16x16x32_bf16 v[148:151], a[212:215], v[84:87], v[148:151]
    v_cvt_pk_bf16_f32 v186, v188, v189
    v_mfma_f32_16x16x32_bf16 v[152:155], a[216:219], v[84:87], v[152:155]
    v_mfma_f32_16x16x32_bf16 v[156:159], a[220:223], v[84:87], v[156:159]
    v_mfma_f32_16x16x32_bf16 v[144:147], a[224:227], v[88:91], v[144:147]
    v_cvt_pk_bf16_f32 v187, v190, v191
    v_mfma_f32_16x16x32_bf16 v[148:151], a[228:231], v[88:91], v[148:151]
    s_mov_b32 s68, 2097152
    v_mfma_f32_16x16x32_bf16 v[152:155], a[232:235], v[88:91], v[152:155]
    buffer_load_dword v0, v31, s[64:67], s68 offen
    v_mfma_f32_16x16x32_bf16 v[156:159], a[236:239], v[88:91], v[156:159]
    buffer_store_dwordx4 v[184:187], v27, s[36:39], s53 offen offset:1024 sc1
    v_mfma_f32_16x16x32_bf16 v[144:147], a[240:243], v[92:95], v[144:147]
    v_mfma_f32_16x16x32_bf16 v[148:151], a[244:247], v[92:95], v[148:151]
    v_mfma_f32_16x16x32_bf16 v[152:155], a[248:251], v[92:95], v[152:155]
    v_mfma_f32_16x16x32_bf16 v[156:159], a[252:255], v[92:95], v[156:159]
    s_waitcnt lgkmcnt(0)
    v_mfma_f32_16x16x32_bf16 v[160:163], a[0:3], v[96:99], 0
    ds_read_b128 v[64:67], v22 offset:16384
    v_mfma_f32_16x16x32_bf16 v[164:167], a[4:7], v[96:99], 0
    v_mfma_f32_16x16x32_bf16 v[168:171], a[8:11], v[96:99], 0
    v_mfma_f32_16x16x32_bf16 v[172:175], a[12:15], v[96:99], 0
    ds_read_b128 v[68:71], v23 offset:16384
    v_mfma_f32_16x16x32_bf16 v[160:163], a[16:19], v[100:103], v[160:163]
    v_mfma_f32_16x16x32_bf16 v[164:167], a[20:23], v[100:103], v[164:167]
    v_cvt_pk_bf16_f32 v192, v192, v193
    v_mfma_f32_16x16x32_bf16 v[168:171], a[24:27], v[100:103], v[168:171]
    ds_read_b128 v[72:75], v24 offset:16384
    v_mfma_f32_16x16x32_bf16 v[172:175], a[28:31], v[100:103], v[172:175]
    v_mfma_f32_16x16x32_bf16 v[160:163], a[32:35], v[104:107], v[160:163]
    v_cvt_pk_bf16_f32 v193, v194, v195
    v_mfma_f32_16x16x32_bf16 v[164:167], a[36:39], v[104:107], v[164:167]
    ds_read_b128 v[76:79], v25 offset:16384
    v_mfma_f32_16x16x32_bf16 v[168:171], a[40:43], v[104:107], v[168:171]
    v_mfma_f32_16x16x32_bf16 v[172:175], a[44:47], v[104:107], v[172:175]
    v_cvt_pk_bf16_f32 v194, v196, v197
    v_mfma_f32_16x16x32_bf16 v[160:163], a[48:51], v[108:111], v[160:163]
    ds_read_b128 v[80:83], v22 offset:16640
    v_mfma_f32_16x16x32_bf16 v[164:167], a[52:55], v[108:111], v[164:167]
    v_cvt_pk_bf16_f32 v195, v198, v199
    v_mfma_f32_16x16x32_bf16 v[168:171], a[56:59], v[108:111], v[168:171]
    v_mfma_f32_16x16x32_bf16 v[172:175], a[60:63], v[108:111], v[172:175]
    ds_read_b128 v[84:87], v23 offset:16640
    s_mov_b32 s53, 16384
    v_mfma_f32_16x16x32_bf16 v[160:163], a[64:67], v[112:115], v[160:163]
    buffer_store_dwordx4 v[192:195], v26, s[36:39], s53 offen offset:0 sc1
    v_mfma_f32_16x16x32_bf16 v[164:167], a[68:71], v[112:115], v[164:167]
    v_mfma_f32_16x16x32_bf16 v[168:171], a[72:75], v[112:115], v[168:171]
    ds_read_b128 v[88:91], v24 offset:16640
    v_mfma_f32_16x16x32_bf16 v[172:175], a[76:79], v[112:115], v[172:175]
    v_cvt_pk_bf16_f32 v200, v200, v201
    v_mfma_f32_16x16x32_bf16 v[160:163], a[80:83], v[116:119], v[160:163]
    v_mfma_f32_16x16x32_bf16 v[164:167], a[84:87], v[116:119], v[164:167]
    ds_read_b128 v[92:95], v25 offset:16640
    v_mfma_f32_16x16x32_bf16 v[168:171], a[88:91], v[116:119], v[168:171]
    v_cvt_pk_bf16_f32 v201, v202, v203
    v_mfma_f32_16x16x32_bf16 v[172:175], a[92:95], v[116:119], v[172:175]
    v_mfma_f32_16x16x32_bf16 v[160:163], a[96:99], v[120:123], v[160:163]
    ds_read_b128 v[96:99], v22 offset:16896
    v_mfma_f32_16x16x32_bf16 v[164:167], a[100:103], v[120:123], v[164:167]
    v_cvt_pk_bf16_f32 v202, v204, v205
    v_mfma_f32_16x16x32_bf16 v[168:171], a[104:107], v[120:123], v[168:171]
    v_mfma_f32_16x16x32_bf16 v[172:175], a[108:111], v[120:123], v[172:175]
    ds_read_b128 v[100:103], v23 offset:16896
    v_mfma_f32_16x16x32_bf16 v[160:163], a[112:115], v[124:127], v[160:163]
    v_cvt_pk_bf16_f32 v203, v206, v207
    v_mfma_f32_16x16x32_bf16 v[164:167], a[116:119], v[124:127], v[164:167]
    v_mfma_f32_16x16x32_bf16 v[168:171], a[120:123], v[124:127], v[168:171]
    ds_read_b128 v[104:107], v24 offset:16896
    v_mfma_f32_16x16x32_bf16 v[172:175], a[124:127], v[124:127], v[172:175]
    buffer_store_dwordx4 v[200:203], v26, s[36:39], s53 offen offset:1024 sc1
    v_mfma_f32_16x16x32_bf16 v[160:163], a[128:131], v[32:35], v[160:163]
    v_mfma_f32_16x16x32_bf16 v[164:167], a[132:135], v[32:35], v[164:167]
    ds_read_b128 v[108:111], v25 offset:16896
    v_cvt_pk_bf16_f32 v208, v208, v209
    v_mfma_f32_16x16x32_bf16 v[168:171], a[136:139], v[32:35], v[168:171]
    v_mfma_f32_16x16x32_bf16 v[172:175], a[140:143], v[32:35], v[172:175]
    v_mfma_f32_16x16x32_bf16 v[160:163], a[144:147], v[36:39], v[160:163]
    ds_read_b128 v[112:115], v22 offset:17152
    v_cvt_pk_bf16_f32 v209, v210, v211
    v_mfma_f32_16x16x32_bf16 v[164:167], a[148:151], v[36:39], v[164:167]
    v_mfma_f32_16x16x32_bf16 v[168:171], a[152:155], v[36:39], v[168:171]
    v_mfma_f32_16x16x32_bf16 v[172:175], a[156:159], v[36:39], v[172:175]
    ds_read_b128 v[116:119], v23 offset:17152
    v_cvt_pk_bf16_f32 v210, v212, v213
    v_mfma_f32_16x16x32_bf16 v[160:163], a[160:163], v[40:43], v[160:163]
    v_mfma_f32_16x16x32_bf16 v[164:167], a[164:167], v[40:43], v[164:167]
    v_mfma_f32_16x16x32_bf16 v[168:171], a[168:171], v[40:43], v[168:171]
    ds_read_b128 v[120:123], v24 offset:17152
    v_cvt_pk_bf16_f32 v211, v214, v215
    v_mfma_f32_16x16x32_bf16 v[172:175], a[172:175], v[40:43], v[172:175]
    v_mfma_f32_16x16x32_bf16 v[160:163], a[176:179], v[44:47], v[160:163]
    buffer_store_dwordx4 v[208:211], v27, s[36:39], s53 offen offset:0 sc1
    v_mfma_f32_16x16x32_bf16 v[164:167], a[180:183], v[44:47], v[164:167]
    ds_read_b128 v[124:127], v25 offset:17152
    v_mfma_f32_16x16x32_bf16 v[168:171], a[184:187], v[44:47], v[168:171]
    v_mfma_f32_16x16x32_bf16 v[172:175], a[188:191], v[44:47], v[172:175]
    v_mfma_f32_16x16x32_bf16 v[160:163], a[192:195], v[48:51], v[160:163]
    v_cvt_pk_bf16_f32 v216, v216, v217
    v_mfma_f32_16x16x32_bf16 v[164:167], a[196:199], v[48:51], v[164:167]
    v_mfma_f32_16x16x32_bf16 v[168:171], a[200:203], v[48:51], v[168:171]
    v_mfma_f32_16x16x32_bf16 v[172:175], a[204:207], v[48:51], v[172:175]
    v_cvt_pk_bf16_f32 v217, v218, v219
    v_mfma_f32_16x16x32_bf16 v[160:163], a[208:211], v[52:55], v[160:163]
    v_mfma_f32_16x16x32_bf16 v[164:167], a[212:215], v[52:55], v[164:167]
    v_cvt_pk_bf16_f32 v218, v220, v221
    v_mfma_f32_16x16x32_bf16 v[168:171], a[216:219], v[52:55], v[168:171]
    v_mfma_f32_16x16x32_bf16 v[172:175], a[220:223], v[52:55], v[172:175]
    v_mfma_f32_16x16x32_bf16 v[160:163], a[224:227], v[56:59], v[160:163]
    v_cvt_pk_bf16_f32 v219, v222, v223
    v_mfma_f32_16x16x32_bf16 v[164:167], a[228:231], v[56:59], v[164:167]
    v_mfma_f32_16x16x32_bf16 v[168:171], a[232:235], v[56:59], v[168:171]
    v_mfma_f32_16x16x32_bf16 v[172:175], a[236:239], v[56:59], v[172:175]
    buffer_store_dwordx4 v[216:219], v27, s[36:39], s53 offen offset:1024 sc1
    v_mfma_f32_16x16x32_bf16 v[160:163], a[240:243], v[60:63], v[160:163]
    v_add_u32 v22, 0xfffe0000, v22
    v_mfma_f32_16x16x32_bf16 v[164:167], a[244:247], v[60:63], v[164:167]
    v_add_u32 v23, 0xfffe0000, v23
    v_mfma_f32_16x16x32_bf16 v[168:171], a[248:251], v[60:63], v[168:171]
    v_add_u32 v24, 0xfffe0000, v24
    v_mfma_f32_16x16x32_bf16 v[172:175], a[252:255], v[60:63], v[172:175]
    v_add_u32 v25, 0xfffe0000, v25
    s_waitcnt vmcnt(22) lgkmcnt(0)
    s_barrier
    v_mfma_f32_16x16x32_bf16 v[176:179], a[0:3], v[64:67], 0
    ds_read_b128 v[32:35], v22 offset:0
    v_mfma_f32_16x16x32_bf16 v[180:183], a[4:7], v[64:67], 0
    v_mfma_f32_16x16x32_bf16 v[184:187], a[8:11], v[64:67], 0
    v_mfma_f32_16x16x32_bf16 v[188:191], a[12:15], v[64:67], 0
    ds_read_b128 v[36:39], v23 offset:0
    v_mfma_f32_16x16x32_bf16 v[176:179], a[16:19], v[68:71], v[176:179]
    v_mfma_f32_16x16x32_bf16 v[180:183], a[20:23], v[68:71], v[180:183]
    v_cvt_pk_bf16_f32 v224, v224, v225
    v_mfma_f32_16x16x32_bf16 v[184:187], a[24:27], v[68:71], v[184:187]
    ds_read_b128 v[40:43], v24 offset:0
    v_mfma_f32_16x16x32_bf16 v[188:191], a[28:31], v[68:71], v[188:191]
    v_mfma_f32_16x16x32_bf16 v[176:179], a[32:35], v[72:75], v[176:179]
    v_cvt_pk_bf16_f32 v225, v226, v227
    v_mfma_f32_16x16x32_bf16 v[180:183], a[36:39], v[72:75], v[180:183]
    ds_read_b128 v[44:47], v25 offset:0
    v_mfma_f32_16x16x32_bf16 v[184:187], a[40:43], v[72:75], v[184:187]
    v_mfma_f32_16x16x32_bf16 v[188:191], a[44:47], v[72:75], v[188:191]
    v_cvt_pk_bf16_f32 v226, v228, v229
    v_mfma_f32_16x16x32_bf16 v[176:179], a[48:51], v[76:79], v[176:179]
    ds_read_b128 v[48:51], v22 offset:256
    v_mfma_f32_16x16x32_bf16 v[180:183], a[52:55], v[76:79], v[180:183]
    v_cvt_pk_bf16_f32 v227, v230, v231
    v_mfma_f32_16x16x32_bf16 v[184:187], a[56:59], v[76:79], v[184:187]
    v_mfma_f32_16x16x32_bf16 v[188:191], a[60:63], v[76:79], v[188:191]
    ds_read_b128 v[52:55], v23 offset:256
    s_mov_b32 s53, 24576
    v_mfma_f32_16x16x32_bf16 v[176:179], a[64:67], v[80:83], v[176:179]
    buffer_store_dwordx4 v[224:227], v26, s[36:39], s53 offen offset:0 sc1
    v_mfma_f32_16x16x32_bf16 v[180:183], a[68:71], v[80:83], v[180:183]
    v_mfma_f32_16x16x32_bf16 v[184:187], a[72:75], v[80:83], v[184:187]
    ds_read_b128 v[56:59], v24 offset:256
    v_mfma_f32_16x16x32_bf16 v[188:191], a[76:79], v[80:83], v[188:191]
    v_cvt_pk_bf16_f32 v232, v232, v233
    v_mfma_f32_16x16x32_bf16 v[176:179], a[80:83], v[84:87], v[176:179]
    v_mfma_f32_16x16x32_bf16 v[180:183], a[84:87], v[84:87], v[180:183]
    ds_read_b128 v[60:63], v25 offset:256
    v_mfma_f32_16x16x32_bf16 v[184:187], a[88:91], v[84:87], v[184:187]
    v_cvt_pk_bf16_f32 v233, v234, v235
    v_mfma_f32_16x16x32_bf16 v[188:191], a[92:95], v[84:87], v[188:191]
    v_mfma_f32_16x16x32_bf16 v[176:179], a[96:99], v[88:91], v[176:179]
    ds_read_b128 v[64:67], v22 offset:512
    v_mfma_f32_16x16x32_bf16 v[180:183], a[100:103], v[88:91], v[180:183]
    v_cvt_pk_bf16_f32 v234, v236, v237
    v_mfma_f32_16x16x32_bf16 v[184:187], a[104:107], v[88:91], v[184:187]
    v_mfma_f32_16x16x32_bf16 v[188:191], a[108:111], v[88:91], v[188:191]
    ds_read_b128 v[68:71], v23 offset:512
    v_mfma_f32_16x16x32_bf16 v[176:179], a[112:115], v[92:95], v[176:179]
    v_cvt_pk_bf16_f32 v235, v238, v239
    v_mfma_f32_16x16x32_bf16 v[180:183], a[116:119], v[92:95], v[180:183]
    v_mfma_f32_16x16x32_bf16 v[184:187], a[120:123], v[92:95], v[184:187]
    ds_read_b128 v[72:75], v24 offset:512
    v_mfma_f32_16x16x32_bf16 v[188:191], a[124:127], v[92:95], v[188:191]
    buffer_store_dwordx4 v[232:235], v26, s[36:39], s53 offen offset:1024 sc1
    v_mfma_f32_16x16x32_bf16 v[176:179], a[128:131], v[96:99], v[176:179]
    v_mfma_f32_16x16x32_bf16 v[180:183], a[132:135], v[96:99], v[180:183]
    ds_read_b128 v[76:79], v25 offset:512
    v_cvt_pk_bf16_f32 v240, v240, v241
    v_mfma_f32_16x16x32_bf16 v[184:187], a[136:139], v[96:99], v[184:187]
    v_mfma_f32_16x16x32_bf16 v[188:191], a[140:143], v[96:99], v[188:191]
    v_mfma_f32_16x16x32_bf16 v[176:179], a[144:147], v[100:103], v[176:179]
    ds_read_b128 v[80:83], v22 offset:768
    v_cvt_pk_bf16_f32 v241, v242, v243
    v_mfma_f32_16x16x32_bf16 v[180:183], a[148:151], v[100:103], v[180:183]
    v_mfma_f32_16x16x32_bf16 v[184:187], a[152:155], v[100:103], v[184:187]
    v_mfma_f32_16x16x32_bf16 v[188:191], a[156:159], v[100:103], v[188:191]
    ds_read_b128 v[84:87], v23 offset:768
    v_cvt_pk_bf16_f32 v242, v244, v245
    v_mfma_f32_16x16x32_bf16 v[176:179], a[160:163], v[104:107], v[176:179]
    v_mfma_f32_16x16x32_bf16 v[180:183], a[164:167], v[104:107], v[180:183]
    v_mfma_f32_16x16x32_bf16 v[184:187], a[168:171], v[104:107], v[184:187]
    ds_read_b128 v[88:91], v24 offset:768
    v_cvt_pk_bf16_f32 v243, v246, v247
    v_mfma_f32_16x16x32_bf16 v[188:191], a[172:175], v[104:107], v[188:191]
    v_mfma_f32_16x16x32_bf16 v[176:179], a[176:179], v[108:111], v[176:179]
    buffer_store_dwordx4 v[240:243], v27, s[36:39], s53 offen offset:0 sc1
    v_mfma_f32_16x16x32_bf16 v[180:183], a[180:183], v[108:111], v[180:183]
    ds_read_b128 v[92:95], v25 offset:768
    v_mfma_f32_16x16x32_bf16 v[184:187], a[184:187], v[108:111], v[184:187]
    v_mfma_f32_16x16x32_bf16 v[188:191], a[188:191], v[108:111], v[188:191]
    v_mfma_f32_16x16x32_bf16 v[176:179], a[192:195], v[112:115], v[176:179]
    v_cvt_pk_bf16_f32 v248, v248, v249
    v_mfma_f32_16x16x32_bf16 v[180:183], a[196:199], v[112:115], v[180:183]
    v_mfma_f32_16x16x32_bf16 v[184:187], a[200:203], v[112:115], v[184:187]
    v_mfma_f32_16x16x32_bf16 v[188:191], a[204:207], v[112:115], v[188:191]
    v_cvt_pk_bf16_f32 v249, v250, v251
    v_mfma_f32_16x16x32_bf16 v[176:179], a[208:211], v[116:119], v[176:179]
    v_mfma_f32_16x16x32_bf16 v[180:183], a[212:215], v[116:119], v[180:183]
    v_cvt_pk_bf16_f32 v250, v252, v253
    v_mfma_f32_16x16x32_bf16 v[184:187], a[216:219], v[116:119], v[184:187]
    v_mfma_f32_16x16x32_bf16 v[188:191], a[220:223], v[116:119], v[188:191]
    v_mfma_f32_16x16x32_bf16 v[176:179], a[224:227], v[120:123], v[176:179]
    v_cvt_pk_bf16_f32 v251, v254, v255
    v_mfma_f32_16x16x32_bf16 v[180:183], a[228:231], v[120:123], v[180:183]
    v_mfma_f32_16x16x32_bf16 v[184:187], a[232:235], v[120:123], v[184:187]
    v_mfma_f32_16x16x32_bf16 v[188:191], a[236:239], v[120:123], v[188:191]
    buffer_store_dwordx4 v[248:251], v27, s[36:39], s53 offen offset:1024 sc1
    v_mfma_f32_16x16x32_bf16 v[176:179], a[240:243], v[124:127], v[176:179]
    v_mfma_f32_16x16x32_bf16 v[180:183], a[244:247], v[124:127], v[180:183]
    v_mfma_f32_16x16x32_bf16 v[184:187], a[248:251], v[124:127], v[184:187]
    v_mfma_f32_16x16x32_bf16 v[188:191], a[252:255], v[124:127], v[188:191]
    s_waitcnt lgkmcnt(0)
    v_mfma_f32_16x16x32_bf16 v[192:195], a[0:3], v[32:35], 0
    ds_read_b128 v[96:99], v22 offset:16384
    v_mfma_f32_16x16x32_bf16 v[196:199], a[4:7], v[32:35], 0
    s_lshl_b32 s100, s48, 13
    v_mfma_f32_16x16x32_bf16 v[200:203], a[8:11], v[32:35], 0
    v_mfma_f32_16x16x32_bf16 v[204:207], a[12:15], v[32:35], 0
    ds_read_b128 v[100:103], v23 offset:16384
    v_mfma_f32_16x16x32_bf16 v[192:195], a[16:19], v[36:39], v[192:195]
    v_mfma_f32_16x16x32_bf16 v[196:199], a[20:23], v[36:39], v[196:199]
    s_lshl_b32 s101, s48, 12
    v_cvt_pk_bf16_f32 v128, v128, v129
    v_mfma_f32_16x16x32_bf16 v[200:203], a[24:27], v[36:39], v[200:203]
    ds_read_b128 v[104:107], v24 offset:16384
    v_mfma_f32_16x16x32_bf16 v[204:207], a[28:31], v[36:39], v[204:207]
    v_mfma_f32_16x16x32_bf16 v[192:195], a[32:35], v[40:43], v[192:195]
    s_add_u32 s101, s101, 32768
    v_cvt_pk_bf16_f32 v129, v130, v131
    v_mfma_f32_16x16x32_bf16 v[196:199], a[36:39], v[40:43], v[196:199]
    ds_read_b128 v[108:111], v25 offset:16384
    v_mfma_f32_16x16x32_bf16 v[200:203], a[40:43], v[40:43], v[200:203]
    v_mfma_f32_16x16x32_bf16 v[204:207], a[44:47], v[40:43], v[204:207]
    s_lshl_b32 s99, s49, 8
    v_cvt_pk_bf16_f32 v130, v132, v133
    v_mfma_f32_16x16x32_bf16 v[192:195], a[48:51], v[44:47], v[192:195]
    ds_read_b128 v[112:115], v22 offset:16640
    v_mfma_f32_16x16x32_bf16 v[196:199], a[52:55], v[44:47], v[196:199]
    v_cvt_pk_bf16_f32 v131, v134, v135
    v_mfma_f32_16x16x32_bf16 v[200:203], a[56:59], v[44:47], v[200:203]
    v_mfma_f32_16x16x32_bf16 v[204:207], a[60:63], v[44:47], v[204:207]
    s_sub_u32 s98, 4194304, s99
    ds_read_b128 v[116:119], v23 offset:16640
    v_mfma_f32_16x16x32_bf16 v[192:195], a[64:67], v[48:51], v[192:195]
    s_mov_b32 s53, 32768
    v_mfma_f32_16x16x32_bf16 v[196:199], a[68:71], v[48:51], v[196:199]
    buffer_store_dwordx4 v[128:131], v26, s[36:39], s53 offen offset:0 sc1
    v_mfma_f32_16x16x32_bf16 v[200:203], a[72:75], v[48:51], v[200:203]
    s_add_u32 s44, s14, s99
    s_addc_u32 s45, s15, 0
    v_mfma_f32_16x16x32_bf16 v[204:207], a[76:79], v[48:51], v[204:207]
    ds_read_b128 v[120:123], v24 offset:16640
    v_cvt_pk_bf16_f32 v136, v136, v137
    v_mfma_f32_16x16x32_bf16 v[192:195], a[80:83], v[52:55], v[192:195]
    v_mfma_f32_16x16x32_bf16 v[196:199], a[84:87], v[52:55], v[196:199]
    ds_read_b128 v[124:127], v25 offset:16640
    v_mfma_f32_16x16x32_bf16 v[200:203], a[88:91], v[52:55], v[200:203]
    s_mov_b32 s46, s98
    v_cvt_pk_bf16_f32 v137, v138, v139
    v_mfma_f32_16x16x32_bf16 v[204:207], a[92:95], v[52:55], v[204:207]
    v_mfma_f32_16x16x32_bf16 v[192:195], a[96:99], v[56:59], v[192:195]
    ds_read_b128 v[32:35], v22 offset:16896
    v_mfma_f32_16x16x32_bf16 v[196:199], a[100:103], v[56:59], v[196:199]
    s_mov_b32 s47, 0x20000
    v_cvt_pk_bf16_f32 v138, v140, v141
    v_mfma_f32_16x16x32_bf16 v[200:203], a[104:107], v[56:59], v[200:203]
    v_mfma_f32_16x16x32_bf16 v[204:207], a[108:111], v[56:59], v[204:207]
    ds_read_b128 v[36:39], v23 offset:16896
    v_mfma_f32_16x16x32_bf16 v[192:195], a[112:115], v[60:63], v[192:195]
    s_mov_b32 s40, s10
    v_cvt_pk_bf16_f32 v139, v142, v143
    v_mfma_f32_16x16x32_bf16 v[196:199], a[116:119], v[60:63], v[196:199]
    v_mfma_f32_16x16x32_bf16 v[200:203], a[120:123], v[60:63], v[200:203]
    ds_read_b128 v[40:43], v24 offset:16896
    v_mfma_f32_16x16x32_bf16 v[204:207], a[124:127], v[60:63], v[204:207]
    buffer_store_dwordx4 v[136:139], v26, s[36:39], s53 offen offset:1024 sc1
    v_mfma_f32_16x16x32_bf16 v[192:195], a[128:131], v[64:67], v[192:195]
    s_mov_b32 s41, s11
    v_mfma_f32_16x16x32_bf16 v[196:199], a[132:135], v[64:67], v[196:199]
    ds_read_b128 v[44:47], v25 offset:16896
    v_cvt_pk_bf16_f32 v144, v144, v145
    v_mfma_f32_16x16x32_bf16 v[200:203], a[136:139], v[64:67], v[200:203]
    v_mfma_f32_16x16x32_bf16 v[204:207], a[140:143], v[64:67], v[204:207]
    s_mov_b32 s42, 2097152
    v_mfma_f32_16x16x32_bf16 v[192:195], a[144:147], v[68:71], v[192:195]
    ds_read_b128 v[48:51], v22 offset:17152
    v_cvt_pk_bf16_f32 v145, v146, v147
    v_mfma_f32_16x16x32_bf16 v[196:199], a[148:151], v[68:71], v[196:199]
    v_mfma_f32_16x16x32_bf16 v[200:203], a[152:155], v[68:71], v[200:203]
    s_mov_b32 s43, 0x20000
    v_mfma_f32_16x16x32_bf16 v[204:207], a[156:159], v[68:71], v[204:207]
    ds_read_b128 v[52:55], v23 offset:17152
    v_cvt_pk_bf16_f32 v146, v148, v149
    v_mfma_f32_16x16x32_bf16 v[192:195], a[160:163], v[72:75], v[192:195]
    v_mfma_f32_16x16x32_bf16 v[196:199], a[164:167], v[72:75], v[196:199]
    v_cvt_pk_bf16_f32 v147, v150, v151
    v_mfma_f32_16x16x32_bf16 v[200:203], a[168:171], v[72:75], v[200:203]
    s_lshl_b32 s99, s48, 15
    ds_read_b128 v[56:59], v24 offset:17152
    v_mfma_f32_16x16x32_bf16 v[204:207], a[172:175], v[72:75], v[204:207]
    v_mfma_f32_16x16x32_bf16 v[192:195], a[176:179], v[76:79], v[192:195]
    buffer_store_dwordx4 v[144:147], v27, s[36:39], s53 offen offset:0 sc1
    v_mfma_f32_16x16x32_bf16 v[196:199], a[180:183], v[76:79], v[196:199]
    s_lshl_b32 s97, s50, 17
    ds_read_b128 v[60:63], v25 offset:17152
    v_mfma_f32_16x16x32_bf16 v[200:203], a[184:187], v[76:79], v[200:203]
    v_mfma_f32_16x16x32_bf16 v[204:207], a[188:191], v[76:79], v[204:207]
    v_mfma_f32_16x16x32_bf16 v[192:195], a[192:195], v[80:83], v[192:195]
    v_cvt_pk_bf16_f32 v152, v152, v153
    v_mfma_f32_16x16x32_bf16 v[196:199], a[196:199], v[80:83], v[196:199]
    s_add_u32 s98, s97, s99
    v_mfma_f32_16x16x32_bf16 v[200:203], a[200:203], v[80:83], v[200:203]
    v_mfma_f32_16x16x32_bf16 v[204:207], a[204:207], v[80:83], v[204:207]
    v_cvt_pk_bf16_f32 v153, v154, v155
    v_mfma_f32_16x16x32_bf16 v[192:195], a[208:211], v[84:87], v[192:195]
    s_sub_u32 s97, 1966080, s97
    v_mfma_f32_16x16x32_bf16 v[196:199], a[212:215], v[84:87], v[196:199]
    v_cvt_pk_bf16_f32 v154, v156, v157
    v_mfma_f32_16x16x32_bf16 v[200:203], a[216:219], v[84:87], v[200:203]
    v_mfma_f32_16x16x32_bf16 v[204:207], a[220:223], v[84:87], v[204:207]
    s_add_u32 s97, s97, s99
    v_mfma_f32_16x16x32_bf16 v[192:195], a[224:227], v[88:91], v[192:195]
    v_cvt_pk_bf16_f32 v155, v158, v159
    v_mfma_f32_16x16x32_bf16 v[196:199], a[228:231], v[88:91], v[196:199]
    v_mfma_f32_16x16x32_bf16 v[200:203], a[232:235], v[88:91], v[200:203]
    buffer_store_dwordx4 v[152:155], v27, s[36:39], s53 offen offset:1024 sc1
    v_mfma_f32_16x16x32_bf16 v[204:207], a[236:239], v[88:91], v[204:207]
    s_lshl_b32 s99, s48, 17
    v_mfma_f32_16x16x32_bf16 v[192:195], a[240:243], v[92:95], v[192:195]
    v_add_u32 v22, 0x18000, v22
    v_mfma_f32_16x16x32_bf16 v[196:199], a[244:247], v[92:95], v[196:199]
    v_add_u32 v23, 0x18000, v23
    v_mfma_f32_16x16x32_bf16 v[200:203], a[248:251], v[92:95], v[200:203]
    v_add_u32 v24, 0x18000, v24
    v_mfma_f32_16x16x32_bf16 v[204:207], a[252:255], v[92:95], v[204:207]
    v_add_u32 v25, 0x18000, v25
    s_waitcnt vmcnt(15) lgkmcnt(0)
    s_barrier
    v_mfma_f32_16x16x32_bf16 v[208:211], a[0:3], v[96:99], 0
    ds_read_b128 v[64:67], v22 offset:0
    v_mfma_f32_16x16x32_bf16 v[212:215], a[4:7], v[96:99], 0
    s_add_u32 m0, s100, 0
    v_mfma_f32_16x16x32_bf16 v[216:219], a[8:11], v[96:99], 0
    buffer_load_dwordx4 v8, s[40:43], s97 offen offset:0 lds
    v_mfma_f32_16x16x32_bf16 v[220:223], a[12:15], v[96:99], 0
    ds_read_b128 v[68:71], v23 offset:0
    v_mfma_f32_16x16x32_bf16 v[208:211], a[16:19], v[100:103], v[208:211]
    v_mfma_f32_16x16x32_bf16 v[212:215], a[20:23], v[100:103], v[212:215]
    v_cvt_pk_bf16_f32 v160, v160, v161
    v_mfma_f32_16x16x32_bf16 v[216:219], a[24:27], v[100:103], v[216:219]
    ds_read_b128 v[72:75], v24 offset:0
    v_mfma_f32_16x16x32_bf16 v[220:223], a[28:31], v[100:103], v[220:223]
    buffer_load_dwordx4 v9, s[40:43], s97 offen offset:1024 lds
    v_mfma_f32_16x16x32_bf16 v[208:211], a[32:35], v[104:107], v[208:211]
    v_cvt_pk_bf16_f32 v161, v162, v163
    v_mfma_f32_16x16x32_bf16 v[212:215], a[36:39], v[104:107], v[212:215]
    ds_read_b128 v[76:79], v25 offset:0
    v_mfma_f32_16x16x32_bf16 v[216:219], a[40:43], v[104:107], v[216:219]
    v_mfma_f32_16x16x32_bf16 v[220:223], a[44:47], v[104:107], v[220:223]
    v_cvt_pk_bf16_f32 v162, v164, v165
    v_mfma_f32_16x16x32_bf16 v[208:211], a[48:51], v[108:111], v[208:211]
    buffer_load_dwordx4 v10, s[40:43], s97 offen offset:2048 lds
    v_mfma_f32_16x16x32_bf16 v[212:215], a[52:55], v[108:111], v[212:215]
    ds_read_b128 v[80:83], v22 offset:256
    v_cvt_pk_bf16_f32 v163, v166, v167
    v_mfma_f32_16x16x32_bf16 v[216:219], a[56:59], v[108:111], v[216:219]
    v_mfma_f32_16x16x32_bf16 v[220:223], a[60:63], v[108:111], v[220:223]
    ds_read_b128 v[84:87], v23 offset:256
    s_mov_b32 s53, 40960
    v_mfma_f32_16x16x32_bf16 v[208:211], a[64:67], v[112:115], v[208:211]
    buffer_store_dwordx4 v[160:163], v26, s[36:39], s53 offen offset:0 sc1
    v_mfma_f32_16x16x32_bf16 v[212:215], a[68:71], v[112:115], v[212:215]
    buffer_load_dwordx4 v11, s[40:43], s97 offen offset:3072 lds
    v_mfma_f32_16x16x32_bf16 v[216:219], a[72:75], v[112:115], v[216:219]
    s_add_u32 s97, s97, 128
    ds_read_b128 v[88:91], v24 offset:256
    v_mfma_f32_16x16x32_bf16 v[220:223], a[76:79], v[112:115], v[220:223]
    v_cvt_pk_bf16_f32 v168, v168, v169
    v_mfma_f32_16x16x32_bf16 v[208:211], a[80:83], v[116:119], v[208:211]
    v_mfma_f32_16x16x32_bf16 v[212:215], a[84:87], v[116:119], v[212:215]
    s_add_u32 m0, s100, 4096
    ds_read_b128 v[92:95], v25 offset:256
    v_mfma_f32_16x16x32_bf16 v[216:219], a[88:91], v[116:119], v[216:219]
    buffer_load_dwordx4 v8, s[40:43], s98 offen offset:0 lds
    v_mfma_f32_16x16x32_bf16 v[220:223], a[92:95], v[116:119], v[220:223]
    v_cvt_pk_bf16_f32 v169, v170, v171
    v_mfma_f32_16x16x32_bf16 v[208:211], a[96:99], v[120:123], v[208:211]
    ds_read_b128 v[96:99], v22 offset:512
    v_mfma_f32_16x16x32_bf16 v[212:215], a[100:103], v[120:123], v[212:215]
    v_cvt_pk_bf16_f32 v170, v172, v173
    v_mfma_f32_16x16x32_bf16 v[216:219], a[104:107], v[120:123], v[216:219]
    v_mfma_f32_16x16x32_bf16 v[220:223], a[108:111], v[120:123], v[220:223]
    buffer_load_dwordx4 v9, s[40:43], s98 offen offset:1024 lds
    v_mfma_f32_16x16x32_bf16 v[208:211], a[112:115], v[124:127], v[208:211]
    ds_read_b128 v[100:103], v23 offset:512
    v_cvt_pk_bf16_f32 v171, v174, v175
    v_mfma_f32_16x16x32_bf16 v[212:215], a[116:119], v[124:127], v[212:215]
    v_mfma_f32_16x16x32_bf16 v[216:219], a[120:123], v[124:127], v[216:219]
    ds_read_b128 v[104:107], v24 offset:512
    v_mfma_f32_16x16x32_bf16 v[220:223], a[124:127], v[124:127], v[220:223]
    buffer_store_dwordx4 v[168:171], v26, s[36:39], s53 offen offset:1024 sc1
    v_mfma_f32_16x16x32_bf16 v[208:211], a[128:131], v[32:35], v[208:211]
    v_cvt_pk_bf16_f32 v176, v176, v177
    v_mfma_f32_16x16x32_bf16 v[212:215], a[132:135], v[32:35], v[212:215]
    buffer_load_dwordx4 v10, s[40:43], s98 offen offset:2048 lds
    v_mfma_f32_16x16x32_bf16 v[216:219], a[136:139], v[32:35], v[216:219]
    ds_read_b128 v[108:111], v25 offset:512
    v_mfma_f32_16x16x32_bf16 v[220:223], a[140:143], v[32:35], v[220:223]
    v_mfma_f32_16x16x32_bf16 v[208:211], a[144:147], v[36:39], v[208:211]
    ds_read_b128 v[112:115], v22 offset:768
    v_cvt_pk_bf16_f32 v177, v178, v179
    v_mfma_f32_16x16x32_bf16 v[212:215], a[148:151], v[36:39], v[212:215]
    v_mfma_f32_16x16x32_bf16 v[216:219], a[152:155], v[36:39], v[216:219]
    buffer_load_dwordx4 v11, s[40:43], s98 offen offset:3072 lds
    v_mfma_f32_16x16x32_bf16 v[220:223], a[156:159], v[36:39], v[220:223]
    s_add_u32 s98, s98, 128
    ds_read_b128 v[116:119], v23 offset:768
    v_mfma_f32_16x16x32_bf16 v[208:211], a[160:163], v[40:43], v[208:211]
    v_cvt_pk_bf16_f32 v178, v180, v181
    v_mfma_f32_16x16x32_bf16 v[212:215], a[164:167], v[40:43], v[212:215]
    v_cvt_pk_bf16_f32 v179, v182, v183
    v_mfma_f32_16x16x32_bf16 v[216:219], a[168:171], v[40:43], v[216:219]
    s_add_u32 m0, s101, 0
    ds_read_b128 v[120:123], v24 offset:768
    v_mfma_f32_16x16x32_bf16 v[220:223], a[172:175], v[40:43], v[220:223]
    buffer_load_dwordx4 v12, s[44:47], s99 offen offset:0 nt lds
    v_mfma_f32_16x16x32_bf16 v[208:211], a[176:179], v[44:47], v[208:211]
    buffer_store_dwordx4 v[176:179], v27, s[36:39], s53 offen offset:0 sc1
    v_mfma_f32_16x16x32_bf16 v[212:215], a[180:183], v[44:47], v[212:215]
    ds_read_b128 v[124:127], v25 offset:768
    v_mfma_f32_16x16x32_bf16 v[216:219], a[184:187], v[44:47], v[216:219]
    v_mfma_f32_16x16x32_bf16 v[220:223], a[188:191], v[44:47], v[220:223]
    v_cvt_pk_bf16_f32 v184, v184, v185
    v_mfma_f32_16x16x32_bf16 v[208:211], a[192:195], v[48:51], v[208:211]
    buffer_load_dwordx4 v13, s[44:47], s99 offen offset:1024 nt lds
    v_mfma_f32_16x16x32_bf16 v[212:215], a[196:199], v[48:51], v[212:215]
    v_mfma_f32_16x16x32_bf16 v[216:219], a[200:203], v[48:51], v[216:219]
    v_mfma_f32_16x16x32_bf16 v[220:223], a[204:207], v[48:51], v[220:223]
    v_cvt_pk_bf16_f32 v185, v186, v187
    v_mfma_f32_16x16x32_bf16 v[208:211], a[208:211], v[52:55], v[208:211]
    v_cvt_pk_bf16_f32 v186, v188, v189
    v_mfma_f32_16x16x32_bf16 v[212:215], a[212:215], v[52:55], v[212:215]
    buffer_load_dwordx4 v14, s[44:47], s99 offen offset:2048 nt lds
    v_mfma_f32_16x16x32_bf16 v[216:219], a[216:219], v[52:55], v[216:219]
    v_mfma_f32_16x16x32_bf16 v[220:223], a[220:223], v[52:55], v[220:223]
    v_mfma_f32_16x16x32_bf16 v[208:211], a[224:227], v[56:59], v[208:211]
    v_cvt_pk_bf16_f32 v187, v190, v191
    v_mfma_f32_16x16x32_bf16 v[212:215], a[228:231], v[56:59], v[212:215]
    v_mfma_f32_16x16x32_bf16 v[216:219], a[232:235], v[56:59], v[216:219]
    buffer_load_dwordx4 v15, s[44:47], s99 offen offset:3072 nt lds
    v_mfma_f32_16x16x32_bf16 v[220:223], a[236:239], v[56:59], v[220:223]
    s_add_u32 s99, s99, 524288
    v_mfma_f32_16x16x32_bf16 v[208:211], a[240:243], v[60:63], v[208:211]
    buffer_store_dwordx4 v[184:187], v27, s[36:39], s53 offen offset:1024 sc1
    v_mfma_f32_16x16x32_bf16 v[212:215], a[244:247], v[60:63], v[212:215]
    v_mfma_f32_16x16x32_bf16 v[216:219], a[248:251], v[60:63], v[216:219]
    v_mfma_f32_16x16x32_bf16 v[220:223], a[252:255], v[60:63], v[220:223]
    s_waitcnt lgkmcnt(0)
    v_mfma_f32_16x16x32_bf16 v[224:227], a[0:3], v[64:67], 0
    ds_read_b128 v[32:35], v22 offset:16384
    v_mfma_f32_16x16x32_bf16 v[228:231], a[4:7], v[64:67], 0
    s_add_u32 m0, s100, 49152
    v_mfma_f32_16x16x32_bf16 v[232:235], a[8:11], v[64:67], 0
    buffer_load_dwordx4 v8, s[40:43], s97 offen offset:0 lds
    v_mfma_f32_16x16x32_bf16 v[236:239], a[12:15], v[64:67], 0
    ds_read_b128 v[36:39], v23 offset:16384
    v_mfma_f32_16x16x32_bf16 v[224:227], a[16:19], v[68:71], v[224:227]
    v_mfma_f32_16x16x32_bf16 v[228:231], a[20:23], v[68:71], v[228:231]
    v_mfma_f32_16x16x32_bf16 v[232:235], a[24:27], v[68:71], v[232:235]
    ds_read_b128 v[40:43], v24 offset:16384
    v_mfma_f32_16x16x32_bf16 v[236:239], a[28:31], v[68:71], v[236:239]
    buffer_load_dwordx4 v9, s[40:43], s97 offen offset:1024 lds
    v_mfma_f32_16x16x32_bf16 v[224:227], a[32:35], v[72:75], v[224:227]
    v_mfma_f32_16x16x32_bf16 v[228:231], a[36:39], v[72:75], v[228:231]
    ds_read_b128 v[44:47], v25 offset:16384
    v_mfma_f32_16x16x32_bf16 v[232:235], a[40:43], v[72:75], v[232:235]
    v_mfma_f32_16x16x32_bf16 v[236:239], a[44:47], v[72:75], v[236:239]
    v_mfma_f32_16x16x32_bf16 v[224:227], a[48:51], v[76:79], v[224:227]
    buffer_load_dwordx4 v10, s[40:43], s97 offen offset:2048 lds
    v_mfma_f32_16x16x32_bf16 v[228:231], a[52:55], v[76:79], v[228:231]
    ds_read_b128 v[48:51], v22 offset:16640
    v_mfma_f32_16x16x32_bf16 v[232:235], a[56:59], v[76:79], v[232:235]
    v_mfma_f32_16x16x32_bf16 v[236:239], a[60:63], v[76:79], v[236:239]
    ds_read_b128 v[52:55], v23 offset:16640
    v_mfma_f32_16x16x32_bf16 v[224:227], a[64:67], v[80:83], v[224:227]
    v_mfma_f32_16x16x32_bf16 v[228:231], a[68:71], v[80:83], v[228:231]
    buffer_load_dwordx4 v11, s[40:43], s97 offen offset:3072 lds
    v_mfma_f32_16x16x32_bf16 v[232:235], a[72:75], v[80:83], v[232:235]
    s_add_u32 s97, s97, 128
    ds_read_b128 v[56:59], v24 offset:16640
    v_mfma_f32_16x16x32_bf16 v[236:239], a[76:79], v[80:83], v[236:239]
    v_mfma_f32_16x16x32_bf16 v[224:227], a[80:83], v[84:87], v[224:227]
    v_mfma_f32_16x16x32_bf16 v[228:231], a[84:87], v[84:87], v[228:231]
    s_add_u32 m0, s100, 53248
    ds_read_b128 v[60:63], v25 offset:16640
    v_mfma_f32_16x16x32_bf16 v[232:235], a[88:91], v[84:87], v[232:235]
    buffer_load_dwordx4 v8, s[40:43], s98 offen offset:0 lds
    v_mfma_f32_16x16x32_bf16 v[236:239], a[92:95], v[84:87], v[236:239]
    v_mfma_f32_16x16x32_bf16 v[224:227], a[96:99], v[88:91], v[224:227]
    ds_read_b128 v[64:67], v22 offset:16896
    v_mfma_f32_16x16x32_bf16 v[228:231], a[100:103], v[88:91], v[228:231]
    v_mfma_f32_16x16x32_bf16 v[232:235], a[104:107], v[88:91], v[232:235]
    v_mfma_f32_16x16x32_bf16 v[236:239], a[108:111], v[88:91], v[236:239]
    buffer_load_dwordx4 v9, s[40:43], s98 offen offset:1024 lds
    v_mfma_f32_16x16x32_bf16 v[224:227], a[112:115], v[92:95], v[224:227]
    ds_read_b128 v[68:71], v23 offset:16896
    v_mfma_f32_16x16x32_bf16 v[228:231], a[116:119], v[92:95], v[228:231]
    v_mfma_f32_16x16x32_bf16 v[232:235], a[120:123], v[92:95], v[232:235]
    ds_read_b128 v[72:75], v24 offset:16896
    v_mfma_f32_16x16x32_bf16 v[236:239], a[124:127], v[92:95], v[236:239]
    v_mfma_f32_16x16x32_bf16 v[224:227], a[128:131], v[96:99], v[224:227]
    v_mfma_f32_16x16x32_bf16 v[228:231], a[132:135], v[96:99], v[228:231]
    buffer_load_dwordx4 v10, s[40:43], s98 offen offset:2048 lds
    v_mfma_f32_16x16x32_bf16 v[232:235], a[136:139], v[96:99], v[232:235]
    ds_read_b128 v[76:79], v25 offset:16896
    v_mfma_f32_16x16x32_bf16 v[236:239], a[140:143], v[96:99], v[236:239]
    v_mfma_f32_16x16x32_bf16 v[224:227], a[144:147], v[100:103], v[224:227]
    ds_read_b128 v[80:83], v22 offset:17152
    v_mfma_f32_16x16x32_bf16 v[228:231], a[148:151], v[100:103], v[228:231]
    v_mfma_f32_16x16x32_bf16 v[232:235], a[152:155], v[100:103], v[232:235]
    buffer_load_dwordx4 v11, s[40:43], s98 offen offset:3072 lds
    v_mfma_f32_16x16x32_bf16 v[236:239], a[156:159], v[100:103], v[236:239]
    s_add_u32 s98, s98, 128
    ds_read_b128 v[84:87], v23 offset:17152
    v_mfma_f32_16x16x32_bf16 v[224:227], a[160:163], v[104:107], v[224:227]
    v_mfma_f32_16x16x32_bf16 v[228:231], a[164:167], v[104:107], v[228:231]
    v_mfma_f32_16x16x32_bf16 v[232:235], a[168:171], v[104:107], v[232:235]
    s_add_u32 m0, s101, 49152
    ds_read_b128 v[88:91], v24 offset:17152
    v_mfma_f32_16x16x32_bf16 v[236:239], a[172:175], v[104:107], v[236:239]
    buffer_load_dwordx4 v12, s[44:47], s99 offen offset:0 nt lds
    v_mfma_f32_16x16x32_bf16 v[224:227], a[176:179], v[108:111], v[224:227]
    v_mfma_f32_16x16x32_bf16 v[228:231], a[180:183], v[108:111], v[228:231]
    ds_read_b128 v[92:95], v25 offset:17152
    v_mfma_f32_16x16x32_bf16 v[232:235], a[184:187], v[108:111], v[232:235]
    v_mfma_f32_16x16x32_bf16 v[236:239], a[188:191], v[108:111], v[236:239]
    v_mfma_f32_16x16x32_bf16 v[224:227], a[192:195], v[112:115], v[224:227]
    buffer_load_dwordx4 v13, s[44:47], s99 offen offset:1024 nt lds
    v_mfma_f32_16x16x32_bf16 v[228:231], a[196:199], v[112:115], v[228:231]
    v_mfma_f32_16x16x32_bf16 v[232:235], a[200:203], v[112:115], v[232:235]
    v_mfma_f32_16x16x32_bf16 v[236:239], a[204:207], v[112:115], v[236:239]
    v_mfma_f32_16x16x32_bf16 v[224:227], a[208:211], v[116:119], v[224:227]
    v_mfma_f32_16x16x32_bf16 v[228:231], a[212:215], v[116:119], v[228:231]
    buffer_load_dwordx4 v14, s[44:47], s99 offen offset:2048 nt lds
    v_mfma_f32_16x16x32_bf16 v[232:235], a[216:219], v[116:119], v[232:235]
    v_mfma_f32_16x16x32_bf16 v[236:239], a[220:223], v[116:119], v[236:239]
    v_mfma_f32_16x16x32_bf16 v[224:227], a[224:227], v[120:123], v[224:227]
    v_mfma_f32_16x16x32_bf16 v[228:231], a[228:231], v[120:123], v[228:231]
    v_mfma_f32_16x16x32_bf16 v[232:235], a[232:235], v[120:123], v[232:235]
    buffer_load_dwordx4 v15, s[44:47], s99 offen offset:3072 nt lds
    v_mfma_f32_16x16x32_bf16 v[236:239], a[236:239], v[120:123], v[236:239]
    s_add_u32 s99, s99, 524288
    v_mfma_f32_16x16x32_bf16 v[224:227], a[240:243], v[124:127], v[224:227]
    v_mfma_f32_16x16x32_bf16 v[228:231], a[244:247], v[124:127], v[228:231]
    v_mfma_f32_16x16x32_bf16 v[232:235], a[248:251], v[124:127], v[232:235]
    v_mfma_f32_16x16x32_bf16 v[236:239], a[252:255], v[124:127], v[236:239]
    s_waitcnt vmcnt(13) lgkmcnt(0)
    s_barrier
    v_mfma_f32_16x16x32_bf16 v[240:243], a[0:3], v[32:35], 0
    v_and_b32 v5, 7, v1
    v_cvt_pk_bf16_f32 v96, v192, v193
    v_mfma_f32_16x16x32_bf16 v[244:247], a[4:7], v[32:35], 0
    s_add_u32 m0, s100, 98304
    v_xor_b32 v5, v5, v3
    v_mfma_f32_16x16x32_bf16 v[248:251], a[8:11], v[32:35], 0
    buffer_load_dwordx4 v8, s[40:43], s97 offen offset:0 lds
    v_mfma_f32_16x16x32_bf16 v[252:255], a[12:15], v[32:35], 0
    v_lshlrev_b32 v5, 4, v5
    v_cvt_pk_bf16_f32 v97, v194, v195
    v_mfma_f32_16x16x32_bf16 v[240:243], a[16:19], v[36:39], v[240:243]
    v_lshl_add_u32 v5, v4, 7, v5
    v_mfma_f32_16x16x32_bf16 v[244:247], a[20:23], v[36:39], v[244:247]
    v_cvt_pk_bf16_f32 v98, v196, v197
    v_mfma_f32_16x16x32_bf16 v[248:251], a[24:27], v[36:39], v[248:251]
    v_add_u32 v16, s100, v5
    v_xor_b32 v17, 64, v16
    v_mfma_f32_16x16x32_bf16 v[252:255], a[28:31], v[36:39], v[252:255]
    buffer_load_dwordx4 v9, s[40:43], s97 offen offset:1024 lds
    v_mfma_f32_16x16x32_bf16 v[240:243], a[32:35], v[40:43], v[240:243]
    v_cvt_pk_bf16_f32 v99, v198, v199
    v_mfma_f32_16x16x32_bf16 v[244:247], a[36:39], v[40:43], v[244:247]
    v_lshrrev_b32 v5, 2, v4
    v_mfma_f32_16x16x32_bf16 v[248:251], a[40:43], v[40:43], v[248:251]
    v_lshl_add_u32 v6, v3, 3, v5
    v_mfma_f32_16x16x32_bf16 v[252:255], a[44:47], v[40:43], v[252:255]
    v_lshlrev_b32 v6, 8, v6
    v_cvt_pk_bf16_f32 v100, v200, v201
    v_mfma_f32_16x16x32_bf16 v[240:243], a[48:51], v[44:47], v[240:243]
    buffer_load_dwordx4 v10, s[40:43], s97 offen offset:2048 lds
    v_mfma_f32_16x16x32_bf16 v[244:247], a[52:55], v[44:47], v[244:247]
    v_and_b32 v7, 1, v3
    v_mfma_f32_16x16x32_bf16 v[248:251], a[56:59], v[44:47], v[248:251]
    v_lshl_add_u32 v5, v7, 2, v5
    v_cvt_pk_bf16_f32 v101, v202, v203
    v_mfma_f32_16x16x32_bf16 v[252:255], a[60:63], v[44:47], v[252:255]
    v_cvt_pk_bf16_f32 v102, v204, v205
    v_mfma_f32_16x16x32_bf16 v[240:243], a[64:67], v[48:51], v[240:243]
    v_lshl_add_u32 v6, v5, 5, v6
    v_and_b32 v7, 3, v4
    v_mfma_f32_16x16x32_bf16 v[244:247], a[68:71], v[48:51], v[244:247]
    buffer_load_dwordx4 v11, s[40:43], s97 offen offset:3072 lds
    v_mfma_f32_16x16x32_bf16 v[248:251], a[72:75], v[48:51], v[248:251]
    s_add_u32 s97, s97, 128
    v_mfma_f32_16x16x32_bf16 v[252:255], a[76:79], v[48:51], v[252:255]
    v_lshl_add_u32 v6, v7, 3, v6
    v_cvt_pk_bf16_f32 v103, v206, v207
    v_mfma_f32_16x16x32_bf16 v[240:243], a[80:83], v[52:55], v[240:243]
    v_add_u32 v18, 0x8000, v6
    v_cvt_pk_bf16_f32 v104, v208, v209
    v_mfma_f32_16x16x32_bf16 v[244:247], a[84:87], v[52:55], v[244:247]
    s_add_u32 m0, s100, 102400
    v_xor_b32 v19, 32, v18
    v_mfma_f32_16x16x32_bf16 v[248:251], a[88:91], v[52:55], v[248:251]
    buffer_load_dwordx4 v8, s[40:43], s98 offen offset:0 lds
    v_mfma_f32_16x16x32_bf16 v[252:255], a[92:95], v[52:55], v[252:255]
    v_xor_b32 v20, 64, v18
    v_mfma_f32_16x16x32_bf16 v[240:243], a[96:99], v[56:59], v[240:243]
    v_xor_b32 v21, 96, v18
    v_cvt_pk_bf16_f32 v105, v210, v211
    v_mfma_f32_16x16x32_bf16 v[244:247], a[100:103], v[56:59], v[244:247]
    v_cvt_pk_bf16_f32 v106, v212, v213
    v_mfma_f32_16x16x32_bf16 v[248:251], a[104:107], v[56:59], v[248:251]
    v_xor_b32 v22, 128, v18
    v_xor_b32 v23, 160, v18
    v_mfma_f32_16x16x32_bf16 v[252:255], a[108:111], v[56:59], v[252:255]
    buffer_load_dwordx4 v9, s[40:43], s98 offen offset:1024 lds
    v_mfma_f32_16x16x32_bf16 v[240:243], a[112:115], v[60:63], v[240:243]
    v_xor_b32 v24, 192, v18
    v_mfma_f32_16x16x32_bf16 v[244:247], a[116:119], v[60:63], v[244:247]
    v_cvt_pk_bf16_f32 v107, v214, v215
    v_mfma_f32_16x16x32_bf16 v[248:251], a[120:123], v[60:63], v[248:251]
    v_xor_b32 v25, 224, v18
    v_mfma_f32_16x16x32_bf16 v[252:255], a[124:127], v[60:63], v[252:255]
    v_mfma_f32_16x16x32_bf16 v[240:243], a[128:131], v[64:67], v[240:243]
    v_cvt_pk_bf16_f32 v108, v216, v217
    v_mfma_f32_16x16x32_bf16 v[244:247], a[132:135], v[64:67], v[244:247]
    buffer_load_dwordx4 v10, s[40:43], s98 offen offset:2048 lds
    v_mfma_f32_16x16x32_bf16 v[248:251], a[136:139], v[64:67], v[248:251]
    ds_read_b128 a[32:35], v16 offset:0
    v_cvt_pk_bf16_f32 v109, v218, v219
    v_mfma_f32_16x16x32_bf16 v[252:255], a[140:143], v[64:67], v[252:255]
    ds_read_b64_tr_b16 a[48:49], v18 offset:0
    ds_read_b64_tr_b16 a[50:51], v18 offset:1024
    v_mfma_f32_16x16x32_bf16 v[240:243], a[144:147], v[68:71], v[240:243]
    ds_read_b128 a[80:83], v17 offset:0
    v_cvt_pk_bf16_f32 v110, v220, v221
    v_mfma_f32_16x16x32_bf16 v[244:247], a[148:151], v[68:71], v[244:247]
    ds_read_b64_tr_b16 a[96:97], v18 offset:8192
    ds_read_b64_tr_b16 a[98:99], v18 offset:9216
    v_mfma_f32_16x16x32_bf16 v[248:251], a[152:155], v[68:71], v[248:251]
    buffer_load_dwordx4 v11, s[40:43], s98 offen offset:3072 lds
    v_mfma_f32_16x16x32_bf16 v[252:255], a[156:159], v[68:71], v[252:255]
    s_add_u32 s98, s98, 128
    ds_read_b128 a[36:39], v16 offset:2048
    v_cvt_pk_bf16_f32 v111, v222, v223
    v_mfma_f32_16x16x32_bf16 v[240:243], a[160:163], v[72:75], v[240:243]
    ds_read_b64_tr_b16 a[52:53], v19 offset:0
    ds_read_b64_tr_b16 a[54:55], v19 offset:1024
    v_mfma_f32_16x16x32_bf16 v[244:247], a[164:167], v[72:75], v[244:247]
    ds_read_b128 a[84:87], v17 offset:2048
    ds_read_b64_tr_b16 a[100:101], v19 offset:8192
    v_mfma_f32_16x16x32_bf16 v[248:251], a[168:171], v[72:75], v[248:251]
    s_add_u32 m0, s101, 98304
    ds_read_b64_tr_b16 a[102:103], v19 offset:9216
    v_mfma_f32_16x16x32_bf16 v[252:255], a[172:175], v[72:75], v[252:255]
    buffer_load_dwordx4 v12, s[44:47], s99 offen offset:0 nt lds
    v_mfma_f32_16x16x32_bf16 v[240:243], a[176:179], v[76:79], v[240:243]
    ds_read_b128 a[40:43], v16 offset:4096
    ds_read_b64_tr_b16 a[56:57], v20 offset:0
    v_mfma_f32_16x16x32_bf16 v[244:247], a[180:183], v[76:79], v[244:247]
    ds_read_b64_tr_b16 a[58:59], v20 offset:1024
    ds_read_b128 a[88:91], v17 offset:4096
    v_mfma_f32_16x16x32_bf16 v[248:251], a[184:187], v[76:79], v[248:251]
    ds_read_b64_tr_b16 a[104:105], v20 offset:8192
    v_mfma_f32_16x16x32_bf16 v[252:255], a[188:191], v[76:79], v[252:255]
    ds_read_b64_tr_b16 a[106:107], v20 offset:9216
    ds_read_b128 a[44:47], v16 offset:6144
    v_mfma_f32_16x16x32_bf16 v[240:243], a[192:195], v[80:83], v[240:243]
    buffer_load_dwordx4 v13, s[44:47], s99 offen offset:1024 nt lds
    v_mfma_f32_16x16x32_bf16 v[244:247], a[196:199], v[80:83], v[244:247]
    ds_read_b64_tr_b16 a[60:61], v21 offset:0
    ds_read_b64_tr_b16 a[62:63], v21 offset:1024
    v_mfma_f32_16x16x32_bf16 v[248:251], a[200:203], v[80:83], v[248:251]
    ds_read_b128 a[92:95], v17 offset:6144
    ds_read_b64_tr_b16 a[108:109], v21 offset:8192
    v_mfma_f32_16x16x32_bf16 v[252:255], a[204:207], v[80:83], v[252:255]
    ds_read_b64_tr_b16 a[110:111], v21 offset:9216
    v_mfma_f32_16x16x32_bf16 v[240:243], a[208:211], v[84:87], v[240:243]
    ds_read_b64_tr_b16 a[64:65], v22 offset:0
    ds_read_b64_tr_b16 a[66:67], v22 offset:1024
    v_mfma_f32_16x16x32_bf16 v[244:247], a[212:215], v[84:87], v[244:247]
    buffer_load_dwordx4 v14, s[44:47], s99 offen offset:2048 nt lds
    v_mfma_f32_16x16x32_bf16 v[248:251], a[216:219], v[84:87], v[248:251]
    ds_read_b64_tr_b16 a[112:113], v22 offset:8192
    ds_read_b64_tr_b16 a[114:115], v22 offset:9216
    v_mfma_f32_16x16x32_bf16 v[252:255], a[220:223], v[84:87], v[252:255]
    ds_read_b64_tr_b16 a[68:69], v23 offset:0
    v_mfma_f32_16x16x32_bf16 v[240:243], a[224:227], v[88:91], v[240:243]
    ds_read_b64_tr_b16 a[70:71], v23 offset:1024
    ds_read_b64_tr_b16 a[116:117], v23 offset:8192
    v_mfma_f32_16x16x32_bf16 v[244:247], a[228:231], v[88:91], v[244:247]
    ds_read_b64_tr_b16 a[118:119], v23 offset:9216
    ds_read_b64_tr_b16 a[72:73], v24 offset:0
    v_mfma_f32_16x16x32_bf16 v[248:251], a[232:235], v[88:91], v[248:251]
    buffer_load_dwordx4 v15, s[44:47], s99 offen offset:3072 nt lds
    v_mfma_f32_16x16x32_bf16 v[252:255], a[236:239], v[88:91], v[252:255]
    s_add_u32 s99, s99, 524288
    ds_read_b64_tr_b16 a[74:75], v24 offset:1024
    v_mfma_f32_16x16x32_bf16 v[240:243], a[240:243], v[92:95], v[240:243]
    ds_read_b64_tr_b16 a[120:121], v24 offset:8192
    ds_read_b64_tr_b16 a[122:123], v24 offset:9216
    v_mfma_f32_16x16x32_bf16 v[244:247], a[244:247], v[92:95], v[244:247]
    ds_read_b64_tr_b16 a[76:77], v25 offset:0
    v_mfma_f32_16x16x32_bf16 v[248:251], a[248:251], v[92:95], v[248:251]
    ds_read_b64_tr_b16 a[78:79], v25 offset:1024
    ds_read_b64_tr_b16 a[124:125], v25 offset:8192
    v_mfma_f32_16x16x32_bf16 v[252:255], a[252:255], v[92:95], v[252:255]
    ds_read_b64_tr_b16 a[126:127], v25 offset:9216
    s_nop 3
    v_cvt_pk_bf16_f32 v112, v224, v225
    v_cvt_pk_bf16_f32 v113, v226, v227
    v_cvt_pk_bf16_f32 v114, v228, v229
    v_cvt_pk_bf16_f32 v115, v230, v231
    v_cvt_pk_bf16_f32 v116, v232, v233
    v_cvt_pk_bf16_f32 v117, v234, v235
    v_cvt_pk_bf16_f32 v118, v236, v237
    v_cvt_pk_bf16_f32 v119, v238, v239
    v_cvt_pk_bf16_f32 v120, v240, v241
    v_cvt_pk_bf16_f32 v121, v242, v243
    v_cvt_pk_bf16_f32 v122, v244, v245
    v_cvt_pk_bf16_f32 v123, v246, v247
    v_cvt_pk_bf16_f32 v124, v248, v249
    v_cvt_pk_bf16_f32 v125, v250, v251
    v_cvt_pk_bf16_f32 v126, v252, v253
    v_cvt_pk_bf16_f32 v127, v254, v255
    s_branch L_join
L_vpath:
    s_waitcnt lgkmcnt(0)
    v_mfma_f32_16x16x32_bf16 v[128:131], v[32:35], a[0:3], 0
    s_add_u32 m0, s96, 98304
    s_add_u32 s51, s55, 1048576
    v_mfma_f32_16x16x32_bf16 v[128:131], v[36:39], a[16:19], v[128:131]
    buffer_load_dwordx4 v12, s[32:35], s51 offen offset:0 nt lds
    v_mfma_f32_16x16x32_bf16 v[132:135], v[32:35], a[4:7], 0
    v_mfma_f32_16x16x32_bf16 v[132:135], v[36:39], a[20:23], v[132:135]
    buffer_load_dwordx4 v13, s[32:35], s51 offen offset:1024 nt lds
    v_mfma_f32_16x16x32_bf16 v[136:139], v[32:35], a[8:11], 0
    v_mfma_f32_16x16x32_bf16 v[136:139], v[36:39], a[24:27], v[136:139]
    buffer_load_dwordx4 v14, s[32:35], s51 offen offset:2048 nt lds
    v_mfma_f32_16x16x32_bf16 v[140:143], v[32:35], a[12:15], 0
    v_mfma_f32_16x16x32_bf16 v[140:143], v[36:39], a[28:31], v[140:143]
    buffer_load_dwordx4 v15, s[32:35], s51 offen offset:3072 nt lds
    v_mfma_f32_16x16x32_bf16 v[144:147], v[40:43], a[0:3], 0
    s_add_u32 m0, s96, 102400
    s_add_u32 s51, s55, 1179648
    v_mfma_f32_16x16x32_bf16 v[144:147], v[44:47], a[16:19], v[144:147]
    buffer_load_dwordx4 v12, s[32:35], s51 offen offset:0 nt lds
    v_mfma_f32_16x16x32_bf16 v[148:151], v[40:43], a[4:7], 0
    v_mfma_f32_16x16x32_bf16 v[148:151], v[44:47], a[20:23], v[148:151]
    buffer_load_dwordx4 v13, s[32:35], s51 offen offset:1024 nt lds
    v_mfma_f32_16x16x32_bf16 v[152:155], v[40:43], a[8:11], 0
    v_mfma_f32_16x16x32_bf16 v[152:155], v[44:47], a[24:27], v[152:155]
    buffer_load_dwordx4 v14, s[32:35], s51 offen offset:2048 nt lds
    v_mfma_f32_16x16x32_bf16 v[156:159], v[40:43], a[12:15], 0
    v_mfma_f32_16x16x32_bf16 v[156:159], v[44:47], a[28:31], v[156:159]
    buffer_load_dwordx4 v15, s[32:35], s51 offen offset:3072 nt lds
    v_mfma_f32_16x16x32_bf16 v[160:163], v[48:51], a[0:3], 0
    s_lshr_b32 m0, s96, 1
    s_add_u32 m0, m0, 131072
    s_add_u32 s51, s54, 256
    v_mfma_f32_16x16x32_bf16 v[160:163], v[52:55], a[16:19], v[160:163]
    buffer_load_dwordx4 v8, s[28:31], s51 offen offset:0 lds
    v_mfma_f32_16x16x32_bf16 v[164:167], v[48:51], a[4:7], 0
    v_mfma_f32_16x16x32_bf16 v[164:167], v[52:55], a[20:23], v[164:167]
    buffer_load_dwordx4 v9, s[28:31], s51 offen offset:1024 lds
    v_mfma_f32_16x16x32_bf16 v[168:171], v[48:51], a[8:11], 0
    v_mfma_f32_16x16x32_bf16 v[168:171], v[52:55], a[24:27], v[168:171]
    buffer_load_dwordx4 v10, s[28:31], s51 offen offset:2048 lds
    v_mfma_f32_16x16x32_bf16 v[172:175], v[48:51], a[12:15], 0
    v_mfma_f32_16x16x32_bf16 v[172:175], v[52:55], a[28:31], v[172:175]
    buffer_load_dwordx4 v11, s[28:31], s51 offen offset:3072 lds
    s_waitcnt vmcnt(12) lgkmcnt(0)
    s_barrier
    v_mfma_f32_16x16x32_bf16 v[176:179], v[56:59], a[0:3], 0
    s_add_u32 m0, s96, 0
    s_add_u32 s51, s55, 1572864
    ds_read_b64_tr_b16 a[32:33], v18 offset:0
    v_mfma_f32_16x16x32_bf16 v[176:179], v[60:63], a[16:19], v[176:179]
    buffer_load_dwordx4 v12, s[32:35], s51 offen offset:0 nt lds
    v_mfma_f32_16x16x32_bf16 v[180:183], v[56:59], a[4:7], 0
    ds_read_b128 v[96:99], v16 offset:0
    ds_read_b128 v[100:103], v17 offset:0
    v_mfma_f32_16x16x32_bf16 v[180:183], v[60:63], a[20:23], v[180:183]
    ds_read_b64_tr_b16 a[34:35], v18 offset:1024
    ds_read_b64_tr_b16 a[48:49], v18 offset:8192
    v_mfma_f32_16x16x32_bf16 v[184:187], v[56:59], a[8:11], 0
    buffer_load_dwordx4 v13, s[32:35], s51 offen offset:1024 nt lds
    v_mfma_f32_16x16x32_bf16 v[184:187], v[60:63], a[24:27], v[184:187]
    ds_read_b128 v[104:107], v16 offset:2048
    v_mfma_f32_16x16x32_bf16 v[188:191], v[56:59], a[12:15], 0
    ds_read_b128 v[108:111], v17 offset:2048
    ds_read_b64_tr_b16 a[50:51], v18 offset:9216
    v_mfma_f32_16x16x32_bf16 v[188:191], v[60:63], a[28:31], v[188:191]
    ds_read_b64_tr_b16 a[36:37], v19 offset:0
    v_mfma_f32_16x16x32_bf16 v[192:195], v[64:67], a[0:3], 0
    buffer_load_dwordx4 v14, s[32:35], s51 offen offset:2048 nt lds
    v_mfma_f32_16x16x32_bf16 v[192:195], v[68:71], a[16:19], v[192:195]
    ds_read_b128 v[112:115], v16 offset:4096
    v_mfma_f32_16x16x32_bf16 v[196:199], v[64:67], a[4:7], 0
    ds_read_b128 v[116:119], v17 offset:4096
    ds_read_b64_tr_b16 a[38:39], v19 offset:1024
    v_mfma_f32_16x16x32_bf16 v[196:199], v[68:71], a[20:23], v[196:199]
    buffer_load_dwordx4 v15, s[32:35], s51 offen offset:3072 nt lds
    v_mfma_f32_16x16x32_bf16 v[200:203], v[64:67], a[8:11], 0
    ds_read_b128 v[120:123], v16 offset:6144
    ds_read_b64_tr_b16 a[52:53], v19 offset:8192
    v_mfma_f32_16x16x32_bf16 v[200:203], v[68:71], a[24:27], v[200:203]
    s_add_u32 m0, s96, 4096
    s_add_u32 s51, s55, 1703936
    v_mfma_f32_16x16x32_bf16 v[204:207], v[64:67], a[12:15], 0
    buffer_load_dwordx4 v12, s[32:35], s51 offen offset:0 nt lds
    v_mfma_f32_16x16x32_bf16 v[204:207], v[68:71], a[28:31], v[204:207]
    ds_read_b128 v[124:127], v17 offset:6144
    ds_read_b64_tr_b16 a[54:55], v19 offset:9216
    v_mfma_f32_16x16x32_bf16 v[208:211], v[72:75], a[0:3], 0
    ds_read_b128 v[32:35], v16 offset:8192
    ds_read_b64_tr_b16 a[40:41], v20 offset:0
    v_mfma_f32_16x16x32_bf16 v[208:211], v[76:79], a[16:19], v[208:211]
    buffer_load_dwordx4 v13, s[32:35], s51 offen offset:1024 nt lds
    v_mfma_f32_16x16x32_bf16 v[212:215], v[72:75], a[4:7], 0
    ds_read_b128 v[36:39], v17 offset:8192
    ds_read_b64_tr_b16 a[42:43], v20 offset:1024
    v_mfma_f32_16x16x32_bf16 v[212:215], v[76:79], a[20:23], v[212:215]
    v_mfma_f32_16x16x32_bf16 v[216:219], v[72:75], a[8:11], 0
    ds_read_b128 v[40:43], v16 offset:10240
    ds_read_b64_tr_b16 a[56:57], v20 offset:8192
    v_mfma_f32_16x16x32_bf16 v[216:219], v[76:79], a[24:27], v[216:219]
    buffer_load_dwordx4 v14, s[32:35], s51 offen offset:2048 nt lds
    v_mfma_f32_16x16x32_bf16 v[220:223], v[72:75], a[12:15], 0
    ds_read_b128 v[44:47], v17 offset:10240
    ds_read_b64_tr_b16 a[58:59], v20 offset:9216
    v_mfma_f32_16x16x32_bf16 v[220:223], v[76:79], a[28:31], v[220:223]
    ds_read_b64_tr_b16 a[44:45], v21 offset:0
    v_mfma_f32_16x16x32_bf16 v[224:227], v[80:83], a[0:3], 0
    buffer_load_dwordx4 v15, s[32:35], s51 offen offset:3072 nt lds
    v_mfma_f32_16x16x32_bf16 v[224:227], v[84:87], a[16:19], v[224:227]
    ds_read_b128 v[48:51], v16 offset:12288
    ds_read_b64_tr_b16 a[46:47], v21 offset:1024
    v_mfma_f32_16x16x32_bf16 v[228:231], v[80:83], a[4:7], 0
    s_lshr_b32 m0, s96, 1
    s_add_u32 m0, m0, 32768
    s_add_u32 s51, s54, 384
    v_mfma_f32_16x16x32_bf16 v[228:231], v[84:87], a[20:23], v[228:231]
    buffer_load_dwordx4 v8, s[28:31], s51 offen offset:0 lds
    v_mfma_f32_16x16x32_bf16 v[232:235], v[80:83], a[8:11], 0
    ds_read_b128 v[52:55], v17 offset:12288
    ds_read_b128 v[56:59], v16 offset:14336
    v_mfma_f32_16x16x32_bf16 v[232:235], v[84:87], a[24:27], v[232:235]
    ds_read_b64_tr_b16 a[60:61], v21 offset:8192
    ds_read_b64_tr_b16 a[62:63], v21 offset:9216
    v_mfma_f32_16x16x32_bf16 v[236:239], v[80:83], a[12:15], 0
    buffer_load_dwordx4 v9, s[28:31], s51 offen offset:1024 lds
    v_mfma_f32_16x16x32_bf16 v[236:239], v[84:87], a[28:31], v[236:239]
    ds_read_b128 v[60:63], v17 offset:14336
    v_mfma_f32_16x16x32_bf16 v[240:243], v[88:91], a[0:3], 0
    v_mfma_f32_16x16x32_bf16 v[240:243], v[92:95], a[16:19], v[240:243]
    v_mfma_f32_16x16x32_bf16 v[244:247], v[88:91], a[4:7], 0
    buffer_load_dwordx4 v10, s[28:31], s51 offen offset:2048 lds
    v_mfma_f32_16x16x32_bf16 v[244:247], v[92:95], a[20:23], v[244:247]
    v_add_u32 v16, 0xc000, v16
    v_mfma_f32_16x16x32_bf16 v[248:251], v[88:91], a[8:11], 0
    v_add_u32 v17, 0xc000, v17
    v_add_u32 v18, 0xc000, v18
    v_mfma_f32_16x16x32_bf16 v[248:251], v[92:95], a[24:27], v[248:251]
    buffer_load_dwordx4 v11, s[28:31], s51 offen offset:3072 lds
    v_mfma_f32_16x16x32_bf16 v[252:255], v[88:91], a[12:15], 0
    v_add_u32 v19, 0xc000, v19
    v_add_u32 v20, 0xc000, v20
    v_mfma_f32_16x16x32_bf16 v[252:255], v[92:95], a[28:31], v[252:255]
    v_add_u32 v21, 0xc000, v21
    s_waitcnt vmcnt(12) lgkmcnt(0)
    s_barrier
    v_mfma_f32_16x16x32_bf16 v[128:131], v[96:99], a[32:35], v[128:131]
    ds_read_b128 v[64:67], v16 offset:0
    ds_read_b64_tr_b16 a[64:65], v18 offset:0
    v_mfma_f32_16x16x32_bf16 v[128:131], v[100:103], a[48:51], v[128:131]
    s_add_u32 m0, s96, 49152
    s_add_u32 s51, s55, 2097152
    v_mfma_f32_16x16x32_bf16 v[132:135], v[96:99], a[36:39], v[132:135]
    buffer_load_dwordx4 v12, s[32:35], s51 offen offset:0 nt lds
    v_mfma_f32_16x16x32_bf16 v[132:135], v[100:103], a[52:55], v[132:135]
    ds_read_b128 v[68:71], v17 offset:0
    v_mfma_f32_16x16x32_bf16 v[136:139], v[96:99], a[40:43], v[136:139]
    v_mfma_f32_16x16x32_bf16 v[136:139], v[100:103], a[56:59], v[136:139]
    ds_read_b64_tr_b16 a[66:67], v18 offset:1024
    v_mfma_f32_16x16x32_bf16 v[140:143], v[96:99], a[44:47], v[140:143]
    ds_read_b128 v[72:75], v16 offset:2048
    v_mfma_f32_16x16x32_bf16 v[140:143], v[100:103], a[60:63], v[140:143]
    buffer_load_dwordx4 v13, s[32:35], s51 offen offset:1024 nt lds
    v_mfma_f32_16x16x32_bf16 v[144:147], v[104:107], a[32:35], v[144:147]
    ds_read_b64_tr_b16 a[80:81], v18 offset:8192
    v_mfma_f32_16x16x32_bf16 v[144:147], v[108:111], a[48:51], v[144:147]
    ds_read_b128 v[76:79], v17 offset:2048
    v_mfma_f32_16x16x32_bf16 v[148:151], v[104:107], a[36:39], v[148:151]
    v_mfma_f32_16x16x32_bf16 v[148:151], v[108:111], a[52:55], v[148:151]
    v_mfma_f32_16x16x32_bf16 v[152:155], v[104:107], a[40:43], v[152:155]
    ds_read_b128 v[80:83], v16 offset:4096
    ds_read_b64_tr_b16 a[82:83], v18 offset:9216
    v_mfma_f32_16x16x32_bf16 v[152:155], v[108:111], a[56:59], v[152:155]
    buffer_load_dwordx4 v14, s[32:35], s51 offen offset:2048 nt lds
    v_mfma_f32_16x16x32_bf16 v[156:159], v[104:107], a[44:47], v[156:159]
    v_mfma_f32_16x16x32_bf16 v[156:159], v[108:111], a[60:63], v[156:159]
    ds_read_b128 v[84:87], v17 offset:4096
    ds_read_b64_tr_b16 a[68:69], v19 offset:0
    v_mfma_f32_16x16x32_bf16 v[160:163], v[112:115], a[32:35], v[160:163]
    v_mfma_f32_16x16x32_bf16 v[160:163], v[116:119], a[48:51], v[160:163]
    ds_read_b64_tr_b16 a[70:71], v19 offset:1024
    v_mfma_f32_16x16x32_bf16 v[164:167], v[112:115], a[36:39], v[164:167]
    buffer_load_dwordx4 v15, s[32:35], s51 offen offset:3072 nt lds
    v_mfma_f32_16x16x32_bf16 v[164:167], v[116:119], a[52:55], v[164:167]
    ds_read_b128 v[88:91], v16 offset:6144
    v_mfma_f32_16x16x32_bf16 v[168:171], v[112:115], a[40:43], v[168:171]
    v_mfma_f32_16x16x32_bf16 v[168:171], v[116:119], a[56:59], v[168:171]
    ds_read_b128 v[92:95], v17 offset:6144
    ds_read_b64_tr_b16 a[84:85], v19 offset:8192
    v_mfma_f32_16x16x32_bf16 v[172:175], v[112:115], a[44:47], v[172:175]
    s_add_u32 m0, s96, 53248
    s_add_u32 s51, s55, 2228224
    v_mfma_f32_16x16x32_bf16 v[172:175], v[116:119], a[60:63], v[172:175]
    buffer_load_dwordx4 v12, s[32:35], s51 offen offset:0 nt lds
    v_mfma_f32_16x16x32_bf16 v[176:179], v[120:123], a[32:35], v[176:179]
    ds_read_b128 v[96:99], v16 offset:8192
    v_mfma_f32_16x16x32_bf16 v[176:179], v[124:127], a[48:51], v[176:179]
    ds_read_b64_tr_b16 a[86:87], v19 offset:9216
    v_mfma_f32_16x16x32_bf16 v[180:183], v[120:123], a[36:39], v[180:183]
    v_mfma_f32_16x16x32_bf16 v[180:183], v[124:127], a[52:55], v[180:183]
    ds_read_b128 v[100:103], v17 offset:8192
    v_mfma_f32_16x16x32_bf16 v[184:187], v[120:123], a[40:43], v[184:187]
    buffer_load_dwordx4 v13, s[32:35], s51 offen offset:1024 nt lds
    v_mfma_f32_16x16x32_bf16 v[184:187], v[124:127], a[56:59], v[184:187]
    ds_read_b64_tr_b16 a[72:73], v20 offset:0
    v_mfma_f32_16x16x32_bf16 v[188:191], v[120:123], a[44:47], v[188:191]
    ds_read_b128 v[104:107], v16 offset:10240
    v_mfma_f32_16x16x32_bf16 v[188:191], v[124:127], a[60:63], v[188:191]
    v_mfma_f32_16x16x32_bf16 v[192:195], v[32:35], a[32:35], v[192:195]
    ds_read_b64_tr_b16 a[74:75], v20 offset:1024
    v_mfma_f32_16x16x32_bf16 v[192:195], v[36:39], a[48:51], v[192:195]
    ds_read_b128 v[108:111], v17 offset:10240
    v_mfma_f32_16x16x32_bf16 v[196:199], v[32:35], a[36:39], v[196:199]
    buffer_load_dwordx4 v14, s[32:35], s51 offen offset:2048 nt lds
    v_mfma_f32_16x16x32_bf16 v[196:199], v[36:39], a[52:55], v[196:199]
    v_mfma_f32_16x16x32_bf16 v[200:203], v[32:35], a[40:43], v[200:203]
    ds_read_b128 v[112:115], v16 offset:12288
    ds_read_b64_tr_b16 a[88:89], v20 offset:8192
    v_mfma_f32_16x16x32_bf16 v[200:203], v[36:39], a[56:59], v[200:203]
    v_mfma_f32_16x16x32_bf16 v[204:207], v[32:35], a[44:47], v[204:207]
    ds_read_b64_tr_b16 a[90:91], v20 offset:9216
    v_mfma_f32_16x16x32_bf16 v[204:207], v[36:39], a[60:63], v[204:207]
    buffer_load_dwordx4 v15, s[32:35], s51 offen offset:3072 nt lds
    v_mfma_f32_16x16x32_bf16 v[208:211], v[40:43], a[32:35], v[208:211]
    ds_read_b128 v[116:119], v17 offset:12288
    v_mfma_f32_16x16x32_bf16 v[208:211], v[44:47], a[48:51], v[208:211]
    v_mfma_f32_16x16x32_bf16 v[212:215], v[40:43], a[36:39], v[212:215]
    ds_read_b128 v[120:123], v16 offset:14336
    ds_read_b64_tr_b16 a[76:77], v21 offset:0
    v_mfma_f32_16x16x32_bf16 v[212:215], v[44:47], a[52:55], v[212:215]
    s_lshr_b32 m0, s96, 1
    s_add_u32 m0, m0, 81920
    s_add_u32 s51, s54, 512
    v_mfma_f32_16x16x32_bf16 v[216:219], v[40:43], a[40:43], v[216:219]
    buffer_load_dwordx4 v8, s[28:31], s51 offen offset:0 lds
    v_mfma_f32_16x16x32_bf16 v[216:219], v[44:47], a[56:59], v[216:219]
    ds_read_b128 v[124:127], v17 offset:14336
    v_mfma_f32_16x16x32_bf16 v[220:223], v[40:43], a[44:47], v[220:223]
    ds_read_b64_tr_b16 a[78:79], v21 offset:1024
    v_mfma_f32_16x16x32_bf16 v[220:223], v[44:47], a[60:63], v[220:223]
    v_mfma_f32_16x16x32_bf16 v[224:227], v[48:51], a[32:35], v[224:227]
    ds_read_b64_tr_b16 a[92:93], v21 offset:8192
    v_mfma_f32_16x16x32_bf16 v[224:227], v[52:55], a[48:51], v[224:227]
    buffer_load_dwordx4 v9, s[28:31], s51 offen offset:1024 lds
    v_mfma_f32_16x16x32_bf16 v[228:231], v[48:51], a[36:39], v[228:231]
    v_mfma_f32_16x16x32_bf16 v[228:231], v[52:55], a[52:55], v[228:231]
    v_mfma_f32_16x16x32_bf16 v[232:235], v[48:51], a[40:43], v[232:235]
    v_mfma_f32_16x16x32_bf16 v[232:235], v[52:55], a[56:59], v[232:235]
    ds_read_b64_tr_b16 a[94:95], v21 offset:9216
    v_mfma_f32_16x16x32_bf16 v[236:239], v[48:51], a[44:47], v[236:239]
    v_mfma_f32_16x16x32_bf16 v[236:239], v[52:55], a[60:63], v[236:239]
    buffer_load_dwordx4 v10, s[28:31], s51 offen offset:2048 lds
    v_mfma_f32_16x16x32_bf16 v[240:243], v[56:59], a[32:35], v[240:243]
    v_mfma_f32_16x16x32_bf16 v[240:243], v[60:63], a[48:51], v[240:243]
    v_mfma_f32_16x16x32_bf16 v[244:247], v[56:59], a[36:39], v[244:247]
    v_mfma_f32_16x16x32_bf16 v[244:247], v[60:63], a[52:55], v[244:247]
    v_add_u32 v16, 0xfffe8000, v16
    v_add_u32 v17, 0xfffe8000, v17
    v_mfma_f32_16x16x32_bf16 v[248:251], v[56:59], a[40:43], v[248:251]
    buffer_load_dwordx4 v11, s[28:31], s51 offen offset:3072 lds
    v_mfma_f32_16x16x32_bf16 v[248:251], v[60:63], a[56:59], v[248:251]
    v_add_u32 v18, 0xfffe8000, v18
    v_add_u32 v19, 0xfffe8000, v19
    v_mfma_f32_16x16x32_bf16 v[252:255], v[56:59], a[44:47], v[252:255]
    v_add_u32 v20, 0xfffe8000, v20
    v_mfma_f32_16x16x32_bf16 v[252:255], v[60:63], a[60:63], v[252:255]
    v_add_u32 v21, 0xfffe8000, v21
    s_waitcnt vmcnt(12) lgkmcnt(0)
    s_barrier
    v_mfma_f32_16x16x32_bf16 v[128:131], v[64:67], a[64:67], v[128:131]
    ds_read_b128 v[32:35], v16 offset:0
    ds_read_b64_tr_b16 a[96:97], v18 offset:0
    s_lshr_b32 s53, s48, 1
    v_mfma_f32_16x16x32_bf16 v[128:131], v[68:71], a[80:83], v[128:131]
    s_add_u32 m0, s96, 98304
    s_add_u32 s51, s55, 2621440
    v_mfma_f32_16x16x32_bf16 v[132:135], v[64:67], a[68:71], v[132:135]
    buffer_load_dwordx4 v12, s[32:35], s51 offen offset:0 nt lds
    v_mfma_f32_16x16x32_bf16 v[132:135], v[68:71], a[84:87], v[132:135]
    ds_read_b128 v[36:39], v17 offset:0
    s_lshl_b32 s53, s53, 24
    v_mfma_f32_16x16x32_bf16 v[136:139], v[64:67], a[72:75], v[136:139]
    s_lshl_b32 s52, s49, 19
    s_add_u32 s53, s53, s52
    v_mfma_f32_16x16x32_bf16 v[136:139], v[68:71], a[88:91], v[136:139]
    ds_read_b64_tr_b16 a[98:99], v18 offset:1024
    v_mfma_f32_16x16x32_bf16 v[140:143], v[64:67], a[76:79], v[140:143]
    ds_read_b128 v[40:43], v16 offset:2048
    s_sub_u32 s52, 7, s50
    v_mfma_f32_16x16x32_bf16 v[140:143], v[68:71], a[92:95], v[140:143]
    buffer_load_dwordx4 v13, s[32:35], s51 offen offset:1024 nt lds
    v_mfma_f32_16x16x32_bf16 v[144:147], v[72:75], a[64:67], v[144:147]
    ds_read_b64_tr_b16 a[112:113], v18 offset:8192
    s_lshl_b32 s52, s52, 16
    v_mfma_f32_16x16x32_bf16 v[144:147], v[76:79], a[80:83], v[144:147]
    ds_read_b128 v[44:47], v17 offset:2048
    s_add_u32 s53, s53, s52
    v_mfma_f32_16x16x32_bf16 v[148:151], v[72:75], a[68:71], v[148:151]
    s_add_u32 s36, s26, s53
    s_addc_u32 s37, s27, 0
    v_mfma_f32_16x16x32_bf16 v[148:151], v[76:79], a[84:87], v[148:151]
    s_mov_b32 s38, 65536
    s_mov_b32 s39, 0x20000
    v_mfma_f32_16x16x32_bf16 v[152:155], v[72:75], a[72:75], v[152:155]
    ds_read_b128 v[48:51], v16 offset:4096
    ds_read_b64_tr_b16 a[114:115], v18 offset:9216
    v_mfma_f32_16x16x32_bf16 v[152:155], v[76:79], a[88:91], v[152:155]
    buffer_load_dwordx4 v14, s[32:35], s51 offen offset:2048 nt lds
    v_mfma_f32_16x16x32_bf16 v[156:159], v[72:75], a[76:79], v[156:159]
    s_add_u32 s76, s26, 62914560
    s_addc_u32 s77, s27, 0
    v_mfma_f32_16x16x32_bf16 v[156:159], v[76:79], a[92:95], v[156:159]
    ds_read_b128 v[52:55], v17 offset:4096
    ds_read_b64_tr_b16 a[100:101], v19 offset:0
    v_mfma_f32_16x16x32_bf16 v[160:163], v[80:83], a[64:67], v[160:163]
    s_mov_b32 s78, 65540
    v_mfma_f32_16x16x32_bf16 v[160:163], v[84:87], a[80:83], v[160:163]
    ds_read_b64_tr_b16 a[102:103], v19 offset:1024
    s_mov_b32 s79, 0x20000
    v_mfma_f32_16x16x32_bf16 v[164:167], v[80:83], a[68:71], v[164:167]
    buffer_load_dwordx4 v15, s[32:35], s51 offen offset:3072 nt lds
    v_mfma_f32_16x16x32_bf16 v[164:167], v[84:87], a[84:87], v[164:167]
    ds_read_b128 v[56:59], v16 offset:6144
    s_add_u32 s95, s94, 1
    v_mfma_f32_16x16x32_bf16 v[168:171], v[80:83], a[72:75], v[168:171]
    s_lshl_b32 s52, s48, 2
    v_xor_b32 v5, s52, v1
    v_mfma_f32_16x16x32_bf16 v[168:171], v[84:87], a[88:91], v[168:171]
    ds_read_b128 v[60:63], v17 offset:6144
    ds_read_b64_tr_b16 a[116:117], v19 offset:8192
    v_mfma_f32_16x16x32_bf16 v[172:175], v[80:83], a[76:79], v[172:175]
    s_add_u32 m0, s96, 102400
    s_add_u32 s51, s55, 2752512
    v_mfma_f32_16x16x32_bf16 v[172:175], v[84:87], a[92:95], v[172:175]
    buffer_load_dwordx4 v12, s[32:35], s51 offen offset:0 nt lds
    v_mfma_f32_16x16x32_bf16 v[176:179], v[88:91], a[64:67], v[176:179]
    ds_read_b128 v[64:67], v16 offset:8192
    v_xor_b32 v5, 0, v5
    v_mfma_f32_16x16x32_bf16 v[176:179], v[92:95], a[80:83], v[176:179]
    ds_read_b64_tr_b16 a[118:119], v19 offset:9216
    v_lshlrev_b32 v5, 4, v5
    v_mfma_f32_16x16x32_bf16 v[180:183], v[88:91], a[68:71], v[180:183]
    v_xor_b32 v6, s52, v1
    v_xor_b32 v6, 1, v6
    v_mfma_f32_16x16x32_bf16 v[180:183], v[92:95], a[84:87], v[180:183]
    ds_read_b128 v[68:71], v17 offset:8192
    v_lshlrev_b32 v6, 4, v6
    v_mfma_f32_16x16x32_bf16 v[184:187], v[88:91], a[72:75], v[184:187]
    buffer_load_dwordx4 v13, s[32:35], s51 offen offset:1024 nt lds
    v_mfma_f32_16x16x32_bf16 v[184:187], v[92:95], a[88:91], v[184:187]
    ds_read_b64_tr_b16 a[104:105], v20 offset:0
    v_xor_b32 v7, s52, v1
    v_mfma_f32_16x16x32_bf16 v[188:191], v[88:91], a[76:79], v[188:191]
    ds_read_b128 v[72:75], v16 offset:10240
    v_xor_b32 v7, 2, v7
    v_mfma_f32_16x16x32_bf16 v[188:191], v[92:95], a[92:95], v[188:191]
    v_mfma_f32_16x16x32_bf16 v[192:195], v[96:99], a[64:67], v[192:195]
    ds_read_b64_tr_b16 a[106:107], v20 offset:1024
    v_lshlrev_b32 v7, 4, v7
    v_mfma_f32_16x16x32_bf16 v[192:195], v[100:103], a[80:83], v[192:195]
    ds_read_b128 v[76:79], v17 offset:10240
    v_xor_b32 v28, s52, v1
    v_mfma_f32_16x16x32_bf16 v[196:199], v[96:99], a[68:71], v[196:199]
    buffer_load_dwordx4 v14, s[32:35], s51 offen offset:2048 nt lds
    v_mfma_f32_16x16x32_bf16 v[196:199], v[100:103], a[84:87], v[196:199]
    v_xor_b32 v28, 3, v28
    v_lshlrev_b32 v28, 4, v28
    v_mfma_f32_16x16x32_bf16 v[200:203], v[96:99], a[72:75], v[200:203]
    ds_read_b128 v[80:83], v16 offset:12288
    ds_read_b64_tr_b16 a[120:121], v20 offset:8192
    v_mfma_f32_16x16x32_bf16 v[200:203], v[100:103], a[88:91], v[200:203]
    v_add_u32 v22, 0, v3
    v_mfma_f32_16x16x32_bf16 v[204:207], v[96:99], a[76:79], v[204:207]
    ds_read_b64_tr_b16 a[122:123], v20 offset:9216
    v_xor_b32 v22, v22, v4
    v_mfma_f32_16x16x32_bf16 v[204:207], v[100:103], a[92:95], v[204:207]
    buffer_load_dwordx4 v15, s[32:35], s51 offen offset:3072 nt lds
    v_mfma_f32_16x16x32_bf16 v[208:211], v[104:107], a[64:67], v[208:211]
    ds_read_b128 v[84:87], v17 offset:12288
    v_lshlrev_b32 v22, 4, v22
    v_mfma_f32_16x16x32_bf16 v[208:211], v[108:111], a[80:83], v[208:211]
    v_lshl_add_u32 v22, v4, 10, v22
    v_add_u32 v22, 98304, v22
    v_mfma_f32_16x16x32_bf16 v[212:215], v[104:107], a[68:71], v[212:215]
    ds_read_b128 v[88:91], v16 offset:14336
    ds_read_b64_tr_b16 a[108:109], v21 offset:0
    v_mfma_f32_16x16x32_bf16 v[212:215], v[108:111], a[84:87], v[212:215]
    s_lshr_b32 m0, s96, 1
    s_add_u32 m0, m0, 131072
    s_add_u32 s51, s54, 640
    v_mfma_f32_16x16x32_bf16 v[216:219], v[104:107], a[72:75], v[216:219]
    buffer_load_dwordx4 v8, s[28:31], s51 offen offset:0 lds
    v_mfma_f32_16x16x32_bf16 v[216:219], v[108:111], a[88:91], v[216:219]
    ds_read_b128 v[92:95], v17 offset:14336
    v_add_u32 v23, 4, v3
    v_mfma_f32_16x16x32_bf16 v[220:223], v[104:107], a[76:79], v[220:223]
    ds_read_b64_tr_b16 a[110:111], v21 offset:1024
    v_xor_b32 v23, v23, v4
    v_mfma_f32_16x16x32_bf16 v[220:223], v[108:111], a[92:95], v[220:223]
    v_lshlrev_b32 v23, 4, v23
    v_mfma_f32_16x16x32_bf16 v[224:227], v[112:115], a[64:67], v[224:227]
    ds_read_b64_tr_b16 a[124:125], v21 offset:8192
    v_lshl_add_u32 v23, v4, 10, v23
    v_mfma_f32_16x16x32_bf16 v[224:227], v[116:119], a[80:83], v[224:227]
    buffer_load_dwordx4 v9, s[28:31], s51 offen offset:1024 lds
    v_mfma_f32_16x16x32_bf16 v[228:231], v[112:115], a[68:71], v[228:231]
    v_add_u32 v23, 98304, v23
    v_mfma_f32_16x16x32_bf16 v[228:231], v[116:119], a[84:87], v[228:231]
    v_add_u32 v24, 8, v3
    v_mfma_f32_16x16x32_bf16 v[232:235], v[112:115], a[72:75], v[232:235]
    v_xor_b32 v24, v24, v4
    v_mfma_f32_16x16x32_bf16 v[232:235], v[116:119], a[88:91], v[232:235]
    ds_read_b64_tr_b16 a[126:127], v21 offset:9216
    v_lshlrev_b32 v24, 4, v24
    v_mfma_f32_16x16x32_bf16 v[236:239], v[112:115], a[76:79], v[236:239]
    v_lshl_add_u32 v24, v4, 10, v24
    v_mfma_f32_16x16x32_bf16 v[236:239], v[116:119], a[92:95], v[236:239]
    buffer_load_dwordx4 v10, s[28:31], s51 offen offset:2048 lds
    v_mfma_f32_16x16x32_bf16 v[240:243], v[120:123], a[64:67], v[240:243]
    v_add_u32 v24, 98304, v24
    v_mfma_f32_16x16x32_bf16 v[240:243], v[124:127], a[80:83], v[240:243]
    v_add_u32 v25, 12, v3
    v_mfma_f32_16x16x32_bf16 v[244:247], v[120:123], a[68:71], v[244:247]
    v_xor_b32 v25, v25, v4
    v_lshlrev_b32 v25, 4, v25
    v_mfma_f32_16x16x32_bf16 v[244:247], v[124:127], a[84:87], v[244:247]
    v_add_u32 v16, 0xc000, v16
    v_add_u32 v17, 0xc000, v17
    v_mfma_f32_16x16x32_bf16 v[248:251], v[120:123], a[72:75], v[248:251]
    buffer_load_dwordx4 v11, s[28:31], s51 offen offset:3072 lds
    v_mfma_f32_16x16x32_bf16 v[248:251], v[124:127], a[88:91], v[248:251]
    v_add_u32 v18, 0xc000, v18
    v_add_u32 v19, 0xc000, v19
    v_mfma_f32_16x16x32_bf16 v[252:255], v[120:123], a[76:79], v[252:255]
    v_add_u32 v20, 0xc000, v20
    v_lshl_add_u32 v25, v4, 10, v25
    v_mfma_f32_16x16x32_bf16 v[252:255], v[124:127], a[92:95], v[252:255]
    v_add_u32 v21, 0xc000, v21
    v_add_u32 v25, 98304, v25
    s_waitcnt vmcnt(12) lgkmcnt(0)
    s_barrier
    v_mfma_f32_16x16x32_bf16 v[128:131], v[32:35], a[96:99], v[128:131]
    ds_read_b128 v[96:99], v16 offset:0
    ds_read_b64_tr_b16 a[128:129], v18 offset:0
    v_mfma_f32_16x16x32_bf16 v[128:131], v[36:39], a[112:115], v[128:131]
    s_add_u32 m0, s96, 0
    s_add_u32 s51, s55, 3145728
    v_mfma_f32_16x16x32_bf16 v[132:135], v[32:35], a[100:103], v[132:135]
    buffer_load_dwordx4 v12, s[32:35], s51 offen offset:0 nt lds
    v_mfma_f32_16x16x32_bf16 v[132:135], v[36:39], a[116:119], v[132:135]
    ds_read_b128 v[100:103], v17 offset:0
    v_mfma_f32_16x16x32_bf16 v[136:139], v[32:35], a[104:107], v[136:139]
    v_mfma_f32_16x16x32_bf16 v[136:139], v[36:39], a[120:123], v[136:139]
    ds_read_b64_tr_b16 a[130:131], v18 offset:1024
    v_mfma_f32_16x16x32_bf16 v[140:143], v[32:35], a[108:111], v[140:143]
    ds_read_b128 v[104:107], v16 offset:2048
    v_mfma_f32_16x16x32_bf16 v[140:143], v[36:39], a[124:127], v[140:143]
    buffer_load_dwordx4 v13, s[32:35], s51 offen offset:1024 nt lds
    v_mfma_f32_16x16x32_bf16 v[144:147], v[40:43], a[96:99], v[144:147]
    ds_read_b64_tr_b16 a[144:145], v18 offset:8192
    v_mfma_f32_16x16x32_bf16 v[144:147], v[44:47], a[112:115], v[144:147]
    ds_read_b128 v[108:111], v17 offset:2048
    v_mfma_f32_16x16x32_bf16 v[148:151], v[40:43], a[100:103], v[148:151]
    v_mfma_f32_16x16x32_bf16 v[148:151], v[44:47], a[116:119], v[148:151]
    v_mfma_f32_16x16x32_bf16 v[152:155], v[40:43], a[104:107], v[152:155]
    ds_read_b128 v[112:115], v16 offset:4096
    ds_read_b64_tr_b16 a[146:147], v18 offset:9216
    v_mfma_f32_16x16x32_bf16 v[152:155], v[44:47], a[120:123], v[152:155]
    buffer_load_dwordx4 v14, s[32:35], s51 offen offset:2048 nt lds
    v_mfma_f32_16x16x32_bf16 v[156:159], v[40:43], a[108:111], v[156:159]
    v_mfma_f32_16x16x32_bf16 v[156:159], v[44:47], a[124:127], v[156:159]
    ds_read_b128 v[116:119], v17 offset:4096
    ds_read_b64_tr_b16 a[132:133], v19 offset:0
    v_mfma_f32_16x16x32_bf16 v[160:163], v[48:51], a[96:99], v[160:163]
    v_mfma_f32_16x16x32_bf16 v[160:163], v[52:55], a[112:115], v[160:163]
    ds_read_b64_tr_b16 a[134:135], v19 offset:1024
    v_mfma_f32_16x16x32_bf16 v[164:167], v[48:51], a[100:103], v[164:167]
    buffer_load_dwordx4 v15, s[32:35], s51 offen offset:3072 nt lds
    v_mfma_f32_16x16x32_bf16 v[164:167], v[52:55], a[116:119], v[164:167]
    ds_read_b128 v[120:123], v16 offset:6144
    v_mfma_f32_16x16x32_bf16 v[168:171], v[48:51], a[104:107], v[168:171]
    v_mfma_f32_16x16x32_bf16 v[168:171], v[52:55], a[120:123], v[168:171]
    ds_read_b128 v[124:127], v17 offset:6144
    ds_read_b64_tr_b16 a[148:149], v19 offset:8192
    v_mfma_f32_16x16x32_bf16 v[172:175], v[48:51], a[108:111], v[172:175]
    s_add_u32 m0, s96, 4096
    s_add_u32 s51, s55, 3276800
    v_mfma_f32_16x16x32_bf16 v[172:175], v[52:55], a[124:127], v[172:175]
    buffer_load_dwordx4 v12, s[32:35], s51 offen offset:0 nt lds
    v_mfma_f32_16x16x32_bf16 v[176:179], v[56:59], a[96:99], v[176:179]
    ds_read_b128 v[32:35], v16 offset:8192
    v_mfma_f32_16x16x32_bf16 v[176:179], v[60:63], a[112:115], v[176:179]
    ds_read_b64_tr_b16 a[150:151], v19 offset:9216
    v_mfma_f32_16x16x32_bf16 v[180:183], v[56:59], a[100:103], v[180:183]
    v_mfma_f32_16x16x32_bf16 v[180:183], v[60:63], a[116:119], v[180:183]
    ds_read_b128 v[36:39], v17 offset:8192
    v_mfma_f32_16x16x32_bf16 v[184:187], v[56:59], a[104:107], v[184:187]
    buffer_load_dwordx4 v13, s[32:35], s51 offen offset:1024 nt lds
    v_mfma_f32_16x16x32_bf16 v[184:187], v[60:63], a[120:123], v[184:187]
    ds_read_b64_tr_b16 a[136:137], v20 offset:0
    v_mfma_f32_16x16x32_bf16 v[188:191], v[56:59], a[108:111], v[188:191]
    ds_read_b128 v[40:43], v16 offset:10240
    v_mfma_f32_16x16x32_bf16 v[188:191], v[60:63], a[124:127], v[188:191]
    v_mfma_f32_16x16x32_bf16 v[192:195], v[64:67], a[96:99], v[192:195]
    ds_read_b64_tr_b16 a[138:139], v20 offset:1024
    v_mfma_f32_16x16x32_bf16 v[192:195], v[68:71], a[112:115], v[192:195]
    ds_read_b128 v[44:47], v17 offset:10240
    v_mfma_f32_16x16x32_bf16 v[196:199], v[64:67], a[100:103], v[196:199]
    buffer_load_dwordx4 v14, s[32:35], s51 offen offset:2048 nt lds
    v_mfma_f32_16x16x32_bf16 v[196:199], v[68:71], a[116:119], v[196:199]
    v_mfma_f32_16x16x32_bf16 v[200:203], v[64:67], a[104:107], v[200:203]
    ds_read_b128 v[48:51], v16 offset:12288
    ds_read_b64_tr_b16 a[152:153], v20 offset:8192
    v_mfma_f32_16x16x32_bf16 v[200:203], v[68:71], a[120:123], v[200:203]
    v_mfma_f32_16x16x32_bf16 v[204:207], v[64:67], a[108:111], v[204:207]
    ds_read_b64_tr_b16 a[154:155], v20 offset:9216
    v_mfma_f32_16x16x32_bf16 v[204:207], v[68:71], a[124:127], v[204:207]
    buffer_load_dwordx4 v15, s[32:35], s51 offen offset:3072 nt lds
    v_mfma_f32_16x16x32_bf16 v[208:211], v[72:75], a[96:99], v[208:211]
    ds_read_b128 v[52:55], v17 offset:12288
    v_mfma_f32_16x16x32_bf16 v[208:211], v[76:79], a[112:115], v[208:211]
    v_mfma_f32_16x16x32_bf16 v[212:215], v[72:75], a[100:103], v[212:215]
    ds_read_b128 v[56:59], v16 offset:14336
    ds_read_b64_tr_b16 a[140:141], v21 offset:0
    v_mfma_f32_16x16x32_bf16 v[212:215], v[76:79], a[116:119], v[212:215]
    s_lshr_b32 m0, s96, 1
    s_add_u32 m0, m0, 32768
    s_add_u32 s51, s54, 768
    v_mfma_f32_16x16x32_bf16 v[216:219], v[72:75], a[104:107], v[216:219]
    buffer_load_dwordx4 v8, s[28:31], s51 offen offset:0 lds
    v_mfma_f32_16x16x32_bf16 v[216:219], v[76:79], a[120:123], v[216:219]
    ds_read_b128 v[60:63], v17 offset:14336
    v_mfma_f32_16x16x32_bf16 v[220:223], v[72:75], a[108:111], v[220:223]
    ds_read_b64_tr_b16 a[142:143], v21 offset:1024
    v_mfma_f32_16x16x32_bf16 v[220:223], v[76:79], a[124:127], v[220:223]
    v_mfma_f32_16x16x32_bf16 v[224:227], v[80:83], a[96:99], v[224:227]
    ds_read_b64_tr_b16 a[156:157], v21 offset:8192
    v_mfma_f32_16x16x32_bf16 v[224:227], v[84:87], a[112:115], v[224:227]
    buffer_load_dwordx4 v9, s[28:31], s51 offen offset:1024 lds
    v_mfma_f32_16x16x32_bf16 v[228:231], v[80:83], a[100:103], v[228:231]
    v_mfma_f32_16x16x32_bf16 v[228:231], v[84:87], a[116:119], v[228:231]
    v_mfma_f32_16x16x32_bf16 v[232:235], v[80:83], a[104:107], v[232:235]
    v_mfma_f32_16x16x32_bf16 v[232:235], v[84:87], a[120:123], v[232:235]
    ds_read_b64_tr_b16 a[158:159], v21 offset:9216
    v_mfma_f32_16x16x32_bf16 v[236:239], v[80:83], a[108:111], v[236:239]
    v_mfma_f32_16x16x32_bf16 v[236:239], v[84:87], a[124:127], v[236:239]
    buffer_load_dwordx4 v10, s[28:31], s51 offen offset:2048 lds
    v_mfma_f32_16x16x32_bf16 v[240:243], v[88:91], a[96:99], v[240:243]
    v_mfma_f32_16x16x32_bf16 v[240:243], v[92:95], a[112:115], v[240:243]
    v_mfma_f32_16x16x32_bf16 v[244:247], v[88:91], a[100:103], v[244:247]
    v_mfma_f32_16x16x32_bf16 v[244:247], v[92:95], a[116:119], v[244:247]
    v_add_u32 v16, 0xc000, v16
    v_add_u32 v17, 0xc000, v17
    v_mfma_f32_16x16x32_bf16 v[248:251], v[88:91], a[104:107], v[248:251]
    buffer_load_dwordx4 v11, s[28:31], s51 offen offset:3072 lds
    v_mfma_f32_16x16x32_bf16 v[248:251], v[92:95], a[120:123], v[248:251]
    v_add_u32 v18, 0xc000, v18
    v_add_u32 v19, 0xc000, v19
    v_mfma_f32_16x16x32_bf16 v[252:255], v[88:91], a[108:111], v[252:255]
    v_add_u32 v20, 0xc000, v20
    v_mfma_f32_16x16x32_bf16 v[252:255], v[92:95], a[124:127], v[252:255]
    v_add_u32 v21, 0xc000, v21
    s_waitcnt vmcnt(12) lgkmcnt(0)
    s_barrier
    v_mfma_f32_16x16x32_bf16 v[128:131], v[96:99], a[128:131], v[128:131]
    ds_read_b128 v[64:67], v16 offset:0
    ds_read_b64_tr_b16 a[160:161], v18 offset:0
    v_mfma_f32_16x16x32_bf16 v[128:131], v[100:103], a[144:147], v[128:131]
    s_add_u32 m0, s96, 49152
    s_add_u32 s51, s55, 3670016
    v_mfma_f32_16x16x32_bf16 v[132:135], v[96:99], a[132:135], v[132:135]
    buffer_load_dwordx4 v12, s[32:35], s51 offen offset:0 nt lds
    v_mfma_f32_16x16x32_bf16 v[132:135], v[100:103], a[148:151], v[132:135]
    ds_read_b128 v[68:71], v17 offset:0
    v_mfma_f32_16x16x32_bf16 v[136:139], v[96:99], a[136:139], v[136:139]
    v_mfma_f32_16x16x32_bf16 v[136:139], v[100:103], a[152:155], v[136:139]
    ds_read_b64_tr_b16 a[162:163], v18 offset:1024
    v_mfma_f32_16x16x32_bf16 v[140:143], v[96:99], a[140:143], v[140:143]
    buffer_load_dwordx4 v13, s[32:35], s51 offen offset:1024 nt lds
    v_mfma_f32_16x16x32_bf16 v[140:143], v[100:103], a[156:159], v[140:143]
    ds_read_b128 v[72:75], v16 offset:2048
    v_mfma_f32_16x16x32_bf16 v[144:147], v[104:107], a[128:131], v[144:147]
    ds_read_b64_tr_b16 a[176:177], v18 offset:8192
    v_mfma_f32_16x16x32_bf16 v[144:147], v[108:111], a[144:147], v[144:147]
    ds_read_b128 v[76:79], v17 offset:2048
    v_mfma_f32_16x16x32_bf16 v[148:151], v[104:107], a[132:135], v[148:151]
    buffer_load_dwordx4 v14, s[32:35], s51 offen offset:2048 nt lds
    v_mfma_f32_16x16x32_bf16 v[148:151], v[108:111], a[148:151], v[148:151]
    v_mfma_f32_16x16x32_bf16 v[152:155], v[104:107], a[136:139], v[152:155]
    ds_read_b128 v[80:83], v16 offset:4096
    ds_read_b64_tr_b16 a[178:179], v18 offset:9216
    v_mfma_f32_16x16x32_bf16 v[152:155], v[108:111], a[152:155], v[152:155]
    v_mfma_f32_16x16x32_bf16 v[156:159], v[104:107], a[140:143], v[156:159]
    buffer_load_dwordx4 v15, s[32:35], s51 offen offset:3072 nt lds
    v_mfma_f32_16x16x32_bf16 v[156:159], v[108:111], a[156:159], v[156:159]
    ds_read_b128 v[84:87], v17 offset:4096
    ds_read_b64_tr_b16 a[164:165], v19 offset:0
    v_mfma_f32_16x16x32_bf16 v[160:163], v[112:115], a[128:131], v[160:163]
    v_mfma_f32_16x16x32_bf16 v[160:163], v[116:119], a[144:147], v[160:163]
    s_add_u32 m0, s96, 53248
    s_add_u32 s51, s55, 3801088
    v_mfma_f32_16x16x32_bf16 v[164:167], v[112:115], a[132:135], v[164:167]
    buffer_load_dwordx4 v12, s[32:35], s51 offen offset:0 nt lds
    v_mfma_f32_16x16x32_bf16 v[164:167], v[116:119], a[148:151], v[164:167]
    ds_read_b128 v[88:91], v16 offset:6144
    ds_read_b64_tr_b16 a[166:167], v19 offset:1024
    v_mfma_f32_16x16x32_bf16 v[168:171], v[112:115], a[136:139], v[168:171]
    v_mfma_f32_16x16x32_bf16 v[168:171], v[116:119], a[152:155], v[168:171]
    ds_read_b128 v[92:95], v17 offset:6144
    v_mfma_f32_16x16x32_bf16 v[172:175], v[112:115], a[140:143], v[172:175]
    ds_read_b64_tr_b16 a[180:181], v19 offset:8192
    v_mfma_f32_16x16x32_bf16 v[172:175], v[116:119], a[156:159], v[172:175]
    buffer_load_dwordx4 v13, s[32:35], s51 offen offset:1024 nt lds
    v_mfma_f32_16x16x32_bf16 v[176:179], v[120:123], a[128:131], v[176:179]
    ds_read_b128 v[96:99], v16 offset:8192
    v_mfma_f32_16x16x32_bf16 v[176:179], v[124:127], a[144:147], v[176:179]
    ds_read_b64_tr_b16 a[182:183], v19 offset:9216
    v_mfma_f32_16x16x32_bf16 v[180:183], v[120:123], a[132:135], v[180:183]
    v_mfma_f32_16x16x32_bf16 v[180:183], v[124:127], a[148:151], v[180:183]
    buffer_load_dwordx4 v14, s[32:35], s51 offen offset:2048 nt lds
    v_mfma_f32_16x16x32_bf16 v[184:187], v[120:123], a[136:139], v[184:187]
    ds_read_b128 v[100:103], v17 offset:8192
    v_mfma_f32_16x16x32_bf16 v[184:187], v[124:127], a[152:155], v[184:187]
    ds_read_b64_tr_b16 a[168:169], v20 offset:0
    v_mfma_f32_16x16x32_bf16 v[188:191], v[120:123], a[140:143], v[188:191]
    ds_read_b128 v[104:107], v16 offset:10240
    v_mfma_f32_16x16x32_bf16 v[188:191], v[124:127], a[156:159], v[188:191]
    buffer_load_dwordx4 v15, s[32:35], s51 offen offset:3072 nt lds
    v_mfma_f32_16x16x32_bf16 v[192:195], v[32:35], a[128:131], v[192:195]
    ds_read_b64_tr_b16 a[170:171], v20 offset:1024
    v_mfma_f32_16x16x32_bf16 v[192:195], v[36:39], a[144:147], v[192:195]
    ds_read_b128 v[108:111], v17 offset:10240
    v_mfma_f32_16x16x32_bf16 v[196:199], v[32:35], a[132:135], v[196:199]
    s_lshr_b32 m0, s96, 1
    s_add_u32 m0, m0, 81920
    s_add_u32 s51, s54, 896
    v_mfma_f32_16x16x32_bf16 v[196:199], v[36:39], a[148:151], v[196:199]
    buffer_load_dwordx4 v8, s[28:31], s51 offen offset:0 lds
    v_mfma_f32_16x16x32_bf16 v[200:203], v[32:35], a[136:139], v[200:203]
    ds_read_b128 v[112:115], v16 offset:12288
    ds_read_b64_tr_b16 a[184:185], v20 offset:8192
    v_mfma_f32_16x16x32_bf16 v[200:203], v[36:39], a[152:155], v[200:203]
    v_mfma_f32_16x16x32_bf16 v[204:207], v[32:35], a[140:143], v[204:207]
    ds_read_b64_tr_b16 a[186:187], v20 offset:9216
    v_mfma_f32_16x16x32_bf16 v[204:207], v[36:39], a[156:159], v[204:207]
    buffer_load_dwordx4 v9, s[28:31], s51 offen offset:1024 lds
    v_mfma_f32_16x16x32_bf16 v[208:211], v[40:43], a[128:131], v[208:211]
    ds_read_b128 v[116:119], v17 offset:12288
    v_mfma_f32_16x16x32_bf16 v[208:211], v[44:47], a[144:147], v[208:211]
    v_mfma_f32_16x16x32_bf16 v[212:215], v[40:43], a[132:135], v[212:215]
    ds_read_b128 v[120:123], v16 offset:14336
    ds_read_b64_tr_b16 a[172:173], v21 offset:0
    v_mfma_f32_16x16x32_bf16 v[212:215], v[44:47], a[148:151], v[212:215]
    v_mfma_f32_16x16x32_bf16 v[216:219], v[40:43], a[136:139], v[216:219]
    buffer_load_dwordx4 v10, s[28:31], s51 offen offset:2048 lds
    v_mfma_f32_16x16x32_bf16 v[216:219], v[44:47], a[152:155], v[216:219]
    ds_read_b128 v[124:127], v17 offset:14336
    v_mfma_f32_16x16x32_bf16 v[220:223], v[40:43], a[140:143], v[220:223]
    ds_read_b64_tr_b16 a[174:175], v21 offset:1024
    v_mfma_f32_16x16x32_bf16 v[220:223], v[44:47], a[156:159], v[220:223]
    v_mfma_f32_16x16x32_bf16 v[224:227], v[48:51], a[128:131], v[224:227]
    buffer_load_dwordx4 v11, s[28:31], s51 offen offset:3072 lds
    v_mfma_f32_16x16x32_bf16 v[224:227], v[52:55], a[144:147], v[224:227]
    ds_read_b64_tr_b16 a[188:189], v21 offset:8192
    v_mfma_f32_16x16x32_bf16 v[228:231], v[48:51], a[132:135], v[228:231]
    v_mfma_f32_16x16x32_bf16 v[228:231], v[52:55], a[148:151], v[228:231]
    v_mfma_f32_16x16x32_bf16 v[232:235], v[48:51], a[136:139], v[232:235]
    s_mov_b32 s64, s12
    s_mov_b32 s65, s13
    v_mfma_f32_16x16x32_bf16 v[232:235], v[52:55], a[152:155], v[232:235]
    ds_read_b64_tr_b16 a[190:191], v21 offset:9216
    v_mfma_f32_16x16x32_bf16 v[236:239], v[48:51], a[140:143], v[236:239]
    v_mfma_f32_16x16x32_bf16 v[236:239], v[52:55], a[156:159], v[236:239]
    v_mfma_f32_16x16x32_bf16 v[240:243], v[56:59], a[128:131], v[240:243]
    s_mov_b32 s66, 2097152
    s_mov_b32 s67, 0x20000
    v_mfma_f32_16x16x32_bf16 v[240:243], v[60:63], a[144:147], v[240:243]
    v_mfma_f32_16x16x32_bf16 v[244:247], v[56:59], a[132:135], v[244:247]
    v_mfma_f32_16x16x32_bf16 v[244:247], v[60:63], a[148:151], v[244:247]
    s_mov_b32 s68, 0
    v_add_u32 v16, 0xfffe8000, v16
    v_mfma_f32_16x16x32_bf16 v[248:251], v[56:59], a[136:139], v[248:251]
    buffer_load_dword v0, v29, s[64:67], s68 offen
    v_mfma_f32_16x16x32_bf16 v[248:251], v[60:63], a[152:155], v[248:251]
    v_add_u32 v17, 0xfffe8000, v17
    v_add_u32 v18, 0xfffe8000, v18
    v_mfma_f32_16x16x32_bf16 v[252:255], v[56:59], a[140:143], v[252:255]
    v_add_u32 v19, 0xfffe8000, v19
    v_add_u32 v20, 0xfffe8000, v20
    v_mfma_f32_16x16x32_bf16 v[252:255], v[60:63], a[156:159], v[252:255]
    v_add_u32 v21, 0xfffe8000, v21
    s_waitcnt vmcnt(13) lgkmcnt(0)
    s_barrier
    v_mfma_f32_16x16x32_bf16 v[128:131], v[64:67], a[160:163], v[128:131]
    ds_read_b128 v[32:35], v16 offset:0
    ds_read_b64_tr_b16 a[192:193], v18 offset:0
    v_mfma_f32_16x16x32_bf16 v[128:131], v[68:71], a[176:179], v[128:131]
    s_lshr_b32 m0, s96, 1
    s_add_u32 m0, m0, 98304
    s_add_u32 s51, s3, 131072
    v_mfma_f32_16x16x32_bf16 v[132:135], v[64:67], a[164:167], v[132:135]
    buffer_load_dwordx4 v5, s[28:31], s51 offen offset:0 lds
    v_mfma_f32_16x16x32_bf16 v[132:135], v[68:71], a[180:183], v[132:135]
    ds_read_b128 v[36:39], v17 offset:0
    v_mfma_f32_16x16x32_bf16 v[136:139], v[64:67], a[168:171], v[136:139]
    v_mfma_f32_16x16x32_bf16 v[136:139], v[68:71], a[184:187], v[136:139]
    ds_read_b64_tr_b16 a[194:195], v18 offset:1024
    v_mfma_f32_16x16x32_bf16 v[140:143], v[64:67], a[172:175], v[140:143]
    ds_read_b128 v[40:43], v16 offset:2048
    v_mfma_f32_16x16x32_bf16 v[140:143], v[68:71], a[188:191], v[140:143]
    ds_read_b64_tr_b16 a[208:209], v18 offset:8192
    v_mfma_f32_16x16x32_bf16 v[144:147], v[72:75], a[160:163], v[144:147]
    buffer_load_dwordx4 v6, s[28:31], s51 offen offset:1024 lds
    v_mfma_f32_16x16x32_bf16 v[144:147], v[76:79], a[176:179], v[144:147]
    ds_read_b128 v[44:47], v17 offset:2048
    v_mfma_f32_16x16x32_bf16 v[148:151], v[72:75], a[164:167], v[148:151]
    v_mfma_f32_16x16x32_bf16 v[148:151], v[76:79], a[180:183], v[148:151]
    v_mfma_f32_16x16x32_bf16 v[152:155], v[72:75], a[168:171], v[152:155]
    ds_read_b128 v[48:51], v16 offset:4096
    ds_read_b64_tr_b16 a[210:211], v18 offset:9216
    v_mfma_f32_16x16x32_bf16 v[152:155], v[76:79], a[184:187], v[152:155]
    v_mfma_f32_16x16x32_bf16 v[156:159], v[72:75], a[172:175], v[156:159]
    buffer_load_dwordx4 v7, s[28:31], s51 offen offset:2048 lds
    v_mfma_f32_16x16x32_bf16 v[156:159], v[76:79], a[188:191], v[156:159]
    ds_read_b128 v[52:55], v17 offset:4096
    ds_read_b64_tr_b16 a[196:197], v19 offset:0
    v_mfma_f32_16x16x32_bf16 v[160:163], v[80:83], a[160:163], v[160:163]
    v_mfma_f32_16x16x32_bf16 v[160:163], v[84:87], a[176:179], v[160:163]
    v_mfma_f32_16x16x32_bf16 v[164:167], v[80:83], a[164:167], v[164:167]
    ds_read_b128 v[56:59], v16 offset:6144
    ds_read_b64_tr_b16 a[198:199], v19 offset:1024
    v_mfma_f32_16x16x32_bf16 v[164:167], v[84:87], a[180:183], v[164:167]
    v_mfma_f32_16x16x32_bf16 v[168:171], v[80:83], a[168:171], v[168:171]
    buffer_load_dwordx4 v28, s[28:31], s51 offen offset:3072 lds
    v_mfma_f32_16x16x32_bf16 v[168:171], v[84:87], a[184:187], v[168:171]
    ds_read_b128 v[60:63], v17 offset:6144
    v_mfma_f32_16x16x32_bf16 v[172:175], v[80:83], a[172:175], v[172:175]
    ds_read_b64_tr_b16 a[212:213], v19 offset:8192
    v_mfma_f32_16x16x32_bf16 v[172:175], v[84:87], a[188:191], v[172:175]
    v_mfma_f32_16x16x32_bf16 v[176:179], v[88:91], a[160:163], v[176:179]
    s_lshr_b32 m0, s96, 1
    s_add_u32 m0, m0, 114688
    s_add_u32 s51, s3, 147456
    v_mfma_f32_16x16x32_bf16 v[176:179], v[92:95], a[176:179], v[176:179]
    buffer_load_dwordx4 v5, s[28:31], s51 offen offset:0 lds
    v_mfma_f32_16x16x32_bf16 v[180:183], v[88:91], a[164:167], v[180:183]
    ds_read_b128 v[64:67], v16 offset:8192
    ds_read_b64_tr_b16 a[214:215], v19 offset:9216
    v_mfma_f32_16x16x32_bf16 v[180:183], v[92:95], a[180:183], v[180:183]
    ds_read_b128 v[68:71], v17 offset:8192
    v_mfma_f32_16x16x32_bf16 v[184:187], v[88:91], a[168:171], v[184:187]
    v_mfma_f32_16x16x32_bf16 v[184:187], v[92:95], a[184:187], v[184:187]
    ds_read_b64_tr_b16 a[200:201], v20 offset:0
    v_mfma_f32_16x16x32_bf16 v[188:191], v[88:91], a[172:175], v[188:191]
    ds_read_b128 v[72:75], v16 offset:10240
    v_mfma_f32_16x16x32_bf16 v[188:191], v[92:95], a[188:191], v[188:191]
    buffer_load_dwordx4 v6, s[28:31], s51 offen offset:1024 lds
    v_mfma_f32_16x16x32_bf16 v[192:195], v[96:99], a[160:163], v[192:195]
    ds_read_b64_tr_b16 a[202:203], v20 offset:1024
    v_mfma_f32_16x16x32_bf16 v[192:195], v[100:103], a[176:179], v[192:195]
    ds_read_b128 v[76:79], v17 offset:10240
    v_mfma_f32_16x16x32_bf16 v[196:199], v[96:99], a[164:167], v[196:199]
    v_mfma_f32_16x16x32_bf16 v[196:199], v[100:103], a[180:183], v[196:199]
    v_mfma_f32_16x16x32_bf16 v[200:203], v[96:99], a[168:171], v[200:203]
    ds_read_b128 v[80:83], v16 offset:12288
    ds_read_b64_tr_b16 a[216:217], v20 offset:8192
    v_mfma_f32_16x16x32_bf16 v[200:203], v[100:103], a[184:187], v[200:203]
    buffer_load_dwordx4 v7, s[28:31], s51 offen offset:2048 lds
    v_mfma_f32_16x16x32_bf16 v[204:207], v[96:99], a[172:175], v[204:207]
    v_mfma_f32_16x16x32_bf16 v[204:207], v[100:103], a[188:191], v[204:207]
    ds_read_b128 v[84:87], v17 offset:12288
    ds_read_b64_tr_b16 a[218:219], v20 offset:9216
    v_mfma_f32_16x16x32_bf16 v[208:211], v[104:107], a[160:163], v[208:211]
    v_mfma_f32_16x16x32_bf16 v[208:211], v[108:111], a[176:179], v[208:211]
    ds_read_b64_tr_b16 a[204:205], v21 offset:0
    v_mfma_f32_16x16x32_bf16 v[212:215], v[104:107], a[164:167], v[212:215]
    buffer_load_dwordx4 v28, s[28:31], s51 offen offset:3072 lds
    v_mfma_f32_16x16x32_bf16 v[212:215], v[108:111], a[180:183], v[212:215]
    ds_read_b128 v[88:91], v16 offset:14336
    v_mfma_f32_16x16x32_bf16 v[216:219], v[104:107], a[168:171], v[216:219]
    v_mfma_f32_16x16x32_bf16 v[216:219], v[108:111], a[184:187], v[216:219]
    ds_read_b128 v[92:95], v17 offset:14336
    v_mfma_f32_16x16x32_bf16 v[220:223], v[104:107], a[172:175], v[220:223]
    ds_read_b64_tr_b16 a[206:207], v21 offset:1024
    v_mfma_f32_16x16x32_bf16 v[220:223], v[108:111], a[188:191], v[220:223]
    v_mfma_f32_16x16x32_bf16 v[224:227], v[112:115], a[160:163], v[224:227]
    s_mov_b32 s64, s10
    s_mov_b32 s65, s11
    v_mfma_f32_16x16x32_bf16 v[224:227], v[116:119], a[176:179], v[224:227]
    ds_read_b64_tr_b16 a[220:221], v21 offset:8192
    v_mfma_f32_16x16x32_bf16 v[228:231], v[112:115], a[164:167], v[228:231]
    v_mfma_f32_16x16x32_bf16 v[228:231], v[116:119], a[180:183], v[228:231]
    v_mfma_f32_16x16x32_bf16 v[232:235], v[112:115], a[168:171], v[232:235]
    v_mfma_f32_16x16x32_bf16 v[232:235], v[116:119], a[184:187], v[232:235]
    ds_read_b64_tr_b16 a[222:223], v21 offset:9216
    v_mfma_f32_16x16x32_bf16 v[236:239], v[112:115], a[172:175], v[236:239]
    s_mov_b32 s66, 2097152
    s_mov_b32 s67, 0x20000
    v_mfma_f32_16x16x32_bf16 v[236:239], v[116:119], a[188:191], v[236:239]
    v_mfma_f32_16x16x32_bf16 v[240:243], v[120:123], a[160:163], v[240:243]
    v_mfma_f32_16x16x32_bf16 v[240:243], v[124:127], a[176:179], v[240:243]
    v_mfma_f32_16x16x32_bf16 v[244:247], v[120:123], a[164:167], v[244:247]
    v_mfma_f32_16x16x32_bf16 v[244:247], v[124:127], a[180:183], v[244:247]
    s_mov_b32 s68, 0
    v_add_u32 v16, 0xc000, v16
    v_mfma_f32_16x16x32_bf16 v[248:251], v[120:123], a[168:171], v[248:251]
    buffer_load_dword v0, v29, s[64:67], s68 offen
    v_mfma_f32_16x16x32_bf16 v[248:251], v[124:127], a[184:187], v[248:251]
    v_add_u32 v17, 0xc000, v17
    v_add_u32 v18, 0xc000, v18
    v_mfma_f32_16x16x32_bf16 v[252:255], v[120:123], a[172:175], v[252:255]
    v_add_u32 v19, 0xc000, v19
    v_add_u32 v20, 0xc000, v20
    v_mfma_f32_16x16x32_bf16 v[252:255], v[124:127], a[188:191], v[252:255]
    v_add_u32 v21, 0xc000, v21
    s_waitcnt vmcnt(10) lgkmcnt(0)
    s_barrier
    v_mfma_f32_16x16x32_bf16 v[128:131], v[32:35], a[192:195], v[128:131]
    ds_read_b128 v[96:99], v16 offset:0
    v_mfma_f32_16x16x32_bf16 v[128:131], v[36:39], a[208:211], v[128:131]
    ds_read_b64_tr_b16 a[224:225], v18 offset:0
    v_mfma_f32_16x16x32_bf16 v[132:135], v[32:35], a[196:199], v[132:135]
    s_lshr_b32 m0, s96, 1
    s_add_u32 m0, m0, 131072
    s_add_u32 s51, s3, 163840
    v_mfma_f32_16x16x32_bf16 v[132:135], v[36:39], a[212:215], v[132:135]
    buffer_load_dwordx4 v5, s[28:31], s51 offen offset:0 lds
    v_mfma_f32_16x16x32_bf16 v[136:139], v[32:35], a[200:203], v[136:139]
    ds_read_b128 v[100:103], v17 offset:0
    v_mfma_f32_16x16x32_bf16 v[136:139], v[36:39], a[216:219], v[136:139]
    ds_read_b64_tr_b16 a[226:227], v18 offset:1024
    v_mfma_f32_16x16x32_bf16 v[140:143], v[32:35], a[204:207], v[140:143]
    ds_read_b128 v[104:107], v16 offset:2048
    v_mfma_f32_16x16x32_bf16 v[140:143], v[36:39], a[220:223], v[140:143]
    v_mfma_f32_16x16x32_bf16 v[144:147], v[40:43], a[192:195], v[144:147]
    ds_read_b64_tr_b16 a[240:241], v18 offset:8192
    s_and_b32 s52, s48, 1
    v_mfma_f32_16x16x32_bf16 v[144:147], v[44:47], a[208:211], v[144:147]
    ds_read_b128 v[108:111], v17 offset:2048
    v_mfma_f32_16x16x32_bf16 v[148:151], v[40:43], a[196:199], v[148:151]
    v_mfma_f32_16x16x32_bf16 v[148:151], v[44:47], a[212:215], v[148:151]
    buffer_load_dwordx4 v6, s[28:31], s51 offen offset:1024 lds
    v_mfma_f32_16x16x32_bf16 v[152:155], v[40:43], a[200:203], v[152:155]
    ds_read_b128 v[112:115], v16 offset:4096
    ds_read_b64_tr_b16 a[242:243], v18 offset:9216
    v_mfma_f32_16x16x32_bf16 v[152:155], v[44:47], a[216:219], v[152:155]
    v_mfma_f32_16x16x32_bf16 v[156:159], v[40:43], a[204:207], v[156:159]
    v_mfma_f32_16x16x32_bf16 v[156:159], v[44:47], a[220:223], v[156:159]
    ds_read_b128 v[116:119], v17 offset:4096
    ds_read_b64_tr_b16 a[228:229], v19 offset:0
    v_mfma_f32_16x16x32_bf16 v[160:163], v[48:51], a[192:195], v[160:163]
    v_mfma_f32_16x16x32_bf16 v[160:163], v[52:55], a[208:211], v[160:163]
    v_mfma_f32_16x16x32_bf16 v[164:167], v[48:51], a[196:199], v[164:167]
    ds_read_b128 v[120:123], v16 offset:6144
    ds_read_b64_tr_b16 a[230:231], v19 offset:1024
    v_mfma_f32_16x16x32_bf16 v[164:167], v[52:55], a[212:215], v[164:167]
    buffer_load_dwordx4 v7, s[28:31], s51 offen offset:2048 lds
    v_mfma_f32_16x16x32_bf16 v[168:171], v[48:51], a[200:203], v[168:171]
    v_mfma_f32_16x16x32_bf16 v[168:171], v[52:55], a[216:219], v[168:171]
    ds_read_b128 v[124:127], v17 offset:6144
    v_mfma_f32_16x16x32_bf16 v[172:175], v[48:51], a[204:207], v[172:175]
    ds_read_b64_tr_b16 a[244:245], v19 offset:8192
    v_mfma_f32_16x16x32_bf16 v[172:175], v[52:55], a[220:223], v[172:175]
    v_mfma_f32_16x16x32_bf16 v[176:179], v[56:59], a[192:195], v[176:179]
    ds_read_b128 v[32:35], v16 offset:8192
    s_lshl_b32 s52, s52, 12
    v_mfma_f32_16x16x32_bf16 v[176:179], v[60:63], a[208:211], v[176:179]
    ds_read_b64_tr_b16 a[246:247], v19 offset:9216
    v_mfma_f32_16x16x32_bf16 v[180:183], v[56:59], a[196:199], v[180:183]
    v_mfma_f32_16x16x32_bf16 v[180:183], v[60:63], a[212:215], v[180:183]
    buffer_load_dwordx4 v28, s[28:31], s51 offen offset:3072 lds
    v_mfma_f32_16x16x32_bf16 v[184:187], v[56:59], a[200:203], v[184:187]
    ds_read_b128 v[36:39], v17 offset:8192
    v_mfma_f32_16x16x32_bf16 v[184:187], v[60:63], a[216:219], v[184:187]
    ds_read_b64_tr_b16 a[232:233], v20 offset:0
    v_mfma_f32_16x16x32_bf16 v[188:191], v[56:59], a[204:207], v[188:191]
    ds_read_b128 v[40:43], v16 offset:10240
    v_mfma_f32_16x16x32_bf16 v[188:191], v[60:63], a[220:223], v[188:191]
    v_mfma_f32_16x16x32_bf16 v[192:195], v[64:67], a[192:195], v[192:195]
    ds_read_b64_tr_b16 a[234:235], v20 offset:1024
    v_mfma_f32_16x16x32_bf16 v[192:195], v[68:71], a[208:211], v[192:195]
    ds_read_b128 v[44:47], v17 offset:10240
    v_mfma_f32_16x16x32_bf16 v[196:199], v[64:67], a[196:199], v[196:199]
    s_lshr_b32 m0, s96, 1
    s_add_u32 m0, m0, 147456
    s_add_u32 s51, s3, 180224
    v_mfma_f32_16x16x32_bf16 v[196:199], v[68:71], a[212:215], v[196:199]
    buffer_load_dwordx4 v5, s[28:31], s51 offen offset:0 lds
    v_mfma_f32_16x16x32_bf16 v[200:203], v[64:67], a[200:203], v[200:203]
    ds_read_b128 v[48:51], v16 offset:12288
    ds_read_b64_tr_b16 a[248:249], v20 offset:8192
    v_mfma_f32_16x16x32_bf16 v[200:203], v[68:71], a[216:219], v[200:203]
    v_mfma_f32_16x16x32_bf16 v[204:207], v[64:67], a[204:207], v[204:207]
    v_mfma_f32_16x16x32_bf16 v[204:207], v[68:71], a[220:223], v[204:207]
    ds_read_b128 v[52:55], v17 offset:12288
    ds_read_b64_tr_b16 a[250:251], v20 offset:9216
    v_mfma_f32_16x16x32_bf16 v[208:211], v[72:75], a[192:195], v[208:211]
    v_add_u32 v26, s52, v2
    v_mfma_f32_16x16x32_bf16 v[208:211], v[76:79], a[208:211], v[208:211]
    v_mfma_f32_16x16x32_bf16 v[212:215], v[72:75], a[196:199], v[212:215]
    ds_read_b128 v[56:59], v16 offset:14336
    ds_read_b64_tr_b16 a[236:237], v21 offset:0
    v_mfma_f32_16x16x32_bf16 v[212:215], v[76:79], a[212:215], v[212:215]
    buffer_load_dwordx4 v6, s[28:31], s51 offen offset:1024 lds
    v_mfma_f32_16x16x32_bf16 v[216:219], v[72:75], a[200:203], v[216:219]
    v_mfma_f32_16x16x32_bf16 v[216:219], v[76:79], a[216:219], v[216:219]
    ds_read_b128 v[60:63], v17 offset:14336
    v_mfma_f32_16x16x32_bf16 v[220:223], v[72:75], a[204:207], v[220:223]
    ds_read_b64_tr_b16 a[238:239], v21 offset:1024
    v_mfma_f32_16x16x32_bf16 v[220:223], v[76:79], a[220:223], v[220:223]
    v_mfma_f32_16x16x32_bf16 v[224:227], v[80:83], a[192:195], v[224:227]
    v_mfma_f32_16x16x32_bf16 v[224:227], v[84:87], a[208:211], v[224:227]
    ds_read_b64_tr_b16 a[252:253], v21 offset:8192
    v_mfma_f32_16x16x32_bf16 v[228:231], v[80:83], a[196:199], v[228:231]
    v_mfma_f32_16x16x32_bf16 v[228:231], v[84:87], a[212:215], v[228:231]
    buffer_load_dwordx4 v7, s[28:31], s51 offen offset:2048 lds
    v_mfma_f32_16x16x32_bf16 v[232:235], v[80:83], a[200:203], v[232:235]
    v_mfma_f32_16x16x32_bf16 v[232:235], v[84:87], a[216:219], v[232:235]
    ds_read_b64_tr_b16 a[254:255], v21 offset:9216
    v_mfma_f32_16x16x32_bf16 v[236:239], v[80:83], a[204:207], v[236:239]
    v_mfma_f32_16x16x32_bf16 v[236:239], v[84:87], a[220:223], v[236:239]
    v_mfma_f32_16x16x32_bf16 v[240:243], v[88:91], a[192:195], v[240:243]
    v_add_u32 v27, 2048, v26
    v_mfma_f32_16x16x32_bf16 v[240:243], v[92:95], a[208:211], v[240:243]
    v_mfma_f32_16x16x32_bf16 v[244:247], v[88:91], a[196:199], v[244:247]
    v_mfma_f32_16x16x32_bf16 v[244:247], v[92:95], a[212:215], v[244:247]
    buffer_load_dwordx4 v28, s[28:31], s51 offen offset:3072 lds
    v_mfma_f32_16x16x32_bf16 v[248:251], v[88:91], a[200:203], v[248:251]
    v_mfma_f32_16x16x32_bf16 v[248:251], v[92:95], a[216:219], v[248:251]
    v_mfma_f32_16x16x32_bf16 v[252:255], v[88:91], a[204:207], v[252:255]
    v_mfma_f32_16x16x32_bf16 v[252:255], v[92:95], a[220:223], v[252:255]
    s_waitcnt vmcnt(9) lgkmcnt(0)
    s_barrier
    v_mfma_f32_16x16x32_bf16 v[128:131], v[96:99], a[224:227], v[128:131]
    ds_read_b128 v[64:67], v22 offset:0
    v_mfma_f32_16x16x32_bf16 v[128:131], v[100:103], a[240:243], v[128:131]
    s_lshr_b32 m0, s96, 1
    s_add_u32 m0, m0, 0
    s_add_u32 s51, s3, 196608
    v_mfma_f32_16x16x32_bf16 v[132:135], v[96:99], a[228:231], v[132:135]
    buffer_load_dwordx4 v5, s[28:31], s51 offen offset:0 lds
    v_mfma_f32_16x16x32_bf16 v[132:135], v[100:103], a[244:247], v[132:135]
    ds_read_b128 v[68:71], v23 offset:0
    v_mfma_f32_16x16x32_bf16 v[136:139], v[96:99], a[232:235], v[136:139]
    v_mfma_f32_16x16x32_bf16 v[136:139], v[100:103], a[248:251], v[136:139]
    v_mfma_f32_16x16x32_bf16 v[140:143], v[96:99], a[236:239], v[140:143]
    ds_read_b128 v[72:75], v24 offset:0
    v_mfma_f32_16x16x32_bf16 v[140:143], v[100:103], a[252:255], v[140:143]
    v_mfma_f32_16x16x32_bf16 v[144:147], v[104:107], a[224:227], v[144:147]
    buffer_load_dwordx4 v6, s[28:31], s51 offen offset:1024 lds
    v_mfma_f32_16x16x32_bf16 v[144:147], v[108:111], a[240:243], v[144:147]
    ds_read_b128 v[76:79], v25 offset:0
    v_mfma_f32_16x16x32_bf16 v[148:151], v[104:107], a[228:231], v[148:151]
    v_mfma_f32_16x16x32_bf16 v[148:151], v[108:111], a[244:247], v[148:151]
    v_mfma_f32_16x16x32_bf16 v[152:155], v[104:107], a[232:235], v[152:155]
    ds_read_b128 v[80:83], v22 offset:256
    v_mfma_f32_16x16x32_bf16 v[152:155], v[108:111], a[248:251], v[152:155]
    v_mfma_f32_16x16x32_bf16 v[156:159], v[104:107], a[236:239], v[156:159]
    buffer_load_dwordx4 v7, s[28:31], s51 offen offset:2048 lds
    v_mfma_f32_16x16x32_bf16 v[156:159], v[108:111], a[252:255], v[156:159]
    ds_read_b128 v[84:87], v23 offset:256
    v_mfma_f32_16x16x32_bf16 v[160:163], v[112:115], a[224:227], v[160:163]
    v_mfma_f32_16x16x32_bf16 v[160:163], v[116:119], a[240:243], v[160:163]
    v_mfma_f32_16x16x32_bf16 v[164:167], v[112:115], a[228:231], v[164:167]
    ds_read_b128 v[88:91], v24 offset:256
    v_mfma_f32_16x16x32_bf16 v[164:167], v[116:119], a[244:247], v[164:167]
    v_mfma_f32_16x16x32_bf16 v[168:171], v[112:115], a[232:235], v[168:171]
    buffer_load_dwordx4 v28, s[28:31], s51 offen offset:3072 lds
    v_mfma_f32_16x16x32_bf16 v[168:171], v[116:119], a[248:251], v[168:171]
    ds_read_b128 v[92:95], v25 offset:256
    v_mfma_f32_16x16x32_bf16 v[172:175], v[112:115], a[236:239], v[172:175]
    v_mfma_f32_16x16x32_bf16 v[172:175], v[116:119], a[252:255], v[172:175]
    v_mfma_f32_16x16x32_bf16 v[176:179], v[120:123], a[224:227], v[176:179]
    s_lshr_b32 m0, s96, 1
    s_add_u32 m0, m0, 16384
    s_add_u32 s51, s3, 212992
    v_mfma_f32_16x16x32_bf16 v[176:179], v[124:127], a[240:243], v[176:179]
    buffer_load_dwordx4 v5, s[28:31], s51 offen offset:0 lds
    v_mfma_f32_16x16x32_bf16 v[180:183], v[120:123], a[228:231], v[180:183]
    ds_read_b128 v[96:99], v22 offset:512
    v_mfma_f32_16x16x32_bf16 v[180:183], v[124:127], a[244:247], v[180:183]
    ds_read_b128 v[100:103], v23 offset:512
    v_mfma_f32_16x16x32_bf16 v[184:187], v[120:123], a[232:235], v[184:187]
    v_mfma_f32_16x16x32_bf16 v[184:187], v[124:127], a[248:251], v[184:187]
    v_mfma_f32_16x16x32_bf16 v[188:191], v[120:123], a[236:239], v[188:191]
    ds_read_b128 v[104:107], v24 offset:512
    v_mfma_f32_16x16x32_bf16 v[188:191], v[124:127], a[252:255], v[188:191]
    buffer_load_dwordx4 v6, s[28:31], s51 offen offset:1024 lds
    v_mfma_f32_16x16x32_bf16 v[192:195], v[32:35], a[224:227], v[192:195]
    v_mfma_f32_16x16x32_bf16 v[192:195], v[36:39], a[240:243], v[192:195]
    ds_read_b128 v[108:111], v25 offset:512
    v_mfma_f32_16x16x32_bf16 v[196:199], v[32:35], a[228:231], v[196:199]
    v_mfma_f32_16x16x32_bf16 v[196:199], v[36:39], a[244:247], v[196:199]
    v_mfma_f32_16x16x32_bf16 v[200:203], v[32:35], a[232:235], v[200:203]
    ds_read_b128 v[112:115], v22 offset:768
    v_mfma_f32_16x16x32_bf16 v[200:203], v[36:39], a[248:251], v[200:203]
    buffer_load_dwordx4 v7, s[28:31], s51 offen offset:2048 lds
    v_mfma_f32_16x16x32_bf16 v[204:207], v[32:35], a[236:239], v[204:207]
    v_mfma_f32_16x16x32_bf16 v[204:207], v[36:39], a[252:255], v[204:207]
    ds_read_b128 v[116:119], v23 offset:768
    v_mfma_f32_16x16x32_bf16 v[208:211], v[40:43], a[224:227], v[208:211]
    v_mfma_f32_16x16x32_bf16 v[208:211], v[44:47], a[240:243], v[208:211]
    v_mfma_f32_16x16x32_bf16 v[212:215], v[40:43], a[228:231], v[212:215]
    buffer_load_dwordx4 v28, s[28:31], s51 offen offset:3072 lds
    v_mfma_f32_16x16x32_bf16 v[212:215], v[44:47], a[244:247], v[212:215]
    ds_read_b128 v[120:123], v24 offset:768
    v_mfma_f32_16x16x32_bf16 v[216:219], v[40:43], a[232:235], v[216:219]
    v_mfma_f32_16x16x32_bf16 v[216:219], v[44:47], a[248:251], v[216:219]
    ds_read_b128 v[124:127], v25 offset:768
    v_mfma_f32_16x16x32_bf16 v[220:223], v[40:43], a[236:239], v[220:223]
    v_mfma_f32_16x16x32_bf16 v[220:223], v[44:47], a[252:255], v[220:223]
    v_mfma_f32_16x16x32_bf16 v[224:227], v[48:51], a[224:227], v[224:227]
    s_mov_b32 s64, s14
    s_mov_b32 s65, s15
    v_mfma_f32_16x16x32_bf16 v[224:227], v[52:55], a[240:243], v[224:227]
    v_mfma_f32_16x16x32_bf16 v[228:231], v[48:51], a[228:231], v[228:231]
    v_mfma_f32_16x16x32_bf16 v[228:231], v[52:55], a[244:247], v[228:231]
    v_mfma_f32_16x16x32_bf16 v[232:235], v[48:51], a[232:235], v[232:235]
    v_mfma_f32_16x16x32_bf16 v[232:235], v[52:55], a[248:251], v[232:235]
    v_mfma_f32_16x16x32_bf16 v[236:239], v[48:51], a[236:239], v[236:239]
    s_mov_b32 s66, 4194304
    s_mov_b32 s67, 0x20000
    v_mfma_f32_16x16x32_bf16 v[236:239], v[52:55], a[252:255], v[236:239]
    v_mfma_f32_16x16x32_bf16 v[240:243], v[56:59], a[224:227], v[240:243]
    v_mfma_f32_16x16x32_bf16 v[240:243], v[60:63], a[240:243], v[240:243]
    v_mfma_f32_16x16x32_bf16 v[244:247], v[56:59], a[228:231], v[244:247]
    v_mfma_f32_16x16x32_bf16 v[244:247], v[60:63], a[244:247], v[244:247]
    s_mov_b32 s68, 0
    v_mfma_f32_16x16x32_bf16 v[248:251], v[56:59], a[232:235], v[248:251]
    buffer_load_dword v0, v31, s[64:67], s68 offen
    v_mfma_f32_16x16x32_bf16 v[248:251], v[60:63], a[248:251], v[248:251]
    v_mfma_f32_16x16x32_bf16 v[252:255], v[56:59], a[236:239], v[252:255]
    v_mfma_f32_16x16x32_bf16 v[252:255], v[60:63], a[252:255], v[252:255]
    v_cvt_pk_bf16_f32 v147, v146, v147
    v_cvt_pk_bf16_f32 v146, v144, v145
    v_cvt_pk_bf16_f32 v145, v130, v131
    v_cvt_pk_bf16_f32 v144, v128, v129
    v_cvt_pk_bf16_f32 v151, v150, v151
    v_cvt_pk_bf16_f32 v150, v148, v149
    v_cvt_pk_bf16_f32 v149, v134, v135
    v_cvt_pk_bf16_f32 v148, v132, v133
    v_cvt_pk_bf16_f32 v155, v154, v155
    v_cvt_pk_bf16_f32 v154, v152, v153
    v_cvt_pk_bf16_f32 v153, v138, v139
    v_cvt_pk_bf16_f32 v152, v136, v137
    v_cvt_pk_bf16_f32 v159, v158, v159
    v_cvt_pk_bf16_f32 v158, v156, v157
    v_cvt_pk_bf16_f32 v157, v142, v143
    v_cvt_pk_bf16_f32 v156, v140, v141
    s_waitcnt lgkmcnt(0)
    v_mfma_f32_16x16x32_bf16 v[128:131], v[64:67], a[0:3], 0
    ds_read_b128 v[32:35], v22 offset:16384
    v_mfma_f32_16x16x32_bf16 v[132:135], v[64:67], a[4:7], 0
    v_mfma_f32_16x16x32_bf16 v[136:139], v[64:67], a[8:11], 0
    v_mfma_f32_16x16x32_bf16 v[140:143], v[64:67], a[12:15], 0
    ds_read_b128 v[36:39], v23 offset:16384
    v_mfma_f32_16x16x32_bf16 v[128:131], v[68:71], a[16:19], v[128:131]
    v_mfma_f32_16x16x32_bf16 v[132:135], v[68:71], a[20:23], v[132:135]
    v_mfma_f32_16x16x32_bf16 v[136:139], v[68:71], a[24:27], v[136:139]
    ds_read_b128 v[40:43], v24 offset:16384
    v_mfma_f32_16x16x32_bf16 v[140:143], v[68:71], a[28:31], v[140:143]
    v_mfma_f32_16x16x32_bf16 v[128:131], v[72:75], a[32:35], v[128:131]
    v_mfma_f32_16x16x32_bf16 v[132:135], v[72:75], a[36:39], v[132:135]
    ds_read_b128 v[44:47], v25 offset:16384
    v_mfma_f32_16x16x32_bf16 v[136:139], v[72:75], a[40:43], v[136:139]
    s_mov_b32 s53, 0
    v_mfma_f32_16x16x32_bf16 v[140:143], v[72:75], a[44:47], v[140:143]
    buffer_store_dwordx4 v[144:147], v26, s[36:39], s53 offen offset:0 sc1
    v_mfma_f32_16x16x32_bf16 v[128:131], v[76:79], a[48:51], v[128:131]
    ds_read_b128 v[48:51], v22 offset:16640
    v_mfma_f32_16x16x32_bf16 v[132:135], v[76:79], a[52:55], v[132:135]
    v_mfma_f32_16x16x32_bf16 v[136:139], v[76:79], a[56:59], v[136:139]
    v_mfma_f32_16x16x32_bf16 v[140:143], v[76:79], a[60:63], v[140:143]
    ds_read_b128 v[52:55], v23 offset:16640
    v_mfma_f32_16x16x32_bf16 v[128:131], v[80:83], a[64:67], v[128:131]
    v_mfma_f32_16x16x32_bf16 v[132:135], v[80:83], a[68:71], v[132:135]
    v_mfma_f32_16x16x32_bf16 v[136:139], v[80:83], a[72:75], v[136:139]
    ds_read_b128 v[56:59], v24 offset:16640
    v_mfma_f32_16x16x32_bf16 v[140:143], v[80:83], a[76:79], v[140:143]
    v_mfma_f32_16x16x32_bf16 v[128:131], v[84:87], a[80:83], v[128:131]
    v_mfma_f32_16x16x32_bf16 v[132:135], v[84:87], a[84:87], v[132:135]
    ds_read_b128 v[60:63], v25 offset:16640
    v_mfma_f32_16x16x32_bf16 v[136:139], v[84:87], a[88:91], v[136:139]
    v_mfma_f32_16x16x32_bf16 v[140:143], v[84:87], a[92:95], v[140:143]
    v_mfma_f32_16x16x32_bf16 v[128:131], v[88:91], a[96:99], v[128:131]
    ds_read_b128 v[64:67], v22 offset:16896
    v_mfma_f32_16x16x32_bf16 v[132:135], v[88:91], a[100:103], v[132:135]
    buffer_store_dwordx4 v[148:151], v26, s[36:39], s53 offen offset:1024 sc1
    v_mfma_f32_16x16x32_bf16 v[136:139], v[88:91], a[104:107], v[136:139]
    v_mfma_f32_16x16x32_bf16 v[140:143], v[88:91], a[108:111], v[140:143]
    ds_read_b128 v[68:71], v23 offset:16896
    v_mfma_f32_16x16x32_bf16 v[128:131], v[92:95], a[112:115], v[128:131]
    v_mfma_f32_16x16x32_bf16 v[132:135], v[92:95], a[116:119], v[132:135]
    v_mfma_f32_16x16x32_bf16 v[136:139], v[92:95], a[120:123], v[136:139]
    ds_read_b128 v[72:75], v24 offset:16896
    v_mfma_f32_16x16x32_bf16 v[140:143], v[92:95], a[124:127], v[140:143]
    v_mfma_f32_16x16x32_bf16 v[128:131], v[96:99], a[128:131], v[128:131]
    v_mfma_f32_16x16x32_bf16 v[132:135], v[96:99], a[132:135], v[132:135]
    ds_read_b128 v[76:79], v25 offset:16896
    v_mfma_f32_16x16x32_bf16 v[136:139], v[96:99], a[136:139], v[136:139]
    v_mfma_f32_16x16x32_bf16 v[140:143], v[96:99], a[140:143], v[140:143]
    v_mfma_f32_16x16x32_bf16 v[128:131], v[100:103], a[144:147], v[128:131]
    ds_read_b128 v[80:83], v22 offset:17152
    v_mfma_f32_16x16x32_bf16 v[132:135], v[100:103], a[148:151], v[132:135]
    v_mfma_f32_16x16x32_bf16 v[136:139], v[100:103], a[152:155], v[136:139]
    buffer_store_dwordx4 v[152:155], v27, s[36:39], s53 offen offset:0 sc1
    v_mfma_f32_16x16x32_bf16 v[140:143], v[100:103], a[156:159], v[140:143]
    ds_read_b128 v[84:87], v23 offset:17152
    v_mfma_f32_16x16x32_bf16 v[128:131], v[104:107], a[160:163], v[128:131]
    v_mfma_f32_16x16x32_bf16 v[132:135], v[104:107], a[164:167], v[132:135]
    v_mfma_f32_16x16x32_bf16 v[136:139], v[104:107], a[168:171], v[136:139]
    ds_read_b128 v[88:91], v24 offset:17152
    v_mfma_f32_16x16x32_bf16 v[140:143], v[104:107], a[172:175], v[140:143]
    v_mfma_f32_16x16x32_bf16 v[128:131], v[108:111], a[176:179], v[128:131]
    v_mfma_f32_16x16x32_bf16 v[132:135], v[108:111], a[180:183], v[132:135]
    ds_read_b128 v[92:95], v25 offset:17152
    v_mfma_f32_16x16x32_bf16 v[136:139], v[108:111], a[184:187], v[136:139]
    v_mfma_f32_16x16x32_bf16 v[140:143], v[108:111], a[188:191], v[140:143]
    v_mfma_f32_16x16x32_bf16 v[128:131], v[112:115], a[192:195], v[128:131]
    v_mfma_f32_16x16x32_bf16 v[132:135], v[112:115], a[196:199], v[132:135]
    v_mfma_f32_16x16x32_bf16 v[136:139], v[112:115], a[200:203], v[136:139]
    v_mfma_f32_16x16x32_bf16 v[140:143], v[112:115], a[204:207], v[140:143]
    v_mfma_f32_16x16x32_bf16 v[128:131], v[116:119], a[208:211], v[128:131]
    v_mfma_f32_16x16x32_bf16 v[132:135], v[116:119], a[212:215], v[132:135]
    buffer_store_dwordx4 v[156:159], v27, s[36:39], s53 offen offset:1024 sc1
    v_mfma_f32_16x16x32_bf16 v[136:139], v[116:119], a[216:219], v[136:139]
    v_mfma_f32_16x16x32_bf16 v[140:143], v[116:119], a[220:223], v[140:143]
    v_mfma_f32_16x16x32_bf16 v[128:131], v[120:123], a[224:227], v[128:131]
    v_mfma_f32_16x16x32_bf16 v[132:135], v[120:123], a[228:231], v[132:135]
    v_mfma_f32_16x16x32_bf16 v[136:139], v[120:123], a[232:235], v[136:139]
    v_mfma_f32_16x16x32_bf16 v[140:143], v[120:123], a[236:239], v[140:143]
    v_mfma_f32_16x16x32_bf16 v[128:131], v[124:127], a[240:243], v[128:131]
    v_add_u32 v22, 0x8000, v22
    v_mfma_f32_16x16x32_bf16 v[132:135], v[124:127], a[244:247], v[132:135]
    v_add_u32 v23, 0x8000, v23
    v_mfma_f32_16x16x32_bf16 v[136:139], v[124:127], a[248:251], v[136:139]
    v_add_u32 v24, 0x8000, v24
    v_mfma_f32_16x16x32_bf16 v[140:143], v[124:127], a[252:255], v[140:143]
    v_add_u32 v25, 0x8000, v25
    s_waitcnt vmcnt(13) lgkmcnt(0)
    s_barrier
    v_mfma_f32_16x16x32_bf16 v[144:147], v[32:35], a[0:3], 0
    ds_read_b128 v[96:99], v22 offset:0
    v_mfma_f32_16x16x32_bf16 v[148:151], v[32:35], a[4:7], 0
    s_lshr_b32 m0, s96, 1
    s_add_u32 m0, m0, 98304
    s_add_u32 s51, s3, 229376
    v_mfma_f32_16x16x32_bf16 v[152:155], v[32:35], a[8:11], 0
    buffer_load_dwordx4 v5, s[28:31], s51 offen offset:0 lds
    v_mfma_f32_16x16x32_bf16 v[156:159], v[32:35], a[12:15], 0
    ds_read_b128 v[100:103], v23 offset:0
    v_mfma_f32_16x16x32_bf16 v[144:147], v[36:39], a[16:19], v[144:147]
    v_mfma_f32_16x16x32_bf16 v[148:151], v[36:39], a[20:23], v[148:151]
    v_cvt_pk_bf16_f32 v160, v160, v161
    v_mfma_f32_16x16x32_bf16 v[152:155], v[36:39], a[24:27], v[152:155]
    ds_read_b128 v[104:107], v24 offset:0
    v_mfma_f32_16x16x32_bf16 v[156:159], v[36:39], a[28:31], v[156:159]
    v_cvt_pk_bf16_f32 v161, v162, v163
    v_mfma_f32_16x16x32_bf16 v[144:147], v[40:43], a[32:35], v[144:147]
    buffer_load_dwordx4 v6, s[28:31], s51 offen offset:1024 lds
    v_mfma_f32_16x16x32_bf16 v[148:151], v[40:43], a[36:39], v[148:151]
    ds_read_b128 v[108:111], v25 offset:0
    v_mfma_f32_16x16x32_bf16 v[152:155], v[40:43], a[40:43], v[152:155]
    v_mfma_f32_16x16x32_bf16 v[156:159], v[40:43], a[44:47], v[156:159]
    v_cvt_pk_bf16_f32 v162, v176, v177
    v_mfma_f32_16x16x32_bf16 v[144:147], v[44:47], a[48:51], v[144:147]
    ds_read_b128 v[112:115], v22 offset:256
    v_cvt_pk_bf16_f32 v163, v178, v179
    v_mfma_f32_16x16x32_bf16 v[148:151], v[44:47], a[52:55], v[148:151]
    buffer_load_dwordx4 v7, s[28:31], s51 offen offset:2048 lds
    v_mfma_f32_16x16x32_bf16 v[152:155], v[44:47], a[56:59], v[152:155]
    v_mfma_f32_16x16x32_bf16 v[156:159], v[44:47], a[60:63], v[156:159]
    ds_read_b128 v[116:119], v23 offset:256
    s_mov_b32 s53, 8192
    v_mfma_f32_16x16x32_bf16 v[144:147], v[48:51], a[64:67], v[144:147]
    buffer_store_dwordx4 v[160:163], v26, s[36:39], s53 offen offset:0 sc1
    v_mfma_f32_16x16x32_bf16 v[148:151], v[48:51], a[68:71], v[148:151]
    v_mfma_f32_16x16x32_bf16 v[152:155], v[48:51], a[72:75], v[152:155]
    ds_read_b128 v[120:123], v24 offset:256
    v_cvt_pk_bf16_f32 v164, v164, v165
    v_mfma_f32_16x16x32_bf16 v[156:159], v[48:51], a[76:79], v[156:159]
    buffer_load_dwordx4 v28, s[28:31], s51 offen offset:3072 lds
    v_mfma_f32_16x16x32_bf16 v[144:147], v[52:55], a[80:83], v[144:147]
    v_mfma_f32_16x16x32_bf16 v[148:151], v[52:55], a[84:87], v[148:151]
    ds_read_b128 v[124:127], v25 offset:256
    v_mfma_f32_16x16x32_bf16 v[152:155], v[52:55], a[88:91], v[152:155]
    v_cvt_pk_bf16_f32 v165, v166, v167
    v_mfma_f32_16x16x32_bf16 v[156:159], v[52:55], a[92:95], v[156:159]
    s_lshr_b32 m0, s96, 1
    s_add_u32 m0, m0, 114688
    s_add_u32 s51, s3, 245760
    v_mfma_f32_16x16x32_bf16 v[144:147], v[56:59], a[96:99], v[144:147]
    buffer_load_dwordx4 v5, s[28:31], s51 offen offset:0 lds
    v_mfma_f32_16x16x32_bf16 v[148:151], v[56:59], a[100:103], v[148:151]
    ds_read_b128 v[32:35], v22 offset:512
    v_cvt_pk_bf16_f32 v166, v180, v181
    v_mfma_f32_16x16x32_bf16 v[152:155], v[56:59], a[104:107], v[152:155]
    v_mfma_f32_16x16x32_bf16 v[156:159], v[56:59], a[108:111], v[156:159]
    ds_read_b128 v[36:39], v23 offset:512
    v_mfma_f32_16x16x32_bf16 v[144:147], v[60:63], a[112:115], v[144:147]
    v_cvt_pk_bf16_f32 v167, v182, v183
    v_mfma_f32_16x16x32_bf16 v[148:151], v[60:63], a[116:119], v[148:151]
    v_mfma_f32_16x16x32_bf16 v[152:155], v[60:63], a[120:123], v[152:155]
    buffer_load_dwordx4 v6, s[28:31], s51 offen offset:1024 lds
    v_mfma_f32_16x16x32_bf16 v[156:159], v[60:63], a[124:127], v[156:159]
    ds_read_b128 v[40:43], v24 offset:512
    v_mfma_f32_16x16x32_bf16 v[144:147], v[64:67], a[128:131], v[144:147]
    buffer_store_dwordx4 v[164:167], v26, s[36:39], s53 offen offset:1024 sc1
    v_mfma_f32_16x16x32_bf16 v[148:151], v[64:67], a[132:135], v[148:151]
    ds_read_b128 v[44:47], v25 offset:512
    v_cvt_pk_bf16_f32 v168, v168, v169
    v_mfma_f32_16x16x32_bf16 v[152:155], v[64:67], a[136:139], v[152:155]
    v_mfma_f32_16x16x32_bf16 v[156:159], v[64:67], a[140:143], v[156:159]
    v_cvt_pk_bf16_f32 v169, v170, v171
    v_mfma_f32_16x16x32_bf16 v[144:147], v[68:71], a[144:147], v[144:147]
    buffer_load_dwordx4 v7, s[28:31], s51 offen offset:2048 lds
    v_mfma_f32_16x16x32_bf16 v[148:151], v[68:71], a[148:151], v[148:151]
    ds_read_b128 v[48:51], v22 offset:768
    v_mfma_f32_16x16x32_bf16 v[152:155], v[68:71], a[152:155], v[152:155]
    v_mfma_f32_16x16x32_bf16 v[156:159], v[68:71], a[156:159], v[156:159]
    ds_read_b128 v[52:55], v23 offset:768
    v_cvt_pk_bf16_f32 v170, v184, v185
    v_mfma_f32_16x16x32_bf16 v[144:147], v[72:75], a[160:163], v[144:147]
    v_mfma_f32_16x16x32_bf16 v[148:151], v[72:75], a[164:167], v[148:151]
    buffer_load_dwordx4 v28, s[28:31], s51 offen offset:3072 lds
    v_mfma_f32_16x16x32_bf16 v[152:155], v[72:75], a[168:171], v[152:155]
    ds_read_b128 v[56:59], v24 offset:768
    v_cvt_pk_bf16_f32 v171, v186, v187
    v_mfma_f32_16x16x32_bf16 v[156:159], v[72:75], a[172:175], v[156:159]
    v_mfma_f32_16x16x32_bf16 v[144:147], v[76:79], a[176:179], v[144:147]
    buffer_store_dwordx4 v[168:171], v27, s[36:39], s53 offen offset:0 sc1
    v_mfma_f32_16x16x32_bf16 v[148:151], v[76:79], a[180:183], v[148:151]
    ds_read_b128 v[60:63], v25 offset:768
    v_mfma_f32_16x16x32_bf16 v[152:155], v[76:79], a[184:187], v[152:155]
    v_mfma_f32_16x16x32_bf16 v[156:159], v[76:79], a[188:191], v[156:159]
    s_mov_b32 s64, s14
    s_mov_b32 s65, s15
    v_mfma_f32_16x16x32_bf16 v[144:147], v[80:83], a[192:195], v[144:147]
    v_cvt_pk_bf16_f32 v172, v172, v173
    v_mfma_f32_16x16x32_bf16 v[148:151], v[80:83], a[196:199], v[148:151]
    v_mfma_f32_16x16x32_bf16 v[152:155], v[80:83], a[200:203], v[152:155]
    v_mfma_f32_16x16x32_bf16 v[156:159], v[80:83], a[204:207], v[156:159]
    v_cvt_pk_bf16_f32 v173, v174, v175
    v_mfma_f32_16x16x32_bf16 v[144:147], v[84:87], a[208:211], v[144:147]
    s_mov_b32 s66, 4194304
    s_mov_b32 s67, 0x20000
    v_mfma_f32_16x16x32_bf16 v[148:151], v[84:87], a[212:215], v[148:151]
    v_cvt_pk_bf16_f32 v174, v188, v189
    v_mfma_f32_16x16x32_bf16 v[152:155], v[84:87], a[216:219], v[152:155]
    v_mfma_f32_16x16x32_bf16 v[156:159], v[84:87], a[220:223], v[156:159]
    v_mfma_f32_16x16x32_bf16 v[144:147], v[88:91], a[224:227], v[144:147]
    v_cvt_pk_bf16_f32 v175, v190, v191
    v_mfma_f32_16x16x32_bf16 v[148:151], v[88:91], a[228:231], v[148:151]
    s_mov_b32 s68, 2097152
    v_mfma_f32_16x16x32_bf16 v[152:155], v[88:91], a[232:235], v[152:155]
    buffer_load_dword v0, v31, s[64:67], s68 offen
    v_mfma_f32_16x16x32_bf16 v[156:159], v[88:91], a[236:239], v[156:159]
    buffer_store_dwordx4 v[172:175], v27, s[36:39], s53 offen offset:1024 sc1
    v_mfma_f32_16x16x32_bf16 v[144:147], v[92:95], a[240:243], v[144:147]
    v_mfma_f32_16x16x32_bf16 v[148:151], v[92:95], a[244:247], v[148:151]
    v_mfma_f32_16x16x32_bf16 v[152:155], v[92:95], a[248:251], v[152:155]
    v_mfma_f32_16x16x32_bf16 v[156:159], v[92:95], a[252:255], v[156:159]
    s_waitcnt lgkmcnt(0)
    v_mfma_f32_16x16x32_bf16 v[160:163], v[96:99], a[0:3], 0
    ds_read_b128 v[64:67], v22 offset:16384
    v_mfma_f32_16x16x32_bf16 v[164:167], v[96:99], a[4:7], 0
    v_mfma_f32_16x16x32_bf16 v[168:171], v[96:99], a[8:11], 0
    v_mfma_f32_16x16x32_bf16 v[172:175], v[96:99], a[12:15], 0
    ds_read_b128 v[68:71], v23 offset:16384
    v_mfma_f32_16x16x32_bf16 v[160:163], v[100:103], a[16:19], v[160:163]
    v_mfma_f32_16x16x32_bf16 v[164:167], v[100:103], a[20:23], v[164:167]
    v_cvt_pk_bf16_f32 v192, v192, v193
    v_mfma_f32_16x16x32_bf16 v[168:171], v[100:103], a[24:27], v[168:171]
    ds_read_b128 v[72:75], v24 offset:16384
    v_mfma_f32_16x16x32_bf16 v[172:175], v[100:103], a[28:31], v[172:175]
    v_mfma_f32_16x16x32_bf16 v[160:163], v[104:107], a[32:35], v[160:163]
    v_cvt_pk_bf16_f32 v193, v194, v195
    v_mfma_f32_16x16x32_bf16 v[164:167], v[104:107], a[36:39], v[164:167]
    ds_read_b128 v[76:79], v25 offset:16384
    v_mfma_f32_16x16x32_bf16 v[168:171], v[104:107], a[40:43], v[168:171]
    v_mfma_f32_16x16x32_bf16 v[172:175], v[104:107], a[44:47], v[172:175]
    v_cvt_pk_bf16_f32 v194, v208, v209
    v_mfma_f32_16x16x32_bf16 v[160:163], v[108:111], a[48:51], v[160:163]
    ds_read_b128 v[80:83], v22 offset:16640
    v_mfma_f32_16x16x32_bf16 v[164:167], v[108:111], a[52:55], v[164:167]
    v_cvt_pk_bf16_f32 v195, v210, v211
    v_mfma_f32_16x16x32_bf16 v[168:171], v[108:111], a[56:59], v[168:171]
    v_mfma_f32_16x16x32_bf16 v[172:175], v[108:111], a[60:63], v[172:175]
    ds_read_b128 v[84:87], v23 offset:16640
    s_mov_b32 s53, 16384
    v_mfma_f32_16x16x32_bf16 v[160:163], v[112:115], a[64:67], v[160:163]
    buffer_store_dwordx4 v[192:195], v26, s[36:39], s53 offen offset:0 sc1
    v_mfma_f32_16x16x32_bf16 v[164:167], v[112:115], a[68:71], v[164:167]
    v_mfma_f32_16x16x32_bf16 v[168:171], v[112:115], a[72:75], v[168:171]
    ds_read_b128 v[88:91], v24 offset:16640
    v_mfma_f32_16x16x32_bf16 v[172:175], v[112:115], a[76:79], v[172:175]
    v_cvt_pk_bf16_f32 v196, v196, v197
    v_mfma_f32_16x16x32_bf16 v[160:163], v[116:119], a[80:83], v[160:163]
    v_mfma_f32_16x16x32_bf16 v[164:167], v[116:119], a[84:87], v[164:167]
    ds_read_b128 v[92:95], v25 offset:16640
    v_mfma_f32_16x16x32_bf16 v[168:171], v[116:119], a[88:91], v[168:171]
    v_cvt_pk_bf16_f32 v197, v198, v199
    v_mfma_f32_16x16x32_bf16 v[172:175], v[116:119], a[92:95], v[172:175]
    v_mfma_f32_16x16x32_bf16 v[160:163], v[120:123], a[96:99], v[160:163]
    ds_read_b128 v[96:99], v22 offset:16896
    v_mfma_f32_16x16x32_bf16 v[164:167], v[120:123], a[100:103], v[164:167]
    v_cvt_pk_bf16_f32 v198, v212, v213
    v_mfma_f32_16x16x32_bf16 v[168:171], v[120:123], a[104:107], v[168:171]
    v_mfma_f32_16x16x32_bf16 v[172:175], v[120:123], a[108:111], v[172:175]
    ds_read_b128 v[100:103], v23 offset:16896
    v_mfma_f32_16x16x32_bf16 v[160:163], v[124:127], a[112:115], v[160:163]
    v_cvt_pk_bf16_f32 v199, v214, v215
    v_mfma_f32_16x16x32_bf16 v[164:167], v[124:127], a[116:119], v[164:167]
    v_mfma_f32_16x16x32_bf16 v[168:171], v[124:127], a[120:123], v[168:171]
    ds_read_b128 v[104:107], v24 offset:16896
    v_mfma_f32_16x16x32_bf16 v[172:175], v[124:127], a[124:127], v[172:175]
    buffer_store_dwordx4 v[196:199], v26, s[36:39], s53 offen offset:1024 sc1
    v_mfma_f32_16x16x32_bf16 v[160:163], v[32:35], a[128:131], v[160:163]
    v_mfma_f32_16x16x32_bf16 v[164:167], v[32:35], a[132:135], v[164:167]
    ds_read_b128 v[108:111], v25 offset:16896
    v_cvt_pk_bf16_f32 v200, v200, v201
    v_mfma_f32_16x16x32_bf16 v[168:171], v[32:35], a[136:139], v[168:171]
    v_mfma_f32_16x16x32_bf16 v[172:175], v[32:35], a[140:143], v[172:175]
    v_mfma_f32_16x16x32_bf16 v[160:163], v[36:39], a[144:147], v[160:163]
    ds_read_b128 v[112:115], v22 offset:17152
    v_cvt_pk_bf16_f32 v201, v202, v203
    v_mfma_f32_16x16x32_bf16 v[164:167], v[36:39], a[148:151], v[164:167]
    v_mfma_f32_16x16x32_bf16 v[168:171], v[36:39], a[152:155], v[168:171]
    v_mfma_f32_16x16x32_bf16 v[172:175], v[36:39], a[156:159], v[172:175]
    ds_read_b128 v[116:119], v23 offset:17152
    v_cvt_pk_bf16_f32 v202, v216, v217
    v_mfma_f32_16x16x32_bf16 v[160:163], v[40:43], a[160:163], v[160:163]
    v_mfma_f32_16x16x32_bf16 v[164:167], v[40:43], a[164:167], v[164:167]
    v_mfma_f32_16x16x32_bf16 v[168:171], v[40:43], a[168:171], v[168:171]
    ds_read_b128 v[120:123], v24 offset:17152
    v_cvt_pk_bf16_f32 v203, v218, v219
    v_mfma_f32_16x16x32_bf16 v[172:175], v[40:43], a[172:175], v[172:175]
    v_mfma_f32_16x16x32_bf16 v[160:163], v[44:47], a[176:179], v[160:163]
    buffer_store_dwordx4 v[200:203], v27, s[36:39], s53 offen offset:0 sc1
    v_mfma_f32_16x16x32_bf16 v[164:167], v[44:47], a[180:183], v[164:167]
    ds_read_b128 v[124:127], v25 offset:17152
    v_mfma_f32_16x16x32_bf16 v[168:171], v[44:47], a[184:187], v[168:171]
    v_mfma_f32_16x16x32_bf16 v[172:175], v[44:47], a[188:191], v[172:175]
    v_mfma_f32_16x16x32_bf16 v[160:163], v[48:51], a[192:195], v[160:163]
    v_cvt_pk_bf16_f32 v204, v204, v205
    v_mfma_f32_16x16x32_bf16 v[164:167], v[48:51], a[196:199], v[164:167]
    v_mfma_f32_16x16x32_bf16 v[168:171], v[48:51], a[200:203], v[168:171]
    v_mfma_f32_16x16x32_bf16 v[172:175], v[48:51], a[204:207], v[172:175]
    v_cvt_pk_bf16_f32 v205, v206, v207
    v_mfma_f32_16x16x32_bf16 v[160:163], v[52:55], a[208:211], v[160:163]
    v_mfma_f32_16x16x32_bf16 v[164:167], v[52:55], a[212:215], v[164:167]
    v_cvt_pk_bf16_f32 v206, v220, v221
    v_mfma_f32_16x16x32_bf16 v[168:171], v[52:55], a[216:219], v[168:171]
    v_mfma_f32_16x16x32_bf16 v[172:175], v[52:55], a[220:223], v[172:175]
    v_mfma_f32_16x16x32_bf16 v[160:163], v[56:59], a[224:227], v[160:163]
    v_cvt_pk_bf16_f32 v207, v222, v223
    v_mfma_f32_16x16x32_bf16 v[164:167], v[56:59], a[228:231], v[164:167]
    v_mfma_f32_16x16x32_bf16 v[168:171], v[56:59], a[232:235], v[168:171]
    v_mfma_f32_16x16x32_bf16 v[172:175], v[56:59], a[236:239], v[172:175]
    buffer_store_dwordx4 v[204:207], v27, s[36:39], s53 offen offset:1024 sc1
    v_mfma_f32_16x16x32_bf16 v[160:163], v[60:63], a[240:243], v[160:163]
    v_add_u32 v22, 0xfffe0000, v22
    v_mfma_f32_16x16x32_bf16 v[164:167], v[60:63], a[244:247], v[164:167]
    v_add_u32 v23, 0xfffe0000, v23
    v_mfma_f32_16x16x32_bf16 v[168:171], v[60:63], a[248:251], v[168:171]
    v_add_u32 v24, 0xfffe0000, v24
    v_mfma_f32_16x16x32_bf16 v[172:175], v[60:63], a[252:255], v[172:175]
    v_add_u32 v25, 0xfffe0000, v25
    s_waitcnt vmcnt(22) lgkmcnt(0)
    s_barrier
    v_mfma_f32_16x16x32_bf16 v[176:179], v[64:67], a[0:3], 0
    ds_read_b128 v[32:35], v22 offset:0
    v_mfma_f32_16x16x32_bf16 v[180:183], v[64:67], a[4:7], 0
    v_mfma_f32_16x16x32_bf16 v[184:187], v[64:67], a[8:11], 0
    v_mfma_f32_16x16x32_bf16 v[188:191], v[64:67], a[12:15], 0
    ds_read_b128 v[36:39], v23 offset:0
    v_mfma_f32_16x16x32_bf16 v[176:179], v[68:71], a[16:19], v[176:179]
    v_mfma_f32_16x16x32_bf16 v[180:183], v[68:71], a[20:23], v[180:183]
    v_cvt_pk_bf16_f32 v224, v224, v225
    v_mfma_f32_16x16x32_bf16 v[184:187], v[68:71], a[24:27], v[184:187]
    ds_read_b128 v[40:43], v24 offset:0
    v_mfma_f32_16x16x32_bf16 v[188:191], v[68:71], a[28:31], v[188:191]
    v_mfma_f32_16x16x32_bf16 v[176:179], v[72:75], a[32:35], v[176:179]
    v_cvt_pk_bf16_f32 v225, v226, v227
    v_mfma_f32_16x16x32_bf16 v[180:183], v[72:75], a[36:39], v[180:183]
    ds_read_b128 v[44:47], v25 offset:0
    v_mfma_f32_16x16x32_bf16 v[184:187], v[72:75], a[40:43], v[184:187]
    v_mfma_f32_16x16x32_bf16 v[188:191], v[72:75], a[44:47], v[188:191]
    v_cvt_pk_bf16_f32 v226, v240, v241
    v_mfma_f32_16x16x32_bf16 v[176:179], v[76:79], a[48:51], v[176:179]
    ds_read_b128 v[48:51], v22 offset:256
    v_mfma_f32_16x16x32_bf16 v[180:183], v[76:79], a[52:55], v[180:183]
    v_cvt_pk_bf16_f32 v227, v242, v243
    v_mfma_f32_16x16x32_bf16 v[184:187], v[76:79], a[56:59], v[184:187]
    v_mfma_f32_16x16x32_bf16 v[188:191], v[76:79], a[60:63], v[188:191]
    ds_read_b128 v[52:55], v23 offset:256
    s_mov_b32 s53, 24576
    v_mfma_f32_16x16x32_bf16 v[176:179], v[80:83], a[64:67], v[176:179]
    buffer_store_dwordx4 v[224:227], v26, s[36:39], s53 offen offset:0 sc1
    v_mfma_f32_16x16x32_bf16 v[180:183], v[80:83], a[68:71], v[180:183]
    v_mfma_f32_16x16x32_bf16 v[184:187], v[80:83], a[72:75], v[184:187]
    ds_read_b128 v[56:59], v24 offset:256
    v_mfma_f32_16x16x32_bf16 v[188:191], v[80:83], a[76:79], v[188:191]
    v_cvt_pk_bf16_f32 v228, v228, v229
    v_mfma_f32_16x16x32_bf16 v[176:179], v[84:87], a[80:83], v[176:179]
    v_mfma_f32_16x16x32_bf16 v[180:183], v[84:87], a[84:87], v[180:183]
    ds_read_b128 v[60:63], v25 offset:256
    v_mfma_f32_16x16x32_bf16 v[184:187], v[84:87], a[88:91], v[184:187]
    v_cvt_pk_bf16_f32 v229, v230, v231
    v_mfma_f32_16x16x32_bf16 v[188:191], v[84:87], a[92:95], v[188:191]
    v_mfma_f32_16x16x32_bf16 v[176:179], v[88:91], a[96:99], v[176:179]
    ds_read_b128 v[64:67], v22 offset:512
    v_mfma_f32_16x16x32_bf16 v[180:183], v[88:91], a[100:103], v[180:183]
    v_cvt_pk_bf16_f32 v230, v244, v245
    v_mfma_f32_16x16x32_bf16 v[184:187], v[88:91], a[104:107], v[184:187]
    v_mfma_f32_16x16x32_bf16 v[188:191], v[88:91], a[108:111], v[188:191]
    ds_read_b128 v[68:71], v23 offset:512
    v_mfma_f32_16x16x32_bf16 v[176:179], v[92:95], a[112:115], v[176:179]
    v_cvt_pk_bf16_f32 v231, v246, v247
    v_mfma_f32_16x16x32_bf16 v[180:183], v[92:95], a[116:119], v[180:183]
    v_mfma_f32_16x16x32_bf16 v[184:187], v[92:95], a[120:123], v[184:187]
    ds_read_b128 v[72:75], v24 offset:512
    v_mfma_f32_16x16x32_bf16 v[188:191], v[92:95], a[124:127], v[188:191]
    buffer_store_dwordx4 v[228:231], v26, s[36:39], s53 offen offset:1024 sc1
    v_mfma_f32_16x16x32_bf16 v[176:179], v[96:99], a[128:131], v[176:179]
    v_mfma_f32_16x16x32_bf16 v[180:183], v[96:99], a[132:135], v[180:183]
    ds_read_b128 v[76:79], v25 offset:512
    v_cvt_pk_bf16_f32 v232, v232, v233
    v_mfma_f32_16x16x32_bf16 v[184:187], v[96:99], a[136:139], v[184:187]
    v_mfma_f32_16x16x32_bf16 v[188:191], v[96:99], a[140:143], v[188:191]
    v_mfma_f32_16x16x32_bf16 v[176:179], v[100:103], a[144:147], v[176:179]
    ds_read_b128 v[80:83], v22 offset:768
    v_cvt_pk_bf16_f32 v233, v234, v235
    v_mfma_f32_16x16x32_bf16 v[180:183], v[100:103], a[148:151], v[180:183]
    v_mfma_f32_16x16x32_bf16 v[184:187], v[100:103], a[152:155], v[184:187]
    v_mfma_f32_16x16x32_bf16 v[188:191], v[100:103], a[156:159], v[188:191]
    ds_read_b128 v[84:87], v23 offset:768
    v_cvt_pk_bf16_f32 v234, v248, v249
    v_mfma_f32_16x16x32_bf16 v[176:179], v[104:107], a[160:163], v[176:179]
    v_mfma_f32_16x16x32_bf16 v[180:183], v[104:107], a[164:167], v[180:183]
    v_mfma_f32_16x16x32_bf16 v[184:187], v[104:107], a[168:171], v[184:187]
    ds_read_b128 v[88:91], v24 offset:768
    v_cvt_pk_bf16_f32 v235, v250, v251
    v_mfma_f32_16x16x32_bf16 v[188:191], v[104:107], a[172:175], v[188:191]
    v_mfma_f32_16x16x32_bf16 v[176:179], v[108:111], a[176:179], v[176:179]
    buffer_store_dwordx4 v[232:235], v27, s[36:39], s53 offen offset:0 sc1
    v_mfma_f32_16x16x32_bf16 v[180:183], v[108:111], a[180:183], v[180:183]
    ds_read_b128 v[92:95], v25 offset:768
    v_mfma_f32_16x16x32_bf16 v[184:187], v[108:111], a[184:187], v[184:187]
    v_mfma_f32_16x16x32_bf16 v[188:191], v[108:111], a[188:191], v[188:191]
    v_mfma_f32_16x16x32_bf16 v[176:179], v[112:115], a[192:195], v[176:179]
    v_cvt_pk_bf16_f32 v236, v236, v237
    v_mfma_f32_16x16x32_bf16 v[180:183], v[112:115], a[196:199], v[180:183]
    v_mfma_f32_16x16x32_bf16 v[184:187], v[112:115], a[200:203], v[184:187]
    v_mfma_f32_16x16x32_bf16 v[188:191], v[112:115], a[204:207], v[188:191]
    v_cvt_pk_bf16_f32 v237, v238, v239
    v_mfma_f32_16x16x32_bf16 v[176:179], v[116:119], a[208:211], v[176:179]
    v_mfma_f32_16x16x32_bf16 v[180:183], v[116:119], a[212:215], v[180:183]
    v_cvt_pk_bf16_f32 v238, v252, v253
    v_mfma_f32_16x16x32_bf16 v[184:187], v[116:119], a[216:219], v[184:187]
    v_mfma_f32_16x16x32_bf16 v[188:191], v[116:119], a[220:223], v[188:191]
    v_mfma_f32_16x16x32_bf16 v[176:179], v[120:123], a[224:227], v[176:179]
    v_cvt_pk_bf16_f32 v239, v254, v255
    v_mfma_f32_16x16x32_bf16 v[180:183], v[120:123], a[228:231], v[180:183]
    v_mfma_f32_16x16x32_bf16 v[184:187], v[120:123], a[232:235], v[184:187]
    v_mfma_f32_16x16x32_bf16 v[188:191], v[120:123], a[236:239], v[188:191]
    buffer_store_dwordx4 v[236:239], v27, s[36:39], s53 offen offset:1024 sc1
    v_mfma_f32_16x16x32_bf16 v[176:179], v[124:127], a[240:243], v[176:179]
    v_mfma_f32_16x16x32_bf16 v[180:183], v[124:127], a[244:247], v[180:183]
    v_mfma_f32_16x16x32_bf16 v[184:187], v[124:127], a[248:251], v[184:187]
    v_mfma_f32_16x16x32_bf16 v[188:191], v[124:127], a[252:255], v[188:191]
    s_waitcnt lgkmcnt(0)
    v_mfma_f32_16x16x32_bf16 v[192:195], v[32:35], a[0:3], 0
    ds_read_b128 v[96:99], v22 offset:16384
    v_mfma_f32_16x16x32_bf16 v[196:199], v[32:35], a[4:7], 0
    s_lshl_b32 s100, s48, 13
    v_mfma_f32_16x16x32_bf16 v[200:203], v[32:35], a[8:11], 0
    v_mfma_f32_16x16x32_bf16 v[204:207], v[32:35], a[12:15], 0
    ds_read_b128 v[100:103], v23 offset:16384
    v_mfma_f32_16x16x32_bf16 v[192:195], v[36:39], a[16:19], v[192:195]
    v_mfma_f32_16x16x32_bf16 v[196:199], v[36:39], a[20:23], v[196:199]
    s_lshl_b32 s101, s48, 12
    v_cvt_pk_bf16_f32 v128, v128, v129
    v_mfma_f32_16x16x32_bf16 v[200:203], v[36:39], a[24:27], v[200:203]
    ds_read_b128 v[104:107], v24 offset:16384
    v_mfma_f32_16x16x32_bf16 v[204:207], v[36:39], a[28:31], v[204:207]
    v_mfma_f32_16x16x32_bf16 v[192:195], v[40:43], a[32:35], v[192:195]
    s_add_u32 s101, s101, 32768
    v_cvt_pk_bf16_f32 v129, v130, v131
    v_mfma_f32_16x16x32_bf16 v[196:199], v[40:43], a[36:39], v[196:199]
    ds_read_b128 v[108:111], v25 offset:16384
    v_mfma_f32_16x16x32_bf16 v[200:203], v[40:43], a[40:43], v[200:203]
    v_mfma_f32_16x16x32_bf16 v[204:207], v[40:43], a[44:47], v[204:207]
    s_lshl_b32 s99, s49, 8
    v_cvt_pk_bf16_f32 v130, v144, v145
    v_mfma_f32_16x16x32_bf16 v[192:195], v[44:47], a[48:51], v[192:195]
    ds_read_b128 v[112:115], v22 offset:16640
    v_mfma_f32_16x16x32_bf16 v[196:199], v[44:47], a[52:55], v[196:199]
    v_cvt_pk_bf16_f32 v131, v146, v147
    v_mfma_f32_16x16x32_bf16 v[200:203], v[44:47], a[56:59], v[200:203]
    v_mfma_f32_16x16x32_bf16 v[204:207], v[44:47], a[60:63], v[204:207]
    s_sub_u32 s98, 4194304, s99
    ds_read_b128 v[116:119], v23 offset:16640
    v_mfma_f32_16x16x32_bf16 v[192:195], v[48:51], a[64:67], v[192:195]
    s_mov_b32 s53, 32768
    v_mfma_f32_16x16x32_bf16 v[196:199], v[48:51], a[68:71], v[196:199]
    buffer_store_dwordx4 v[128:131], v26, s[36:39], s53 offen offset:0 sc1
    v_mfma_f32_16x16x32_bf16 v[200:203], v[48:51], a[72:75], v[200:203]
    s_add_u32 s44, s14, s99
    s_addc_u32 s45, s15, 0
    v_mfma_f32_16x16x32_bf16 v[204:207], v[48:51], a[76:79], v[204:207]
    ds_read_b128 v[120:123], v24 offset:16640
    v_cvt_pk_bf16_f32 v132, v132, v133
    v_mfma_f32_16x16x32_bf16 v[192:195], v[52:55], a[80:83], v[192:195]
    v_mfma_f32_16x16x32_bf16 v[196:199], v[52:55], a[84:87], v[196:199]
    ds_read_b128 v[124:127], v25 offset:16640
    v_mfma_f32_16x16x32_bf16 v[200:203], v[52:55], a[88:91], v[200:203]
    s_mov_b32 s46, s98
    v_cvt_pk_bf16_f32 v133, v134, v135
    v_mfma_f32_16x16x32_bf16 v[204:207], v[52:55], a[92:95], v[204:207]
    v_mfma_f32_16x16x32_bf16 v[192:195], v[56:59], a[96:99], v[192:195]
    ds_read_b128 v[32:35], v22 offset:16896
    v_mfma_f32_16x16x32_bf16 v[196:199], v[56:59], a[100:103], v[196:199]
    s_mov_b32 s47, 0x20000
    v_cvt_pk_bf16_f32 v134, v148, v149
    v_mfma_f32_16x16x32_bf16 v[200:203], v[56:59], a[104:107], v[200:203]
    v_mfma_f32_16x16x32_bf16 v[204:207], v[56:59], a[108:111], v[204:207]
    ds_read_b128 v[36:39], v23 offset:16896
    v_mfma_f32_16x16x32_bf16 v[192:195], v[60:63], a[112:115], v[192:195]
    s_mov_b32 s40, s10
    v_cvt_pk_bf16_f32 v135, v150, v151
    v_mfma_f32_16x16x32_bf16 v[196:199], v[60:63], a[116:119], v[196:199]
    v_mfma_f32_16x16x32_bf16 v[200:203], v[60:63], a[120:123], v[200:203]
    ds_read_b128 v[40:43], v24 offset:16896
    v_mfma_f32_16x16x32_bf16 v[204:207], v[60:63], a[124:127], v[204:207]
    buffer_store_dwordx4 v[132:135], v26, s[36:39], s53 offen offset:1024 sc1
    v_mfma_f32_16x16x32_bf16 v[192:195], v[64:67], a[128:131], v[192:195]
    s_mov_b32 s41, s11
    v_mfma_f32_16x16x32_bf16 v[196:199], v[64:67], a[132:135], v[196:199]
    ds_read_b128 v[44:47], v25 offset:16896
    v_cvt_pk_bf16_f32 v136, v136, v137
    v_mfma_f32_16x16x32_bf16 v[200:203], v[64:67], a[136:139], v[200:203]
    v_mfma_f32_16x16x32_bf16 v[204:207], v[64:67], a[140:143], v[204:207]
    s_mov_b32 s42, 2097152
    v_mfma_f32_16x16x32_bf16 v[192:195], v[68:71], a[144:147], v[192:195]
    ds_read_b128 v[48:51], v22 offset:17152
    v_cvt_pk_bf16_f32 v137, v138, v139
    v_mfma_f32_16x16x32_bf16 v[196:199], v[68:71], a[148:151], v[196:199]
    v_mfma_f32_16x16x32_bf16 v[200:203], v[68:71], a[152:155], v[200:203]
    s_mov_b32 s43, 0x20000
    v_mfma_f32_16x16x32_bf16 v[204:207], v[68:71], a[156:159], v[204:207]
    ds_read_b128 v[52:55], v23 offset:17152
    v_cvt_pk_bf16_f32 v138, v152, v153
    v_mfma_f32_16x16x32_bf16 v[192:195], v[72:75], a[160:163], v[192:195]
    v_mfma_f32_16x16x32_bf16 v[196:199], v[72:75], a[164:167], v[196:199]
    v_cvt_pk_bf16_f32 v139, v154, v155
    v_mfma_f32_16x16x32_bf16 v[200:203], v[72:75], a[168:171], v[200:203]
    s_lshl_b32 s99, s48, 15
    ds_read_b128 v[56:59], v24 offset:17152
    v_mfma_f32_16x16x32_bf16 v[204:207], v[72:75], a[172:175], v[204:207]
    v_mfma_f32_16x16x32_bf16 v[192:195], v[76:79], a[176:179], v[192:195]
    buffer_store_dwordx4 v[136:139], v27, s[36:39], s53 offen offset:0 sc1
    v_mfma_f32_16x16x32_bf16 v[196:199], v[76:79], a[180:183], v[196:199]
    s_lshl_b32 s97, s50, 17
    ds_read_b128 v[60:63], v25 offset:17152
    v_mfma_f32_16x16x32_bf16 v[200:203], v[76:79], a[184:187], v[200:203]
    v_mfma_f32_16x16x32_bf16 v[204:207], v[76:79], a[188:191], v[204:207]
    v_mfma_f32_16x16x32_bf16 v[192:195], v[80:83], a[192:195], v[192:195]
    v_cvt_pk_bf16_f32 v140, v140, v141
    v_mfma_f32_16x16x32_bf16 v[196:199], v[80:83], a[196:199], v[196:199]
    s_add_u32 s98, s97, s99
    v_mfma_f32_16x16x32_bf16 v[200:203], v[80:83], a[200:203], v[200:203]
    v_mfma_f32_16x16x32_bf16 v[204:207], v[80:83], a[204:207], v[204:207]
    v_cvt_pk_bf16_f32 v141, v142, v143
    v_mfma_f32_16x16x32_bf16 v[192:195], v[84:87], a[208:211], v[192:195]
    s_sub_u32 s97, 1966080, s97
    v_mfma_f32_16x16x32_bf16 v[196:199], v[84:87], a[212:215], v[196:199]
    v_cvt_pk_bf16_f32 v142, v156, v157
    v_mfma_f32_16x16x32_bf16 v[200:203], v[84:87], a[216:219], v[200:203]
    v_mfma_f32_16x16x32_bf16 v[204:207], v[84:87], a[220:223], v[204:207]
    s_add_u32 s97, s97, s99
    v_mfma_f32_16x16x32_bf16 v[192:195], v[88:91], a[224:227], v[192:195]
    v_cvt_pk_bf16_f32 v143, v158, v159
    v_mfma_f32_16x16x32_bf16 v[196:199], v[88:91], a[228:231], v[196:199]
    v_mfma_f32_16x16x32_bf16 v[200:203], v[88:91], a[232:235], v[200:203]
    buffer_store_dwordx4 v[140:143], v27, s[36:39], s53 offen offset:1024 sc1
    v_mfma_f32_16x16x32_bf16 v[204:207], v[88:91], a[236:239], v[204:207]
    s_lshl_b32 s99, s48, 17
    v_mfma_f32_16x16x32_bf16 v[192:195], v[92:95], a[240:243], v[192:195]
    v_add_u32 v22, 0x18000, v22
    v_mfma_f32_16x16x32_bf16 v[196:199], v[92:95], a[244:247], v[196:199]
    v_add_u32 v23, 0x18000, v23
    v_mfma_f32_16x16x32_bf16 v[200:203], v[92:95], a[248:251], v[200:203]
    v_add_u32 v24, 0x18000, v24
    v_mfma_f32_16x16x32_bf16 v[204:207], v[92:95], a[252:255], v[204:207]
    v_add_u32 v25, 0x18000, v25
    s_waitcnt vmcnt(15) lgkmcnt(0)
    s_barrier
    v_mfma_f32_16x16x32_bf16 v[208:211], v[96:99], a[0:3], 0
    ds_read_b128 v[64:67], v22 offset:0
    v_mfma_f32_16x16x32_bf16 v[212:215], v[96:99], a[4:7], 0
    s_add_u32 m0, s100, 0
    v_mfma_f32_16x16x32_bf16 v[216:219], v[96:99], a[8:11], 0
    buffer_load_dwordx4 v8, s[40:43], s97 offen offset:0 lds
    v_mfma_f32_16x16x32_bf16 v[220:223], v[96:99], a[12:15], 0
    ds_read_b128 v[68:71], v23 offset:0
    v_mfma_f32_16x16x32_bf16 v[208:211], v[100:103], a[16:19], v[208:211]
    v_mfma_f32_16x16x32_bf16 v[212:215], v[100:103], a[20:23], v[212:215]
    v_cvt_pk_bf16_f32 v160, v160, v161
    v_mfma_f32_16x16x32_bf16 v[216:219], v[100:103], a[24:27], v[216:219]
    ds_read_b128 v[72:75], v24 offset:0
    v_mfma_f32_16x16x32_bf16 v[220:223], v[100:103], a[28:31], v[220:223]
    buffer_load_dwordx4 v9, s[40:43], s97 offen offset:1024 lds
    v_mfma_f32_16x16x32_bf16 v[208:211], v[104:107], a[32:35], v[208:211]
    v_cvt_pk_bf16_f32 v161, v162, v163
    v_mfma_f32_16x16x32_bf16 v[212:215], v[104:107], a[36:39], v[212:215]
    ds_read_b128 v[76:79], v25 offset:0
    v_mfma_f32_16x16x32_bf16 v[216:219], v[104:107], a[40:43], v[216:219]
    v_mfma_f32_16x16x32_bf16 v[220:223], v[104:107], a[44:47], v[220:223]
    v_cvt_pk_bf16_f32 v162, v176, v177
    v_mfma_f32_16x16x32_bf16 v[208:211], v[108:111], a[48:51], v[208:211]
    buffer_load_dwordx4 v10, s[40:43], s97 offen offset:2048 lds
    v_mfma_f32_16x16x32_bf16 v[212:215], v[108:111], a[52:55], v[212:215]
    ds_read_b128 v[80:83], v22 offset:256
    v_cvt_pk_bf16_f32 v163, v178, v179
    v_mfma_f32_16x16x32_bf16 v[216:219], v[108:111], a[56:59], v[216:219]
    v_mfma_f32_16x16x32_bf16 v[220:223], v[108:111], a[60:63], v[220:223]
    ds_read_b128 v[84:87], v23 offset:256
    s_mov_b32 s53, 40960
    v_mfma_f32_16x16x32_bf16 v[208:211], v[112:115], a[64:67], v[208:211]
    buffer_store_dwordx4 v[160:163], v26, s[36:39], s53 offen offset:0 sc1
    v_mfma_f32_16x16x32_bf16 v[212:215], v[112:115], a[68:71], v[212:215]
    buffer_load_dwordx4 v11, s[40:43], s97 offen offset:3072 lds
    v_mfma_f32_16x16x32_bf16 v[216:219], v[112:115], a[72:75], v[216:219]
    s_add_u32 s97, s97, 128
    ds_read_b128 v[88:91], v24 offset:256
    v_mfma_f32_16x16x32_bf16 v[220:223], v[112:115], a[76:79], v[220:223]
    v_cvt_pk_bf16_f32 v164, v164, v165
    v_mfma_f32_16x16x32_bf16 v[208:211], v[116:119], a[80:83], v[208:211]
    v_mfma_f32_16x16x32_bf16 v[212:215], v[116:119], a[84:87], v[212:215]
    s_add_u32 m0, s100, 4096
    ds_read_b128 v[92:95], v25 offset:256
    v_mfma_f32_16x16x32_bf16 v[216:219], v[116:119], a[88:91], v[216:219]
    buffer_load_dwordx4 v8, s[40:43], s98 offen offset:0 lds
    v_mfma_f32_16x16x32_bf16 v[220:223], v[116:119], a[92:95], v[220:223]
    v_cvt_pk_bf16_f32 v165, v166, v167
    v_mfma_f32_16x16x32_bf16 v[208:211], v[120:123], a[96:99], v[208:211]
    ds_read_b128 v[96:99], v22 offset:512
    v_mfma_f32_16x16x32_bf16 v[212:215], v[120:123], a[100:103], v[212:215]
    v_cvt_pk_bf16_f32 v166, v180, v181
    v_mfma_f32_16x16x32_bf16 v[216:219], v[120:123], a[104:107], v[216:219]
    v_mfma_f32_16x16x32_bf16 v[220:223], v[120:123], a[108:111], v[220:223]
    buffer_load_dwordx4 v9, s[40:43], s98 offen offset:1024 lds
    v_mfma_f32_16x16x32_bf16 v[208:211], v[124:127], a[112:115], v[208:211]
    ds_read_b128 v[100:103], v23 offset:512
    v_cvt_pk_bf16_f32 v167, v182, v183
    v_mfma_f32_16x16x32_bf16 v[212:215], v[124:127], a[116:119], v[212:215]
    v_mfma_f32_16x16x32_bf16 v[216:219], v[124:127], a[120:123], v[216:219]
    ds_read_b128 v[104:107], v24 offset:512
    v_mfma_f32_16x16x32_bf16 v[220:223], v[124:127], a[124:127], v[220:223]
    buffer_store_dwordx4 v[164:167], v26, s[36:39], s53 offen offset:1024 sc1
    v_mfma_f32_16x16x32_bf16 v[208:211], v[32:35], a[128:131], v[208:211]
    v_cvt_pk_bf16_f32 v168, v168, v169
    v_mfma_f32_16x16x32_bf16 v[212:215], v[32:35], a[132:135], v[212:215]
    buffer_load_dwordx4 v10, s[40:43], s98 offen offset:2048 lds
    v_mfma_f32_16x16x32_bf16 v[216:219], v[32:35], a[136:139], v[216:219]
    ds_read_b128 v[108:111], v25 offset:512
    v_mfma_f32_16x16x32_bf16 v[220:223], v[32:35], a[140:143], v[220:223]
    v_mfma_f32_16x16x32_bf16 v[208:211], v[36:39], a[144:147], v[208:211]
    ds_read_b128 v[112:115], v22 offset:768
    v_cvt_pk_bf16_f32 v169, v170, v171
    v_mfma_f32_16x16x32_bf16 v[212:215], v[36:39], a[148:151], v[212:215]
    v_mfma_f32_16x16x32_bf16 v[216:219], v[36:39], a[152:155], v[216:219]
    buffer_load_dwordx4 v11, s[40:43], s98 offen offset:3072 lds
    v_mfma_f32_16x16x32_bf16 v[220:223], v[36:39], a[156:159], v[220:223]
    s_add_u32 s98, s98, 128
    ds_read_b128 v[116:119], v23 offset:768
    v_mfma_f32_16x16x32_bf16 v[208:211], v[40:43], a[160:163], v[208:211]
    v_cvt_pk_bf16_f32 v170, v184, v185
    v_mfma_f32_16x16x32_bf16 v[212:215], v[40:43], a[164:167], v[212:215]
    v_cvt_pk_bf16_f32 v171, v186, v187
    v_mfma_f32_16x16x32_bf16 v[216:219], v[40:43], a[168:171], v[216:219]
    s_add_u32 m0, s101, 0
    ds_read_b128 v[120:123], v24 offset:768
    v_mfma_f32_16x16x32_bf16 v[220:223], v[40:43], a[172:175], v[220:223]
    buffer_load_dwordx4 v12, s[44:47], s99 offen offset:0 nt lds
    v_mfma_f32_16x16x32_bf16 v[208:211], v[44:47], a[176:179], v[208:211]
    buffer_store_dwordx4 v[168:171], v27, s[36:39], s53 offen offset:0 sc1
    v_mfma_f32_16x16x32_bf16 v[212:215], v[44:47], a[180:183], v[212:215]
    ds_read_b128 v[124:127], v25 offset:768
    v_mfma_f32_16x16x32_bf16 v[216:219], v[44:47], a[184:187], v[216:219]
    v_mfma_f32_16x16x32_bf16 v[220:223], v[44:47], a[188:191], v[220:223]
    v_cvt_pk_bf16_f32 v172, v172, v173
    v_mfma_f32_16x16x32_bf16 v[208:211], v[48:51], a[192:195], v[208:211]
    buffer_load_dwordx4 v13, s[44:47], s99 offen offset:1024 nt lds
    v_mfma_f32_16x16x32_bf16 v[212:215], v[48:51], a[196:199], v[212:215]
    v_mfma_f32_16x16x32_bf16 v[216:219], v[48:51], a[200:203], v[216:219]
    v_mfma_f32_16x16x32_bf16 v[220:223], v[48:51], a[204:207], v[220:223]
    v_cvt_pk_bf16_f32 v173, v174, v175
    v_mfma_f32_16x16x32_bf16 v[208:211], v[52:55], a[208:211], v[208:211]
    v_cvt_pk_bf16_f32 v174, v188, v189
    v_mfma_f32_16x16x32_bf16 v[212:215], v[52:55], a[212:215], v[212:215]
    buffer_load_dwordx4 v14, s[44:47], s99 offen offset:2048 nt lds
    v_mfma_f32_16x16x32_bf16 v[216:219], v[52:55], a[216:219], v[216:219]
    v_mfma_f32_16x16x32_bf16 v[220:223], v[52:55], a[220:223], v[220:223]
    v_mfma_f32_16x16x32_bf16 v[208:211], v[56:59], a[224:227], v[208:211]
    v_cvt_pk_bf16_f32 v175, v190, v191
    v_mfma_f32_16x16x32_bf16 v[212:215], v[56:59], a[228:231], v[212:215]
    v_mfma_f32_16x16x32_bf16 v[216:219], v[56:59], a[232:235], v[216:219]
    buffer_load_dwordx4 v15, s[44:47], s99 offen offset:3072 nt lds
    v_mfma_f32_16x16x32_bf16 v[220:223], v[56:59], a[236:239], v[220:223]
    s_add_u32 s99, s99, 524288
    v_mfma_f32_16x16x32_bf16 v[208:211], v[60:63], a[240:243], v[208:211]
    buffer_store_dwordx4 v[172:175], v27, s[36:39], s53 offen offset:1024 sc1
    v_mfma_f32_16x16x32_bf16 v[212:215], v[60:63], a[244:247], v[212:215]
    v_mfma_f32_16x16x32_bf16 v[216:219], v[60:63], a[248:251], v[216:219]
    v_mfma_f32_16x16x32_bf16 v[220:223], v[60:63], a[252:255], v[220:223]
    s_waitcnt lgkmcnt(0)
    v_mfma_f32_16x16x32_bf16 v[224:227], v[64:67], a[0:3], 0
    ds_read_b128 v[32:35], v22 offset:16384
    v_mfma_f32_16x16x32_bf16 v[228:231], v[64:67], a[4:7], 0
    s_add_u32 m0, s100, 49152
    v_mfma_f32_16x16x32_bf16 v[232:235], v[64:67], a[8:11], 0
    buffer_load_dwordx4 v8, s[40:43], s97 offen offset:0 lds
    v_mfma_f32_16x16x32_bf16 v[236:239], v[64:67], a[12:15], 0
    ds_read_b128 v[36:39], v23 offset:16384
    v_mfma_f32_16x16x32_bf16 v[224:227], v[68:71], a[16:19], v[224:227]
    v_mfma_f32_16x16x32_bf16 v[228:231], v[68:71], a[20:23], v[228:231]
    v_mfma_f32_16x16x32_bf16 v[232:235], v[68:71], a[24:27], v[232:235]
    ds_read_b128 v[40:43], v24 offset:16384
    v_mfma_f32_16x16x32_bf16 v[236:239], v[68:71], a[28:31], v[236:239]
    buffer_load_dwordx4 v9, s[40:43], s97 offen offset:1024 lds
    v_mfma_f32_16x16x32_bf16 v[224:227], v[72:75], a[32:35], v[224:227]
    v_mfma_f32_16x16x32_bf16 v[228:231], v[72:75], a[36:39], v[228:231]
    ds_read_b128 v[44:47], v25 offset:16384
    v_mfma_f32_16x16x32_bf16 v[232:235], v[72:75], a[40:43], v[232:235]
    v_mfma_f32_16x16x32_bf16 v[236:239], v[72:75], a[44:47], v[236:239]
    v_mfma_f32_16x16x32_bf16 v[224:227], v[76:79], a[48:51], v[224:227]
    buffer_load_dwordx4 v10, s[40:43], s97 offen offset:2048 lds
    v_mfma_f32_16x16x32_bf16 v[228:231], v[76:79], a[52:55], v[228:231]
    ds_read_b128 v[48:51], v22 offset:16640
    v_mfma_f32_16x16x32_bf16 v[232:235], v[76:79], a[56:59], v[232:235]
    v_mfma_f32_16x16x32_bf16 v[236:239], v[76:79], a[60:63], v[236:239]
    ds_read_b128 v[52:55], v23 offset:16640
    v_mfma_f32_16x16x32_bf16 v[224:227], v[80:83], a[64:67], v[224:227]
    v_mfma_f32_16x16x32_bf16 v[228:231], v[80:83], a[68:71], v[228:231]
    buffer_load_dwordx4 v11, s[40:43], s97 offen offset:3072 lds
    v_mfma_f32_16x16x32_bf16 v[232:235], v[80:83], a[72:75], v[232:235]
    s_add_u32 s97, s97, 128
    ds_read_b128 v[56:59], v24 offset:16640
    v_mfma_f32_16x16x32_bf16 v[236:239], v[80:83], a[76:79], v[236:239]
    v_mfma_f32_16x16x32_bf16 v[224:227], v[84:87], a[80:83], v[224:227]
    v_mfma_f32_16x16x32_bf16 v[228:231], v[84:87], a[84:87], v[228:231]
    s_add_u32 m0, s100, 53248
    ds_read_b128 v[60:63], v25 offset:16640
    v_mfma_f32_16x16x32_bf16 v[232:235], v[84:87], a[88:91], v[232:235]
    buffer_load_dwordx4 v8, s[40:43], s98 offen offset:0 lds
    v_mfma_f32_16x16x32_bf16 v[236:239], v[84:87], a[92:95], v[236:239]
    v_mfma_f32_16x16x32_bf16 v[224:227], v[88:91], a[96:99], v[224:227]
    ds_read_b128 v[64:67], v22 offset:16896
    v_mfma_f32_16x16x32_bf16 v[228:231], v[88:91], a[100:103], v[228:231]
    v_mfma_f32_16x16x32_bf16 v[232:235], v[88:91], a[104:107], v[232:235]
    v_mfma_f32_16x16x32_bf16 v[236:239], v[88:91], a[108:111], v[236:239]
    buffer_load_dwordx4 v9, s[40:43], s98 offen offset:1024 lds
    v_mfma_f32_16x16x32_bf16 v[224:227], v[92:95], a[112:115], v[224:227]
    ds_read_b128 v[68:71], v23 offset:16896
    v_mfma_f32_16x16x32_bf16 v[228:231], v[92:95], a[116:119], v[228:231]
    v_mfma_f32_16x16x32_bf16 v[232:235], v[92:95], a[120:123], v[232:235]
    ds_read_b128 v[72:75], v24 offset:16896
    v_mfma_f32_16x16x32_bf16 v[236:239], v[92:95], a[124:127], v[236:239]
    v_mfma_f32_16x16x32_bf16 v[224:227], v[96:99], a[128:131], v[224:227]
    v_mfma_f32_16x16x32_bf16 v[228:231], v[96:99], a[132:135], v[228:231]
    buffer_load_dwordx4 v10, s[40:43], s98 offen offset:2048 lds
    v_mfma_f32_16x16x32_bf16 v[232:235], v[96:99], a[136:139], v[232:235]
    ds_read_b128 v[76:79], v25 offset:16896
    v_mfma_f32_16x16x32_bf16 v[236:239], v[96:99], a[140:143], v[236:239]
    v_mfma_f32_16x16x32_bf16 v[224:227], v[100:103], a[144:147], v[224:227]
    ds_read_b128 v[80:83], v22 offset:17152
    v_mfma_f32_16x16x32_bf16 v[228:231], v[100:103], a[148:151], v[228:231]
    v_mfma_f32_16x16x32_bf16 v[232:235], v[100:103], a[152:155], v[232:235]
    buffer_load_dwordx4 v11, s[40:43], s98 offen offset:3072 lds
    v_mfma_f32_16x16x32_bf16 v[236:239], v[100:103], a[156:159], v[236:239]
    s_add_u32 s98, s98, 128
    ds_read_b128 v[84:87], v23 offset:17152
    v_mfma_f32_16x16x32_bf16 v[224:227], v[104:107], a[160:163], v[224:227]
    v_mfma_f32_16x16x32_bf16 v[228:231], v[104:107], a[164:167], v[228:231]
    v_mfma_f32_16x16x32_bf16 v[232:235], v[104:107], a[168:171], v[232:235]
    s_add_u32 m0, s101, 49152
    ds_read_b128 v[88:91], v24 offset:17152
    v_mfma_f32_16x16x32_bf16 v[236:239], v[104:107], a[172:175], v[236:239]
    buffer_load_dwordx4 v12, s[44:47], s99 offen offset:0 nt lds
    v_mfma_f32_16x16x32_bf16 v[224:227], v[108:111], a[176:179], v[224:227]
    v_mfma_f32_16x16x32_bf16 v[228:231], v[108:111], a[180:183], v[228:231]
    ds_read_b128 v[92:95], v25 offset:17152
    v_mfma_f32_16x16x32_bf16 v[232:235], v[108:111], a[184:187], v[232:235]
    v_mfma_f32_16x16x32_bf16 v[236:239], v[108:111], a[188:191], v[236:239]
    v_mfma_f32_16x16x32_bf16 v[224:227], v[112:115], a[192:195], v[224:227]
    buffer_load_dwordx4 v13, s[44:47], s99 offen offset:1024 nt lds
    v_mfma_f32_16x16x32_bf16 v[228:231], v[112:115], a[196:199], v[228:231]
    v_mfma_f32_16x16x32_bf16 v[232:235], v[112:115], a[200:203], v[232:235]
    v_mfma_f32_16x16x32_bf16 v[236:239], v[112:115], a[204:207], v[236:239]
    v_mfma_f32_16x16x32_bf16 v[224:227], v[116:119], a[208:211], v[224:227]
    v_mfma_f32_16x16x32_bf16 v[228:231], v[116:119], a[212:215], v[228:231]
    buffer_load_dwordx4 v14, s[44:47], s99 offen offset:2048 nt lds
    v_mfma_f32_16x16x32_bf16 v[232:235], v[116:119], a[216:219], v[232:235]
    v_mfma_f32_16x16x32_bf16 v[236:239], v[116:119], a[220:223], v[236:239]
    v_mfma_f32_16x16x32_bf16 v[224:227], v[120:123], a[224:227], v[224:227]
    v_mfma_f32_16x16x32_bf16 v[228:231], v[120:123], a[228:231], v[228:231]
    v_mfma_f32_16x16x32_bf16 v[232:235], v[120:123], a[232:235], v[232:235]
    buffer_load_dwordx4 v15, s[44:47], s99 offen offset:3072 nt lds
    v_mfma_f32_16x16x32_bf16 v[236:239], v[120:123], a[236:239], v[236:239]
    s_add_u32 s99, s99, 524288
    v_mfma_f32_16x16x32_bf16 v[224:227], v[124:127], a[240:243], v[224:227]
    v_mfma_f32_16x16x32_bf16 v[228:231], v[124:127], a[244:247], v[228:231]
    v_mfma_f32_16x16x32_bf16 v[232:235], v[124:127], a[248:251], v[232:235]
    v_mfma_f32_16x16x32_bf16 v[236:239], v[124:127], a[252:255], v[236:239]
    s_waitcnt vmcnt(13) lgkmcnt(0)
    s_barrier
    v_mfma_f32_16x16x32_bf16 v[240:243], v[32:35], a[0:3], 0
    v_and_b32 v5, 7, v1
    v_cvt_pk_bf16_f32 v96, v192, v193
    v_mfma_f32_16x16x32_bf16 v[244:247], v[32:35], a[4:7], 0
    s_add_u32 m0, s100, 98304
    v_xor_b32 v5, v5, v3
    v_mfma_f32_16x16x32_bf16 v[248:251], v[32:35], a[8:11], 0
    buffer_load_dwordx4 v8, s[40:43], s97 offen offset:0 lds
    v_mfma_f32_16x16x32_bf16 v[252:255], v[32:35], a[12:15], 0
    v_lshlrev_b32 v5, 4, v5
    v_cvt_pk_bf16_f32 v97, v194, v195
    v_mfma_f32_16x16x32_bf16 v[240:243], v[36:39], a[16:19], v[240:243]
    v_lshl_add_u32 v5, v4, 7, v5
    v_mfma_f32_16x16x32_bf16 v[244:247], v[36:39], a[20:23], v[244:247]
    v_cvt_pk_bf16_f32 v98, v208, v209
    v_mfma_f32_16x16x32_bf16 v[248:251], v[36:39], a[24:27], v[248:251]
    v_add_u32 v16, s100, v5
    v_xor_b32 v17, 64, v16
    v_mfma_f32_16x16x32_bf16 v[252:255], v[36:39], a[28:31], v[252:255]
    buffer_load_dwordx4 v9, s[40:43], s97 offen offset:1024 lds
    v_mfma_f32_16x16x32_bf16 v[240:243], v[40:43], a[32:35], v[240:243]
    v_cvt_pk_bf16_f32 v99, v210, v211
    v_mfma_f32_16x16x32_bf16 v[244:247], v[40:43], a[36:39], v[244:247]
    v_lshrrev_b32 v5, 2, v4
    v_mfma_f32_16x16x32_bf16 v[248:251], v[40:43], a[40:43], v[248:251]
    v_lshl_add_u32 v6, v3, 3, v5
    v_mfma_f32_16x16x32_bf16 v[252:255], v[40:43], a[44:47], v[252:255]
    v_lshlrev_b32 v6, 8, v6
    v_cvt_pk_bf16_f32 v100, v196, v197
    v_mfma_f32_16x16x32_bf16 v[240:243], v[44:47], a[48:51], v[240:243]
    buffer_load_dwordx4 v10, s[40:43], s97 offen offset:2048 lds
    v_mfma_f32_16x16x32_bf16 v[244:247], v[44:47], a[52:55], v[244:247]
    v_and_b32 v7, 1, v3
    v_mfma_f32_16x16x32_bf16 v[248:251], v[44:47], a[56:59], v[248:251]
    v_lshl_add_u32 v5, v7, 2, v5
    v_cvt_pk_bf16_f32 v101, v198, v199
    v_mfma_f32_16x16x32_bf16 v[252:255], v[44:47], a[60:63], v[252:255]
    v_cvt_pk_bf16_f32 v102, v212, v213
    v_mfma_f32_16x16x32_bf16 v[240:243], v[48:51], a[64:67], v[240:243]
    v_lshl_add_u32 v6, v5, 5, v6
    v_and_b32 v7, 3, v4
    v_mfma_f32_16x16x32_bf16 v[244:247], v[48:51], a[68:71], v[244:247]
    buffer_load_dwordx4 v11, s[40:43], s97 offen offset:3072 lds
    v_mfma_f32_16x16x32_bf16 v[248:251], v[48:51], a[72:75], v[248:251]
    s_add_u32 s97, s97, 128
    v_mfma_f32_16x16x32_bf16 v[252:255], v[48:51], a[76:79], v[252:255]
    v_lshl_add_u32 v6, v7, 3, v6
    v_cvt_pk_bf16_f32 v103, v214, v215
    v_mfma_f32_16x16x32_bf16 v[240:243], v[52:55], a[80:83], v[240:243]
    v_add_u32 v18, 0x8000, v6
    v_cvt_pk_bf16_f32 v104, v200, v201
    v_mfma_f32_16x16x32_bf16 v[244:247], v[52:55], a[84:87], v[244:247]
    s_add_u32 m0, s100, 102400
    v_xor_b32 v19, 32, v18
    v_mfma_f32_16x16x32_bf16 v[248:251], v[52:55], a[88:91], v[248:251]
    buffer_load_dwordx4 v8, s[40:43], s98 offen offset:0 lds
    v_mfma_f32_16x16x32_bf16 v[252:255], v[52:55], a[92:95], v[252:255]
    v_xor_b32 v20, 64, v18
    v_mfma_f32_16x16x32_bf16 v[240:243], v[56:59], a[96:99], v[240:243]
    v_xor_b32 v21, 96, v18
    v_cvt_pk_bf16_f32 v105, v202, v203
    v_mfma_f32_16x16x32_bf16 v[244:247], v[56:59], a[100:103], v[244:247]
    v_cvt_pk_bf16_f32 v106, v216, v217
    v_mfma_f32_16x16x32_bf16 v[248:251], v[56:59], a[104:107], v[248:251]
    v_xor_b32 v22, 128, v18
    v_xor_b32 v23, 160, v18
    v_mfma_f32_16x16x32_bf16 v[252:255], v[56:59], a[108:111], v[252:255]
    buffer_load_dwordx4 v9, s[40:43], s98 offen offset:1024 lds
    v_mfma_f32_16x16x32_bf16 v[240:243], v[60:63], a[112:115], v[240:243]
    v_xor_b32 v24, 192, v18
    v_mfma_f32_16x16x32_bf16 v[244:247], v[60:63], a[116:119], v[244:247]
    v_cvt_pk_bf16_f32 v107, v218, v219
    v_mfma_f32_16x16x32_bf16 v[248:251], v[60:63], a[120:123], v[248:251]
    v_xor_b32 v25, 224, v18
    v_mfma_f32_16x16x32_bf16 v[252:255], v[60:63], a[124:127], v[252:255]
    v_mfma_f32_16x16x32_bf16 v[240:243], v[64:67], a[128:131], v[240:243]
    v_cvt_pk_bf16_f32 v108, v204, v205
    v_mfma_f32_16x16x32_bf16 v[244:247], v[64:67], a[132:135], v[244:247]
    buffer_load_dwordx4 v10, s[40:43], s98 offen offset:2048 lds
    v_mfma_f32_16x16x32_bf16 v[248:251], v[64:67], a[136:139], v[248:251]
    ds_read_b128 a[32:35], v16 offset:0
    v_cvt_pk_bf16_f32 v109, v206, v207
    v_mfma_f32_16x16x32_bf16 v[252:255], v[64:67], a[140:143], v[252:255]
    ds_read_b64_tr_b16 a[48:49], v18 offset:0
    ds_read_b64_tr_b16 a[50:51], v18 offset:1024
    v_mfma_f32_16x16x32_bf16 v[240:243], v[68:71], a[144:147], v[240:243]
    ds_read_b128 a[80:83], v17 offset:0
    v_cvt_pk_bf16_f32 v110, v220, v221
    v_mfma_f32_16x16x32_bf16 v[244:247], v[68:71], a[148:151], v[244:247]
    ds_read_b64_tr_b16 a[96:97], v18 offset:8192
    ds_read_b64_tr_b16 a[98:99], v18 offset:9216
    v_mfma_f32_16x16x32_bf16 v[248:251], v[68:71], a[152:155], v[248:251]
    buffer_load_dwordx4 v11, s[40:43], s98 offen offset:3072 lds
    v_mfma_f32_16x16x32_bf16 v[252:255], v[68:71], a[156:159], v[252:255]
    s_add_u32 s98, s98, 128
    ds_read_b128 a[36:39], v16 offset:2048
    v_cvt_pk_bf16_f32 v111, v222, v223
    v_mfma_f32_16x16x32_bf16 v[240:243], v[72:75], a[160:163], v[240:243]
    ds_read_b64_tr_b16 a[52:53], v19 offset:0
    ds_read_b64_tr_b16 a[54:55], v19 offset:1024
    v_mfma_f32_16x16x32_bf16 v[244:247], v[72:75], a[164:167], v[244:247]
    ds_read_b128 a[84:87], v17 offset:2048
    ds_read_b64_tr_b16 a[100:101], v19 offset:8192
    v_mfma_f32_16x16x32_bf16 v[248:251], v[72:75], a[168:171], v[248:251]
    s_add_u32 m0, s101, 98304
    ds_read_b64_tr_b16 a[102:103], v19 offset:9216
    v_mfma_f32_16x16x32_bf16 v[252:255], v[72:75], a[172:175], v[252:255]
    buffer_load_dwordx4 v12, s[44:47], s99 offen offset:0 nt lds
    v_mfma_f32_16x16x32_bf16 v[240:243], v[76:79], a[176:179], v[240:243]
    ds_read_b128 a[40:43], v16 offset:4096
    ds_read_b64_tr_b16 a[56:57], v20 offset:0
    v_mfma_f32_16x16x32_bf16 v[244:247], v[76:79], a[180:183], v[244:247]
    ds_read_b64_tr_b16 a[58:59], v20 offset:1024
    ds_read_b128 a[88:91], v17 offset:4096
    v_mfma_f32_16x16x32_bf16 v[248:251], v[76:79], a[184:187], v[248:251]
    ds_read_b64_tr_b16 a[104:105], v20 offset:8192
    v_mfma_f32_16x16x32_bf16 v[252:255], v[76:79], a[188:191], v[252:255]
    ds_read_b64_tr_b16 a[106:107], v20 offset:9216
    ds_read_b128 a[44:47], v16 offset:6144
    v_mfma_f32_16x16x32_bf16 v[240:243], v[80:83], a[192:195], v[240:243]
    buffer_load_dwordx4 v13, s[44:47], s99 offen offset:1024 nt lds
    v_mfma_f32_16x16x32_bf16 v[244:247], v[80:83], a[196:199], v[244:247]
    ds_read_b64_tr_b16 a[60:61], v21 offset:0
    ds_read_b64_tr_b16 a[62:63], v21 offset:1024
    v_mfma_f32_16x16x32_bf16 v[248:251], v[80:83], a[200:203], v[248:251]
    ds_read_b128 a[92:95], v17 offset:6144
    ds_read_b64_tr_b16 a[108:109], v21 offset:8192
    v_mfma_f32_16x16x32_bf16 v[252:255], v[80:83], a[204:207], v[252:255]
    ds_read_b64_tr_b16 a[110:111], v21 offset:9216
    v_mfma_f32_16x16x32_bf16 v[240:243], v[84:87], a[208:211], v[240:243]
    ds_read_b64_tr_b16 a[64:65], v22 offset:0
    ds_read_b64_tr_b16 a[66:67], v22 offset:1024
    v_mfma_f32_16x16x32_bf16 v[244:247], v[84:87], a[212:215], v[244:247]
    buffer_load_dwordx4 v14, s[44:47], s99 offen offset:2048 nt lds
    v_mfma_f32_16x16x32_bf16 v[248:251], v[84:87], a[216:219], v[248:251]
    ds_read_b64_tr_b16 a[112:113], v22 offset:8192
    ds_read_b64_tr_b16 a[114:115], v22 offset:9216
    v_mfma_f32_16x16x32_bf16 v[252:255], v[84:87], a[220:223], v[252:255]
    ds_read_b64_tr_b16 a[68:69], v23 offset:0
    v_mfma_f32_16x16x32_bf16 v[240:243], v[88:91], a[224:227], v[240:243]
    ds_read_b64_tr_b16 a[70:71], v23 offset:1024
    ds_read_b64_tr_b16 a[116:117], v23 offset:8192
    v_mfma_f32_16x16x32_bf16 v[244:247], v[88:91], a[228:231], v[244:247]
    ds_read_b64_tr_b16 a[118:119], v23 offset:9216
    ds_read_b64_tr_b16 a[72:73], v24 offset:0
    v_mfma_f32_16x16x32_bf16 v[248:251], v[88:91], a[232:235], v[248:251]
    buffer_load_dwordx4 v15, s[44:47], s99 offen offset:3072 nt lds
    v_mfma_f32_16x16x32_bf16 v[252:255], v[88:91], a[236:239], v[252:255]
    s_add_u32 s99, s99, 524288
    ds_read_b64_tr_b16 a[74:75], v24 offset:1024
    v_mfma_f32_16x16x32_bf16 v[240:243], v[92:95], a[240:243], v[240:243]
    ds_read_b64_tr_b16 a[120:121], v24 offset:8192
    ds_read_b64_tr_b16 a[122:123], v24 offset:9216
    v_mfma_f32_16x16x32_bf16 v[244:247], v[92:95], a[244:247], v[244:247]
    ds_read_b64_tr_b16 a[76:77], v25 offset:0
    v_mfma_f32_16x16x32_bf16 v[248:251], v[92:95], a[248:251], v[248:251]
    ds_read_b64_tr_b16 a[78:79], v25 offset:1024
    ds_read_b64_tr_b16 a[124:125], v25 offset:8192
    v_mfma_f32_16x16x32_bf16 v[252:255], v[92:95], a[252:255], v[252:255]
    ds_read_b64_tr_b16 a[126:127], v25 offset:9216
    s_nop 3
    v_cvt_pk_bf16_f32 v112, v224, v225
    v_cvt_pk_bf16_f32 v113, v226, v227
    v_cvt_pk_bf16_f32 v114, v240, v241
    v_cvt_pk_bf16_f32 v115, v242, v243
    v_cvt_pk_bf16_f32 v116, v228, v229
    v_cvt_pk_bf16_f32 v117, v230, v231
    v_cvt_pk_bf16_f32 v118, v244, v245
    v_cvt_pk_bf16_f32 v119, v246, v247
    v_cvt_pk_bf16_f32 v120, v232, v233
    v_cvt_pk_bf16_f32 v121, v234, v235
    v_cvt_pk_bf16_f32 v122, v248, v249
    v_cvt_pk_bf16_f32 v123, v250, v251
    v_cvt_pk_bf16_f32 v124, v236, v237
    v_cvt_pk_bf16_f32 v125, v238, v239
    v_cvt_pk_bf16_f32 v126, v252, v253
    v_cvt_pk_bf16_f32 v127, v254, v255
L_join:
    v_add_u32 v16, 0xc000, v16
    v_add_u32 v17, 0xc000, v17
    v_add_u32 v18, 0xc000, v18
    v_add_u32 v19, 0xc000, v19
    v_add_u32 v20, 0xc000, v20
    v_add_u32 v21, 0xc000, v21
    v_add_u32 v22, 0xc000, v22
    v_add_u32 v23, 0xc000, v23
    v_add_u32 v24, 0xc000, v24
    v_add_u32 v25, 0xc000, v25
    s_waitcnt vmcnt(12) lgkmcnt(0)
    s_barrier
    v_mfma_f32_16x16x32_bf16 v[128:131], a[48:51], a[32:35], 0
    ds_read_b128 a[128:131], v16 offset:0
    v_mfma_f32_16x16x32_bf16 v[128:131], a[96:99], a[80:83], v[128:131]
    s_add_u32 m0, s100, 0
    ds_read_b64_tr_b16 a[144:145], v18 offset:0
    v_mfma_f32_16x16x32_bf16 v[132:135], a[52:55], a[32:35], 0
    buffer_load_dwordx4 v8, s[40:43], s97 offen offset:0 lds
    v_mfma_f32_16x16x32_bf16 v[132:135], a[100:103], a[80:83], v[132:135]
    ds_read_b64_tr_b16 a[146:147], v18 offset:1024
    v_mfma_f32_16x16x32_bf16 v[136:139], a[56:59], a[32:35], 0
    ds_read_b128 a[176:179], v17 offset:0
    v_mfma_f32_16x16x32_bf16 v[136:139], a[104:107], a[80:83], v[136:139]
    ds_read_b64_tr_b16 a[192:193], v18 offset:8192
    v_mfma_f32_16x16x32_bf16 v[140:143], a[60:63], a[32:35], 0
    ds_read_b64_tr_b16 a[194:195], v18 offset:9216
    v_mfma_f32_16x16x32_bf16 v[140:143], a[108:111], a[80:83], v[140:143]
    buffer_load_dwordx4 v9, s[40:43], s97 offen offset:1024 lds
    v_mfma_f32_16x16x32_bf16 v[144:147], a[64:67], a[32:35], 0
    ds_read_b128 a[132:135], v16 offset:2048
    v_mfma_f32_16x16x32_bf16 v[144:147], a[112:115], a[80:83], v[144:147]
    ds_read_b64_tr_b16 a[148:149], v19 offset:0
    s_mov_b32 s53, 49152
    v_mfma_f32_16x16x32_bf16 v[148:151], a[68:71], a[32:35], 0
    buffer_store_dwordx4 v[96:99], v26, s[36:39], s53 offen offset:0 sc1
    v_mfma_f32_16x16x32_bf16 v[148:151], a[116:119], a[80:83], v[148:151]
    ds_read_b64_tr_b16 a[150:151], v19 offset:1024
    v_mfma_f32_16x16x32_bf16 v[152:155], a[72:75], a[32:35], 0
    ds_read_b128 a[180:183], v17 offset:2048
    ds_read_b64_tr_b16 a[196:197], v19 offset:8192
    v_mfma_f32_16x16x32_bf16 v[152:155], a[120:123], a[80:83], v[152:155]
    buffer_load_dwordx4 v10, s[40:43], s97 offen offset:2048 lds
    v_mfma_f32_16x16x32_bf16 v[156:159], a[76:79], a[32:35], 0
    v_mfma_f32_16x16x32_bf16 v[156:159], a[124:127], a[80:83], v[156:159]
    ds_read_b64_tr_b16 a[198:199], v19 offset:9216
    v_mfma_f32_16x16x32_bf16 v[188:191], a[76:79], a[36:39], 0
    ds_read_b128 a[136:139], v16 offset:4096
    v_mfma_f32_16x16x32_bf16 v[188:191], a[124:127], a[84:87], v[188:191]
    ds_read_b64_tr_b16 a[152:153], v20 offset:0
    v_mfma_f32_16x16x32_bf16 v[184:187], a[72:75], a[36:39], 0
    buffer_load_dwordx4 v11, s[40:43], s97 offen offset:3072 lds
    v_mfma_f32_16x16x32_bf16 v[184:187], a[120:123], a[84:87], v[184:187]
    s_add_u32 s97, s97, 128
    ds_read_b64_tr_b16 a[154:155], v20 offset:1024
    v_mfma_f32_16x16x32_bf16 v[180:183], a[68:71], a[36:39], 0
    ds_read_b128 a[184:187], v17 offset:4096
    v_mfma_f32_16x16x32_bf16 v[180:183], a[116:119], a[84:87], v[180:183]
    ds_read_b64_tr_b16 a[200:201], v20 offset:8192
    v_mfma_f32_16x16x32_bf16 v[176:179], a[64:67], a[36:39], 0
    s_add_u32 m0, s100, 4096
    ds_read_b64_tr_b16 a[202:203], v20 offset:9216
    v_mfma_f32_16x16x32_bf16 v[176:179], a[112:115], a[84:87], v[176:179]
    buffer_load_dwordx4 v8, s[40:43], s98 offen offset:0 lds
    v_mfma_f32_16x16x32_bf16 v[172:175], a[60:63], a[36:39], 0
    ds_read_b128 a[140:143], v16 offset:6144
    v_mfma_f32_16x16x32_bf16 v[172:175], a[108:111], a[84:87], v[172:175]
    ds_read_b64_tr_b16 a[156:157], v21 offset:0
    v_mfma_f32_16x16x32_bf16 v[168:171], a[56:59], a[36:39], 0
    buffer_store_dwordx4 v[100:103], v26, s[36:39], s53 offen offset:1024 sc1
    v_mfma_f32_16x16x32_bf16 v[168:171], a[104:107], a[84:87], v[168:171]
    ds_read_b64_tr_b16 a[158:159], v21 offset:1024
    ds_read_b128 a[188:191], v17 offset:6144
    v_mfma_f32_16x16x32_bf16 v[164:167], a[52:55], a[36:39], 0
    buffer_load_dwordx4 v9, s[40:43], s98 offen offset:1024 lds
    v_mfma_f32_16x16x32_bf16 v[164:167], a[100:103], a[84:87], v[164:167]
    ds_read_b64_tr_b16 a[204:205], v21 offset:8192
    v_mfma_f32_16x16x32_bf16 v[160:163], a[48:51], a[36:39], 0
    v_mfma_f32_16x16x32_bf16 v[160:163], a[96:99], a[84:87], v[160:163]
    ds_read_b64_tr_b16 a[206:207], v21 offset:9216
    v_mfma_f32_16x16x32_bf16 v[192:195], a[48:51], a[40:43], 0
    ds_read_b64_tr_b16 a[160:161], v22 offset:0
    v_mfma_f32_16x16x32_bf16 v[192:195], a[96:99], a[88:91], v[192:195]
    ds_read_b64_tr_b16 a[162:163], v22 offset:1024
    v_mfma_f32_16x16x32_bf16 v[196:199], a[52:55], a[40:43], 0
    buffer_load_dwordx4 v10, s[40:43], s98 offen offset:2048 lds
    v_mfma_f32_16x16x32_bf16 v[196:199], a[100:103], a[88:91], v[196:199]
    ds_read_b64_tr_b16 a[208:209], v22 offset:8192
    v_mfma_f32_16x16x32_bf16 v[200:203], a[56:59], a[40:43], 0
    ds_read_b64_tr_b16 a[210:211], v22 offset:9216
    v_mfma_f32_16x16x32_bf16 v[200:203], a[104:107], a[88:91], v[200:203]
    ds_read_b64_tr_b16 a[164:165], v23 offset:0
    v_mfma_f32_16x16x32_bf16 v[204:207], a[60:63], a[40:43], 0
    ds_read_b64_tr_b16 a[166:167], v23 offset:1024
    buffer_store_dwordx4 v[104:107], v27, s[36:39], s53 offen offset:0 sc1
    v_mfma_f32_16x16x32_bf16 v[204:207], a[108:111], a[88:91], v[204:207]
    buffer_load_dwordx4 v11, s[40:43], s98 offen offset:3072 lds
    v_mfma_f32_16x16x32_bf16 v[208:211], a[64:67], a[40:43], 0
    s_add_u32 s98, s98, 128
    ds_read_b64_tr_b16 a[212:213], v23 offset:8192
    v_mfma_f32_16x16x32_bf16 v[208:211], a[112:115], a[88:91], v[208:211]
    ds_read_b64_tr_b16 a[214:215], v23 offset:9216
    v_mfma_f32_16x16x32_bf16 v[212:215], a[68:71], a[40:43], 0
    v_mfma_f32_16x16x32_bf16 v[212:215], a[116:119], a[88:91], v[212:215]
    s_add_u32 m0, s101, 0
    ds_read_b64_tr_b16 a[168:169], v24 offset:0
    v_mfma_f32_16x16x32_bf16 v[216:219], a[72:75], a[40:43], 0
    buffer_load_dwordx4 v12, s[44:47], s99 offen offset:0 nt lds
    v_mfma_f32_16x16x32_bf16 v[216:219], a[120:123], a[88:91], v[216:219]
    ds_read_b64_tr_b16 a[170:171], v24 offset:1024
    ds_read_b64_tr_b16 a[216:217], v24 offset:8192
    v_mfma_f32_16x16x32_bf16 v[220:223], a[76:79], a[40:43], 0
    v_mfma_f32_16x16x32_bf16 v[220:223], a[124:127], a[88:91], v[220:223]
    ds_read_b64_tr_b16 a[218:219], v24 offset:9216
    v_mfma_f32_16x16x32_bf16 v[252:255], a[76:79], a[44:47], 0
    ds_read_b64_tr_b16 a[172:173], v25 offset:0
    ds_read_b64_tr_b16 a[174:175], v25 offset:1024
    v_mfma_f32_16x16x32_bf16 v[252:255], a[124:127], a[92:95], v[252:255]
    buffer_load_dwordx4 v13, s[44:47], s99 offen offset:1024 nt lds
    v_mfma_f32_16x16x32_bf16 v[248:251], a[72:75], a[44:47], 0
    v_mfma_f32_16x16x32_bf16 v[248:251], a[120:123], a[92:95], v[248:251]
    ds_read_b64_tr_b16 a[220:221], v25 offset:8192
    v_mfma_f32_16x16x32_bf16 v[244:247], a[68:71], a[44:47], 0
    ds_read_b64_tr_b16 a[222:223], v25 offset:9216
    v_mfma_f32_16x16x32_bf16 v[244:247], a[116:119], a[92:95], v[244:247]
    buffer_store_dwordx4 v[108:111], v27, s[36:39], s53 offen offset:1024 sc1
    v_mfma_f32_16x16x32_bf16 v[240:243], a[64:67], a[44:47], 0
    v_add_u32 v16, 0xc000, v16
    v_add_u32 v17, 0xc000, v17
    v_mfma_f32_16x16x32_bf16 v[240:243], a[112:115], a[92:95], v[240:243]
    buffer_load_dwordx4 v14, s[44:47], s99 offen offset:2048 nt lds
    v_mfma_f32_16x16x32_bf16 v[236:239], a[60:63], a[44:47], 0
    v_add_u32 v18, 0xc000, v18
    v_mfma_f32_16x16x32_bf16 v[236:239], a[108:111], a[92:95], v[236:239]
    v_add_u32 v19, 0xc000, v19
    v_mfma_f32_16x16x32_bf16 v[232:235], a[56:59], a[44:47], 0
    v_add_u32 v20, 0xc000, v20
    v_mfma_f32_16x16x32_bf16 v[232:235], a[104:107], a[92:95], v[232:235]
    v_add_u32 v21, 0xc000, v21
    v_add_u32 v22, 0xc000, v22
    v_mfma_f32_16x16x32_bf16 v[228:231], a[52:55], a[44:47], 0
    buffer_load_dwordx4 v15, s[44:47], s99 offen offset:3072 nt lds
    v_mfma_f32_16x16x32_bf16 v[228:231], a[100:103], a[92:95], v[228:231]
    s_add_u32 s99, s99, 524288
    v_add_u32 v23, 0xc000, v23
    v_mfma_f32_16x16x32_bf16 v[224:227], a[48:51], a[44:47], 0
    v_add_u32 v24, 0xc000, v24
    v_mfma_f32_16x16x32_bf16 v[224:227], a[96:99], a[92:95], v[224:227]
    v_add_u32 v25, 0xc000, v25
    s_waitcnt vmcnt(16) lgkmcnt(0)
    s_barrier
    v_mfma_f32_16x16x32_bf16 v[128:131], a[144:147], a[128:131], v[128:131]
    ds_read_b128 a[32:35], v16 offset:0
    v_mfma_f32_16x16x32_bf16 v[128:131], a[192:195], a[176:179], v[128:131]
    s_add_u32 m0, s100, 49152
    ds_read_b64_tr_b16 a[48:49], v18 offset:0
    v_mfma_f32_16x16x32_bf16 v[132:135], a[148:151], a[128:131], v[132:135]
    buffer_load_dwordx4 v8, s[40:43], s97 offen offset:0 lds
    v_mfma_f32_16x16x32_bf16 v[132:135], a[196:199], a[176:179], v[132:135]
    ds_read_b64_tr_b16 a[50:51], v18 offset:1024
    v_mfma_f32_16x16x32_bf16 v[136:139], a[152:155], a[128:131], v[136:139]
    ds_read_b128 a[80:83], v17 offset:0
    v_mfma_f32_16x16x32_bf16 v[136:139], a[200:203], a[176:179], v[136:139]
    ds_read_b64_tr_b16 a[96:97], v18 offset:8192
    v_mfma_f32_16x16x32_bf16 v[140:143], a[156:159], a[128:131], v[140:143]
    ds_read_b64_tr_b16 a[98:99], v18 offset:9216
    v_mfma_f32_16x16x32_bf16 v[140:143], a[204:207], a[176:179], v[140:143]
    buffer_load_dwordx4 v9, s[40:43], s97 offen offset:1024 lds
    v_mfma_f32_16x16x32_bf16 v[144:147], a[160:163], a[128:131], v[144:147]
    ds_read_b128 a[36:39], v16 offset:2048
    v_mfma_f32_16x16x32_bf16 v[144:147], a[208:211], a[176:179], v[144:147]
    ds_read_b64_tr_b16 a[52:53], v19 offset:0
    s_mov_b32 s53, 57344
    v_mfma_f32_16x16x32_bf16 v[148:151], a[164:167], a[128:131], v[148:151]
    buffer_store_dwordx4 v[112:115], v26, s[36:39], s53 offen offset:0 sc1
    v_mfma_f32_16x16x32_bf16 v[148:151], a[212:215], a[176:179], v[148:151]
    ds_read_b64_tr_b16 a[54:55], v19 offset:1024
    v_mfma_f32_16x16x32_bf16 v[152:155], a[168:171], a[128:131], v[152:155]
    ds_read_b128 a[84:87], v17 offset:2048
    ds_read_b64_tr_b16 a[100:101], v19 offset:8192
    v_mfma_f32_16x16x32_bf16 v[152:155], a[216:219], a[176:179], v[152:155]
    buffer_load_dwordx4 v10, s[40:43], s97 offen offset:2048 lds
    v_mfma_f32_16x16x32_bf16 v[156:159], a[172:175], a[128:131], v[156:159]
    v_mfma_f32_16x16x32_bf16 v[156:159], a[220:223], a[176:179], v[156:159]
    ds_read_b64_tr_b16 a[102:103], v19 offset:9216
    v_mfma_f32_16x16x32_bf16 v[188:191], a[172:175], a[132:135], v[188:191]
    ds_read_b128 a[40:43], v16 offset:4096
    v_mfma_f32_16x16x32_bf16 v[188:191], a[220:223], a[180:183], v[188:191]
    ds_read_b64_tr_b16 a[56:57], v20 offset:0
    v_mfma_f32_16x16x32_bf16 v[184:187], a[168:171], a[132:135], v[184:187]
    buffer_load_dwordx4 v11, s[40:43], s97 offen offset:3072 lds
    v_mfma_f32_16x16x32_bf16 v[184:187], a[216:219], a[180:183], v[184:187]
    s_add_u32 s97, s97, 128
    ds_read_b64_tr_b16 a[58:59], v20 offset:1024
    v_mfma_f32_16x16x32_bf16 v[180:183], a[164:167], a[132:135], v[180:183]
    ds_read_b128 a[88:91], v17 offset:4096
    v_mfma_f32_16x16x32_bf16 v[180:183], a[212:215], a[180:183], v[180:183]
    ds_read_b64_tr_b16 a[104:105], v20 offset:8192
    v_mfma_f32_16x16x32_bf16 v[176:179], a[160:163], a[132:135], v[176:179]
    s_add_u32 m0, s100, 53248
    ds_read_b64_tr_b16 a[106:107], v20 offset:9216
    v_mfma_f32_16x16x32_bf16 v[176:179], a[208:211], a[180:183], v[176:179]
    buffer_load_dwordx4 v8, s[40:43], s98 offen offset:0 lds
    v_mfma_f32_16x16x32_bf16 v[172:175], a[156:159], a[132:135], v[172:175]
    ds_read_b128 a[44:47], v16 offset:6144
    v_mfma_f32_16x16x32_bf16 v[172:175], a[204:207], a[180:183], v[172:175]
    ds_read_b64_tr_b16 a[60:61], v21 offset:0
    v_mfma_f32_16x16x32_bf16 v[168:171], a[152:155], a[132:135], v[168:171]
    buffer_store_dwordx4 v[116:119], v26, s[36:39], s53 offen offset:1024 sc1
    v_mfma_f32_16x16x32_bf16 v[168:171], a[200:203], a[180:183], v[168:171]
    ds_read_b64_tr_b16 a[62:63], v21 offset:1024
    ds_read_b128 a[92:95], v17 offset:6144
    v_mfma_f32_16x16x32_bf16 v[164:167], a[148:151], a[132:135], v[164:167]
    buffer_load_dwordx4 v9, s[40:43], s98 offen offset:1024 lds
    v_mfma_f32_16x16x32_bf16 v[164:167], a[196:199], a[180:183], v[164:167]
    ds_read_b64_tr_b16 a[108:109], v21 offset:8192
    v_mfma_f32_16x16x32_bf16 v[160:163], a[144:147], a[132:135], v[160:163]
    v_mfma_f32_16x16x32_bf16 v[160:163], a[192:195], a[180:183], v[160:163]
    ds_read_b64_tr_b16 a[110:111], v21 offset:9216
    v_mfma_f32_16x16x32_bf16 v[192:195], a[144:147], a[136:139], v[192:195]
    ds_read_b64_tr_b16 a[64:65], v22 offset:0
    v_mfma_f32_16x16x32_bf16 v[192:195], a[192:195], a[184:187], v[192:195]
    ds_read_b64_tr_b16 a[66:67], v22 offset:1024
    v_mfma_f32_16x16x32_bf16 v[196:199], a[148:151], a[136:139], v[196:199]
    buffer_load_dwordx4 v10, s[40:43], s98 offen offset:2048 lds
    v_mfma_f32_16x16x32_bf16 v[196:199], a[196:199], a[184:187], v[196:199]
    ds_read_b64_tr_b16 a[112:113], v22 offset:8192
    v_mfma_f32_16x16x32_bf16 v[200:203], a[152:155], a[136:139], v[200:203]
    ds_read_b64_tr_b16 a[114:115], v22 offset:9216
    v_mfma_f32_16x16x32_bf16 v[200:203], a[200:203], a[184:187], v[200:203]
    ds_read_b64_tr_b16 a[68:69], v23 offset:0
    v_mfma_f32_16x16x32_bf16 v[204:207], a[156:159], a[136:139], v[204:207]
    ds_read_b64_tr_b16 a[70:71], v23 offset:1024
    buffer_store_dwordx4 v[120:123], v27, s[36:39], s53 offen offset:0 sc1
    v_mfma_f32_16x16x32_bf16 v[204:207], a[204:207], a[184:187], v[204:207]
    buffer_load_dwordx4 v11, s[40:43], s98 offen offset:3072 lds
    v_mfma_f32_16x16x32_bf16 v[208:211], a[160:163], a[136:139], v[208:211]
    s_add_u32 s98, s98, 128
    ds_read_b64_tr_b16 a[116:117], v23 offset:8192
    v_mfma_f32_16x16x32_bf16 v[208:211], a[208:211], a[184:187], v[208:211]
    ds_read_b64_tr_b16 a[118:119], v23 offset:9216
    v_mfma_f32_16x16x32_bf16 v[212:215], a[164:167], a[136:139], v[212:215]
    v_mfma_f32_16x16x32_bf16 v[212:215], a[212:215], a[184:187], v[212:215]
    s_add_u32 m0, s101, 49152
    ds_read_b64_tr_b16 a[72:73], v24 offset:0
    v_mfma_f32_16x16x32_bf16 v[216:219], a[168:171], a[136:139], v[216:219]
    buffer_load_dwordx4 v12, s[44:47], s99 offen offset:0 nt lds
    v_mfma_f32_16x16x32_bf16 v[216:219], a[216:219], a[184:187], v[216:219]
    ds_read_b64_tr_b16 a[74:75], v24 offset:1024
    ds_read_b64_tr_b16 a[120:121], v24 offset:8192
    v_mfma_f32_16x16x32_bf16 v[220:223], a[172:175], a[136:139], v[220:223]
    v_mfma_f32_16x16x32_bf16 v[220:223], a[220:223], a[184:187], v[220:223]
    ds_read_b64_tr_b16 a[122:123], v24 offset:9216
    v_mfma_f32_16x16x32_bf16 v[252:255], a[172:175], a[140:143], v[252:255]
    ds_read_b64_tr_b16 a[76:77], v25 offset:0
    ds_read_b64_tr_b16 a[78:79], v25 offset:1024
    v_mfma_f32_16x16x32_bf16 v[252:255], a[220:223], a[188:191], v[252:255]
    buffer_load_dwordx4 v13, s[44:47], s99 offen offset:1024 nt lds
    v_mfma_f32_16x16x32_bf16 v[248:251], a[168:171], a[140:143], v[248:251]
    v_mfma_f32_16x16x32_bf16 v[248:251], a[216:219], a[188:191], v[248:251]
    ds_read_b64_tr_b16 a[124:125], v25 offset:8192
    v_mfma_f32_16x16x32_bf16 v[244:247], a[164:167], a[140:143], v[244:247]
    ds_read_b64_tr_b16 a[126:127], v25 offset:9216
    v_mfma_f32_16x16x32_bf16 v[244:247], a[212:215], a[188:191], v[244:247]
    buffer_store_dwordx4 v[124:127], v27, s[36:39], s53 offen offset:1024 sc1
    v_mfma_f32_16x16x32_bf16 v[240:243], a[160:163], a[140:143], v[240:243]
    v_add_u32 v16, 0xfffe8000, v16
    v_add_u32 v17, 0xfffe8000, v17
    v_mfma_f32_16x16x32_bf16 v[240:243], a[208:211], a[188:191], v[240:243]
    buffer_load_dwordx4 v14, s[44:47], s99 offen offset:2048 nt lds
    v_mfma_f32_16x16x32_bf16 v[236:239], a[156:159], a[140:143], v[236:239]
    v_add_u32 v18, 0xfffe8000, v18
    v_mfma_f32_16x16x32_bf16 v[236:239], a[204:207], a[188:191], v[236:239]
    v_add_u32 v19, 0xfffe8000, v19
    v_mfma_f32_16x16x32_bf16 v[232:235], a[152:155], a[140:143], v[232:235]
    v_add_u32 v20, 0xfffe8000, v20
    v_mfma_f32_16x16x32_bf16 v[232:235], a[200:203], a[188:191], v[232:235]
    v_add_u32 v21, 0xfffe8000, v21
    v_add_u32 v22, 0xfffe8000, v22
    v_mfma_f32_16x16x32_bf16 v[228:231], a[148:151], a[140:143], v[228:231]
    buffer_load_dwordx4 v15, s[44:47], s99 offen offset:3072 nt lds
    v_mfma_f32_16x16x32_bf16 v[228:231], a[196:199], a[188:191], v[228:231]
    s_add_u32 s99, s99, 524288
    v_add_u32 v23, 0xfffe8000, v23
    v_mfma_f32_16x16x32_bf16 v[224:227], a[144:147], a[140:143], v[224:227]
    v_add_u32 v24, 0xfffe8000, v24
    v_mfma_f32_16x16x32_bf16 v[224:227], a[192:195], a[188:191], v[224:227]
    v_add_u32 v25, 0xfffe8000, v25
    s_waitcnt vmcnt(16) lgkmcnt(0)
    s_barrier
    v_mfma_f32_16x16x32_bf16 v[128:131], a[48:51], a[32:35], v[128:131]
    s_add_u32 m0, s100, 98304
    ds_read_b128 a[128:131], v16 offset:0
    v_mfma_f32_16x16x32_bf16 v[128:131], a[96:99], a[80:83], v[128:131]
    buffer_load_dwordx4 v8, s[40:43], s97 offen offset:0 lds
    v_mfma_f32_16x16x32_bf16 v[132:135], a[52:55], a[32:35], v[132:135]
    ds_read_b64_tr_b16 a[144:145], v18 offset:0
    v_mfma_f32_16x16x32_bf16 v[132:135], a[100:103], a[80:83], v[132:135]
    ds_read_b64_tr_b16 a[146:147], v18 offset:1024
    ds_read_b128 a[176:179], v17 offset:0
    v_mfma_f32_16x16x32_bf16 v[136:139], a[56:59], a[32:35], v[136:139]
    buffer_load_dwordx4 v9, s[40:43], s97 offen offset:1024 lds
    v_mfma_f32_16x16x32_bf16 v[136:139], a[104:107], a[80:83], v[136:139]
    ds_read_b64_tr_b16 a[192:193], v18 offset:8192
    v_mfma_f32_16x16x32_bf16 v[140:143], a[60:63], a[32:35], v[140:143]
    v_mfma_f32_16x16x32_bf16 v[140:143], a[108:111], a[80:83], v[140:143]
    ds_read_b64_tr_b16 a[194:195], v18 offset:9216
    ds_read_b128 a[132:135], v16 offset:2048
    v_mfma_f32_16x16x32_bf16 v[144:147], a[64:67], a[32:35], v[144:147]
    buffer_load_dwordx4 v10, s[40:43], s97 offen offset:2048 lds
    v_mfma_f32_16x16x32_bf16 v[144:147], a[112:115], a[80:83], v[144:147]
    ds_read_b64_tr_b16 a[148:149], v19 offset:0
    v_mfma_f32_16x16x32_bf16 v[148:151], a[68:71], a[32:35], v[148:151]
    ds_read_b64_tr_b16 a[150:151], v19 offset:1024
    v_mfma_f32_16x16x32_bf16 v[148:151], a[116:119], a[80:83], v[148:151]
    buffer_load_dwordx4 v11, s[40:43], s97 offen offset:3072 lds
    v_mfma_f32_16x16x32_bf16 v[152:155], a[72:75], a[32:35], v[152:155]
    s_add_u32 s97, s97, 128
    ds_read_b128 a[180:183], v17 offset:2048
    v_mfma_f32_16x16x32_bf16 v[152:155], a[120:123], a[80:83], v[152:155]
    s_add_u32 m0, s100, 102400
    ds_read_b64_tr_b16 a[196:197], v19 offset:8192
    v_mfma_f32_16x16x32_bf16 v[156:159], a[76:79], a[32:35], v[156:159]
    buffer_load_dwordx4 v8, s[40:43], s98 offen offset:0 lds
    v_mfma_f32_16x16x32_bf16 v[156:159], a[124:127], a[80:83], v[156:159]
    ds_read_b64_tr_b16 a[198:199], v19 offset:9216
    v_mfma_f32_16x16x32_bf16 v[188:191], a[76:79], a[36:39], v[188:191]
    ds_read_b128 a[136:139], v16 offset:4096
    v_mfma_f32_16x16x32_bf16 v[188:191], a[124:127], a[84:87], v[188:191]
    ds_read_b64_tr_b16 a[152:153], v20 offset:0
    v_mfma_f32_16x16x32_bf16 v[184:187], a[72:75], a[36:39], v[184:187]
    buffer_load_dwordx4 v9, s[40:43], s98 offen offset:1024 lds
    v_mfma_f32_16x16x32_bf16 v[184:187], a[120:123], a[84:87], v[184:187]
    ds_read_b64_tr_b16 a[154:155], v20 offset:1024
    v_mfma_f32_16x16x32_bf16 v[180:183], a[68:71], a[36:39], v[180:183]
    ds_read_b128 a[184:187], v17 offset:4096
    ds_read_b64_tr_b16 a[200:201], v20 offset:8192
    v_mfma_f32_16x16x32_bf16 v[180:183], a[116:119], a[84:87], v[180:183]
    buffer_load_dwordx4 v10, s[40:43], s98 offen offset:2048 lds
    v_mfma_f32_16x16x32_bf16 v[176:179], a[64:67], a[36:39], v[176:179]
    v_mfma_f32_16x16x32_bf16 v[176:179], a[112:115], a[84:87], v[176:179]
    ds_read_b64_tr_b16 a[202:203], v20 offset:9216
    ds_read_b128 a[140:143], v16 offset:6144
    v_mfma_f32_16x16x32_bf16 v[172:175], a[60:63], a[36:39], v[172:175]
    buffer_load_dwordx4 v11, s[40:43], s98 offen offset:3072 lds
    v_mfma_f32_16x16x32_bf16 v[172:175], a[108:111], a[84:87], v[172:175]
    s_add_u32 s98, s98, 128
    ds_read_b64_tr_b16 a[156:157], v21 offset:0
    v_mfma_f32_16x16x32_bf16 v[168:171], a[56:59], a[36:39], v[168:171]
    v_mfma_f32_16x16x32_bf16 v[168:171], a[104:107], a[84:87], v[168:171]
    s_add_u32 m0, s101, 98304
    ds_read_b64_tr_b16 a[158:159], v21 offset:1024
    v_mfma_f32_16x16x32_bf16 v[164:167], a[52:55], a[36:39], v[164:167]
    buffer_load_dwordx4 v12, s[44:47], s99 offen offset:0 nt lds
    v_mfma_f32_16x16x32_bf16 v[164:167], a[100:103], a[84:87], v[164:167]
    ds_read_b128 a[188:191], v17 offset:6144
    ds_read_b64_tr_b16 a[204:205], v21 offset:8192
    v_mfma_f32_16x16x32_bf16 v[160:163], a[48:51], a[36:39], v[160:163]
    ds_read_b64_tr_b16 a[206:207], v21 offset:9216
    v_mfma_f32_16x16x32_bf16 v[160:163], a[96:99], a[84:87], v[160:163]
    buffer_load_dwordx4 v13, s[44:47], s99 offen offset:1024 nt lds
    v_mfma_f32_16x16x32_bf16 v[192:195], a[48:51], a[40:43], v[192:195]
    ds_read_b64_tr_b16 a[160:161], v22 offset:0
    v_mfma_f32_16x16x32_bf16 v[192:195], a[96:99], a[88:91], v[192:195]
    ds_read_b64_tr_b16 a[162:163], v22 offset:1024
    v_mfma_f32_16x16x32_bf16 v[196:199], a[52:55], a[40:43], v[196:199]
    buffer_load_dwordx4 v14, s[44:47], s99 offen offset:2048 nt lds
    v_mfma_f32_16x16x32_bf16 v[196:199], a[100:103], a[88:91], v[196:199]
    ds_read_b64_tr_b16 a[208:209], v22 offset:8192
    v_mfma_f32_16x16x32_bf16 v[200:203], a[56:59], a[40:43], v[200:203]
    ds_read_b64_tr_b16 a[210:211], v22 offset:9216
    v_mfma_f32_16x16x32_bf16 v[200:203], a[104:107], a[88:91], v[200:203]
    ds_read_b64_tr_b16 a[164:165], v23 offset:0
    v_mfma_f32_16x16x32_bf16 v[204:207], a[60:63], a[40:43], v[204:207]
    buffer_load_dwordx4 v15, s[44:47], s99 offen offset:3072 nt lds
    v_mfma_f32_16x16x32_bf16 v[204:207], a[108:111], a[88:91], v[204:207]
    s_add_u32 s99, s99, 524288
    ds_read_b64_tr_b16 a[166:167], v23 offset:1024
    v_mfma_f32_16x16x32_bf16 v[208:211], a[64:67], a[40:43], v[208:211]
    ds_read_b64_tr_b16 a[212:213], v23 offset:8192
    ds_read_b64_tr_b16 a[214:215], v23 offset:9216
    v_mfma_f32_16x16x32_bf16 v[208:211], a[112:115], a[88:91], v[208:211]
    s_getpc_b64 s[64:65]
L_pc1:
    v_mfma_f32_16x16x32_bf16 v[212:215], a[68:71], a[40:43], v[212:215]
    v_mfma_f32_16x16x32_bf16 v[212:215], a[116:119], a[88:91], v[212:215]
    ds_read_b64_tr_b16 a[168:169], v24 offset:0
    ds_read_b64_tr_b16 a[170:171], v24 offset:1024
    v_mfma_f32_16x16x32_bf16 v[216:219], a[72:75], a[40:43], v[216:219]
    s_add_u32 s64, s64, L_fill-L_pc1
    s_addc_u32 s65, s65, 0
    v_mfma_f32_16x16x32_bf16 v[216:219], a[120:123], a[88:91], v[216:219]
    ds_read_b64_tr_b16 a[216:217], v24 offset:8192
    v_mfma_f32_16x16x32_bf16 v[220:223], a[76:79], a[40:43], v[220:223]
    v_mfma_f32_16x16x32_bf16 v[220:223], a[124:127], a[88:91], v[220:223]
    ds_read_b64_tr_b16 a[218:219], v24 offset:9216
    ds_read_b64_tr_b16 a[172:173], v25 offset:0
    v_mfma_f32_16x16x32_bf16 v[252:255], a[76:79], a[44:47], v[252:255]
    s_lshr_b32 s66, s2, 3
    s_lshl_b32 s66, s66, 2
    v_mfma_f32_16x16x32_bf16 v[252:255], a[124:127], a[92:95], v[252:255]
    ds_read_b64_tr_b16 a[174:175], v25 offset:1024
    v_mfma_f32_16x16x32_bf16 v[248:251], a[72:75], a[44:47], v[248:251]
    ds_read_b64_tr_b16 a[220:221], v25 offset:8192
    v_mfma_f32_16x16x32_bf16 v[248:251], a[120:123], a[92:95], v[248:251]
    s_add_u32 s66, s66, s48
    s_lshl_b32 s66, s66, 10
    v_mfma_f32_16x16x32_bf16 v[244:247], a[68:71], a[44:47], v[244:247]
    ds_read_b64_tr_b16 a[222:223], v25 offset:9216
    v_mfma_f32_16x16x32_bf16 v[244:247], a[116:119], a[92:95], v[244:247]
    v_mfma_f32_16x16x32_bf16 v[240:243], a[64:67], a[44:47], v[240:243]
    v_and_b32 v28, 7, v1
    v_lshlrev_b32 v28, 7, v28
    v_mfma_f32_16x16x32_bf16 v[240:243], a[112:115], a[92:95], v[240:243]
    v_add_u32 v16, 0xc000, v16
    v_add_u32 v17, 0xc000, v17
    v_mfma_f32_16x16x32_bf16 v[236:239], a[60:63], a[44:47], v[236:239]
    v_add_u32 v18, 0xc000, v18
    v_mfma_f32_16x16x32_bf16 v[236:239], a[108:111], a[92:95], v[236:239]
    v_add_u32 v19, 0xc000, v19
    v_add_u32 v20, 0xc000, v20
    v_mfma_f32_16x16x32_bf16 v[232:235], a[56:59], a[44:47], v[232:235]
    v_add_u32 v28, s66, v28
    v_min_u32 v28, L_tail-L_fill-4, v28
    v_mfma_f32_16x16x32_bf16 v[232:235], a[104:107], a[92:95], v[232:235]
    v_add_u32 v21, 0xc000, v21
    v_mfma_f32_16x16x32_bf16 v[228:231], a[52:55], a[44:47], v[228:231]
    v_add_u32 v22, 0xc000, v22
    v_add_u32 v23, 0xc000, v23
    v_mfma_f32_16x16x32_bf16 v[228:231], a[100:103], a[92:95], v[228:231]
    global_load_dword v0, v28, s[64:65]
    v_mfma_f32_16x16x32_bf16 v[224:227], a[48:51], a[44:47], v[224:227]
    v_add_u32 v24, 0xc000, v24
    v_mfma_f32_16x16x32_bf16 v[224:227], a[96:99], a[92:95], v[224:227]
    v_add_u32 v25, 0xc000, v25
    s_waitcnt vmcnt(13) lgkmcnt(0)
    s_barrier
    s_cmp_eq_u32 s48, 0
    s_cbranch_scc0 L_w0_s2
    s_mov_b64 exec, 1
    v_mov_b32 v27, s95
    s_lshl_b32 s51, s2, 7
    v_mov_b32 v26, s51
    buffer_store_dword v27, v26, s[76:79], 0 offen offset:0 sc1
    s_mov_b64 exec, -1
L_w0_s2:
    v_mfma_f32_16x16x32_bf16 v[128:131], a[144:147], a[128:131], v[128:131]
    ds_read_b128 a[32:35], v16 offset:0
    v_mfma_f32_16x16x32_bf16 v[128:131], a[192:195], a[176:179], v[128:131]
    s_add_u32 m0, s100, 0
    ds_read_b64_tr_b16 a[48:49], v18 offset:0
    v_mfma_f32_16x16x32_bf16 v[132:135], a[148:151], a[128:131], v[132:135]
    buffer_load_dwordx4 v8, s[40:43], s97 offen offset:0 lds
    v_mfma_f32_16x16x32_bf16 v[132:135], a[196:199], a[176:179], v[132:135]
    ds_read_b64_tr_b16 a[50:51], v18 offset:1024
    v_mfma_f32_16x16x32_bf16 v[136:139], a[152:155], a[128:131], v[136:139]
    ds_read_b128 a[80:83], v17 offset:0
    v_mfma_f32_16x16x32_bf16 v[136:139], a[200:203], a[176:179], v[136:139]
    ds_read_b64_tr_b16 a[96:97], v18 offset:8192
    v_mfma_f32_16x16x32_bf16 v[140:143], a[156:159], a[128:131], v[140:143]
    ds_read_b64_tr_b16 a[98:99], v18 offset:9216
    v_mfma_f32_16x16x32_bf16 v[140:143], a[204:207], a[176:179], v[140:143]
    buffer_load_dwordx4 v9, s[40:43], s97 offen offset:1024 lds
    v_mfma_f32_16x16x32_bf16 v[144:147], a[160:163], a[128:131], v[144:147]
    ds_read_b128 a[36:39], v16 offset:2048
    v_mfma_f32_16x16x32_bf16 v[144:147], a[208:211], a[176:179], v[144:147]
    ds_read_b64_tr_b16 a[52:53], v19 offset:0
    v_mfma_f32_16x16x32_bf16 v[148:151], a[164:167], a[128:131], v[148:151]
    v_mfma_f32_16x16x32_bf16 v[148:151], a[212:215], a[176:179], v[148:151]
    ds_read_b64_tr_b16 a[54:55], v19 offset:1024
    v_mfma_f32_16x16x32_bf16 v[152:155], a[168:171], a[128:131], v[152:155]
    ds_read_b128 a[84:87], v17 offset:2048
    ds_read_b64_tr_b16 a[100:101], v19 offset:8192
    v_mfma_f32_16x16x32_bf16 v[152:155], a[216:219], a[176:179], v[152:155]
    buffer_load_dwordx4 v10, s[40:43], s97 offen offset:2048 lds
    v_mfma_f32_16x16x32_bf16 v[156:159], a[172:175], a[128:131], v[156:159]
    v_mfma_f32_16x16x32_bf16 v[156:159], a[220:223], a[176:179], v[156:159]
    ds_read_b64_tr_b16 a[102:103], v19 offset:9216
    v_mfma_f32_16x16x32_bf16 v[188:191], a[172:175], a[132:135], v[188:191]
    ds_read_b128 a[40:43], v16 offset:4096
    v_mfma_f32_16x16x32_bf16 v[188:191], a[220:223], a[180:183], v[188:191]
    ds_read_b64_tr_b16 a[56:57], v20 offset:0
    v_mfma_f32_16x16x32_bf16 v[184:187], a[168:171], a[132:135], v[184:187]
    buffer_load_dwordx4 v11, s[40:43], s97 offen offset:3072 lds
    v_mfma_f32_16x16x32_bf16 v[184:187], a[216:219], a[180:183], v[184:187]
    s_add_u32 s97, s97, 128
    ds_read_b64_tr_b16 a[58:59], v20 offset:1024
    v_mfma_f32_16x16x32_bf16 v[180:183], a[164:167], a[132:135], v[180:183]
    ds_read_b128 a[88:91], v17 offset:4096
    v_mfma_f32_16x16x32_bf16 v[180:183], a[212:215], a[180:183], v[180:183]
    ds_read_b64_tr_b16 a[104:105], v20 offset:8192
    v_mfma_f32_16x16x32_bf16 v[176:179], a[160:163], a[132:135], v[176:179]
    s_add_u32 m0, s100, 4096
    ds_read_b64_tr_b16 a[106:107], v20 offset:9216
    v_mfma_f32_16x16x32_bf16 v[176:179], a[208:211], a[180:183], v[176:179]
    buffer_load_dwordx4 v8, s[40:43], s98 offen offset:0 lds
    v_mfma_f32_16x16x32_bf16 v[172:175], a[156:159], a[132:135], v[172:175]
    ds_read_b128 a[44:47], v16 offset:6144
    v_mfma_f32_16x16x32_bf16 v[172:175], a[204:207], a[180:183], v[172:175]
    ds_read_b64_tr_b16 a[60:61], v21 offset:0
    v_mfma_f32_16x16x32_bf16 v[168:171], a[152:155], a[132:135], v[168:171]
    v_mfma_f32_16x16x32_bf16 v[168:171], a[200:203], a[180:183], v[168:171]
    ds_read_b64_tr_b16 a[62:63], v21 offset:1024
    ds_read_b128 a[92:95], v17 offset:6144
    v_mfma_f32_16x16x32_bf16 v[164:167], a[148:151], a[132:135], v[164:167]
    buffer_load_dwordx4 v9, s[40:43], s98 offen offset:1024 lds
    v_mfma_f32_16x16x32_bf16 v[164:167], a[196:199], a[180:183], v[164:167]
    ds_read_b64_tr_b16 a[108:109], v21 offset:8192
    v_mfma_f32_16x16x32_bf16 v[160:163], a[144:147], a[132:135], v[160:163]
    v_mfma_f32_16x16x32_bf16 v[160:163], a[192:195], a[180:183], v[160:163]
    ds_read_b64_tr_b16 a[110:111], v21 offset:9216
    v_mfma_f32_16x16x32_bf16 v[192:195], a[144:147], a[136:139], v[192:195]
    ds_read_b64_tr_b16 a[64:65], v22 offset:0
    v_mfma_f32_16x16x32_bf16 v[192:195], a[192:195], a[184:187], v[192:195]
    ds_read_b64_tr_b16 a[66:67], v22 offset:1024
    v_mfma_f32_16x16x32_bf16 v[196:199], a[148:151], a[136:139], v[196:199]
    buffer_load_dwordx4 v10, s[40:43], s98 offen offset:2048 lds
    v_mfma_f32_16x16x32_bf16 v[196:199], a[196:199], a[184:187], v[196:199]
    ds_read_b64_tr_b16 a[112:113], v22 offset:8192
    v_mfma_f32_16x16x32_bf16 v[200:203], a[152:155], a[136:139], v[200:203]
    ds_read_b64_tr_b16 a[114:115], v22 offset:9216
    v_mfma_f32_16x16x32_bf16 v[200:203], a[200:203], a[184:187], v[200:203]
    ds_read_b64_tr_b16 a[68:69], v23 offset:0
    v_mfma_f32_16x16x32_bf16 v[204:207], a[156:159], a[136:139], v[204:207]
    ds_read_b64_tr_b16 a[70:71], v23 offset:1024
    v_mfma_f32_16x16x32_bf16 v[204:207], a[204:207], a[184:187], v[204:207]
    buffer_load_dwordx4 v11, s[40:43], s98 offen offset:3072 lds
    v_mfma_f32_16x16x32_bf16 v[208:211], a[160:163], a[136:139], v[208:211]
    s_add_u32 s98, s98, 128
    ds_read_b64_tr_b16 a[116:117], v23 offset:8192
    v_mfma_f32_16x16x32_bf16 v[208:211], a[208:211], a[184:187], v[208:211]
    ds_read_b64_tr_b16 a[118:119], v23 offset:9216
    v_mfma_f32_16x16x32_bf16 v[212:215], a[164:167], a[136:139], v[212:215]
    v_mfma_f32_16x16x32_bf16 v[212:215], a[212:215], a[184:187], v[212:215]
    s_add_u32 m0, s101, 0
    ds_read_b64_tr_b16 a[72:73], v24 offset:0
    v_mfma_f32_16x16x32_bf16 v[216:219], a[168:171], a[136:139], v[216:219]
    buffer_load_dwordx4 v12, s[44:47], s99 offen offset:0 nt lds
    v_mfma_f32_16x16x32_bf16 v[216:219], a[216:219], a[184:187], v[216:219]
    ds_read_b64_tr_b16 a[74:75], v24 offset:1024
    ds_read_b64_tr_b16 a[120:121], v24 offset:8192
    v_mfma_f32_16x16x32_bf16 v[220:223], a[172:175], a[136:139], v[220:223]
    v_mfma_f32_16x16x32_bf16 v[220:223], a[220:223], a[184:187], v[220:223]
    ds_read_b64_tr_b16 a[122:123], v24 offset:9216
    v_mfma_f32_16x16x32_bf16 v[252:255], a[172:175], a[140:143], v[252:255]
    ds_read_b64_tr_b16 a[76:77], v25 offset:0
    ds_read_b64_tr_b16 a[78:79], v25 offset:1024
    v_mfma_f32_16x16x32_bf16 v[252:255], a[220:223], a[188:191], v[252:255]
    buffer_load_dwordx4 v13, s[44:47], s99 offen offset:1024 nt lds
    v_mfma_f32_16x16x32_bf16 v[248:251], a[168:171], a[140:143], v[248:251]
    v_mfma_f32_16x16x32_bf16 v[248:251], a[216:219], a[188:191], v[248:251]
    ds_read_b64_tr_b16 a[124:125], v25 offset:8192
    v_mfma_f32_16x16x32_bf16 v[244:247], a[164:167], a[140:143], v[244:247]
    ds_read_b64_tr_b16 a[126:127], v25 offset:9216
    v_mfma_f32_16x16x32_bf16 v[244:247], a[212:215], a[188:191], v[244:247]
    v_mfma_f32_16x16x32_bf16 v[240:243], a[160:163], a[140:143], v[240:243]
    v_add_u32 v16, 0xc000, v16
    v_add_u32 v17, 0xc000, v17
    v_mfma_f32_16x16x32_bf16 v[240:243], a[208:211], a[188:191], v[240:243]
    buffer_load_dwordx4 v14, s[44:47], s99 offen offset:2048 nt lds
    v_mfma_f32_16x16x32_bf16 v[236:239], a[156:159], a[140:143], v[236:239]
    v_add_u32 v18, 0xc000, v18
    v_mfma_f32_16x16x32_bf16 v[236:239], a[204:207], a[188:191], v[236:239]
    v_add_u32 v19, 0xc000, v19
    v_mfma_f32_16x16x32_bf16 v[232:235], a[152:155], a[140:143], v[232:235]
    v_add_u32 v20, 0xc000, v20
    v_mfma_f32_16x16x32_bf16 v[232:235], a[200:203], a[188:191], v[232:235]
    v_add_u32 v21, 0xc000, v21
    v_add_u32 v22, 0xc000, v22
    v_mfma_f32_16x16x32_bf16 v[228:231], a[148:151], a[140:143], v[228:231]
    buffer_load_dwordx4 v15, s[44:47], s99 offen offset:3072 nt lds
    v_mfma_f32_16x16x32_bf16 v[228:231], a[196:199], a[188:191], v[228:231]
    s_add_u32 s99, s99, 524288
    v_add_u32 v23, 0xc000, v23
    v_mfma_f32_16x16x32_bf16 v[224:227], a[144:147], a[140:143], v[224:227]
    v_add_u32 v24, 0xc000, v24
    v_mfma_f32_16x16x32_bf16 v[224:227], a[192:195], a[188:191], v[224:227]
    v_add_u32 v25, 0xc000, v25
    s_waitcnt vmcnt(13) lgkmcnt(0)
    s_barrier
    v_mfma_f32_16x16x32_bf16 v[128:131], a[48:51], a[32:35], v[128:131]
    ds_read_b128 a[128:131], v16 offset:0
    s_lshl_b32 s51, s49, 19
    v_mfma_f32_16x16x32_bf16 v[128:131], a[96:99], a[80:83], v[128:131]
    s_add_u32 m0, s100, 49152
    ds_read_b64_tr_b16 a[144:145], v18 offset:0
    v_mfma_f32_16x16x32_bf16 v[132:135], a[52:55], a[32:35], v[132:135]
    buffer_load_dwordx4 v8, s[40:43], s97 offen offset:0 lds
    v_mfma_f32_16x16x32_bf16 v[132:135], a[100:103], a[80:83], v[132:135]
    ds_read_b64_tr_b16 a[146:147], v18 offset:1024
    v_mfma_f32_16x16x32_bf16 v[136:139], a[56:59], a[32:35], v[136:139]
    ds_read_b128 a[176:179], v17 offset:0
    s_lshl_b32 s52, s50, 15
    v_mfma_f32_16x16x32_bf16 v[136:139], a[104:107], a[80:83], v[136:139]
    ds_read_b64_tr_b16 a[192:193], v18 offset:8192
    v_mfma_f32_16x16x32_bf16 v[140:143], a[60:63], a[32:35], v[140:143]
    ds_read_b64_tr_b16 a[194:195], v18 offset:9216
    v_mfma_f32_16x16x32_bf16 v[140:143], a[108:111], a[80:83], v[140:143]
    buffer_load_dwordx4 v9, s[40:43], s97 offen offset:1024 lds
    v_mfma_f32_16x16x32_bf16 v[144:147], a[64:67], a[32:35], v[144:147]
    ds_read_b128 a[132:135], v16 offset:2048
    s_sub_u32 s52, 524288, s52
    v_mfma_f32_16x16x32_bf16 v[144:147], a[112:115], a[80:83], v[144:147]
    ds_read_b64_tr_b16 a[148:149], v19 offset:0
    v_mfma_f32_16x16x32_bf16 v[148:151], a[68:71], a[32:35], v[148:151]
    s_add_u32 s28, s26, s51
    s_addc_u32 s29, s27, 0
    v_mfma_f32_16x16x32_bf16 v[148:151], a[116:119], a[80:83], v[148:151]
    ds_read_b64_tr_b16 a[150:151], v19 offset:1024
    v_mfma_f32_16x16x32_bf16 v[152:155], a[72:75], a[32:35], v[152:155]
    ds_read_b128 a[180:183], v17 offset:2048
    ds_read_b64_tr_b16 a[196:197], v19 offset:8192
    v_mfma_f32_16x16x32_bf16 v[152:155], a[120:123], a[80:83], v[152:155]
    buffer_load_dwordx4 v10, s[40:43], s97 offen offset:2048 lds
    v_mfma_f32_16x16x32_bf16 v[156:159], a[76:79], a[32:35], v[156:159]
    s_mov_b32 s30, s52
    v_mfma_f32_16x16x32_bf16 v[156:159], a[124:127], a[80:83], v[156:159]
    ds_read_b64_tr_b16 a[198:199], v19 offset:9216
    v_mfma_f32_16x16x32_bf16 v[188:191], a[76:79], a[36:39], v[188:191]
    ds_read_b128 a[136:139], v16 offset:4096
    v_mfma_f32_16x16x32_bf16 v[188:191], a[124:127], a[84:87], v[188:191]
    ds_read_b64_tr_b16 a[152:153], v20 offset:0
    s_mov_b32 s31, 0x20000
    v_mfma_f32_16x16x32_bf16 v[184:187], a[72:75], a[36:39], v[184:187]
    buffer_load_dwordx4 v11, s[40:43], s97 offen offset:3072 lds
    v_mfma_f32_16x16x32_bf16 v[184:187], a[120:123], a[84:87], v[184:187]
    s_add_u32 s97, s97, 128
    ds_read_b64_tr_b16 a[154:155], v20 offset:1024
    v_mfma_f32_16x16x32_bf16 v[180:183], a[68:71], a[36:39], v[180:183]
    ds_read_b128 a[184:187], v17 offset:4096
    s_add_u32 s51, s51, 16777216
    v_mfma_f32_16x16x32_bf16 v[180:183], a[116:119], a[84:87], v[180:183]
    ds_read_b64_tr_b16 a[200:201], v20 offset:8192
    v_mfma_f32_16x16x32_bf16 v[176:179], a[64:67], a[36:39], v[176:179]
    s_add_u32 m0, s100, 53248
    ds_read_b64_tr_b16 a[202:203], v20 offset:9216
    v_mfma_f32_16x16x32_bf16 v[176:179], a[112:115], a[84:87], v[176:179]
    buffer_load_dwordx4 v8, s[40:43], s98 offen offset:0 lds
    v_mfma_f32_16x16x32_bf16 v[172:175], a[60:63], a[36:39], v[172:175]
    ds_read_b128 a[140:143], v16 offset:6144
    v_mfma_f32_16x16x32_bf16 v[172:175], a[108:111], a[84:87], v[172:175]
    ds_read_b64_tr_b16 a[156:157], v21 offset:0
    v_mfma_f32_16x16x32_bf16 v[168:171], a[56:59], a[36:39], v[168:171]
    s_add_u32 s32, s26, s51
    s_addc_u32 s33, s27, 0
    v_mfma_f32_16x16x32_bf16 v[168:171], a[104:107], a[84:87], v[168:171]
    ds_read_b64_tr_b16 a[158:159], v21 offset:1024
    ds_read_b128 a[188:191], v17 offset:6144
    v_mfma_f32_16x16x32_bf16 v[164:167], a[52:55], a[36:39], v[164:167]
    buffer_load_dwordx4 v9, s[40:43], s98 offen offset:1024 lds
    v_mfma_f32_16x16x32_bf16 v[164:167], a[100:103], a[84:87], v[164:167]
    ds_read_b64_tr_b16 a[204:205], v21 offset:8192
    s_mov_b32 s34, s52
    v_mfma_f32_16x16x32_bf16 v[160:163], a[48:51], a[36:39], v[160:163]
    s_mov_b32 s35, 0x20000
    v_mfma_f32_16x16x32_bf16 v[160:163], a[96:99], a[84:87], v[160:163]
    ds_read_b64_tr_b16 a[206:207], v21 offset:9216
    v_mfma_f32_16x16x32_bf16 v[192:195], a[48:51], a[40:43], v[192:195]
    ds_read_b64_tr_b16 a[160:161], v22 offset:0
    v_mfma_f32_16x16x32_bf16 v[192:195], a[96:99], a[88:91], v[192:195]
    ds_read_b64_tr_b16 a[162:163], v22 offset:1024
    v_lshlrev_b32 v26, 2, v3
    v_mfma_f32_16x16x32_bf16 v[196:199], a[52:55], a[40:43], v[196:199]
    buffer_load_dwordx4 v10, s[40:43], s98 offen offset:2048 lds
    v_mfma_f32_16x16x32_bf16 v[196:199], a[100:103], a[88:91], v[196:199]
    ds_read_b64_tr_b16 a[208:209], v22 offset:8192
    v_mfma_f32_16x16x32_bf16 v[200:203], a[56:59], a[40:43], v[200:203]
    ds_read_b64_tr_b16 a[210:211], v22 offset:9216
    v_sub_u32 v26, v4, v26
    v_mfma_f32_16x16x32_bf16 v[200:203], a[104:107], a[88:91], v[200:203]
    ds_read_b64_tr_b16 a[164:165], v23 offset:0
    v_mfma_f32_16x16x32_bf16 v[204:207], a[60:63], a[40:43], v[204:207]
    ds_read_b64_tr_b16 a[166:167], v23 offset:1024
    v_mfma_f32_16x16x32_bf16 v[204:207], a[108:111], a[88:91], v[204:207]
    buffer_load_dwordx4 v11, s[40:43], s98 offen offset:3072 lds
    v_mfma_f32_16x16x32_bf16 v[208:211], a[64:67], a[40:43], v[208:211]
    s_add_u32 s98, s98, 128
    ds_read_b64_tr_b16 a[212:213], v23 offset:8192
    v_mfma_f32_16x16x32_bf16 v[208:211], a[112:115], a[88:91], v[208:211]
    ds_read_b64_tr_b16 a[214:215], v23 offset:9216
    v_cmp_le_i32 s[56:57], 0, v26
    v_mfma_f32_16x16x32_bf16 v[212:215], a[68:71], a[40:43], v[212:215]
    v_cmp_le_i32 s[58:59], 1, v26
    v_mfma_f32_16x16x32_bf16 v[212:215], a[116:119], a[88:91], v[212:215]
    s_add_u32 m0, s101, 49152
    ds_read_b64_tr_b16 a[168:169], v24 offset:0
    v_mfma_f32_16x16x32_bf16 v[216:219], a[72:75], a[40:43], v[216:219]
    buffer_load_dwordx4 v12, s[44:47], s99 offen offset:0 nt lds
    v_mfma_f32_16x16x32_bf16 v[216:219], a[120:123], a[88:91], v[216:219]
    ds_read_b64_tr_b16 a[170:171], v24 offset:1024
    ds_read_b64_tr_b16 a[216:217], v24 offset:8192
    v_mfma_f32_16x16x32_bf16 v[220:223], a[76:79], a[40:43], v[220:223]
    v_cmp_le_i32 s[60:61], 2, v26
    v_mfma_f32_16x16x32_bf16 v[220:223], a[124:127], a[88:91], v[220:223]
    ds_read_b64_tr_b16 a[218:219], v24 offset:9216
    v_mfma_f32_16x16x32_bf16 v[252:255], a[76:79], a[44:47], v[252:255]
    ds_read_b64_tr_b16 a[172:173], v25 offset:0
    ds_read_b64_tr_b16 a[174:175], v25 offset:1024
    v_mfma_f32_16x16x32_bf16 v[252:255], a[124:127], a[92:95], v[252:255]
    buffer_load_dwordx4 v13, s[44:47], s99 offen offset:1024 nt lds
    v_mfma_f32_16x16x32_bf16 v[248:251], a[72:75], a[44:47], v[248:251]
    v_cmp_le_i32 s[62:63], 3, v26
    v_mfma_f32_16x16x32_bf16 v[248:251], a[120:123], a[92:95], v[248:251]
    ds_read_b64_tr_b16 a[220:221], v25 offset:8192
    v_mfma_f32_16x16x32_bf16 v[244:247], a[68:71], a[44:47], v[244:247]
    ds_read_b64_tr_b16 a[222:223], v25 offset:9216
    v_and_b32 v30, 7, v1
    v_mfma_f32_16x16x32_bf16 v[244:247], a[116:119], a[92:95], v[244:247]
    v_mfma_f32_16x16x32_bf16 v[240:243], a[64:67], a[44:47], v[240:243]
    v_add_u32 v16, 0xfffe8000, v16
    v_add_u32 v17, 0xfffe8000, v17
    v_mfma_f32_16x16x32_bf16 v[240:243], a[112:115], a[92:95], v[240:243]
    buffer_load_dwordx4 v14, s[44:47], s99 offen offset:2048 nt lds
    v_mfma_f32_16x16x32_bf16 v[236:239], a[60:63], a[44:47], v[236:239]
    v_add_u32 v18, 0xfffe8000, v18
    s_and_b32 s52, s2, 31
    v_mfma_f32_16x16x32_bf16 v[236:239], a[108:111], a[92:95], v[236:239]
    v_add_u32 v19, 0xfffe8000, v19
    v_mfma_f32_16x16x32_bf16 v[232:235], a[56:59], a[44:47], v[232:235]
    v_add_u32 v20, 0xfffe8000, v20
    v_lshl_add_u32 v30, v30, 5, s52
    v_mfma_f32_16x16x32_bf16 v[232:235], a[104:107], a[92:95], v[232:235]
    v_add_u32 v21, 0xfffe8000, v21
    v_add_u32 v22, 0xfffe8000, v22
    v_mfma_f32_16x16x32_bf16 v[228:231], a[52:55], a[44:47], v[228:231]
    buffer_load_dwordx4 v15, s[44:47], s99 offen offset:3072 nt lds
    v_mfma_f32_16x16x32_bf16 v[228:231], a[100:103], a[92:95], v[228:231]
    s_add_u32 s99, s99, 524288
    v_add_u32 v23, 0xfffe8000, v23
    v_mfma_f32_16x16x32_bf16 v[224:227], a[48:51], a[44:47], v[224:227]
    v_add_u32 v24, 0xfffe8000, v24
    v_lshlrev_b32 v30, 7, v30
    v_mfma_f32_16x16x32_bf16 v[224:227], a[96:99], a[92:95], v[224:227]
    v_add_u32 v25, 0xfffe8000, v25
    s_waitcnt vmcnt(12) lgkmcnt(0)
    s_barrier
    buffer_load_dword v27, v30, s[76:79], 0 offen offset:0 sc1
    v_mfma_f32_16x16x32_bf16 v[128:131], a[144:147], a[128:131], v[128:131]
    ds_read_b128 a[32:35], v16 offset:0
    s_mov_b32 s40, s20
    v_mfma_f32_16x16x32_bf16 v[128:131], a[192:195], a[176:179], v[128:131]
    ds_read_b64_tr_b16 a[48:49], v18 offset:0
    v_add_u32 v6, 0, v2
    v_mfma_f32_16x16x32_bf16 v[132:135], a[148:151], a[128:131], v[132:135]
    s_mov_b32 s41, s21
    v_mfma_f32_16x16x32_bf16 v[132:135], a[196:199], a[176:179], v[132:135]
    ds_read_b64_tr_b16 a[50:51], v18 offset:1024
    v_add_u32 v5, 98304, v2
    v_mfma_f32_16x16x32_bf16 v[136:139], a[152:155], a[128:131], v[136:139]
    ds_read_b128 a[80:83], v17 offset:0
    s_mov_b32 s42, 4194304
    v_mfma_f32_16x16x32_bf16 v[136:139], a[200:203], a[176:179], v[136:139]
    ds_read_b64_tr_b16 a[96:97], v18 offset:8192
    v_mov_b32 v11, 0xff800000
    v_mfma_f32_16x16x32_bf16 v[140:143], a[156:159], a[128:131], v[140:143]
    s_mov_b32 s43, 0x20000
    v_mfma_f32_16x16x32_bf16 v[140:143], a[204:207], a[176:179], v[140:143]
    ds_read_b64_tr_b16 a[98:99], v18 offset:9216
    v_mov_b32 v7, 0
    v_mfma_f32_16x16x32_bf16 v[144:147], a[160:163], a[128:131], v[144:147]
    ds_read_b128 a[36:39], v16 offset:2048
    s_mov_b32 s44, s8
    v_mfma_f32_16x16x32_bf16 v[144:147], a[208:211], a[176:179], v[144:147]
    ds_read_b64_tr_b16 a[52:53], v19 offset:0
    s_mov_b32 s45, s9
    v_mfma_f32_16x16x32_bf16 v[148:151], a[164:167], a[128:131], v[148:151]
    v_mov_b32 v8, 0
    v_mfma_f32_16x16x32_bf16 v[148:151], a[212:215], a[176:179], v[148:151]
    ds_read_b64_tr_b16 a[54:55], v19 offset:1024
    s_mov_b32 s46, 524288
    v_mfma_f32_16x16x32_bf16 v[152:155], a[168:171], a[128:131], v[152:155]
    ds_read_b128 a[84:87], v17 offset:2048
    v_mov_b32 v9, 0
    v_mfma_f32_16x16x32_bf16 v[152:155], a[216:219], a[176:179], v[152:155]
    ds_read_b64_tr_b16 a[100:101], v19 offset:8192
    s_mov_b32 s47, 0x20000
    v_mfma_f32_16x16x32_bf16 v[156:159], a[172:175], a[128:131], v[156:159]
    v_mov_b32 v10, 0
    v_mfma_f32_16x16x32_bf16 v[156:159], a[220:223], a[176:179], v[156:159]
    ds_read_b64_tr_b16 a[102:103], v19 offset:9216
    s_lshl_b32 s73, s2, 2
    v_mfma_f32_16x16x32_bf16 v[188:191], a[172:175], a[132:135], v[188:191]
    ds_read_b128 a[40:43], v16 offset:4096
    s_add_u32 s73, s73, s48
    v_mfma_f32_16x16x32_bf16 v[188:191], a[220:223], a[180:183], v[188:191]
    ds_read_b64_tr_b16 a[56:57], v20 offset:0
    s_lshl_b32 s72, s50, 2
    v_mfma_f32_16x16x32_bf16 v[184:187], a[168:171], a[132:135], v[184:187]
    s_lshr_b32 s52, s73, 3
    v_mfma_f32_16x16x32_bf16 v[184:187], a[216:219], a[180:183], v[184:187]
    ds_read_b64_tr_b16 a[58:59], v20 offset:1024
    s_add_u32 s72, s72, s48
    v_mfma_f32_16x16x32_bf16 v[180:183], a[164:167], a[132:135], v[180:183]
    ds_read_b128 a[88:91], v17 offset:4096
    s_and_b32 s73, s73, 7
    v_mfma_f32_16x16x32_bf16 v[180:183], a[212:215], a[180:183], v[180:183]
    ds_read_b64_tr_b16 a[104:105], v20 offset:8192
    s_mov_b32 s98, -1
    v_mfma_f32_16x16x32_bf16 v[176:179], a[160:163], a[132:135], v[176:179]
    s_lshl_b32 s74, s52, 15
    v_mfma_f32_16x16x32_bf16 v[176:179], a[208:211], a[180:183], v[176:179]
    ds_read_b64_tr_b16 a[106:107], v20 offset:9216
    s_mov_b32 s96, 32768
    v_mfma_f32_16x16x32_bf16 v[172:175], a[156:159], a[132:135], v[172:175]
    ds_read_b128 a[44:47], v16 offset:6144
    s_lshl_b32 s75, s73, 7
    v_mfma_f32_16x16x32_bf16 v[172:175], a[204:207], a[180:183], v[172:175]
    ds_read_b64_tr_b16 a[60:61], v21 offset:0
    s_add_u32 s74, s74, s75
    v_mfma_f32_16x16x32_bf16 v[168:171], a[152:155], a[132:135], v[168:171]
    s_mov_b32 s97, 16384
    v_mfma_f32_16x16x32_bf16 v[168:171], a[200:203], a[180:183], v[168:171]
    ds_read_b64_tr_b16 a[62:63], v21 offset:1024
    s_mul_i32 s75, s73, 589824
    v_mfma_f32_16x16x32_bf16 v[164:167], a[148:151], a[132:135], v[164:167]
    ds_read_b128 a[92:95], v17 offset:6144
    v_mov_b32 v64, 0
    v_mfma_f32_16x16x32_bf16 v[164:167], a[196:199], a[180:183], v[164:167]
    ds_read_b64_tr_b16 a[108:109], v21 offset:8192
    s_lshl_b32 s52, s52, 12
    v_mfma_f32_16x16x32_bf16 v[160:163], a[144:147], a[132:135], v[160:163]
    v_mov_b32 v65, 0
    v_mfma_f32_16x16x32_bf16 v[160:163], a[192:195], a[180:183], v[160:163]
    ds_read_b64_tr_b16 a[110:111], v21 offset:9216
    s_add_u32 s75, s75, s52
    v_mfma_f32_16x16x32_bf16 v[192:195], a[144:147], a[136:139], v[192:195]
    ds_read_b64_tr_b16 a[64:65], v22 offset:0
    v_lshrrev_b32 v14, 3, v1
    v_mfma_f32_16x16x32_bf16 v[192:195], a[192:195], a[184:187], v[192:195]
    ds_read_b64_tr_b16 a[66:67], v22 offset:1024
    v_mov_b32 v66, 0
    v_mfma_f32_16x16x32_bf16 v[196:199], a[148:151], a[136:139], v[196:199]
    v_bfe_u32 v15, v1, 4, 2
    v_mfma_f32_16x16x32_bf16 v[196:199], a[196:199], a[184:187], v[196:199]
    ds_read_b64_tr_b16 a[112:113], v22 offset:8192
    v_mov_b32 v67, 0
    v_mfma_f32_16x16x32_bf16 v[200:203], a[152:155], a[136:139], v[200:203]
    ds_read_b64_tr_b16 a[114:115], v22 offset:9216
    v_bfe_u32 v12, v1, 1, 2
    v_mfma_f32_16x16x32_bf16 v[200:203], a[200:203], a[184:187], v[200:203]
    ds_read_b64_tr_b16 a[68:69], v23 offset:0
    v_mov_b32 v68, 0
    v_mfma_f32_16x16x32_bf16 v[204:207], a[156:159], a[136:139], v[204:207]
    v_xor_b32 v15, v15, v12
    v_mfma_f32_16x16x32_bf16 v[204:207], a[204:207], a[184:187], v[204:207]
    ds_read_b64_tr_b16 a[70:71], v23 offset:1024
    v_mov_b32 v69, 0
    v_mfma_f32_16x16x32_bf16 v[208:211], a[160:163], a[136:139], v[208:211]
    ds_read_b64_tr_b16 a[116:117], v23 offset:8192
    v_and_b32 v12, 1, v1
    v_mfma_f32_16x16x32_bf16 v[208:211], a[208:211], a[184:187], v[208:211]
    ds_read_b64_tr_b16 a[118:119], v23 offset:9216
    v_lshl_add_u32 v15, v15, 1, v12
    v_mfma_f32_16x16x32_bf16 v[212:215], a[164:167], a[136:139], v[212:215]
    v_mov_b32 v70, 0
    v_mfma_f32_16x16x32_bf16 v[212:215], a[212:215], a[184:187], v[212:215]
    ds_read_b64_tr_b16 a[72:73], v24 offset:0
    v_lshlrev_b32 v15, 4, v15
    v_mfma_f32_16x16x32_bf16 v[216:219], a[168:171], a[136:139], v[216:219]
    ds_read_b64_tr_b16 a[74:75], v24 offset:1024
    v_mov_b32 v71, 0
    v_mfma_f32_16x16x32_bf16 v[216:219], a[216:219], a[184:187], v[216:219]
    ds_read_b64_tr_b16 a[120:121], v24 offset:8192
    v_lshl_add_u32 v13, v14, 10, v15
    v_mfma_f32_16x16x32_bf16 v[220:223], a[172:175], a[136:139], v[220:223]
    v_mov_b32 v72, 0
    v_mfma_f32_16x16x32_bf16 v[220:223], a[220:223], a[184:187], v[220:223]
    ds_read_b64_tr_b16 a[122:123], v24 offset:9216
    v_lshrrev_b32 v14, 2, v4
    v_mfma_f32_16x16x32_bf16 v[252:255], a[172:175], a[140:143], v[252:255]
    ds_read_b64_tr_b16 a[76:77], v25 offset:0
    v_lshl_add_u32 v14, v3, 2, v14
    v_mfma_f32_16x16x32_bf16 v[252:255], a[220:223], a[188:191], v[252:255]
    ds_read_b64_tr_b16 a[78:79], v25 offset:1024
    v_mov_b32 v73, 0
    v_mfma_f32_16x16x32_bf16 v[248:251], a[168:171], a[140:143], v[248:251]
    v_bfe_u32 v15, v14, 1, 2
    v_mfma_f32_16x16x32_bf16 v[248:251], a[216:219], a[188:191], v[248:251]
    ds_read_b64_tr_b16 a[124:125], v25 offset:8192
    v_mov_b32 v74, 0
    v_mfma_f32_16x16x32_bf16 v[244:247], a[164:167], a[140:143], v[244:247]
    ds_read_b64_tr_b16 a[126:127], v25 offset:9216
    v_lshlrev_b32 v14, 7, v14
    v_mfma_f32_16x16x32_bf16 v[244:247], a[212:215], a[188:191], v[244:247]
    v_mov_b32 v75, 0
    v_mfma_f32_16x16x32_bf16 v[240:243], a[160:163], a[140:143], v[240:243]
    v_add_u32 v16, 0xc000, v16
    v_lshl_add_u32 v14, v15, 5, v14
    v_mfma_f32_16x16x32_bf16 v[240:243], a[208:211], a[188:191], v[240:243]
    v_add_u32 v17, 0xc000, v17
    v_mov_b32 v76, 0
    v_mfma_f32_16x16x32_bf16 v[236:239], a[156:159], a[140:143], v[236:239]
    v_add_u32 v18, 0xc000, v18
    v_and_b32 v15, 3, v4
    v_mfma_f32_16x16x32_bf16 v[236:239], a[204:207], a[188:191], v[236:239]
    v_add_u32 v19, 0xc000, v19
    s_lshl_b32 s73, s48, 13
    v_mfma_f32_16x16x32_bf16 v[232:235], a[152:155], a[140:143], v[232:235]
    v_add_u32 v20, 0xc000, v20
    v_mov_b32 v77, 0
    v_mfma_f32_16x16x32_bf16 v[232:235], a[200:203], a[188:191], v[232:235]
    v_add_u32 v21, 0xc000, v21
    s_add_u32 s73, s73, 65536
    v_mfma_f32_16x16x32_bf16 v[228:231], a[148:151], a[140:143], v[228:231]
    v_add_u32 v22, 0xc000, v22
    v_mov_b32 v78, 0
    v_mfma_f32_16x16x32_bf16 v[228:231], a[196:199], a[188:191], v[228:231]
    v_add_u32 v23, 0xc000, v23
    v_lshl_add_u32 v14, v15, 3, v14
    v_mfma_f32_16x16x32_bf16 v[224:227], a[144:147], a[140:143], v[224:227]
    v_add_u32 v24, 0xc000, v24
    v_mov_b32 v79, 0
    v_mfma_f32_16x16x32_bf16 v[224:227], a[192:195], a[188:191], v[224:227]
    v_add_u32 v25, 0xc000, v25
    v_add_u32 v12, s73, v14
    s_waitcnt vmcnt(0) lgkmcnt(0)
    s_mov_b32 s52, 0
L_poll1:
    v_cmp_eq_u32 vcc, s95, v27
    s_nop 0
    s_cmp_eq_u64 vcc, -1
    s_cbranch_scc1 L_poll1_ok
    s_add_u32 s52, s52, 1
    s_cmp_gt_u32 s52, 0x40000
    s_cbranch_scc1 L_poll1_ok
    s_sleep 1
    buffer_load_dword v27, v30, s[76:79], 0 offen offset:0 sc1
    s_waitcnt vmcnt(0)
    s_branch L_poll1
L_poll1_ok:
    s_barrier
    v_mfma_f32_16x16x32_bf16 v[128:131], a[48:51], a[32:35], v[128:131]
    ds_read_b128 a[128:131], v16 offset:0
    ds_read_b64_tr_b16 a[144:145], v18 offset:0
    v_mfma_f32_16x16x32_bf16 v[128:131], a[96:99], a[80:83], v[128:131]
    s_lshl_b32 s99, s48, 12
    s_mov_b32 s100, 0
    s_add_u32 s54, s99, 98304
    v_mfma_f32_16x16x32_bf16 v[132:135], a[52:55], a[32:35], v[132:135]
    v_mfma_f32_16x16x32_bf16 v[132:135], a[100:103], a[80:83], v[132:135]
    ds_read_b64_tr_b16 a[146:147], v18 offset:1024
    v_mfma_f32_16x16x32_bf16 v[136:139], a[56:59], a[32:35], v[136:139]
    ds_read_b128 a[176:179], v17 offset:0
    ds_read_b64_tr_b16 a[192:193], v18 offset:8192
    v_mfma_f32_16x16x32_bf16 v[136:139], a[104:107], a[80:83], v[136:139]
    s_lshl_b32 s101, s48, 12
    s_mov_b32 s3, 0
    s_add_u32 s55, s101, 0
    v_mfma_f32_16x16x32_bf16 v[140:143], a[60:63], a[32:35], v[140:143]
    v_mfma_f32_16x16x32_bf16 v[140:143], a[108:111], a[80:83], v[140:143]
    ds_read_b64_tr_b16 a[194:195], v18 offset:9216
    ds_read_b128 a[132:135], v16 offset:2048
    v_mfma_f32_16x16x32_bf16 v[144:147], a[64:67], a[32:35], v[144:147]
    s_add_u32 m0, s54, s100
    s_add_u32 s100, s100, 16384
    v_mfma_f32_16x16x32_bf16 v[144:147], a[112:115], a[80:83], v[144:147]
    buffer_load_dwordx4 v2, s[28:31], s99 offen offset:0 sc1 lds
    v_mfma_f32_16x16x32_bf16 v[148:151], a[68:71], a[32:35], v[148:151]
    ds_read_b64_tr_b16 a[148:149], v19 offset:0
    v_mfma_f32_16x16x32_bf16 v[148:151], a[116:119], a[80:83], v[148:151]
    ds_read_b64_tr_b16 a[150:151], v19 offset:1024
    ds_read_b128 a[180:183], v17 offset:2048
    v_mfma_f32_16x16x32_bf16 v[152:155], a[72:75], a[32:35], v[152:155]
    buffer_load_dwordx4 v2, s[28:31], s99 offen offset:1024 sc1 lds
    v_mfma_f32_16x16x32_bf16 v[152:155], a[120:123], a[80:83], v[152:155]
    ds_read_b64_tr_b16 a[196:197], v19 offset:8192
    v_mfma_f32_16x16x32_bf16 v[156:159], a[76:79], a[32:35], v[156:159]
    v_mfma_f32_16x16x32_bf16 v[156:159], a[124:127], a[80:83], v[156:159]
    ds_read_b64_tr_b16 a[198:199], v19 offset:9216
    ds_read_b128 a[136:139], v16 offset:4096
    v_mfma_f32_16x16x32_bf16 v[188:191], a[76:79], a[36:39], v[188:191]
    buffer_load_dwordx4 v2, s[28:31], s99 offen offset:2048 sc1 lds
    v_mfma_f32_16x16x32_bf16 v[188:191], a[124:127], a[84:87], v[188:191]
    ds_read_b64_tr_b16 a[152:153], v20 offset:0
    v_mfma_f32_16x16x32_bf16 v[184:187], a[72:75], a[36:39], v[184:187]
    v_mfma_f32_16x16x32_bf16 v[184:187], a[120:123], a[84:87], v[184:187]
    ds_read_b64_tr_b16 a[154:155], v20 offset:1024
    ds_read_b128 a[184:187], v17 offset:4096
    v_mfma_f32_16x16x32_bf16 v[180:183], a[68:71], a[36:39], v[180:183]
    buffer_load_dwordx4 v2, s[28:31], s99 offen offset:3072 sc1 lds
    v_mfma_f32_16x16x32_bf16 v[180:183], a[116:119], a[84:87], v[180:183]
    ds_read_b64_tr_b16 a[200:201], v20 offset:8192
    v_mfma_f32_16x16x32_bf16 v[176:179], a[64:67], a[36:39], v[176:179]
    v_mfma_f32_16x16x32_bf16 v[176:179], a[112:115], a[84:87], v[176:179]
    ds_read_b64_tr_b16 a[202:203], v20 offset:9216
    ds_read_b128 a[140:143], v16 offset:6144
    v_mfma_f32_16x16x32_bf16 v[172:175], a[60:63], a[36:39], v[172:175]
    s_add_u32 s99, s99, 16384
    s_and_b32 s100, s100, 0xffff
    v_mfma_f32_16x16x32_bf16 v[172:175], a[108:111], a[84:87], v[172:175]
    ds_read_b64_tr_b16 a[156:157], v21 offset:0
    v_mfma_f32_16x16x32_bf16 v[168:171], a[56:59], a[36:39], v[168:171]
    s_add_u32 m0, s54, s100
    s_add_u32 s100, s100, 16384
    v_mfma_f32_16x16x32_bf16 v[168:171], a[104:107], a[84:87], v[168:171]
    buffer_load_dwordx4 v2, s[28:31], s99 offen offset:0 sc1 lds
    v_mfma_f32_16x16x32_bf16 v[164:167], a[52:55], a[36:39], v[164:167]
    ds_read_b64_tr_b16 a[158:159], v21 offset:1024
    ds_read_b128 a[188:191], v17 offset:6144
    v_mfma_f32_16x16x32_bf16 v[164:167], a[100:103], a[84:87], v[164:167]
    ds_read_b64_tr_b16 a[204:205], v21 offset:8192
    v_mfma_f32_16x16x32_bf16 v[160:163], a[48:51], a[36:39], v[160:163]
    ds_read_b64_tr_b16 a[206:207], v21 offset:9216
    v_mfma_f32_16x16x32_bf16 v[160:163], a[96:99], a[84:87], v[160:163]
    buffer_load_dwordx4 v2, s[28:31], s99 offen offset:1024 sc1 lds
    v_mfma_f32_16x16x32_bf16 v[192:195], a[48:51], a[40:43], v[192:195]
    ds_read_b64_tr_b16 a[160:161], v22 offset:0
    v_mfma_f32_16x16x32_bf16 v[192:195], a[96:99], a[88:91], v[192:195]
    ds_read_b64_tr_b16 a[162:163], v22 offset:1024
    v_mfma_f32_16x16x32_bf16 v[196:199], a[52:55], a[40:43], v[196:199]
    ds_read_b64_tr_b16 a[208:209], v22 offset:8192
    v_mfma_f32_16x16x32_bf16 v[196:199], a[100:103], a[88:91], v[196:199]
    buffer_load_dwordx4 v2, s[28:31], s99 offen offset:2048 sc1 lds
    v_mfma_f32_16x16x32_bf16 v[200:203], a[56:59], a[40:43], v[200:203]
    ds_read_b64_tr_b16 a[210:211], v22 offset:9216
    v_mfma_f32_16x16x32_bf16 v[200:203], a[104:107], a[88:91], v[200:203]
    ds_read_b64_tr_b16 a[164:165], v23 offset:0
    v_mfma_f32_16x16x32_bf16 v[204:207], a[60:63], a[40:43], v[204:207]
    buffer_load_dwordx4 v2, s[28:31], s99 offen offset:3072 sc1 lds
    v_mfma_f32_16x16x32_bf16 v[204:207], a[108:111], a[88:91], v[204:207]
    ds_read_b64_tr_b16 a[166:167], v23 offset:1024
    v_mfma_f32_16x16x32_bf16 v[208:211], a[64:67], a[40:43], v[208:211]
    ds_read_b64_tr_b16 a[212:213], v23 offset:8192
    v_mfma_f32_16x16x32_bf16 v[208:211], a[112:115], a[88:91], v[208:211]
    ds_read_b64_tr_b16 a[214:215], v23 offset:9216
    v_mfma_f32_16x16x32_bf16 v[212:215], a[68:71], a[40:43], v[212:215]
    s_add_u32 s99, s99, 16384
    s_and_b32 s100, s100, 0xffff
    v_mfma_f32_16x16x32_bf16 v[212:215], a[116:119], a[88:91], v[212:215]
    ds_read_b64_tr_b16 a[168:169], v24 offset:0
    v_mfma_f32_16x16x32_bf16 v[216:219], a[72:75], a[40:43], v[216:219]
    ds_read_b64_tr_b16 a[170:171], v24 offset:1024
    ds_read_b64_tr_b16 a[216:217], v24 offset:8192
    v_mfma_f32_16x16x32_bf16 v[216:219], a[120:123], a[88:91], v[216:219]
    s_add_u32 m0, s55, s3
    s_add_u32 s3, s3, 16384
    v_mfma_f32_16x16x32_bf16 v[220:223], a[76:79], a[40:43], v[220:223]
    buffer_load_dwordx4 v2, s[32:35], s101 offen offset:0 sc1 lds
    v_mfma_f32_16x16x32_bf16 v[220:223], a[124:127], a[88:91], v[220:223]
    ds_read_b64_tr_b16 a[218:219], v24 offset:9216
    v_mfma_f32_16x16x32_bf16 v[252:255], a[76:79], a[44:47], v[252:255]
    ds_read_b64_tr_b16 a[172:173], v25 offset:0
    v_mfma_f32_16x16x32_bf16 v[252:255], a[124:127], a[92:95], v[252:255]
    ds_read_b64_tr_b16 a[174:175], v25 offset:1024
    v_mfma_f32_16x16x32_bf16 v[248:251], a[72:75], a[44:47], v[248:251]
    buffer_load_dwordx4 v2, s[32:35], s101 offen offset:1024 sc1 lds
    v_mfma_f32_16x16x32_bf16 v[248:251], a[120:123], a[92:95], v[248:251]
    ds_read_b64_tr_b16 a[220:221], v25 offset:8192
    v_mfma_f32_16x16x32_bf16 v[244:247], a[68:71], a[44:47], v[244:247]
    ds_read_b64_tr_b16 a[222:223], v25 offset:9216
    v_mfma_f32_16x16x32_bf16 v[244:247], a[116:119], a[92:95], v[244:247]
    buffer_load_dwordx4 v2, s[32:35], s101 offen offset:2048 sc1 lds
    v_mfma_f32_16x16x32_bf16 v[240:243], a[64:67], a[44:47], v[240:243]
    v_mfma_f32_16x16x32_bf16 v[240:243], a[112:115], a[92:95], v[240:243]
    v_mfma_f32_16x16x32_bf16 v[236:239], a[60:63], a[44:47], v[236:239]
    v_mfma_f32_16x16x32_bf16 v[236:239], a[108:111], a[92:95], v[236:239]
    buffer_load_dwordx4 v2, s[32:35], s101 offen offset:3072 sc1 lds
    v_mfma_f32_16x16x32_bf16 v[232:235], a[56:59], a[44:47], v[232:235]
    v_mfma_f32_16x16x32_bf16 v[232:235], a[104:107], a[92:95], v[232:235]
    v_mfma_f32_16x16x32_bf16 v[228:231], a[52:55], a[44:47], v[228:231]
    v_mfma_f32_16x16x32_bf16 v[228:231], a[100:103], a[92:95], v[228:231]
    s_add_u32 s101, s101, 16384
    s_and_b32 s3, s3, 0xffff
    v_mfma_f32_16x16x32_bf16 v[224:227], a[48:51], a[44:47], v[224:227]
    v_mfma_f32_16x16x32_bf16 v[224:227], a[96:99], a[92:95], v[224:227]
    s_waitcnt lgkmcnt(0)
    s_barrier
    v_mfma_f32_16x16x32_bf16 v[224:227], a[144:147], a[140:143], v[224:227]
    s_add_u32 m0, s54, s100
    s_add_u32 s100, s100, 16384
    v_mfma_f32_16x16x32_bf16 v[224:227], a[192:195], a[188:191], v[224:227]
    buffer_load_dwordx4 v2, s[28:31], s99 offen offset:0 sc1 lds
    v_mfma_f32_16x16x32_bf16 v[228:231], a[148:151], a[140:143], v[228:231]
    v_mfma_f32_16x16x32_bf16 v[228:231], a[196:199], a[188:191], v[228:231]
    v_mfma_f32_16x16x32_bf16 v[232:235], a[152:155], a[140:143], v[232:235]
    buffer_load_dwordx4 v2, s[28:31], s99 offen offset:1024 sc1 lds
    v_mfma_f32_16x16x32_bf16 v[232:235], a[200:203], a[188:191], v[232:235]
    v_mfma_f32_16x16x32_bf16 v[236:239], a[156:159], a[140:143], v[236:239]
    v_mfma_f32_16x16x32_bf16 v[236:239], a[204:207], a[188:191], v[236:239]
    buffer_load_dwordx4 v2, s[28:31], s99 offen offset:2048 sc1 lds
    v_mfma_f32_16x16x32_bf16 v[240:243], a[160:163], a[140:143], v[240:243]
    v_mfma_f32_16x16x32_bf16 v[240:243], a[208:211], a[188:191], v[240:243]
    v_mfma_f32_16x16x32_bf16 v[244:247], a[164:167], a[140:143], v[244:247]
    v_mfma_f32_16x16x32_bf16 v[244:247], a[212:215], a[188:191], v[244:247]
    buffer_load_dwordx4 v2, s[28:31], s99 offen offset:3072 sc1 lds
    v_mfma_f32_16x16x32_bf16 v[248:251], a[168:171], a[140:143], v[248:251]
    v_mfma_f32_16x16x32_bf16 v[248:251], a[216:219], a[188:191], v[248:251]
    v_mfma_f32_16x16x32_bf16 v[252:255], a[172:175], a[140:143], v[252:255]
    s_add_u32 s99, s99, 16384
    s_and_b32 s100, s100, 0xffff
    v_mfma_f32_16x16x32_bf16 v[252:255], a[220:223], a[188:191], v[252:255]
    v_mfma_f32_16x16x32_bf16 v[220:223], a[172:175], a[136:139], v[220:223]
    s_add_u32 m0, s54, s100
    s_add_u32 s100, s100, 16384
    v_mfma_f32_16x16x32_bf16 v[220:223], a[220:223], a[184:187], v[220:223]
    buffer_load_dwordx4 v2, s[28:31], s99 offen offset:0 sc1 lds
    v_mfma_f32_16x16x32_bf16 v[216:219], a[168:171], a[136:139], v[216:219]
    v_mfma_f32_16x16x32_bf16 v[216:219], a[216:219], a[184:187], v[216:219]
    v_mfma_f32_16x16x32_bf16 v[212:215], a[164:167], a[136:139], v[212:215]
    buffer_load_dwordx4 v2, s[28:31], s99 offen offset:1024 sc1 lds
    v_mfma_f32_16x16x32_bf16 v[212:215], a[212:215], a[184:187], v[212:215]
    v_mfma_f32_16x16x32_bf16 v[208:211], a[160:163], a[136:139], v[208:211]
    s_mov_b32 s51, 0x3e0293ee
    v_mul_f32 v224, s51, v224
    v_mfma_f32_16x16x32_bf16 v[208:211], a[208:211], a[184:187], v[208:211]
    buffer_load_dwordx4 v2, s[28:31], s99 offen offset:2048 sc1 lds
    v_mfma_f32_16x16x32_bf16 v[204:207], a[156:159], a[136:139], v[204:207]
    v_mul_f32 v225, s51, v225
    v_mfma_f32_16x16x32_bf16 v[204:207], a[204:207], a[184:187], v[204:207]
    v_mul_f32 v226, s51, v226
    v_mul_f32 v227, s51, v227
    v_mfma_f32_16x16x32_bf16 v[200:203], a[152:155], a[136:139], v[200:203]
    buffer_load_dwordx4 v2, s[28:31], s99 offen offset:3072 sc1 lds
    v_mfma_f32_16x16x32_bf16 v[200:203], a[200:203], a[184:187], v[200:203]
    v_mul_f32 v228, s51, v228
    v_mul_f32 v229, s51, v229
    v_mfma_f32_16x16x32_bf16 v[196:199], a[148:151], a[136:139], v[196:199]
    v_mul_f32 v230, s51, v230
    v_mul_f32 v231, s51, v231
    v_mfma_f32_16x16x32_bf16 v[196:199], a[196:199], a[184:187], v[196:199]
    s_add_u32 s99, s99, 16384
    s_and_b32 s100, s100, 0xffff
    v_mfma_f32_16x16x32_bf16 v[192:195], a[144:147], a[136:139], v[192:195]
    v_cvt_pk_bf16_f32 v224, v224, v225
    v_mfma_f32_16x16x32_bf16 v[192:195], a[192:195], a[184:187], v[192:195]
    v_cvt_pk_bf16_f32 v225, v226, v227
    v_cvt_pk_bf16_f32 v226, v228, v229
    v_mfma_f32_16x16x32_bf16 v[160:163], a[144:147], a[132:135], v[160:163]
    s_add_u32 m0, s55, s3
    s_add_u32 s3, s3, 16384
    v_mfma_f32_16x16x32_bf16 v[160:163], a[192:195], a[180:183], v[160:163]
    buffer_load_dwordx4 v2, s[32:35], s101 offen offset:0 sc1 lds
    v_mfma_f32_16x16x32_bf16 v[164:167], a[148:151], a[132:135], v[164:167]
    v_cvt_pk_bf16_f32 v227, v230, v231
    v_mul_f32 v232, s51, v232
    v_mfma_f32_16x16x32_bf16 v[164:167], a[196:199], a[180:183], v[164:167]
    v_mul_f32 v233, s51, v233
    v_mul_f32 v234, s51, v234
    v_mfma_f32_16x16x32_bf16 v[168:171], a[152:155], a[132:135], v[168:171]
    buffer_load_dwordx4 v2, s[32:35], s101 offen offset:1024 sc1 lds
    v_mfma_f32_16x16x32_bf16 v[168:171], a[200:203], a[180:183], v[168:171]
    v_mul_f32 v235, s51, v235
    v_mul_f32 v236, s51, v236
    v_mfma_f32_16x16x32_bf16 v[172:175], a[156:159], a[132:135], v[172:175]
    v_mul_f32 v237, s51, v237
    v_mul_f32 v238, s51, v238
    v_mfma_f32_16x16x32_bf16 v[172:175], a[204:207], a[180:183], v[172:175]
    buffer_load_dwordx4 v2, s[32:35], s101 offen offset:2048 sc1 lds
    v_mfma_f32_16x16x32_bf16 v[176:179], a[160:163], a[132:135], v[176:179]
    v_mul_f32 v239, s51, v239
    v_cvt_pk_bf16_f32 v228, v232, v233
    v_mfma_f32_16x16x32_bf16 v[176:179], a[208:211], a[180:183], v[176:179]
    v_cvt_pk_bf16_f32 v229, v234, v235
    v_cvt_pk_bf16_f32 v230, v236, v237
    v_mfma_f32_16x16x32_bf16 v[180:183], a[164:167], a[132:135], v[180:183]
    buffer_load_dwordx4 v2, s[32:35], s101 offen offset:3072 sc1 lds
    v_mfma_f32_16x16x32_bf16 v[180:183], a[212:215], a[180:183], v[180:183]
    v_cvt_pk_bf16_f32 v231, v238, v239
    v_mul_f32 v240, s51, v240
    v_mfma_f32_16x16x32_bf16 v[184:187], a[168:171], a[132:135], v[184:187]
    v_mul_f32 v241, s51, v241
    v_mul_f32 v242, s51, v242
    v_mfma_f32_16x16x32_bf16 v[184:187], a[216:219], a[180:183], v[184:187]
    s_add_u32 s101, s101, 16384
    s_and_b32 s3, s3, 0xffff
    v_mfma_f32_16x16x32_bf16 v[188:191], a[172:175], a[132:135], v[188:191]
    v_mul_f32 v243, s51, v243
    v_mul_f32 v244, s51, v244
    v_mfma_f32_16x16x32_bf16 v[188:191], a[220:223], a[180:183], v[188:191]
    s_add_u32 m0, s55, s3
    s_add_u32 s3, s3, 16384
    v_mfma_f32_16x16x32_bf16 v[156:159], a[172:175], a[128:131], v[156:159]
    buffer_load_dwordx4 v2, s[32:35], s101 offen offset:0 sc1 lds
    v_mfma_f32_16x16x32_bf16 v[156:159], a[220:223], a[176:179], v[156:159]
    v_mul_f32 v245, s51, v245
    v_mul_f32 v246, s51, v246
    v_mfma_f32_16x16x32_bf16 v[152:155], a[168:171], a[128:131], v[152:155]
    v_mul_f32 v247, s51, v247
    v_cvt_pk_bf16_f32 v232, v240, v241
    v_mfma_f32_16x16x32_bf16 v[152:155], a[216:219], a[176:179], v[152:155]
    buffer_load_dwordx4 v2, s[32:35], s101 offen offset:1024 sc1 lds
    v_mfma_f32_16x16x32_bf16 v[148:151], a[164:167], a[128:131], v[148:151]
    v_cvt_pk_bf16_f32 v233, v242, v243
    v_cvt_pk_bf16_f32 v234, v244, v245
    v_mfma_f32_16x16x32_bf16 v[148:151], a[212:215], a[176:179], v[148:151]
    v_cvt_pk_bf16_f32 v235, v246, v247
    v_mfma_f32_16x16x32_bf16 v[144:147], a[160:163], a[128:131], v[144:147]
    v_mul_f32 v248, s51, v248
    v_mul_f32 v249, s51, v249
    v_mfma_f32_16x16x32_bf16 v[144:147], a[208:211], a[176:179], v[144:147]
    buffer_load_dwordx4 v2, s[32:35], s101 offen offset:2048 sc1 lds
    v_mfma_f32_16x16x32_bf16 v[140:143], a[156:159], a[128:131], v[140:143]
    v_mul_f32 v250, s51, v250
    v_mul_f32 v251, s51, v251
    v_mfma_f32_16x16x32_bf16 v[140:143], a[204:207], a[176:179], v[140:143]
    v_mul_f32 v252, s51, v252
    v_mul_f32 v253, s51, v253
    v_mfma_f32_16x16x32_bf16 v[136:139], a[152:155], a[128:131], v[136:139]
    buffer_load_dwordx4 v2, s[32:35], s101 offen offset:3072 sc1 lds
    v_mfma_f32_16x16x32_bf16 v[136:139], a[200:203], a[176:179], v[136:139]
    v_mul_f32 v254, s51, v254
    v_mfma_f32_16x16x32_bf16 v[132:135], a[148:151], a[128:131], v[132:135]
    v_mul_f32 v255, s51, v255
    v_cvt_pk_bf16_f32 v236, v248, v249
    v_mfma_f32_16x16x32_bf16 v[132:135], a[196:199], a[176:179], v[132:135]
    s_add_u32 s101, s101, 16384
    s_and_b32 s3, s3, 0xffff
    v_mfma_f32_16x16x32_bf16 v[128:131], a[144:147], a[128:131], v[128:131]
    v_cvt_pk_bf16_f32 v237, v250, v251
    v_cvt_pk_bf16_f32 v238, v252, v253
    v_mfma_f32_16x16x32_bf16 v[128:131], a[192:195], a[176:179], v[128:131]
    v_cvt_pk_bf16_f32 v239, v254, v255
L_fill:
    s_waitcnt vmcnt(20)
    s_barrier
    ds_read_b128 a[128:131], v5 offset:0
    ds_read_b128 a[132:135], v5 offset:1024
    ds_read_b128 a[136:139], v5 offset:2048
    ds_read_b128 a[140:143], v5 offset:3072
    ds_read_b128 a[144:147], v5 offset:4096
    ds_read_b128 a[148:151], v5 offset:5120
    ds_read_b128 a[152:155], v5 offset:6144
    ds_read_b128 a[156:159], v5 offset:7168
    s_add_u32 s36, s26, 33554432
    s_addc_u32 s37, s27, 0
    s_mov_b32 s38, 16777216
    s_mov_b32 s39, 0x20000
    s_sub_u32 s51, s98, s72
    s_add_u32 s51, s51, 1
    s_cmp_lt_u32 s51, 2
    s_cbranch_scc0 L_nsp3
    s_cmp_eq_u32 s51, 0
    s_cselect_b64 s[64:65], s[56:57], 0
    s_cselect_b64 s[66:67], s[58:59], 0
    s_cselect_b64 s[68:69], s[60:61], 0
    s_cselect_b64 s[70:71], s[62:63], 0
    s_cselect_b64 vcc, -1, 0
    v_cndmask_b32 v64, v11, v9, s[64:65]
    v_cndmask_b32 v76, v11, v10, s[64:65]
    v_mov_b32 v72, v11
    v_cndmask_b32 v68, v11, v10, vcc
    v_cndmask_b32 v65, v11, v9, s[66:67]
    v_cndmask_b32 v77, v11, v10, s[66:67]
    v_mov_b32 v73, v11
    v_cndmask_b32 v69, v11, v10, vcc
    v_cndmask_b32 v66, v11, v9, s[68:69]
    v_cndmask_b32 v78, v11, v10, s[68:69]
    v_mov_b32 v74, v11
    v_cndmask_b32 v70, v11, v10, vcc
    v_cndmask_b32 v67, v11, v9, s[70:71]
    v_cndmask_b32 v79, v11, v10, s[70:71]
    v_mov_b32 v75, v11
    v_cndmask_b32 v71, v11, v10, vcc
    s_nop 1
L_nsp3:
    s_mov_b32 s51, 0x3e0293ee
    s_waitcnt lgkmcnt(0)
    v_mfma_f32_16x16x32_bf16 v[56:59], a[128:131], v[224:227], v[68:71]
    v_mul_f32 v216, s51, v216
    v_mul_f32 v217, s51, v217
    v_mfma_f32_16x16x32_bf16 v[60:63], a[144:147], v[224:227], v[76:79]
    v_mul_f32 v218, s51, v218
    v_mul_f32 v219, s51, v219
    v_mfma_f32_16x16x32_bf16 v[56:59], a[132:135], v[228:231], v[56:59]
    v_mul_f32 v220, s51, v220
    v_mul_f32 v221, s51, v221
    v_mfma_f32_16x16x32_bf16 v[60:63], a[148:151], v[228:231], v[60:63]
    v_mul_f32 v222, s51, v222
    v_mul_f32 v223, s51, v223
    v_cvt_pk_bf16_f32 v223, v222, v223
    v_cvt_pk_bf16_f32 v222, v220, v221
    v_cvt_pk_bf16_f32 v221, v218, v219
    v_cvt_pk_bf16_f32 v220, v216, v217
    v_mfma_f32_16x16x32_bf16 v[56:59], a[136:139], v[232:235], v[56:59]
    v_mul_f32 v208, s51, v208
    v_mul_f32 v209, s51, v209
    v_mul_f32 v210, s51, v210
    v_mul_f32 v211, s51, v211
    v_mul_f32 v212, s51, v212
    v_mul_f32 v213, s51, v213
    v_mfma_f32_16x16x32_bf16 v[60:63], a[152:155], v[232:235], v[60:63]
    v_mul_f32 v214, s51, v214
    v_mul_f32 v215, s51, v215
    v_cvt_pk_bf16_f32 v219, v214, v215
    v_cvt_pk_bf16_f32 v218, v212, v213
    v_cvt_pk_bf16_f32 v217, v210, v211
    v_cvt_pk_bf16_f32 v216, v208, v209
    v_mfma_f32_16x16x32_bf16 v[56:59], a[140:143], v[236:239], v[56:59]
    v_mul_f32 v200, s51, v200
    v_mul_f32 v201, s51, v201
    v_mul_f32 v202, s51, v202
    v_mul_f32 v203, s51, v203
    v_mul_f32 v204, s51, v204
    v_mul_f32 v205, s51, v205
    v_mfma_f32_16x16x32_bf16 v[60:63], a[156:159], v[236:239], v[60:63]
    v_mul_f32 v206, s51, v206
    v_mul_f32 v207, s51, v207
    v_cvt_pk_bf16_f32 v215, v206, v207
    v_cvt_pk_bf16_f32 v214, v204, v205
    v_cvt_pk_bf16_f32 v213, v202, v203
    v_cvt_pk_bf16_f32 v212, v200, v201
    v_mul_f32 v192, s51, v192
    v_mul_f32 v193, s51, v193
    v_mul_f32 v194, s51, v194
    v_mul_f32 v195, s51, v195
    v_mul_f32 v196, s51, v196
    v_mul_f32 v197, s51, v197
    v_mul_f32 v198, s51, v198
    v_mul_f32 v199, s51, v199
    v_cvt_pk_bf16_f32 v211, v198, v199
    v_cvt_pk_bf16_f32 v210, v196, v197
    v_cvt_pk_bf16_f32 v209, v194, v195
    v_cvt_pk_bf16_f32 v208, v192, v193
    s_nop 1
    v_mfma_f32_16x16x32_bf16 v[48:51], a[128:131], v[208:211], v[64:67]
    v_mul_f32 v160, s51, v160
    v_mul_f32 v161, s51, v161
    v_mfma_f32_16x16x32_bf16 v[52:55], a[144:147], v[208:211], v[72:75]
    v_mul_f32 v162, s51, v162
    v_mul_f32 v163, s51, v163
    v_mfma_f32_16x16x32_bf16 v[48:51], a[132:135], v[212:215], v[48:51]
    v_mul_f32 v164, s51, v164
    v_mul_f32 v165, s51, v165
    v_mfma_f32_16x16x32_bf16 v[52:55], a[148:151], v[212:215], v[52:55]
    v_mul_f32 v166, s51, v166
    v_mul_f32 v167, s51, v167
    v_cvt_pk_bf16_f32 v192, v160, v161
    v_cvt_pk_bf16_f32 v193, v162, v163
    v_cvt_pk_bf16_f32 v194, v164, v165
    v_cvt_pk_bf16_f32 v195, v166, v167
    v_mfma_f32_16x16x32_bf16 v[48:51], a[136:139], v[216:219], v[48:51]
    v_mul_f32 v168, s51, v168
    v_mul_f32 v169, s51, v169
    v_mul_f32 v170, s51, v170
    v_mul_f32 v171, s51, v171
    v_mul_f32 v172, s51, v172
    v_mul_f32 v173, s51, v173
    v_mfma_f32_16x16x32_bf16 v[52:55], a[152:155], v[216:219], v[52:55]
    v_mul_f32 v174, s51, v174
    v_mul_f32 v175, s51, v175
    v_cvt_pk_bf16_f32 v196, v168, v169
    v_cvt_pk_bf16_f32 v197, v170, v171
    v_cvt_pk_bf16_f32 v198, v172, v173
    v_cvt_pk_bf16_f32 v199, v174, v175
    v_mfma_f32_16x16x32_bf16 v[48:51], a[140:143], v[220:223], v[48:51]
    v_mul_f32 v176, s51, v176
    v_mul_f32 v177, s51, v177
    v_mul_f32 v178, s51, v178
    v_mul_f32 v179, s51, v179
    v_mul_f32 v180, s51, v180
    v_mul_f32 v181, s51, v181
    v_mfma_f32_16x16x32_bf16 v[52:55], a[156:159], v[220:223], v[52:55]
    v_mul_f32 v182, s51, v182
    v_mul_f32 v183, s51, v183
    v_cvt_pk_bf16_f32 v200, v176, v177
    v_cvt_pk_bf16_f32 v201, v178, v179
    v_cvt_pk_bf16_f32 v202, v180, v181
    v_cvt_pk_bf16_f32 v203, v182, v183
    v_mul_f32 v184, s51, v184
    v_mul_f32 v185, s51, v185
    v_mul_f32 v186, s51, v186
    v_mul_f32 v187, s51, v187
    v_mul_f32 v188, s51, v188
    v_mul_f32 v189, s51, v189
    v_mul_f32 v190, s51, v190
    v_mul_f32 v191, s51, v191
    v_cvt_pk_bf16_f32 v204, v184, v185
    v_cvt_pk_bf16_f32 v205, v186, v187
    v_cvt_pk_bf16_f32 v206, v188, v189
    v_cvt_pk_bf16_f32 v207, v190, v191
    s_nop 1
    v_mfma_f32_16x16x32_bf16 v[40:43], a[128:131], v[192:195], 0
    v_mul_f32 v128, s51, v128
    v_mul_f32 v129, s51, v129
    v_mfma_f32_16x16x32_bf16 v[44:47], a[144:147], v[192:195], 0
    v_mul_f32 v130, s51, v130
    v_mul_f32 v131, s51, v131
    v_mfma_f32_16x16x32_bf16 v[40:43], a[132:135], v[196:199], v[40:43]
    v_mul_f32 v132, s51, v132
    v_mul_f32 v133, s51, v133
    v_mfma_f32_16x16x32_bf16 v[44:47], a[148:151], v[196:199], v[44:47]
    v_mul_f32 v134, s51, v134
    v_mul_f32 v135, s51, v135
    v_cvt_pk_bf16_f32 v176, v128, v129
    v_cvt_pk_bf16_f32 v177, v130, v131
    v_cvt_pk_bf16_f32 v178, v132, v133
    v_cvt_pk_bf16_f32 v179, v134, v135
    v_mfma_f32_16x16x32_bf16 v[40:43], a[136:139], v[200:203], v[40:43]
    v_mul_f32 v136, s51, v136
    v_mul_f32 v137, s51, v137
    v_mul_f32 v138, s51, v138
    v_mul_f32 v139, s51, v139
    v_mul_f32 v140, s51, v140
    v_mul_f32 v141, s51, v141
    v_mfma_f32_16x16x32_bf16 v[44:47], a[152:155], v[200:203], v[44:47]
    v_mul_f32 v142, s51, v142
    v_mul_f32 v143, s51, v143
    v_cvt_pk_bf16_f32 v180, v136, v137
    v_cvt_pk_bf16_f32 v181, v138, v139
    v_cvt_pk_bf16_f32 v182, v140, v141
    v_cvt_pk_bf16_f32 v183, v142, v143
    v_mfma_f32_16x16x32_bf16 v[40:43], a[140:143], v[204:207], v[40:43]
    v_mul_f32 v144, s51, v144
    v_mul_f32 v145, s51, v145
    v_mul_f32 v146, s51, v146
    v_mul_f32 v147, s51, v147
    v_mul_f32 v148, s51, v148
    v_mul_f32 v149, s51, v149
    v_mfma_f32_16x16x32_bf16 v[44:47], a[156:159], v[204:207], v[44:47]
    v_mul_f32 v150, s51, v150
    v_mul_f32 v151, s51, v151
    v_cvt_pk_bf16_f32 v184, v144, v145
    v_cvt_pk_bf16_f32 v185, v146, v147
    v_cvt_pk_bf16_f32 v186, v148, v149
    v_cvt_pk_bf16_f32 v187, v150, v151
    v_mul_f32 v152, s51, v152
    v_mul_f32 v153, s51, v153
    v_mul_f32 v154, s51, v154
    v_mul_f32 v155, s51, v155
    v_mul_f32 v156, s51, v156
    v_mul_f32 v157, s51, v157
    v_mul_f32 v158, s51, v158
    v_mul_f32 v159, s51, v159
    v_cvt_pk_bf16_f32 v188, v152, v153
    v_cvt_pk_bf16_f32 v189, v154, v155
    v_cvt_pk_bf16_f32 v190, v156, v157
    v_cvt_pk_bf16_f32 v191, v158, v159
    s_nop 1
    v_mfma_f32_16x16x32_bf16 v[32:35], a[128:131], v[176:179], 0
    v_mfma_f32_16x16x32_bf16 v[36:39], a[144:147], v[176:179], 0
    v_mfma_f32_16x16x32_bf16 v[32:35], a[132:135], v[180:183], v[32:35]
    v_mfma_f32_16x16x32_bf16 v[36:39], a[148:151], v[180:183], v[36:39]
    v_mfma_f32_16x16x32_bf16 v[32:35], a[136:139], v[184:187], v[32:35]
    v_mfma_f32_16x16x32_bf16 v[36:39], a[152:155], v[184:187], v[36:39]
    v_mfma_f32_16x16x32_bf16 v[32:35], a[140:143], v[188:191], v[32:35]
    v_mfma_f32_16x16x32_bf16 v[36:39], a[156:159], v[188:191], v[36:39]
    ds_read_b128 a[128:131], v5 offset:8192
    ds_read_b128 a[132:135], v5 offset:9216
    ds_read_b128 a[136:139], v5 offset:10240
    ds_read_b128 a[140:143], v5 offset:11264
    ds_read_b128 a[144:147], v5 offset:12288
    ds_read_b128 a[148:151], v5 offset:13312
    ds_read_b128 a[152:155], v5 offset:14336
    ds_read_b128 a[156:159], v5 offset:15360
    v_add_u32 v5, 114688, v2
    v_mov_b32 v28, 0x3f803f80
    v_mov_b32 v29, 0x3f803f80
    v_mov_b32 v30, 0x3f803f80
    v_mov_b32 v31, 0x3f803f80
    v_max3_f32 v10, v56, v57, v58
    v_max3_f32 v20, v59, v60, v61
    v_max3_f32 v10, v10, v62, v63
    v_max_f32 v10, v10, v20
    v_max3_f32 v9, v48, v49, v50
    v_max3_f32 v20, v51, v52, v53
    v_max3_f32 v9, v9, v54, v55
    v_max_f32 v9, v9, v20
    v_max3_f32 v8, v40, v41, v42
    v_max3_f32 v20, v43, v44, v45
    v_max3_f32 v8, v8, v46, v47
    v_max_f32 v8, v8, v20
    v_max3_f32 v7, v32, v33, v34
    v_max3_f32 v20, v35, v36, v37
    v_max3_f32 v7, v7, v38, v39
    v_max_f32 v7, v7, v20
    v_mov_b32 v16, v7
    v_mov_b32 v17, v8
    v_mov_b32 v18, v9
    v_mov_b32 v19, v10
    s_nop 0
    v_permlane16_swap_b32 v7, v16
    v_permlane16_swap_b32 v8, v17
    v_permlane16_swap_b32 v9, v18
    v_permlane16_swap_b32 v10, v19
    v_max_f32 v7, v7, v16
    v_max_f32 v8, v8, v17
    v_max_f32 v9, v9, v18
    v_max_f32 v10, v10, v19
    v_mov_b32 v16, v7
    v_mov_b32 v17, v8
    v_mov_b32 v18, v9
    v_mov_b32 v19, v10
    s_nop 0
    v_permlane32_swap_b32 v7, v16
    v_permlane32_swap_b32 v8, v17
    v_permlane32_swap_b32 v9, v18
    v_permlane32_swap_b32 v10, v19
    v_max_f32 v7, v7, v16
    v_max_f32 v8, v8, v17
    v_max_f32 v9, v9, v18
    v_max_f32 v10, v10, v19
    v_sub_f32 v7, 0, v7
    v_sub_f32 v8, 0, v8
    v_sub_f32 v9, 0, v9
    v_sub_f32 v10, 0, v10
    v_mov_b32 v128, v7
    v_mov_b32 v129, v7
    v_mov_b32 v130, v7
    v_mov_b32 v131, v7
    v_mov_b32 v132, v8
    v_mov_b32 v133, v8
    v_mov_b32 v134, v8
    v_mov_b32 v135, v8
    v_mov_b32 v160, v9
    v_mov_b32 v161, v9
    v_mov_b32 v162, v9
    v_mov_b32 v163, v9
    v_mov_b32 v164, v10
    v_mov_b32 v165, v10
    v_mov_b32 v166, v10
    v_mov_b32 v167, v10
    v_mov_b32 v136, v7
    v_mov_b32 v137, v7
    v_mov_b32 v138, v7
    v_mov_b32 v139, v7
    v_mov_b32 v140, v8
    v_mov_b32 v141, v8
    v_mov_b32 v142, v8
    v_mov_b32 v143, v8
    v_mov_b32 v168, v9
    v_mov_b32 v169, v9
    v_mov_b32 v170, v9
    v_mov_b32 v171, v9
    v_mov_b32 v172, v10
    v_mov_b32 v173, v10
    v_mov_b32 v174, v10
    v_mov_b32 v175, v10
    v_add_f32 v32, v7, v32
    v_add_f32 v33, v7, v33
    v_add_f32 v34, v7, v34
    v_add_f32 v35, v7, v35
    v_add_f32 v36, v7, v36
    v_add_f32 v37, v7, v37
    v_add_f32 v38, v7, v38
    v_add_f32 v39, v7, v39
    v_add_f32 v40, v8, v40
    v_add_f32 v41, v8, v41
    v_add_f32 v42, v8, v42
    v_add_f32 v43, v8, v43
    v_add_f32 v44, v8, v44
    v_add_f32 v45, v8, v45
    v_add_f32 v46, v8, v46
    v_add_f32 v47, v8, v47
    v_add_f32 v48, v9, v48
    v_add_f32 v49, v9, v49
    v_add_f32 v50, v9, v50
    v_add_f32 v51, v9, v51
    v_add_f32 v52, v9, v52
    v_add_f32 v53, v9, v53
    v_add_f32 v54, v9, v54
    v_add_f32 v55, v9, v55
    v_add_f32 v56, v10, v56
    v_add_f32 v57, v10, v57
    v_add_f32 v58, v10, v58
    v_add_f32 v59, v10, v59
    v_add_f32 v60, v10, v60
    v_add_f32 v61, v10, v61
    v_add_f32 v62, v10, v62
    v_add_f32 v63, v10, v63
    s_mov_b32 s92, 99
    s_cmp_lt_i32 s98, 32
    s_cselect_b32 s92, 32, s92
    s_cmp_lt_i32 s98, 31
    s_cselect_b32 s92, 31, s92
    s_sub_u32 s51, s72, 0
    s_cmp_lt_i32 s98, s51
    s_cselect_b32 s51, s51, 99
    s_min_u32 s92, s92, s51
    s_sub_u32 s51, s72, 1
    s_cmp_lt_i32 s98, s51
    s_cselect_b32 s51, s51, 99
    s_min_u32 s92, s92, s51
    s_add_u32 s98, s98, 1
    s_cmp_eq_u32 s98, s92
    s_waitcnt vmcnt(16) lgkmcnt(0)
    s_barrier
    s_cbranch_scc1 L_ev4_h
L_ev4:
    v_mfma_f32_16x16x32_bf16 v[64:67], a[128:131], v[176:179], v[128:131]
    v_exp_f32 v32, v32
    s_add_u32 m0, s54, s100
    s_add_u32 s100, s100, 16384
    v_mfma_f32_16x16x32_bf16 v[64:67], a[132:135], v[180:183], v[64:67]
    v_exp_f32 v33, v33
    ds_read_b128 a[160:163], v5 offset:0
    buffer_load_dwordx4 v2, s[28:31], s99 offen offset:0 sc1 lds
    v_mfma_f32_16x16x32_bf16 v[64:67], a[136:139], v[184:187], v[64:67]
    v_exp_f32 v34, v34
    buffer_load_dwordx4 v2, s[28:31], s99 offen offset:1024 sc1 lds
    v_mfma_f32_16x16x32_bf16 v[64:67], a[140:143], v[188:191], v[64:67]
    v_exp_f32 v35, v35
    v_cvt_pk_bf16_f32 v96, v32, v33
    v_mfma_f32_16x16x32_bf16 v[72:75], a[128:131], v[192:195], v[132:135]
    v_exp_f32 v36, v36
    ds_read_b128 a[164:167], v5 offset:1024
    v_mfma_f32_16x16x32_bf16 v[72:75], a[132:135], v[196:199], v[72:75]
    v_exp_f32 v37, v37
    v_cvt_pk_bf16_f32 v97, v34, v35
    v_mfma_f32_16x16x32_bf16 v[72:75], a[136:139], v[200:203], v[72:75]
    v_exp_f32 v38, v38
    buffer_load_dwordx4 v2, s[28:31], s99 offen offset:2048 sc1 lds
    v_mfma_f32_16x16x32_bf16 v[72:75], a[140:143], v[204:207], v[72:75]
    v_exp_f32 v39, v39
    v_cvt_pk_bf16_f32 v98, v36, v37
    ds_read_b128 a[168:171], v5 offset:2048
    v_mfma_f32_16x16x32_bf16 v[80:83], a[128:131], v[208:211], v[160:163]
    v_exp_f32 v40, v40
    buffer_load_dwordx4 v2, s[28:31], s99 offen offset:3072 sc1 lds
    v_mfma_f32_16x16x32_bf16 v[80:83], a[132:135], v[212:215], v[80:83]
    v_exp_f32 v41, v41
    v_cvt_pk_bf16_f32 v99, v38, v39
    v_mfma_f32_16x16x32_bf16 v[80:83], a[136:139], v[216:219], v[80:83]
    v_exp_f32 v42, v42
    ds_read_b128 a[172:175], v5 offset:3072
    v_mfma_f32_16x16x32_bf16 v[80:83], a[140:143], v[220:223], v[80:83]
    v_exp_f32 v43, v43
    v_cvt_pk_bf16_f32 v100, v40, v41
    s_add_u32 s99, s99, 16384
    s_and_b32 s100, s100, 0xffff
    v_mfma_f32_16x16x32_bf16 v[88:91], a[128:131], v[224:227], v[164:167]
    v_exp_f32 v44, v44
    ds_read_b128 a[176:179], v5 offset:4096
    v_mfma_f32_16x16x32_bf16 v[88:91], a[132:135], v[228:231], v[88:91]
    v_exp_f32 v45, v45
    v_cvt_pk_bf16_f32 v101, v42, v43
    s_lshl_b32 s52, s2, 2
    v_mfma_f32_16x16x32_bf16 v[88:91], a[136:139], v[232:235], v[88:91]
    v_exp_f32 v46, v46
    v_mfma_f32_16x16x32_bf16 v[88:91], a[140:143], v[236:239], v[88:91]
    v_exp_f32 v47, v47
    v_cvt_pk_bf16_f32 v102, v44, v45
    ds_read_b128 a[180:183], v5 offset:5120
    v_mfma_f32_16x16x32_bf16 v[68:71], a[144:147], v[176:179], v[136:139]
    v_exp_f32 v48, v48
    s_add_u32 s52, s52, s48
    v_mfma_f32_16x16x32_bf16 v[68:71], a[148:151], v[180:183], v[68:71]
    v_exp_f32 v49, v49
    v_cvt_pk_bf16_f32 v103, v46, v47
    v_mfma_f32_16x16x32_bf16 v[68:71], a[152:155], v[184:187], v[68:71]
    v_exp_f32 v50, v50
    ds_read_b128 a[184:187], v5 offset:6144
    s_lshl_b32 s52, s52, 11
    v_mfma_f32_16x16x32_bf16 v[68:71], a[156:159], v[188:191], v[68:71]
    v_exp_f32 v51, v51
    v_cvt_pk_bf16_f32 v104, v48, v49
    v_mfma_f32_16x16x32_bf16 v[76:79], a[144:147], v[192:195], v[140:143]
    v_exp_f32 v52, v52
    v_lshlrev_b32 v18, 7, v4
    v_mfma_f32_16x16x32_bf16 v[76:79], a[148:151], v[196:199], v[76:79]
    v_exp_f32 v53, v53
    v_cvt_pk_bf16_f32 v105, v50, v51
    ds_read_b128 a[188:191], v5 offset:7168
    v_mfma_f32_16x16x32_bf16 v[76:79], a[152:155], v[200:203], v[76:79]
    v_exp_f32 v54, v54
    v_mfma_f32_16x16x32_bf16 v[76:79], a[156:159], v[204:207], v[76:79]
    v_exp_f32 v55, v55
    v_cvt_pk_bf16_f32 v106, v52, v53
    v_add_u32 v18, s52, v18
    v_mfma_f32_16x16x32_bf16 v[84:87], a[144:147], v[208:211], v[168:171]
    v_exp_f32 v56, v56
    s_mov_b32 s64, s6
    s_mov_b32 s65, s7
    v_mfma_f32_16x16x32_bf16 v[84:87], a[148:151], v[212:215], v[84:87]
    v_exp_f32 v57, v57
    v_cvt_pk_bf16_f32 v107, v54, v55
    v_mfma_f32_16x16x32_bf16 v[84:87], a[152:155], v[216:219], v[84:87]
    v_exp_f32 v58, v58
    v_mfma_f32_16x16x32_bf16 v[84:87], a[156:159], v[220:223], v[84:87]
    v_exp_f32 v59, v59
    v_cvt_pk_bf16_f32 v108, v56, v57
    v_mfma_f32_16x16x32_bf16 v[92:95], a[144:147], v[224:227], v[172:175]
    v_exp_f32 v60, v60
    s_mov_b32 s66, 1572864
    s_mov_b32 s67, 0x20000
    v_mfma_f32_16x16x32_bf16 v[92:95], a[148:151], v[228:231], v[92:95]
    v_exp_f32 v61, v61
    v_cvt_pk_bf16_f32 v109, v58, v59
    s_mov_b32 s68, 0
    v_mfma_f32_16x16x32_bf16 v[92:95], a[152:155], v[232:235], v[92:95]
    v_exp_f32 v62, v62
    buffer_load_dword v0, v18, s[64:67], s68 offen
    v_mfma_f32_16x16x32_bf16 v[92:95], a[156:159], v[236:239], v[92:95]
    v_exp_f32 v63, v63
    v_cvt_pk_bf16_f32 v110, v60, v61
    v_cvt_pk_bf16_f32 v111, v62, v63
    s_add_u32 s98, s98, 1
    s_cmp_eq_u32 s98, s92
    s_waitcnt vmcnt(13) lgkmcnt(0)
    s_barrier
    s_cbranch_scc1 L_ev5_h
L_ev5:
    v_mfma_f32_16x16x32_bf16 v[32:35], a[160:163], v[176:179], v[128:131]
    v_exp_f32 v64, v64
    v_mfma_f32_16x16x32_bf16 v[32:35], a[164:167], v[180:183], v[32:35]
    v_exp_f32 v65, v65
    v_mfma_f32_16x16x32_bf16 v[32:35], a[168:171], v[184:187], v[32:35]
    v_exp_f32 v66, v66
    v_mfma_f32_16x16x32_bf16 v[32:35], a[172:175], v[188:191], v[32:35]
    v_exp_f32 v67, v67
    v_mfma_f32_16x16x32_bf16 v[40:43], a[160:163], v[192:195], v[132:135]
    v_exp_f32 v68, v68
    v_mfma_f32_16x16x32_bf16 v[40:43], a[164:167], v[196:199], v[40:43]
    v_mov_b32 v144, v7
    ds_read_b128 a[208:211], v6 offset:0
    v_mfma_f32_16x16x32_bf16 v[40:43], a[168:171], v[200:203], v[40:43]
    v_exp_f32 v69, v69
    v_mfma_f32_16x16x32_bf16 v[40:43], a[172:175], v[204:207], v[40:43]
    v_exp_f32 v70, v70
    v_mfma_f32_16x16x32_bf16 v[48:51], a[160:163], v[208:211], v[160:163]
    v_exp_f32 v71, v71
    v_mfma_f32_16x16x32_bf16 v[48:51], a[164:167], v[212:215], v[48:51]
    v_mov_b32 v145, v7
    ds_read_b128 a[212:215], v6 offset:1024
    v_mfma_f32_16x16x32_bf16 v[48:51], a[168:171], v[216:219], v[48:51]
    v_exp_f32 v72, v72
    v_mfma_f32_16x16x32_bf16 v[48:51], a[172:175], v[220:223], v[48:51]
    ds_read_b128 a[216:219], v6 offset:2048
    v_mov_b32 v146, v7
    v_mfma_f32_16x16x32_bf16 v[56:59], a[160:163], v[224:227], v[164:167]
    v_exp_f32 v73, v73
    v_mfma_f32_16x16x32_bf16 v[56:59], a[164:167], v[228:231], v[56:59]
    ds_read_b128 a[220:223], v6 offset:3072
    v_mov_b32 v147, v7
    v_mfma_f32_16x16x32_bf16 v[56:59], a[168:171], v[232:235], v[56:59]
    v_exp_f32 v74, v74
    v_mfma_f32_16x16x32_bf16 v[56:59], a[172:175], v[236:239], v[56:59]
    ds_read_b128 a[224:227], v6 offset:4096
    v_mov_b32 v148, v8
    v_mfma_f32_16x16x32_bf16 v[36:39], a[176:179], v[176:179], v[136:139]
    v_exp_f32 v75, v75
    v_mfma_f32_16x16x32_bf16 v[36:39], a[180:183], v[180:183], v[36:39]
    ds_read_b128 a[228:231], v6 offset:5120
    v_mov_b32 v149, v8
    v_mfma_f32_16x16x32_bf16 v[36:39], a[184:187], v[184:187], v[36:39]
    v_exp_f32 v76, v76
    v_mfma_f32_16x16x32_bf16 v[36:39], a[188:191], v[188:191], v[36:39]
    ds_read_b128 a[232:235], v6 offset:6144
    ds_read_b128 a[236:239], v6 offset:7168
    v_mfma_f32_16x16x32_bf16 v[44:47], a[176:179], v[192:195], v[140:143]
    v_exp_f32 v77, v77
    v_mfma_f32_16x16x32_bf16 v[44:47], a[180:183], v[196:199], v[44:47]
    v_mov_b32 v150, v8
    v_mov_b32 v151, v8
    v_mfma_f32_16x16x32_bf16 v[44:47], a[184:187], v[200:203], v[44:47]
    v_exp_f32 v78, v78
    v_mfma_f32_16x16x32_bf16 v[44:47], a[188:191], v[204:207], v[44:47]
    v_mov_b32 v152, v7
    v_cvt_pk_bf16_f32 v112, v64, v65
    v_mfma_f32_16x16x32_bf16 v[52:55], a[176:179], v[208:211], v[168:171]
    v_exp_f32 v79, v79
    v_mfma_f32_16x16x32_bf16 v[52:55], a[180:183], v[212:215], v[52:55]
    v_mov_b32 v153, v7
    v_cvt_pk_bf16_f32 v113, v66, v67
    v_mfma_f32_16x16x32_bf16 v[52:55], a[184:187], v[216:219], v[52:55]
    v_exp_f32 v80, v80
    v_mfma_f32_16x16x32_bf16 v[52:55], a[188:191], v[220:223], v[52:55]
    s_add_u32 s51, s96, 98304
    v_cvt_pk_bf16_f32 v114, v68, v69
    v_mfma_f32_16x16x32_bf16 v[60:63], a[176:179], v[224:227], v[172:175]
    v_exp_f32 v81, v81
    v_mfma_f32_16x16x32_bf16 v[60:63], a[180:183], v[228:231], v[60:63]
    v_mov_b32 v154, v7
    v_cvt_pk_bf16_f32 v115, v70, v71
    v_mfma_f32_16x16x32_bf16 v[60:63], a[184:187], v[232:235], v[60:63]
    v_exp_f32 v82, v82
    v_mfma_f32_16x16x32_bf16 v[60:63], a[188:191], v[236:239], v[60:63]
    v_mov_b32 v155, v7
    v_cvt_pk_bf16_f32 v116, v72, v73
    s_waitcnt lgkmcnt(0)
    v_mfma_f32_16x16x32_bf16 a[0:3], a[208:211], v[96:99], 0
    v_exp_f32 v83, v83
    v_mfma_f32_16x16x32_bf16 a[32:35], a[208:211], v[100:103], 0
    ds_read_b128 a[128:131], v5 offset:8192
    s_mov_b32 s64, s4
    s_mov_b32 s65, s5
    v_mfma_f32_16x16x32_bf16 a[64:67], a[208:211], v[104:107], 0
    v_exp_f32 v84, v84
    v_mfma_f32_16x16x32_bf16 a[96:99], a[208:211], v[108:111], 0
    v_exp_f32 v85, v85
    v_mfma_f32_16x16x32_bf16 a[100:103], a[212:215], v[108:111], 0
    ds_read_b128 a[132:135], v5 offset:9216
    ds_read_b128 a[136:139], v5 offset:10240
    v_mfma_f32_16x16x32_bf16 a[68:71], a[212:215], v[104:107], 0
    v_exp_f32 v86, v86
    v_mfma_f32_16x16x32_bf16 a[36:39], a[212:215], v[100:103], 0
    ds_read_b128 a[140:143], v5 offset:11264
    v_mov_b32 v156, v8
    v_mfma_f32_16x16x32_bf16 a[4:7], a[212:215], v[96:99], 0
    v_exp_f32 v87, v87
    v_mfma_f32_16x16x32_bf16 a[192:195], v[28:31], v[96:99], 0
    ds_read_b128 a[144:147], v5 offset:12288
    s_mov_b32 s66, 2097152
    s_mov_b32 s67, 0x20000
    v_mfma_f32_16x16x32_bf16 a[8:11], a[216:219], v[96:99], 0
    v_exp_f32 v88, v88
    v_mfma_f32_16x16x32_bf16 a[40:43], a[216:219], v[100:103], 0
    s_add_u32 s96, s96, 16384
    v_mov_b32 v157, v8
    v_mfma_f32_16x16x32_bf16 a[72:75], a[216:219], v[104:107], 0
    v_exp_f32 v89, v89
    v_mfma_f32_16x16x32_bf16 a[104:107], a[216:219], v[108:111], 0
    ds_read_b128 a[148:151], v5 offset:13312
    v_cvt_pk_bf16_f32 v117, v74, v75
    v_mfma_f32_16x16x32_bf16 a[108:111], a[220:223], v[108:111], 0
    v_exp_f32 v90, v90
    v_mfma_f32_16x16x32_bf16 a[76:79], a[220:223], v[104:107], 0
    v_mov_b32 v158, v8
    ds_read_b128 a[152:155], v5 offset:14336
    v_mfma_f32_16x16x32_bf16 a[44:47], a[220:223], v[100:103], 0
    v_exp_f32 v91, v91
    v_mfma_f32_16x16x32_bf16 a[12:15], a[220:223], v[96:99], 0
    s_mov_b32 s68, 0
    v_mov_b32 v159, v8
    v_mfma_f32_16x16x32_bf16 a[196:199], v[28:31], v[100:103], 0
    v_exp_f32 v92, v92
    v_mfma_f32_16x16x32_bf16 a[16:19], a[224:227], v[96:99], 0
    ds_read_b128 a[156:159], v5 offset:15360
    v_cvt_pk_bf16_f32 v118, v76, v77
    v_mfma_f32_16x16x32_bf16 a[48:51], a[224:227], v[100:103], 0
    v_exp_f32 v93, v93
    v_mfma_f32_16x16x32_bf16 a[80:83], a[224:227], v[104:107], 0
    s_and_b32 s96, s96, 0xffff
    v_cvt_pk_bf16_f32 v119, v78, v79
    v_mfma_f32_16x16x32_bf16 a[112:115], a[224:227], v[108:111], 0
    v_exp_f32 v94, v94
    v_mfma_f32_16x16x32_bf16 a[116:119], a[228:231], v[108:111], 0
    v_cvt_pk_bf16_f32 v120, v80, v81
    v_cvt_pk_bf16_f32 v121, v82, v83
    v_mfma_f32_16x16x32_bf16 a[84:87], a[228:231], v[104:107], 0
    v_exp_f32 v95, v95
    v_mfma_f32_16x16x32_bf16 a[52:55], a[228:231], v[100:103], 0
    v_cvt_pk_bf16_f32 v122, v84, v85
    v_cvt_pk_bf16_f32 v123, v86, v87
    v_mfma_f32_16x16x32_bf16 a[20:23], a[228:231], v[96:99], 0
    v_cvt_pk_bf16_f32 v124, v88, v89
    v_cvt_pk_bf16_f32 v125, v90, v91
    v_mfma_f32_16x16x32_bf16 a[200:203], v[28:31], v[104:107], 0
    v_cvt_pk_bf16_f32 v126, v92, v93
    v_cvt_pk_bf16_f32 v127, v94, v95
    v_mfma_f32_16x16x32_bf16 a[24:27], a[232:235], v[96:99], 0
    v_mfma_f32_16x16x32_bf16 a[56:59], a[232:235], v[100:103], 0
    buffer_load_dword v0, v18, s[64:67], s68 offen
    v_mfma_f32_16x16x32_bf16 a[88:91], a[232:235], v[104:107], 0
    v_mfma_f32_16x16x32_bf16 a[120:123], a[232:235], v[108:111], 0
    v_mfma_f32_16x16x32_bf16 a[124:127], a[236:239], v[108:111], 0
    v_add_u32 v5, s51, v2
    v_mfma_f32_16x16x32_bf16 a[92:95], a[236:239], v[104:107], 0
    v_mfma_f32_16x16x32_bf16 a[60:63], a[236:239], v[100:103], 0
    v_mfma_f32_16x16x32_bf16 a[28:31], a[236:239], v[96:99], 0
    v_mfma_f32_16x16x32_bf16 a[204:207], v[28:31], v[108:111], 0
    s_lshl_b32 s53, s50, 1
    s_cmp_eq_u32 s53, 0
    s_cbranch_scc1 L_endA
    s_lshl_b32 s51, s48, 2
    s_add_u32 s51, s51, 65536
    v_mov_b32 v22, s51
    v_and_b32 v23, 3, v1
    v_lshlrev_b32 v23, 2, v23
    v_add_u32 v23, 65536, v23
    v_mov_b32 v20, 0
    v_mov_b32 v21, 0
    ds_write_b32 v22, v20
    s_waitcnt lgkmcnt(0)
    s_barrier
    s_and_b32 s51, s48, 1
    s_cmp_eq_u32 s51, 1
    s_cbranch_scc1 L_loopA1
.p2align 5
L_loopA:
    s_add_u32 s98, s98, 1
    s_cmp_eq_u32 s98, s92
    s_waitcnt vmcnt(8) lgkmcnt(0)
    s_cbranch_scc1 L_ev6_h
L_ev6:
    v_mfma_f32_16x16x32_bf16 v[64:67], a[128:131], v[176:179], v[128:131]
    v_add_u32 v20, 1, v20
    ds_write_b32 v22, v20
    v_mfma_f32_16x16x32_bf16 v[64:67], a[132:135], v[180:183], v[64:67]
    v_exp_f32 v32, v32
    v_mfma_f32_16x16x32_bf16 v[64:67], a[136:139], v[184:187], v[64:67]
    v_exp_f32 v33, v33
    v_mfma_f32_16x16x32_bf16 v[64:67], a[140:143], v[188:191], v[64:67]
    v_exp_f32 v34, v34
    v_mfma_f32_16x16x32_bf16 v[72:75], a[128:131], v[192:195], v[132:135]
    v_exp_f32 v35, v35
    v_mfma_f32_16x16x32_bf16 v[72:75], a[132:135], v[196:199], v[72:75]
    v_exp_f32 v36, v36
    v_mfma_f32_16x16x32_bf16 v[72:75], a[136:139], v[200:203], v[72:75]
    ds_read_b128 a[208:211], v6 offset:8192
    ds_read_b128 a[212:215], v6 offset:9216
    v_mfma_f32_16x16x32_bf16 v[72:75], a[140:143], v[204:207], v[72:75]
    v_exp_f32 v37, v37
    v_mfma_f32_16x16x32_bf16 v[80:83], a[128:131], v[208:211], v[160:163]
    v_exp_f32 v38, v38
    v_mfma_f32_16x16x32_bf16 v[80:83], a[132:135], v[212:215], v[80:83]
    v_exp_f32 v39, v39
    v_mfma_f32_16x16x32_bf16 v[80:83], a[136:139], v[216:219], v[80:83]
    v_exp_f32 v40, v40
    v_mfma_f32_16x16x32_bf16 v[80:83], a[140:143], v[220:223], v[80:83]
    v_exp_f32 v41, v41
    v_mfma_f32_16x16x32_bf16 v[88:91], a[128:131], v[224:227], v[164:167]
    ds_read_b128 a[216:219], v6 offset:10240
    ds_read_b128 a[220:223], v6 offset:11264
    v_mfma_f32_16x16x32_bf16 v[88:91], a[132:135], v[228:231], v[88:91]
    v_exp_f32 v42, v42
    v_mfma_f32_16x16x32_bf16 v[88:91], a[136:139], v[232:235], v[88:91]
    v_exp_f32 v43, v43
    v_mfma_f32_16x16x32_bf16 v[88:91], a[140:143], v[236:239], v[88:91]
    v_exp_f32 v44, v44
    v_mfma_f32_16x16x32_bf16 v[68:71], a[144:147], v[176:179], v[136:139]
    v_exp_f32 v45, v45
    v_mfma_f32_16x16x32_bf16 v[68:71], a[148:151], v[180:183], v[68:71]
    v_exp_f32 v46, v46
    v_mfma_f32_16x16x32_bf16 v[68:71], a[152:155], v[184:187], v[68:71]
    ds_read_b128 a[224:227], v6 offset:12288
    ds_read_b128 a[228:231], v6 offset:13312
    v_mfma_f32_16x16x32_bf16 v[68:71], a[156:159], v[188:191], v[68:71]
    v_exp_f32 v47, v47
    v_mfma_f32_16x16x32_bf16 v[76:79], a[144:147], v[192:195], v[140:143]
    v_exp_f32 v48, v48
    v_mfma_f32_16x16x32_bf16 v[76:79], a[148:151], v[196:199], v[76:79]
    v_exp_f32 v49, v49
    v_mfma_f32_16x16x32_bf16 v[76:79], a[152:155], v[200:203], v[76:79]
    v_exp_f32 v50, v50
    v_mfma_f32_16x16x32_bf16 v[76:79], a[156:159], v[204:207], v[76:79]
    ds_read_b128 a[232:235], v6 offset:14336
    ds_read_b128 a[236:239], v6 offset:15360
    v_mfma_f32_16x16x32_bf16 v[84:87], a[144:147], v[208:211], v[168:171]
    v_exp_f32 v51, v51
    v_mfma_f32_16x16x32_bf16 v[84:87], a[148:151], v[212:215], v[84:87]
    v_cvt_pk_bf16_f32 v96, v32, v33
    v_cvt_pk_bf16_f32 v97, v34, v35
    v_mfma_f32_16x16x32_bf16 v[84:87], a[152:155], v[216:219], v[84:87]
    v_exp_f32 v52, v52
    v_mfma_f32_16x16x32_bf16 v[84:87], a[156:159], v[220:223], v[84:87]
    ds_read_b32 v21, v23
    v_cvt_pk_bf16_f32 v98, v36, v37
    v_mfma_f32_16x16x32_bf16 v[92:95], a[144:147], v[224:227], v[172:175]
    v_exp_f32 v53, v53
    v_mfma_f32_16x16x32_bf16 v[92:95], a[148:151], v[228:231], v[92:95]
    s_add_u32 m0, s54, s100
    s_add_u32 s100, s100, 16384
    v_mfma_f32_16x16x32_bf16 v[92:95], a[152:155], v[232:235], v[92:95]
    v_exp_f32 v54, v54
    v_mfma_f32_16x16x32_bf16 v[92:95], a[156:159], v[236:239], v[92:95]
    v_add_u32 v6, s97, v2
    v_cvt_pk_bf16_f32 v99, v38, v39
    s_waitcnt lgkmcnt(0)
    v_mfma_f32_16x16x32_bf16 a[0:3], a[208:211], v[112:115], a[0:3]
    v_cmp_lt_u32 vcc, v21, v20
    v_mfma_f32_16x16x32_bf16 a[32:35], a[208:211], v[116:119], a[32:35]
    s_cbranch_vccnz L_sb7_s
L_sb7:
    v_mfma_f32_16x16x32_bf16 a[64:67], a[208:211], v[120:123], a[64:67]
    buffer_load_dwordx4 v2, s[28:31], s99 offen offset:0 sc1 lds
    v_mfma_f32_16x16x32_bf16 a[96:99], a[208:211], v[124:127], a[96:99]
    v_exp_f32 v55, v55
    v_mfma_f32_16x16x32_bf16 a[100:103], a[212:215], v[124:127], a[100:103]
    ds_read_b128 a[128:131], v5 offset:0
    ds_read_b128 a[132:135], v5 offset:1024
    v_mfma_f32_16x16x32_bf16 a[68:71], a[212:215], v[120:123], a[68:71]
    v_exp_f32 v56, v56
    v_mfma_f32_16x16x32_bf16 a[36:39], a[212:215], v[116:119], a[36:39]
    ds_read_b128 a[136:139], v5 offset:2048
    ds_read_b128 a[140:143], v5 offset:3072
    v_mfma_f32_16x16x32_bf16 a[4:7], a[212:215], v[112:115], a[4:7]
    v_exp_f32 v57, v57
    v_mfma_f32_16x16x32_bf16 a[192:195], v[28:31], v[112:115], a[192:195]
    ds_read_b128 a[144:147], v5 offset:4096
    v_cvt_pk_bf16_f32 v100, v40, v41
    v_mfma_f32_16x16x32_bf16 a[8:11], a[216:219], v[112:115], a[8:11]
    v_exp_f32 v58, v58
    v_mfma_f32_16x16x32_bf16 a[40:43], a[216:219], v[116:119], a[40:43]
    buffer_load_dwordx4 v2, s[28:31], s99 offen offset:1024 sc1 lds
    v_mfma_f32_16x16x32_bf16 a[72:75], a[216:219], v[120:123], a[72:75]
    s_add_u32 s97, s97, 16384
    ds_read_b128 a[148:151], v5 offset:5120
    v_mfma_f32_16x16x32_bf16 a[104:107], a[216:219], v[124:127], a[104:107]
    v_exp_f32 v59, v59
    v_mfma_f32_16x16x32_bf16 a[108:111], a[220:223], v[124:127], a[108:111]
    ds_read_b128 a[152:155], v5 offset:6144
    v_cvt_pk_bf16_f32 v101, v42, v43
    v_mfma_f32_16x16x32_bf16 a[76:79], a[220:223], v[120:123], a[76:79]
    v_exp_f32 v60, v60
    v_mfma_f32_16x16x32_bf16 a[44:47], a[220:223], v[116:119], a[44:47]
    ds_read_b128 a[156:159], v5 offset:7168
    v_cvt_pk_bf16_f32 v102, v44, v45
    v_mfma_f32_16x16x32_bf16 a[12:15], a[220:223], v[112:115], a[12:15]
    v_exp_f32 v61, v61
    v_mfma_f32_16x16x32_bf16 a[196:199], v[28:31], v[116:119], a[196:199]
    v_cvt_pk_bf16_f32 v103, v46, v47
    v_cvt_pk_bf16_f32 v104, v48, v49
    v_mfma_f32_16x16x32_bf16 a[16:19], a[224:227], v[112:115], a[16:19]
    buffer_load_dwordx4 v2, s[28:31], s99 offen offset:2048 sc1 lds
    v_mfma_f32_16x16x32_bf16 a[48:51], a[224:227], v[116:119], a[48:51]
    v_exp_f32 v62, v62
    v_mfma_f32_16x16x32_bf16 a[80:83], a[224:227], v[120:123], a[80:83]
    s_and_b32 s97, s97, 0xffff
    v_cvt_pk_bf16_f32 v105, v50, v51
    v_mfma_f32_16x16x32_bf16 a[112:115], a[224:227], v[124:127], a[112:115]
    v_exp_f32 v63, v63
    v_mfma_f32_16x16x32_bf16 a[116:119], a[228:231], v[124:127], a[116:119]
    v_cvt_pk_bf16_f32 v106, v52, v53
    v_cvt_pk_bf16_f32 v107, v54, v55
    v_mfma_f32_16x16x32_bf16 a[84:87], a[228:231], v[120:123], a[84:87]
    v_cvt_pk_bf16_f32 v108, v56, v57
    v_cvt_pk_bf16_f32 v109, v58, v59
    v_mfma_f32_16x16x32_bf16 a[52:55], a[228:231], v[116:119], a[52:55]
    v_cvt_pk_bf16_f32 v110, v60, v61
    v_cvt_pk_bf16_f32 v111, v62, v63
    v_mfma_f32_16x16x32_bf16 a[20:23], a[228:231], v[112:115], a[20:23]
    v_mfma_f32_16x16x32_bf16 a[200:203], v[28:31], v[120:123], a[200:203]
    buffer_load_dwordx4 v2, s[28:31], s99 offen offset:3072 sc1 lds
    v_mfma_f32_16x16x32_bf16 a[24:27], a[232:235], v[112:115], a[24:27]
    s_add_u32 s99, s99, 16384
    s_and_b32 s100, s100, 0xffff
    v_mfma_f32_16x16x32_bf16 a[56:59], a[232:235], v[116:119], a[56:59]
    v_mfma_f32_16x16x32_bf16 a[88:91], a[232:235], v[120:123], a[88:91]
    v_mfma_f32_16x16x32_bf16 a[120:123], a[232:235], v[124:127], a[120:123]
    v_mfma_f32_16x16x32_bf16 a[124:127], a[236:239], v[124:127], a[124:127]
    v_mfma_f32_16x16x32_bf16 a[92:95], a[236:239], v[120:123], a[92:95]
    v_mfma_f32_16x16x32_bf16 a[60:63], a[236:239], v[116:119], a[60:63]
    v_mfma_f32_16x16x32_bf16 a[28:31], a[236:239], v[112:115], a[28:31]
    v_mfma_f32_16x16x32_bf16 a[204:207], v[28:31], v[124:127], a[204:207]
    s_add_u32 s98, s98, 1
    s_cmp_eq_u32 s98, s92
    s_waitcnt lgkmcnt(0)
    s_cbranch_scc1 L_ev8_h
L_ev8:
    v_mfma_f32_16x16x32_bf16 v[32:35], a[128:131], v[176:179], v[128:131]
    s_add_u32 m0, s55, s3
    s_add_u32 s3, s3, 16384
    v_mfma_f32_16x16x32_bf16 v[32:35], a[132:135], v[180:183], v[32:35]
    buffer_load_dwordx4 v2, s[32:35], s101 offen offset:0 sc1 lds
    v_mfma_f32_16x16x32_bf16 v[32:35], a[136:139], v[184:187], v[32:35]
    v_exp_f32 v64, v64
    v_mfma_f32_16x16x32_bf16 v[32:35], a[140:143], v[188:191], v[32:35]
    v_exp_f32 v65, v65
    v_mfma_f32_16x16x32_bf16 v[40:43], a[128:131], v[192:195], v[132:135]
    v_exp_f32 v66, v66
    v_mfma_f32_16x16x32_bf16 v[40:43], a[132:135], v[196:199], v[40:43]
    v_exp_f32 v67, v67
    v_mfma_f32_16x16x32_bf16 v[40:43], a[136:139], v[200:203], v[40:43]
    ds_read_b128 a[208:211], v6 offset:0
    ds_read_b128 a[212:215], v6 offset:1024
    v_mfma_f32_16x16x32_bf16 v[40:43], a[140:143], v[204:207], v[40:43]
    v_exp_f32 v68, v68
    v_mfma_f32_16x16x32_bf16 v[48:51], a[128:131], v[208:211], v[160:163]
    v_exp_f32 v69, v69
    v_mfma_f32_16x16x32_bf16 v[48:51], a[132:135], v[212:215], v[48:51]
    v_exp_f32 v70, v70
    v_mfma_f32_16x16x32_bf16 v[48:51], a[136:139], v[216:219], v[48:51]
    v_exp_f32 v71, v71
    v_mfma_f32_16x16x32_bf16 v[48:51], a[140:143], v[220:223], v[48:51]
    v_exp_f32 v72, v72
    v_mfma_f32_16x16x32_bf16 v[56:59], a[128:131], v[224:227], v[164:167]
    ds_read_b128 a[216:219], v6 offset:2048
    ds_read_b128 a[220:223], v6 offset:3072
    v_mfma_f32_16x16x32_bf16 v[56:59], a[132:135], v[228:231], v[56:59]
    v_exp_f32 v73, v73
    v_mfma_f32_16x16x32_bf16 v[56:59], a[136:139], v[232:235], v[56:59]
    v_exp_f32 v74, v74
    v_mfma_f32_16x16x32_bf16 v[56:59], a[140:143], v[236:239], v[56:59]
    v_exp_f32 v75, v75
    v_mfma_f32_16x16x32_bf16 v[36:39], a[144:147], v[176:179], v[136:139]
    v_exp_f32 v76, v76
    v_mfma_f32_16x16x32_bf16 v[36:39], a[148:151], v[180:183], v[36:39]
    buffer_load_dwordx4 v2, s[32:35], s101 offen offset:1024 sc1 lds
    v_mfma_f32_16x16x32_bf16 v[36:39], a[152:155], v[184:187], v[36:39]
    ds_read_b128 a[224:227], v6 offset:4096
    ds_read_b128 a[228:231], v6 offset:5120
    v_mfma_f32_16x16x32_bf16 v[36:39], a[156:159], v[188:191], v[36:39]
    v_exp_f32 v77, v77
    v_mfma_f32_16x16x32_bf16 v[44:47], a[144:147], v[192:195], v[140:143]
    v_exp_f32 v78, v78
    v_mfma_f32_16x16x32_bf16 v[44:47], a[148:151], v[196:199], v[44:47]
    v_exp_f32 v79, v79
    v_mfma_f32_16x16x32_bf16 v[44:47], a[152:155], v[200:203], v[44:47]
    v_exp_f32 v80, v80
    v_mfma_f32_16x16x32_bf16 v[44:47], a[156:159], v[204:207], v[44:47]
    v_exp_f32 v81, v81
    v_mfma_f32_16x16x32_bf16 v[52:55], a[144:147], v[208:211], v[168:171]
    ds_read_b128 a[232:235], v6 offset:6144
    ds_read_b128 a[236:239], v6 offset:7168
    v_mfma_f32_16x16x32_bf16 v[52:55], a[148:151], v[212:215], v[52:55]
    v_exp_f32 v82, v82
    v_mfma_f32_16x16x32_bf16 v[52:55], a[152:155], v[216:219], v[52:55]
    v_exp_f32 v83, v83
    v_mfma_f32_16x16x32_bf16 v[52:55], a[156:159], v[220:223], v[52:55]
    v_exp_f32 v84, v84
    v_mfma_f32_16x16x32_bf16 v[60:63], a[144:147], v[224:227], v[172:175]
    s_add_u32 s51, s96, 98304
    v_cvt_pk_bf16_f32 v112, v64, v65
    v_mfma_f32_16x16x32_bf16 v[60:63], a[148:151], v[228:231], v[60:63]
    v_exp_f32 v85, v85
    v_mfma_f32_16x16x32_bf16 v[60:63], a[152:155], v[232:235], v[60:63]
    v_cvt_pk_bf16_f32 v113, v66, v67
    v_cvt_pk_bf16_f32 v114, v68, v69
    v_mfma_f32_16x16x32_bf16 v[60:63], a[156:159], v[236:239], v[60:63]
    v_exp_f32 v86, v86
    s_waitcnt lgkmcnt(0)
    v_mfma_f32_16x16x32_bf16 a[0:3], a[208:211], v[96:99], a[0:3]
    ds_read_b128 a[128:131], v5 offset:8192
    ds_read_b128 a[132:135], v5 offset:9216
    v_mfma_f32_16x16x32_bf16 a[32:35], a[208:211], v[100:103], a[32:35]
    buffer_load_dwordx4 v2, s[32:35], s101 offen offset:2048 sc1 lds
    v_mfma_f32_16x16x32_bf16 a[64:67], a[208:211], v[104:107], a[64:67]
    v_exp_f32 v87, v87
    v_mfma_f32_16x16x32_bf16 a[96:99], a[208:211], v[108:111], a[96:99]
    ds_read_b128 a[136:139], v5 offset:10240
    ds_read_b128 a[140:143], v5 offset:11264
    v_mfma_f32_16x16x32_bf16 a[100:103], a[212:215], v[108:111], a[100:103]
    v_exp_f32 v88, v88
    v_mfma_f32_16x16x32_bf16 a[68:71], a[212:215], v[104:107], a[68:71]
    ds_read_b128 a[144:147], v5 offset:12288
    v_cvt_pk_bf16_f32 v115, v70, v71
    v_mfma_f32_16x16x32_bf16 a[36:39], a[212:215], v[100:103], a[36:39]
    v_exp_f32 v89, v89
    v_mfma_f32_16x16x32_bf16 a[4:7], a[212:215], v[96:99], a[4:7]
    ds_read_b128 a[148:151], v5 offset:13312
    v_cvt_pk_bf16_f32 v116, v72, v73
    v_mfma_f32_16x16x32_bf16 a[192:195], v[28:31], v[96:99], a[192:195]
    v_exp_f32 v90, v90
    v_mfma_f32_16x16x32_bf16 a[8:11], a[216:219], v[96:99], a[8:11]
    s_add_u32 s96, s96, 16384
    v_cvt_pk_bf16_f32 v117, v74, v75
    v_mfma_f32_16x16x32_bf16 a[40:43], a[216:219], v[100:103], a[40:43]
    v_exp_f32 v91, v91
    v_mfma_f32_16x16x32_bf16 a[72:75], a[216:219], v[104:107], a[72:75]
    ds_read_b128 a[152:155], v5 offset:14336
    v_cvt_pk_bf16_f32 v118, v76, v77
    v_mfma_f32_16x16x32_bf16 a[104:107], a[216:219], v[108:111], a[104:107]
    v_exp_f32 v92, v92
    v_mfma_f32_16x16x32_bf16 a[108:111], a[220:223], v[108:111], a[108:111]
    ds_read_b128 a[156:159], v5 offset:15360
    v_cvt_pk_bf16_f32 v119, v78, v79
    v_mfma_f32_16x16x32_bf16 a[76:79], a[220:223], v[104:107], a[76:79]
    v_exp_f32 v93, v93
    v_mfma_f32_16x16x32_bf16 a[44:47], a[220:223], v[100:103], a[44:47]
    v_cvt_pk_bf16_f32 v120, v80, v81
    v_cvt_pk_bf16_f32 v121, v82, v83
    v_mfma_f32_16x16x32_bf16 a[12:15], a[220:223], v[96:99], a[12:15]
    v_exp_f32 v94, v94
    v_mfma_f32_16x16x32_bf16 a[196:199], v[28:31], v[100:103], a[196:199]
    buffer_load_dwordx4 v2, s[32:35], s101 offen offset:3072 sc1 lds
    v_mfma_f32_16x16x32_bf16 a[16:19], a[224:227], v[96:99], a[16:19]
    s_add_u32 s101, s101, 16384
    s_and_b32 s3, s3, 0xffff
    v_mfma_f32_16x16x32_bf16 a[48:51], a[224:227], v[100:103], a[48:51]
    v_exp_f32 v95, v95
    v_mfma_f32_16x16x32_bf16 a[80:83], a[224:227], v[104:107], a[80:83]
    s_and_b32 s96, s96, 0xffff
    v_cvt_pk_bf16_f32 v122, v84, v85
    v_mfma_f32_16x16x32_bf16 a[112:115], a[224:227], v[108:111], a[112:115]
    v_cvt_pk_bf16_f32 v123, v86, v87
    v_cvt_pk_bf16_f32 v124, v88, v89
    v_mfma_f32_16x16x32_bf16 a[116:119], a[228:231], v[108:111], a[116:119]
    v_cvt_pk_bf16_f32 v125, v90, v91
    v_cvt_pk_bf16_f32 v126, v92, v93
    v_mfma_f32_16x16x32_bf16 a[84:87], a[228:231], v[104:107], a[84:87]
    v_cvt_pk_bf16_f32 v127, v94, v95
    v_mfma_f32_16x16x32_bf16 a[52:55], a[228:231], v[100:103], a[52:55]
    v_mfma_f32_16x16x32_bf16 a[20:23], a[228:231], v[96:99], a[20:23]
    v_mfma_f32_16x16x32_bf16 a[200:203], v[28:31], v[104:107], a[200:203]
    v_mfma_f32_16x16x32_bf16 a[24:27], a[232:235], v[96:99], a[24:27]
    v_mfma_f32_16x16x32_bf16 a[56:59], a[232:235], v[100:103], a[56:59]
    v_mfma_f32_16x16x32_bf16 a[88:91], a[232:235], v[104:107], a[88:91]
    v_mfma_f32_16x16x32_bf16 a[120:123], a[232:235], v[108:111], a[120:123]
    v_mfma_f32_16x16x32_bf16 a[124:127], a[236:239], v[108:111], a[124:127]
    v_add_u32 v5, s51, v2
    v_mfma_f32_16x16x32_bf16 a[92:95], a[236:239], v[104:107], a[92:95]
    v_mfma_f32_16x16x32_bf16 a[60:63], a[236:239], v[100:103], a[60:63]
    v_mfma_f32_16x16x32_bf16 a[28:31], a[236:239], v[96:99], a[28:31]
    v_mfma_f32_16x16x32_bf16 a[204:207], v[28:31], v[108:111], a[204:207]
    s_sub_u32 s53, s53, 1
    s_cmp_lg_u32 s53, 0
    s_cbranch_scc1 L_loopA
    s_branch L_endA
.p2align 5
L_loopA1:
    s_add_u32 s98, s98, 1
    s_cmp_eq_u32 s98, s92
    s_waitcnt vmcnt(8) lgkmcnt(0)
    s_cbranch_scc1 L_ev9_h
L_ev9:
    v_mfma_f32_16x16x32_bf16 v[64:67], a[128:131], v[176:179], v[128:131]
    v_add_u32 v20, 1, v20
    ds_write_b32 v22, v20
    v_mfma_f32_16x16x32_bf16 v[64:67], a[132:135], v[180:183], v[64:67]
    v_exp_f32 v32, v32
    v_mfma_f32_16x16x32_bf16 v[64:67], a[136:139], v[184:187], v[64:67]
    v_exp_f32 v33, v33
    v_mfma_f32_16x16x32_bf16 v[64:67], a[140:143], v[188:191], v[64:67]
    v_exp_f32 v34, v34
    v_mfma_f32_16x16x32_bf16 v[72:75], a[128:131], v[192:195], v[132:135]
    v_exp_f32 v35, v35
    v_mfma_f32_16x16x32_bf16 v[72:75], a[132:135], v[196:199], v[72:75]
    v_exp_f32 v36, v36
    v_mfma_f32_16x16x32_bf16 v[72:75], a[136:139], v[200:203], v[72:75]
    ds_read_b128 a[208:211], v6 offset:8192
    ds_read_b128 a[212:215], v6 offset:9216
    v_mfma_f32_16x16x32_bf16 v[72:75], a[140:143], v[204:207], v[72:75]
    v_exp_f32 v37, v37
    v_mfma_f32_16x16x32_bf16 v[80:83], a[128:131], v[208:211], v[160:163]
    v_exp_f32 v38, v38
    v_mfma_f32_16x16x32_bf16 v[80:83], a[132:135], v[212:215], v[80:83]
    v_exp_f32 v39, v39
    v_mfma_f32_16x16x32_bf16 v[80:83], a[136:139], v[216:219], v[80:83]
    v_exp_f32 v40, v40
    v_mfma_f32_16x16x32_bf16 v[80:83], a[140:143], v[220:223], v[80:83]
    v_exp_f32 v41, v41
    v_mfma_f32_16x16x32_bf16 v[88:91], a[128:131], v[224:227], v[164:167]
    ds_read_b128 a[216:219], v6 offset:10240
    ds_read_b128 a[220:223], v6 offset:11264
    v_mfma_f32_16x16x32_bf16 v[88:91], a[132:135], v[228:231], v[88:91]
    v_exp_f32 v42, v42
    v_mfma_f32_16x16x32_bf16 v[88:91], a[136:139], v[232:235], v[88:91]
    v_exp_f32 v43, v43
    v_mfma_f32_16x16x32_bf16 v[88:91], a[140:143], v[236:239], v[88:91]
    v_exp_f32 v44, v44
    v_mfma_f32_16x16x32_bf16 v[68:71], a[144:147], v[176:179], v[136:139]
    v_exp_f32 v45, v45
    v_mfma_f32_16x16x32_bf16 v[68:71], a[148:151], v[180:183], v[68:71]
    v_exp_f32 v46, v46
    v_mfma_f32_16x16x32_bf16 v[68:71], a[152:155], v[184:187], v[68:71]
    ds_read_b128 a[224:227], v6 offset:12288
    ds_read_b128 a[228:231], v6 offset:13312
    v_mfma_f32_16x16x32_bf16 v[68:71], a[156:159], v[188:191], v[68:71]
    v_exp_f32 v47, v47
    v_mfma_f32_16x16x32_bf16 v[76:79], a[144:147], v[192:195], v[140:143]
    v_exp_f32 v48, v48
    v_mfma_f32_16x16x32_bf16 v[76:79], a[148:151], v[196:199], v[76:79]
    v_exp_f32 v49, v49
    v_mfma_f32_16x16x32_bf16 v[76:79], a[152:155], v[200:203], v[76:79]
    v_exp_f32 v50, v50
    v_mfma_f32_16x16x32_bf16 v[76:79], a[156:159], v[204:207], v[76:79]
    ds_read_b128 a[232:235], v6 offset:14336
    ds_read_b128 a[236:239], v6 offset:15360
    v_mfma_f32_16x16x32_bf16 v[84:87], a[144:147], v[208:211], v[168:171]
    v_exp_f32 v51, v51
    v_mfma_f32_16x16x32_bf16 v[84:87], a[148:151], v[212:215], v[84:87]
    v_cvt_pk_bf16_f32 v96, v32, v33
    v_cvt_pk_bf16_f32 v97, v34, v35
    v_mfma_f32_16x16x32_bf16 v[84:87], a[152:155], v[216:219], v[84:87]
    v_exp_f32 v52, v52
    v_mfma_f32_16x16x32_bf16 v[84:87], a[156:159], v[220:223], v[84:87]
    ds_read_b32 v21, v23
    v_cvt_pk_bf16_f32 v98, v36, v37
    v_mfma_f32_16x16x32_bf16 v[92:95], a[144:147], v[224:227], v[172:175]
    v_exp_f32 v53, v53
    v_mfma_f32_16x16x32_bf16 v[92:95], a[148:151], v[228:231], v[92:95]
    v_add_u32 v6, s97, v2
    v_cvt_pk_bf16_f32 v99, v38, v39
    v_mfma_f32_16x16x32_bf16 v[92:95], a[152:155], v[232:235], v[92:95]
    v_exp_f32 v54, v54
    v_mfma_f32_16x16x32_bf16 v[92:95], a[156:159], v[236:239], v[92:95]
    v_cvt_pk_bf16_f32 v100, v40, v41
    v_cvt_pk_bf16_f32 v101, v42, v43
    s_waitcnt lgkmcnt(0)
    v_mfma_f32_16x16x32_bf16 a[0:3], a[208:211], v[112:115], a[0:3]
    v_cmp_lt_u32 vcc, v21, v20
    v_mfma_f32_16x16x32_bf16 a[32:35], a[208:211], v[116:119], a[32:35]
    s_cbranch_vccnz L_sb10_s
L_sb10:
    v_mfma_f32_16x16x32_bf16 a[64:67], a[208:211], v[120:123], a[64:67]
    v_exp_f32 v55, v55
    v_mfma_f32_16x16x32_bf16 a[96:99], a[208:211], v[124:127], a[96:99]
    s_add_u32 m0, s54, s100
    s_add_u32 s100, s100, 16384
    v_mfma_f32_16x16x32_bf16 a[100:103], a[212:215], v[124:127], a[100:103]
    v_exp_f32 v56, v56
    v_mfma_f32_16x16x32_bf16 a[68:71], a[212:215], v[120:123], a[68:71]
    ds_read_b128 a[128:131], v5 offset:0
    ds_read_b128 a[132:135], v5 offset:1024
    v_mfma_f32_16x16x32_bf16 a[36:39], a[212:215], v[116:119], a[36:39]
    buffer_load_dwordx4 v2, s[28:31], s99 offen offset:0 sc1 lds
    v_mfma_f32_16x16x32_bf16 a[4:7], a[212:215], v[112:115], a[4:7]
    v_exp_f32 v57, v57
    v_mfma_f32_16x16x32_bf16 a[192:195], v[28:31], v[112:115], a[192:195]
    ds_read_b128 a[136:139], v5 offset:2048
    ds_read_b128 a[140:143], v5 offset:3072
    v_mfma_f32_16x16x32_bf16 a[8:11], a[216:219], v[112:115], a[8:11]
    v_exp_f32 v58, v58
    v_mfma_f32_16x16x32_bf16 a[40:43], a[216:219], v[116:119], a[40:43]
    s_add_u32 s97, s97, 16384
    ds_read_b128 a[144:147], v5 offset:4096
    v_mfma_f32_16x16x32_bf16 a[72:75], a[216:219], v[120:123], a[72:75]
    v_exp_f32 v59, v59
    v_mfma_f32_16x16x32_bf16 a[104:107], a[216:219], v[124:127], a[104:107]
    ds_read_b128 a[148:151], v5 offset:5120
    v_cvt_pk_bf16_f32 v102, v44, v45
    v_mfma_f32_16x16x32_bf16 a[108:111], a[220:223], v[124:127], a[108:111]
    v_exp_f32 v60, v60
    v_mfma_f32_16x16x32_bf16 a[76:79], a[220:223], v[120:123], a[76:79]
    buffer_load_dwordx4 v2, s[28:31], s99 offen offset:1024 sc1 lds
    v_mfma_f32_16x16x32_bf16 a[44:47], a[220:223], v[116:119], a[44:47]
    ds_read_b128 a[152:155], v5 offset:6144
    v_cvt_pk_bf16_f32 v103, v46, v47
    v_mfma_f32_16x16x32_bf16 a[12:15], a[220:223], v[112:115], a[12:15]
    v_exp_f32 v61, v61
    v_mfma_f32_16x16x32_bf16 a[196:199], v[28:31], v[116:119], a[196:199]
    ds_read_b128 a[156:159], v5 offset:7168
    v_cvt_pk_bf16_f32 v104, v48, v49
    v_mfma_f32_16x16x32_bf16 a[16:19], a[224:227], v[112:115], a[16:19]
    v_exp_f32 v62, v62
    v_mfma_f32_16x16x32_bf16 a[48:51], a[224:227], v[116:119], a[48:51]
    s_and_b32 s97, s97, 0xffff
    v_cvt_pk_bf16_f32 v105, v50, v51
    v_mfma_f32_16x16x32_bf16 a[80:83], a[224:227], v[120:123], a[80:83]
    v_exp_f32 v63, v63
    v_mfma_f32_16x16x32_bf16 a[112:115], a[224:227], v[124:127], a[112:115]
    v_cvt_pk_bf16_f32 v106, v52, v53
    v_cvt_pk_bf16_f32 v107, v54, v55
    v_mfma_f32_16x16x32_bf16 a[116:119], a[228:231], v[124:127], a[116:119]
    buffer_load_dwordx4 v2, s[28:31], s99 offen offset:2048 sc1 lds
    v_mfma_f32_16x16x32_bf16 a[84:87], a[228:231], v[120:123], a[84:87]
    v_cvt_pk_bf16_f32 v108, v56, v57
    v_cvt_pk_bf16_f32 v109, v58, v59
    v_mfma_f32_16x16x32_bf16 a[52:55], a[228:231], v[116:119], a[52:55]
    v_cvt_pk_bf16_f32 v110, v60, v61
    v_cvt_pk_bf16_f32 v111, v62, v63
    v_mfma_f32_16x16x32_bf16 a[20:23], a[228:231], v[112:115], a[20:23]
    v_mfma_f32_16x16x32_bf16 a[200:203], v[28:31], v[120:123], a[200:203]
    v_mfma_f32_16x16x32_bf16 a[24:27], a[232:235], v[112:115], a[24:27]
    v_mfma_f32_16x16x32_bf16 a[56:59], a[232:235], v[116:119], a[56:59]
    v_mfma_f32_16x16x32_bf16 a[88:91], a[232:235], v[120:123], a[88:91]
    v_mfma_f32_16x16x32_bf16 a[120:123], a[232:235], v[124:127], a[120:123]
    buffer_load_dwordx4 v2, s[28:31], s99 offen offset:3072 sc1 lds
    v_mfma_f32_16x16x32_bf16 a[124:127], a[236:239], v[124:127], a[124:127]
    s_add_u32 s99, s99, 16384
    s_and_b32 s100, s100, 0xffff
    v_mfma_f32_16x16x32_bf16 a[92:95], a[236:239], v[120:123], a[92:95]
    v_mfma_f32_16x16x32_bf16 a[60:63], a[236:239], v[116:119], a[60:63]
    v_mfma_f32_16x16x32_bf16 a[28:31], a[236:239], v[112:115], a[28:31]
    v_mfma_f32_16x16x32_bf16 a[204:207], v[28:31], v[124:127], a[204:207]
    s_add_u32 s98, s98, 1
    s_cmp_eq_u32 s98, s92
    s_waitcnt lgkmcnt(0)
    s_cbranch_scc1 L_ev11_h
L_ev11:
    v_mfma_f32_16x16x32_bf16 v[32:35], a[128:131], v[176:179], v[128:131]
    v_exp_f32 v64, v64
    v_mfma_f32_16x16x32_bf16 v[32:35], a[132:135], v[180:183], v[32:35]
    v_exp_f32 v65, v65
    v_mfma_f32_16x16x32_bf16 v[32:35], a[136:139], v[184:187], v[32:35]
    v_exp_f32 v66, v66
    v_mfma_f32_16x16x32_bf16 v[32:35], a[140:143], v[188:191], v[32:35]
    v_exp_f32 v67, v67
    v_mfma_f32_16x16x32_bf16 v[40:43], a[128:131], v[192:195], v[132:135]
    v_exp_f32 v68, v68
    v_mfma_f32_16x16x32_bf16 v[40:43], a[132:135], v[196:199], v[40:43]
    v_exp_f32 v69, v69
    v_mfma_f32_16x16x32_bf16 v[40:43], a[136:139], v[200:203], v[40:43]
    ds_read_b128 a[208:211], v6 offset:0
    s_add_u32 m0, s55, s3
    v_mfma_f32_16x16x32_bf16 v[40:43], a[140:143], v[204:207], v[40:43]
    v_exp_f32 v70, v70
    v_mfma_f32_16x16x32_bf16 v[48:51], a[128:131], v[208:211], v[160:163]
    s_add_u32 s3, s3, 16384
    ds_read_b128 a[212:215], v6 offset:1024
    v_mfma_f32_16x16x32_bf16 v[48:51], a[132:135], v[212:215], v[48:51]
    buffer_load_dwordx4 v2, s[32:35], s101 offen offset:0 sc1 lds
    v_mfma_f32_16x16x32_bf16 v[48:51], a[136:139], v[216:219], v[48:51]
    v_exp_f32 v71, v71
    v_mfma_f32_16x16x32_bf16 v[48:51], a[140:143], v[220:223], v[48:51]
    v_exp_f32 v72, v72
    v_mfma_f32_16x16x32_bf16 v[56:59], a[128:131], v[224:227], v[164:167]
    ds_read_b128 a[216:219], v6 offset:2048
    ds_read_b128 a[220:223], v6 offset:3072
    v_mfma_f32_16x16x32_bf16 v[56:59], a[132:135], v[228:231], v[56:59]
    v_exp_f32 v73, v73
    v_mfma_f32_16x16x32_bf16 v[56:59], a[136:139], v[232:235], v[56:59]
    v_exp_f32 v74, v74
    v_mfma_f32_16x16x32_bf16 v[56:59], a[140:143], v[236:239], v[56:59]
    v_exp_f32 v75, v75
    v_mfma_f32_16x16x32_bf16 v[36:39], a[144:147], v[176:179], v[136:139]
    v_exp_f32 v76, v76
    v_mfma_f32_16x16x32_bf16 v[36:39], a[148:151], v[180:183], v[36:39]
    v_exp_f32 v77, v77
    v_mfma_f32_16x16x32_bf16 v[36:39], a[152:155], v[184:187], v[36:39]
    ds_read_b128 a[224:227], v6 offset:4096
    ds_read_b128 a[228:231], v6 offset:5120
    v_mfma_f32_16x16x32_bf16 v[36:39], a[156:159], v[188:191], v[36:39]
    v_exp_f32 v78, v78
    v_mfma_f32_16x16x32_bf16 v[44:47], a[144:147], v[192:195], v[140:143]
    v_exp_f32 v79, v79
    v_mfma_f32_16x16x32_bf16 v[44:47], a[148:151], v[196:199], v[44:47]
    v_exp_f32 v80, v80
    v_mfma_f32_16x16x32_bf16 v[44:47], a[152:155], v[200:203], v[44:47]
    v_exp_f32 v81, v81
    v_mfma_f32_16x16x32_bf16 v[44:47], a[156:159], v[204:207], v[44:47]
    v_exp_f32 v82, v82
    v_mfma_f32_16x16x32_bf16 v[52:55], a[144:147], v[208:211], v[168:171]
    ds_read_b128 a[232:235], v6 offset:6144
    ds_read_b128 a[236:239], v6 offset:7168
    v_mfma_f32_16x16x32_bf16 v[52:55], a[148:151], v[212:215], v[52:55]
    buffer_load_dwordx4 v2, s[32:35], s101 offen offset:1024 sc1 lds
    v_mfma_f32_16x16x32_bf16 v[52:55], a[152:155], v[216:219], v[52:55]
    v_exp_f32 v83, v83
    v_mfma_f32_16x16x32_bf16 v[52:55], a[156:159], v[220:223], v[52:55]
    v_exp_f32 v84, v84
    v_mfma_f32_16x16x32_bf16 v[60:63], a[144:147], v[224:227], v[172:175]
    s_add_u32 s51, s96, 98304
    v_cvt_pk_bf16_f32 v112, v64, v65
    v_mfma_f32_16x16x32_bf16 v[60:63], a[148:151], v[228:231], v[60:63]
    v_exp_f32 v85, v85
    v_mfma_f32_16x16x32_bf16 v[60:63], a[152:155], v[232:235], v[60:63]
    v_cvt_pk_bf16_f32 v113, v66, v67
    v_cvt_pk_bf16_f32 v114, v68, v69
    v_mfma_f32_16x16x32_bf16 v[60:63], a[156:159], v[236:239], v[60:63]
    v_exp_f32 v86, v86
    s_waitcnt lgkmcnt(0)
    v_mfma_f32_16x16x32_bf16 a[0:3], a[208:211], v[96:99], a[0:3]
    ds_read_b128 a[128:131], v5 offset:8192
    ds_read_b128 a[132:135], v5 offset:9216
    v_mfma_f32_16x16x32_bf16 a[32:35], a[208:211], v[100:103], a[32:35]
    v_exp_f32 v87, v87
    v_mfma_f32_16x16x32_bf16 a[64:67], a[208:211], v[104:107], a[64:67]
    ds_read_b128 a[136:139], v5 offset:10240
    v_cvt_pk_bf16_f32 v115, v70, v71
    v_mfma_f32_16x16x32_bf16 a[96:99], a[208:211], v[108:111], a[96:99]
    v_exp_f32 v88, v88
    v_mfma_f32_16x16x32_bf16 a[100:103], a[212:215], v[108:111], a[100:103]
    ds_read_b128 a[140:143], v5 offset:11264
    v_cvt_pk_bf16_f32 v116, v72, v73
    v_mfma_f32_16x16x32_bf16 a[68:71], a[212:215], v[104:107], a[68:71]
    v_exp_f32 v89, v89
    v_mfma_f32_16x16x32_bf16 a[36:39], a[212:215], v[100:103], a[36:39]
    ds_read_b128 a[144:147], v5 offset:12288
    v_cvt_pk_bf16_f32 v117, v74, v75
    v_mfma_f32_16x16x32_bf16 a[4:7], a[212:215], v[96:99], a[4:7]
    v_exp_f32 v90, v90
    v_mfma_f32_16x16x32_bf16 a[192:195], v[28:31], v[96:99], a[192:195]
    ds_read_b128 a[148:151], v5 offset:13312
    v_cvt_pk_bf16_f32 v118, v76, v77
    v_mfma_f32_16x16x32_bf16 a[8:11], a[216:219], v[96:99], a[8:11]
    buffer_load_dwordx4 v2, s[32:35], s101 offen offset:2048 sc1 lds
    v_mfma_f32_16x16x32_bf16 a[40:43], a[216:219], v[100:103], a[40:43]
    v_exp_f32 v91, v91
    v_mfma_f32_16x16x32_bf16 a[72:75], a[216:219], v[104:107], a[72:75]
    s_add_u32 s96, s96, 16384
    v_cvt_pk_bf16_f32 v119, v78, v79
    v_mfma_f32_16x16x32_bf16 a[104:107], a[216:219], v[108:111], a[104:107]
    v_exp_f32 v92, v92
    v_mfma_f32_16x16x32_bf16 a[108:111], a[220:223], v[108:111], a[108:111]
    ds_read_b128 a[152:155], v5 offset:14336
    v_cvt_pk_bf16_f32 v120, v80, v81
    v_mfma_f32_16x16x32_bf16 a[76:79], a[220:223], v[104:107], a[76:79]
    v_exp_f32 v93, v93
    v_mfma_f32_16x16x32_bf16 a[44:47], a[220:223], v[100:103], a[44:47]
    ds_read_b128 a[156:159], v5 offset:15360
    v_cvt_pk_bf16_f32 v121, v82, v83
    v_mfma_f32_16x16x32_bf16 a[12:15], a[220:223], v[96:99], a[12:15]
    v_exp_f32 v94, v94
    v_mfma_f32_16x16x32_bf16 a[196:199], v[28:31], v[100:103], a[196:199]
    v_cvt_pk_bf16_f32 v122, v84, v85
    v_cvt_pk_bf16_f32 v123, v86, v87
    v_mfma_f32_16x16x32_bf16 a[16:19], a[224:227], v[96:99], a[16:19]
    v_exp_f32 v95, v95
    v_mfma_f32_16x16x32_bf16 a[48:51], a[224:227], v[100:103], a[48:51]
    s_and_b32 s96, s96, 0xffff
    v_cvt_pk_bf16_f32 v124, v88, v89
    v_mfma_f32_16x16x32_bf16 a[80:83], a[224:227], v[104:107], a[80:83]
    v_cvt_pk_bf16_f32 v125, v90, v91
    v_cvt_pk_bf16_f32 v126, v92, v93
    v_mfma_f32_16x16x32_bf16 a[112:115], a[224:227], v[108:111], a[112:115]
    v_cvt_pk_bf16_f32 v127, v94, v95
    v_mfma_f32_16x16x32_bf16 a[116:119], a[228:231], v[108:111], a[116:119]
    v_mfma_f32_16x16x32_bf16 a[84:87], a[228:231], v[104:107], a[84:87]
    v_mfma_f32_16x16x32_bf16 a[52:55], a[228:231], v[100:103], a[52:55]
    v_mfma_f32_16x16x32_bf16 a[20:23], a[228:231], v[96:99], a[20:23]
    buffer_load_dwordx4 v2, s[32:35], s101 offen offset:3072 sc1 lds
    v_mfma_f32_16x16x32_bf16 a[200:203], v[28:31], v[104:107], a[200:203]
    s_add_u32 s101, s101, 16384
    s_and_b32 s3, s3, 0xffff
    v_mfma_f32_16x16x32_bf16 a[24:27], a[232:235], v[96:99], a[24:27]
    v_mfma_f32_16x16x32_bf16 a[56:59], a[232:235], v[100:103], a[56:59]
    v_mfma_f32_16x16x32_bf16 a[88:91], a[232:235], v[104:107], a[88:91]
    v_mfma_f32_16x16x32_bf16 a[120:123], a[232:235], v[108:111], a[120:123]
    v_mfma_f32_16x16x32_bf16 a[124:127], a[236:239], v[108:111], a[124:127]
    v_add_u32 v5, s51, v2
    v_mfma_f32_16x16x32_bf16 a[92:95], a[236:239], v[104:107], a[92:95]
    v_mfma_f32_16x16x32_bf16 a[60:63], a[236:239], v[100:103], a[60:63]
    v_mfma_f32_16x16x32_bf16 a[28:31], a[236:239], v[96:99], a[28:31]
    v_mfma_f32_16x16x32_bf16 a[204:207], v[28:31], v[108:111], a[204:207]
    s_sub_u32 s53, s53, 1
    s_cmp_lg_u32 s53, 0
    s_cbranch_scc1 L_loopA1
L_endA:
    s_cmp_eq_u32 s50, 7
    s_cbranch_scc0 L_nopa1
    s_add_u32 m0, s73, 4096
    s_add_u32 s52, s74, 4291297280
    buffer_load_dwordx4 v13, s[44:47], s52 offen lds
    s_add_u32 m0, s73, 5120
    s_add_u32 s52, s74, 4291305472
    buffer_load_dwordx4 v13, s[44:47], s52 offen lds
    s_add_u32 m0, s73, 6144
    s_add_u32 s52, s74, 4291313664
    buffer_load_dwordx4 v13, s[44:47], s52 offen lds
    s_add_u32 m0, s73, 7168
    s_add_u32 s52, s74, 4291321856
    buffer_load_dwordx4 v13, s[44:47], s52 offen lds
L_nopa1:
    s_add_u32 s98, s98, 1
    s_cmp_eq_u32 s98, s92
    s_waitcnt vmcnt(8) lgkmcnt(0)
    s_barrier
    s_cbranch_scc1 L_ev12_h
L_ev12:
    v_mfma_f32_16x16x32_bf16 v[64:67], a[128:131], v[176:179], v[128:131]
    v_exp_f32 v32, v32
    v_mfma_f32_16x16x32_bf16 v[64:67], a[132:135], v[180:183], v[64:67]
    v_exp_f32 v33, v33
    v_mfma_f32_16x16x32_bf16 v[64:67], a[136:139], v[184:187], v[64:67]
    v_exp_f32 v34, v34
    v_mfma_f32_16x16x32_bf16 v[64:67], a[140:143], v[188:191], v[64:67]
    s_add_u32 m0, s54, s100
    s_add_u32 s100, s100, 16384
    v_mfma_f32_16x16x32_bf16 v[72:75], a[128:131], v[192:195], v[132:135]
    buffer_load_dwordx4 v2, s[28:31], s99 offen offset:0 sc1 lds
    v_mfma_f32_16x16x32_bf16 v[72:75], a[132:135], v[196:199], v[72:75]
    v_exp_f32 v35, v35
    v_mfma_f32_16x16x32_bf16 v[72:75], a[136:139], v[200:203], v[72:75]
    ds_read_b128 a[208:211], v6 offset:8192
    ds_read_b128 a[212:215], v6 offset:9216
    v_mfma_f32_16x16x32_bf16 v[72:75], a[140:143], v[204:207], v[72:75]
    v_exp_f32 v36, v36
    v_mfma_f32_16x16x32_bf16 v[80:83], a[128:131], v[208:211], v[160:163]
    v_exp_f32 v37, v37
    v_mfma_f32_16x16x32_bf16 v[80:83], a[132:135], v[212:215], v[80:83]
    v_exp_f32 v38, v38
    v_mfma_f32_16x16x32_bf16 v[80:83], a[136:139], v[216:219], v[80:83]
    v_exp_f32 v39, v39
    v_mfma_f32_16x16x32_bf16 v[80:83], a[140:143], v[220:223], v[80:83]
    buffer_load_dwordx4 v2, s[28:31], s99 offen offset:1024 sc1 lds
    v_mfma_f32_16x16x32_bf16 v[88:91], a[128:131], v[224:227], v[164:167]
    ds_read_b128 a[216:219], v6 offset:10240
    ds_read_b128 a[220:223], v6 offset:11264
    v_mfma_f32_16x16x32_bf16 v[88:91], a[132:135], v[228:231], v[88:91]
    v_exp_f32 v40, v40
    v_mfma_f32_16x16x32_bf16 v[88:91], a[136:139], v[232:235], v[88:91]
    ds_read_b128 a[224:227], v6 offset:12288
    ds_read_b128 a[228:231], v6 offset:13312
    v_mfma_f32_16x16x32_bf16 v[88:91], a[140:143], v[236:239], v[88:91]
    v_exp_f32 v41, v41
    v_mfma_f32_16x16x32_bf16 v[68:71], a[144:147], v[176:179], v[136:139]
    ds_read_b128 a[232:235], v6 offset:14336
    ds_read_b128 a[236:239], v6 offset:15360
    v_mfma_f32_16x16x32_bf16 v[68:71], a[148:151], v[180:183], v[68:71]
    v_exp_f32 v42, v42
    v_mfma_f32_16x16x32_bf16 v[68:71], a[152:155], v[184:187], v[68:71]
    v_cvt_pk_bf16_f32 v96, v32, v33
    v_cvt_pk_bf16_f32 v97, v34, v35
    v_mfma_f32_16x16x32_bf16 v[68:71], a[156:159], v[188:191], v[68:71]
    buffer_load_dwordx4 v2, s[28:31], s99 offen offset:2048 sc1 lds
    v_mfma_f32_16x16x32_bf16 v[76:79], a[144:147], v[192:195], v[140:143]
    v_exp_f32 v43, v43
    v_mfma_f32_16x16x32_bf16 v[76:79], a[148:151], v[196:199], v[76:79]
    s_add_u32 s51, s96, 98304
    v_cvt_pk_bf16_f32 v98, v36, v37
    v_mfma_f32_16x16x32_bf16 v[76:79], a[152:155], v[200:203], v[76:79]
    v_exp_f32 v44, v44
    v_mfma_f32_16x16x32_bf16 v[76:79], a[156:159], v[204:207], v[76:79]
    v_cvt_pk_bf16_f32 v99, v38, v39
    v_cvt_pk_bf16_f32 v100, v40, v41
    v_mfma_f32_16x16x32_bf16 v[84:87], a[144:147], v[208:211], v[168:171]
    v_exp_f32 v45, v45
    v_mfma_f32_16x16x32_bf16 v[84:87], a[148:151], v[212:215], v[84:87]
    v_cvt_pk_bf16_f32 v101, v42, v43
    v_cvt_pk_bf16_f32 v102, v44, v45
    v_mfma_f32_16x16x32_bf16 v[84:87], a[152:155], v[216:219], v[84:87]
    buffer_load_dwordx4 v2, s[28:31], s99 offen offset:3072 sc1 lds
    v_mfma_f32_16x16x32_bf16 v[84:87], a[156:159], v[220:223], v[84:87]
    v_exp_f32 v46, v46
    v_mfma_f32_16x16x32_bf16 v[92:95], a[144:147], v[224:227], v[172:175]
    s_add_u32 s99, s99, 16384
    s_and_b32 s100, s100, 0xffff
    v_mfma_f32_16x16x32_bf16 v[92:95], a[148:151], v[228:231], v[92:95]
    v_exp_f32 v47, v47
    v_mfma_f32_16x16x32_bf16 v[92:95], a[152:155], v[232:235], v[92:95]
    s_add_u32 m0, s73, 0
    s_add_u32 s52, s74, 0
    v_mfma_f32_16x16x32_bf16 v[92:95], a[156:159], v[236:239], v[92:95]
    v_exp_f32 v48, v48
    s_waitcnt lgkmcnt(0)
    v_mfma_f32_16x16x32_bf16 a[0:3], a[208:211], v[112:115], a[0:3]
    ds_read_b128 a[128:131], v5 offset:0
    ds_read_b128 a[132:135], v5 offset:1024
    v_mfma_f32_16x16x32_bf16 a[32:35], a[208:211], v[116:119], a[32:35]
    v_exp_f32 v49, v49
    v_mfma_f32_16x16x32_bf16 a[64:67], a[208:211], v[120:123], a[64:67]
    ds_read_b128 a[136:139], v5 offset:2048
    v_add_u32 v6, s97, v2
    v_mfma_f32_16x16x32_bf16 a[96:99], a[208:211], v[124:127], a[96:99]
    v_exp_f32 v50, v50
    v_mfma_f32_16x16x32_bf16 a[100:103], a[212:215], v[124:127], a[100:103]
    ds_read_b128 a[140:143], v5 offset:3072
    ds_read_b128 a[144:147], v5 offset:4096
    v_mfma_f32_16x16x32_bf16 a[68:71], a[212:215], v[120:123], a[68:71]
    v_exp_f32 v51, v51
    v_mfma_f32_16x16x32_bf16 a[36:39], a[212:215], v[116:119], a[36:39]
    ds_read_b128 a[148:151], v5 offset:5120
    ds_read_b128 a[152:155], v5 offset:6144
    v_mfma_f32_16x16x32_bf16 a[4:7], a[212:215], v[112:115], a[4:7]
    v_exp_f32 v52, v52
    v_mfma_f32_16x16x32_bf16 a[192:195], v[28:31], v[112:115], a[192:195]
    buffer_load_dwordx4 v13, s[40:43], s52 offen lds
    v_mfma_f32_16x16x32_bf16 a[8:11], a[216:219], v[112:115], a[8:11]
    s_add_u32 m0, s73, 1024
    s_add_u32 s52, s74, 8192
    v_mfma_f32_16x16x32_bf16 a[40:43], a[216:219], v[116:119], a[40:43]
    v_exp_f32 v53, v53
    v_mfma_f32_16x16x32_bf16 a[72:75], a[216:219], v[120:123], a[72:75]
    ds_read_b128 a[156:159], v5 offset:7168
    ds_read_b128 a[160:163], v5 offset:8192
    v_mfma_f32_16x16x32_bf16 a[104:107], a[216:219], v[124:127], a[104:107]
    v_exp_f32 v54, v54
    v_mfma_f32_16x16x32_bf16 a[108:111], a[220:223], v[124:127], a[108:111]
    s_add_u32 s97, s97, 16384
    s_add_u32 s96, s96, 16384
    v_mfma_f32_16x16x32_bf16 a[76:79], a[220:223], v[120:123], a[76:79]
    v_exp_f32 v55, v55
    v_mfma_f32_16x16x32_bf16 a[44:47], a[220:223], v[116:119], a[44:47]
    buffer_load_dwordx4 v13, s[40:43], s52 offen lds
    v_mfma_f32_16x16x32_bf16 a[12:15], a[220:223], v[112:115], a[12:15]
    ds_read_b128 a[164:167], v5 offset:9216
    ds_read_b128 a[168:171], v5 offset:10240
    v_mfma_f32_16x16x32_bf16 a[196:199], v[28:31], v[116:119], a[196:199]
    v_exp_f32 v56, v56
    v_mfma_f32_16x16x32_bf16 a[16:19], a[224:227], v[112:115], a[16:19]
    s_add_u32 m0, s73, 2048
    s_add_u32 s52, s74, 16384
    v_mfma_f32_16x16x32_bf16 a[48:51], a[224:227], v[116:119], a[48:51]
    v_exp_f32 v57, v57
    v_mfma_f32_16x16x32_bf16 a[80:83], a[224:227], v[120:123], a[80:83]
    ds_read_b128 a[172:175], v5 offset:11264
    ds_read_b128 a[176:179], v5 offset:12288
    v_mfma_f32_16x16x32_bf16 a[112:115], a[224:227], v[124:127], a[112:115]
    v_exp_f32 v58, v58
    v_mfma_f32_16x16x32_bf16 a[116:119], a[228:231], v[124:127], a[116:119]
    ds_read_b128 a[180:183], v5 offset:13312
    ds_read_b128 a[184:187], v5 offset:14336
    v_mfma_f32_16x16x32_bf16 a[84:87], a[228:231], v[120:123], a[84:87]
    buffer_load_dwordx4 v13, s[40:43], s52 offen lds
    v_mfma_f32_16x16x32_bf16 a[52:55], a[228:231], v[116:119], a[52:55]
    v_exp_f32 v59, v59
    v_mfma_f32_16x16x32_bf16 a[20:23], a[228:231], v[112:115], a[20:23]
    s_and_b32 s97, s97, 0xffff
    s_and_b32 s96, s96, 0xffff
    v_mfma_f32_16x16x32_bf16 a[200:203], v[28:31], v[120:123], a[200:203]
    v_exp_f32 v60, v60
    v_mfma_f32_16x16x32_bf16 a[24:27], a[232:235], v[112:115], a[24:27]
    s_add_u32 m0, s73, 3072
    s_add_u32 s52, s74, 24576
    v_mfma_f32_16x16x32_bf16 a[56:59], a[232:235], v[116:119], a[56:59]
    v_exp_f32 v61, v61
    v_mfma_f32_16x16x32_bf16 a[88:91], a[232:235], v[120:123], a[88:91]
    ds_read_b128 a[188:191], v5 offset:15360
    v_cvt_pk_bf16_f32 v103, v46, v47
    v_mfma_f32_16x16x32_bf16 a[120:123], a[232:235], v[124:127], a[120:123]
    buffer_load_dwordx4 v13, s[40:43], s52 offen lds
    v_mfma_f32_16x16x32_bf16 a[124:127], a[236:239], v[124:127], a[124:127]
    v_exp_f32 v62, v62
    v_mfma_f32_16x16x32_bf16 a[92:95], a[236:239], v[120:123], a[92:95]
    v_add_u32 v5, s51, v2
    v_cvt_pk_bf16_f32 v104, v48, v49
    v_mfma_f32_16x16x32_bf16 a[60:63], a[236:239], v[116:119], a[60:63]
    v_exp_f32 v63, v63
    v_mfma_f32_16x16x32_bf16 a[28:31], a[236:239], v[112:115], a[28:31]
    v_cvt_pk_bf16_f32 v105, v50, v51
    v_cvt_pk_bf16_f32 v106, v52, v53
    v_mfma_f32_16x16x32_bf16 a[204:207], v[28:31], v[124:127], a[204:207]
    v_cvt_pk_bf16_f32 v107, v54, v55
    v_cvt_pk_bf16_f32 v108, v56, v57
    v_cvt_pk_bf16_f32 v109, v58, v59
    v_cvt_pk_bf16_f32 v110, v60, v61
    v_cvt_pk_bf16_f32 v111, v62, v63
    s_add_u32 s98, s98, 1
    s_cmp_eq_u32 s98, s92
    s_waitcnt vmcnt(12) lgkmcnt(0)
    s_barrier
    s_cbranch_scc1 L_ev14_h
L_ev14:
    v_mfma_f32_16x16x32_bf16 v[32:35], a[128:131], v[176:179], v[128:131]
    v_exp_f32 v64, v64
    v_mfma_f32_16x16x32_bf16 v[32:35], a[132:135], v[180:183], v[32:35]
    s_add_u32 m0, s54, s100
    s_add_u32 s100, s100, 16384
    v_mfma_f32_16x16x32_bf16 v[32:35], a[136:139], v[184:187], v[32:35]
    buffer_load_dwordx4 v2, s[28:31], s99 offen offset:0 sc1 lds
    v_mfma_f32_16x16x32_bf16 v[32:35], a[140:143], v[188:191], v[32:35]
    v_exp_f32 v65, v65
    v_mfma_f32_16x16x32_bf16 v[40:43], a[128:131], v[192:195], v[132:135]
    v_exp_f32 v66, v66
    v_mfma_f32_16x16x32_bf16 v[40:43], a[132:135], v[196:199], v[40:43]
    ds_read_b128 a[208:211], v6 offset:0
    ds_read_b128 a[212:215], v6 offset:1024
    v_mfma_f32_16x16x32_bf16 v[40:43], a[136:139], v[200:203], v[40:43]
    buffer_load_dwordx4 v2, s[28:31], s99 offen offset:1024 sc1 lds
    v_mfma_f32_16x16x32_bf16 v[40:43], a[140:143], v[204:207], v[40:43]
    v_exp_f32 v67, v67
    v_mfma_f32_16x16x32_bf16 v[36:39], a[144:147], v[176:179], v[136:139]
    v_exp_f32 v68, v68
    v_mfma_f32_16x16x32_bf16 v[36:39], a[148:151], v[180:183], v[36:39]
    ds_read_b128 a[216:219], v6 offset:2048
    ds_read_b128 a[220:223], v6 offset:3072
    v_mfma_f32_16x16x32_bf16 v[36:39], a[152:155], v[184:187], v[36:39]
    buffer_load_dwordx4 v2, s[28:31], s99 offen offset:2048 sc1 lds
    v_mfma_f32_16x16x32_bf16 v[36:39], a[156:159], v[188:191], v[36:39]
    v_exp_f32 v69, v69
    v_mfma_f32_16x16x32_bf16 v[44:47], a[144:147], v[192:195], v[140:143]
    ds_read_b128 a[224:227], v6 offset:4096
    ds_read_b128 a[228:231], v6 offset:5120
    v_mfma_f32_16x16x32_bf16 v[44:47], a[148:151], v[196:199], v[44:47]
    v_exp_f32 v70, v70
    v_mfma_f32_16x16x32_bf16 v[44:47], a[152:155], v[200:203], v[44:47]
    buffer_load_dwordx4 v2, s[28:31], s99 offen offset:3072 sc1 lds
    v_mfma_f32_16x16x32_bf16 v[44:47], a[156:159], v[204:207], v[44:47]
    s_add_u32 s99, s99, 16384
    s_and_b32 s100, s100, 0xffff
    v_mfma_f32_16x16x32_bf16 v[48:51], a[160:163], v[176:179], v[144:147]
    v_exp_f32 v71, v71
    v_mfma_f32_16x16x32_bf16 v[48:51], a[164:167], v[180:183], v[48:51]
    s_add_u32 m0, s55, s3
    s_add_u32 s3, s3, 16384
    v_mfma_f32_16x16x32_bf16 v[48:51], a[168:171], v[184:187], v[48:51]
    v_exp_f32 v72, v72
    v_mfma_f32_16x16x32_bf16 v[48:51], a[172:175], v[188:191], v[48:51]
    ds_read_b128 a[232:235], v6 offset:6144
    ds_read_b128 a[236:239], v6 offset:7168
    v_mfma_f32_16x16x32_bf16 v[56:59], a[160:163], v[192:195], v[148:151]
    v_exp_f32 v73, v73
    v_mfma_f32_16x16x32_bf16 v[56:59], a[164:167], v[196:199], v[56:59]
    s_add_u32 s51, s96, 98304
    v_cvt_pk_bf16_f32 v112, v64, v65
    v_mfma_f32_16x16x32_bf16 v[56:59], a[168:171], v[200:203], v[56:59]
    buffer_load_dwordx4 v2, s[32:35], s101 offen offset:0 sc1 lds
    v_mfma_f32_16x16x32_bf16 v[56:59], a[172:175], v[204:207], v[56:59]
    v_exp_f32 v74, v74
    v_mfma_f32_16x16x32_bf16 v[52:55], a[176:179], v[176:179], v[152:155]
    v_cvt_pk_bf16_f32 v113, v66, v67
    v_cvt_pk_bf16_f32 v114, v68, v69
    v_mfma_f32_16x16x32_bf16 v[52:55], a[180:183], v[180:183], v[52:55]
    buffer_load_dwordx4 v2, s[32:35], s101 offen offset:1024 sc1 lds
    v_mfma_f32_16x16x32_bf16 v[52:55], a[184:187], v[184:187], v[52:55]
    v_exp_f32 v75, v75
    v_mfma_f32_16x16x32_bf16 v[52:55], a[188:191], v[188:191], v[52:55]
    v_cvt_pk_bf16_f32 v115, v70, v71
    v_cvt_pk_bf16_f32 v116, v72, v73
    v_mfma_f32_16x16x32_bf16 v[60:63], a[176:179], v[192:195], v[156:159]
    v_exp_f32 v76, v76
    v_mfma_f32_16x16x32_bf16 v[60:63], a[180:183], v[196:199], v[60:63]
    buffer_load_dwordx4 v2, s[32:35], s101 offen offset:2048 sc1 lds
    v_mfma_f32_16x16x32_bf16 v[60:63], a[184:187], v[200:203], v[60:63]
    v_exp_f32 v77, v77
    v_mfma_f32_16x16x32_bf16 v[60:63], a[188:191], v[204:207], v[60:63]
    v_cvt_pk_bf16_f32 v117, v74, v75
    v_cvt_pk_bf16_f32 v118, v76, v77
    s_waitcnt lgkmcnt(0)
    v_mfma_f32_16x16x32_bf16 a[0:3], a[208:211], v[96:99], a[0:3]
    ds_read_b128 a[128:131], v5 offset:0
    ds_read_b128 a[132:135], v5 offset:1024
    v_mfma_f32_16x16x32_bf16 a[32:35], a[208:211], v[100:103], a[32:35]
    buffer_load_dwordx4 v2, s[32:35], s101 offen offset:3072 sc1 lds
    v_mfma_f32_16x16x32_bf16 a[64:67], a[208:211], v[104:107], a[64:67]
    v_exp_f32 v78, v78
    v_mfma_f32_16x16x32_bf16 a[96:99], a[208:211], v[108:111], a[96:99]
    s_add_u32 s101, s101, 16384
    s_and_b32 s3, s3, 0xffff
    v_mfma_f32_16x16x32_bf16 a[100:103], a[212:215], v[108:111], a[100:103]
    v_exp_f32 v79, v79
    v_mfma_f32_16x16x32_bf16 a[68:71], a[212:215], v[104:107], a[68:71]
    ds_read_b128 a[136:139], v5 offset:2048
    ds_read_b128 a[140:143], v5 offset:3072
    v_mfma_f32_16x16x32_bf16 a[36:39], a[212:215], v[100:103], a[36:39]
    v_exp_f32 v80, v80
    v_mfma_f32_16x16x32_bf16 a[4:7], a[212:215], v[96:99], a[4:7]
    ds_read_b128 a[144:147], v5 offset:4096
    s_getpc_b64 s[44:45]
L_pc13:
    v_mfma_f32_16x16x32_bf16 a[192:195], v[28:31], v[96:99], a[192:195]
    v_exp_f32 v81, v81
    v_mfma_f32_16x16x32_bf16 a[8:11], a[216:219], v[96:99], a[8:11]
    ds_read_b128 a[148:151], v5 offset:5120
    ds_read_b128 a[152:155], v5 offset:6144
    v_mfma_f32_16x16x32_bf16 a[40:43], a[216:219], v[100:103], a[40:43]
    v_exp_f32 v82, v82
    v_mfma_f32_16x16x32_bf16 a[72:75], a[216:219], v[104:107], a[72:75]
    s_add_u32 s44, s44, L_tail-L_pc13
    s_addc_u32 s45, s45, 0
    v_mfma_f32_16x16x32_bf16 a[104:107], a[216:219], v[108:111], a[104:107]
    v_exp_f32 v83, v83
    v_mfma_f32_16x16x32_bf16 a[108:111], a[220:223], v[108:111], a[108:111]
    ds_read_b128 a[156:159], v5 offset:7168
    ds_read_b128 a[160:163], v5 offset:8192
    v_mfma_f32_16x16x32_bf16 a[76:79], a[220:223], v[104:107], a[76:79]
    v_exp_f32 v84, v84
    v_mfma_f32_16x16x32_bf16 a[44:47], a[220:223], v[100:103], a[44:47]
    s_add_u32 s96, s96, 16384
    s_lshr_b32 s46, s2, 3
    s_lshl_b32 s46, s46, 2
    v_mfma_f32_16x16x32_bf16 a[12:15], a[220:223], v[96:99], a[12:15]
    v_exp_f32 v85, v85
    v_mfma_f32_16x16x32_bf16 a[196:199], v[28:31], v[100:103], a[196:199]
    v_exp_f32 v86, v86
    v_mfma_f32_16x16x32_bf16 a[16:19], a[224:227], v[96:99], a[16:19]
    ds_read_b128 a[164:167], v5 offset:9216
    ds_read_b128 a[168:171], v5 offset:10240
    v_mfma_f32_16x16x32_bf16 a[48:51], a[224:227], v[100:103], a[48:51]
    v_exp_f32 v87, v87
    v_mfma_f32_16x16x32_bf16 a[80:83], a[224:227], v[104:107], a[80:83]
    s_add_u32 s46, s46, s48
    s_sub_u32 s46, s46, 96
    s_and_b32 s46, s46, 0xfff
    s_lshl_b32 s46, s46, 10
    v_mfma_f32_16x16x32_bf16 a[112:115], a[224:227], v[108:111], a[112:115]
    v_exp_f32 v88, v88
    v_mfma_f32_16x16x32_bf16 a[116:119], a[228:231], v[108:111], a[116:119]
    v_exp_f32 v89, v89
    v_mfma_f32_16x16x32_bf16 a[84:87], a[228:231], v[104:107], a[84:87]
    ds_read_b128 a[172:175], v5 offset:11264
    ds_read_b128 a[176:179], v5 offset:12288
    v_mfma_f32_16x16x32_bf16 a[52:55], a[228:231], v[100:103], a[52:55]
    v_exp_f32 v90, v90
    v_mfma_f32_16x16x32_bf16 a[20:23], a[228:231], v[96:99], a[20:23]
    ds_read_b128 a[180:183], v5 offset:13312
    v_and_b32 v19, 7, v1
    v_lshlrev_b32 v19, 7, v19
    v_mfma_f32_16x16x32_bf16 a[200:203], v[28:31], v[104:107], a[200:203]
    v_exp_f32 v91, v91
    v_mfma_f32_16x16x32_bf16 a[24:27], a[232:235], v[96:99], a[24:27]
    ds_read_b128 a[184:187], v5 offset:14336
    s_and_b32 s96, s96, 0xffff
    v_mfma_f32_16x16x32_bf16 a[56:59], a[232:235], v[100:103], a[56:59]
    v_exp_f32 v92, v92
    v_mfma_f32_16x16x32_bf16 a[88:91], a[232:235], v[104:107], a[88:91]
    ds_read_b128 a[188:191], v5 offset:15360
    v_add_u32 v19, s46, v19
    v_min_u32 v19, L_end-L_tail-4, v19
    v_mfma_f32_16x16x32_bf16 a[120:123], a[232:235], v[108:111], a[120:123]
    v_exp_f32 v93, v93
    v_mfma_f32_16x16x32_bf16 a[124:127], a[236:239], v[108:111], a[124:127]
    v_exp_f32 v94, v94
    v_mfma_f32_16x16x32_bf16 a[92:95], a[236:239], v[104:107], a[92:95]
    global_load_dword v0, v19, s[44:45]
    v_mfma_f32_16x16x32_bf16 a[60:63], a[236:239], v[100:103], a[60:63]
    v_exp_f32 v95, v95
    v_mfma_f32_16x16x32_bf16 a[28:31], a[236:239], v[96:99], a[28:31]
    v_add_u32 v5, s51, v2
    v_cvt_pk_bf16_f32 v119, v78, v79
    v_mfma_f32_16x16x32_bf16 a[204:207], v[28:31], v[108:111], a[204:207]
    v_cvt_pk_bf16_f32 v120, v80, v81
    v_cvt_pk_bf16_f32 v121, v82, v83
    v_cvt_pk_bf16_f32 v122, v84, v85
    v_cvt_pk_bf16_f32 v123, v86, v87
    v_cvt_pk_bf16_f32 v124, v88, v89
    v_cvt_pk_bf16_f32 v125, v90, v91
    v_cvt_pk_bf16_f32 v126, v92, v93
    v_cvt_pk_bf16_f32 v127, v94, v95
    s_add_u32 s98, s98, 1
    s_cmp_eq_u32 s98, s92
    s_waitcnt vmcnt(9) lgkmcnt(0)
    s_barrier
    s_cbranch_scc1 L_ev15_h
L_ev15:
    v_mfma_f32_16x16x32_bf16 v[64:67], a[128:131], v[176:179], v[128:131]
    v_exp_f32 v32, v32
    v_mfma_f32_16x16x32_bf16 v[64:67], a[132:135], v[180:183], v[64:67]
    v_exp_f32 v33, v33
    v_mfma_f32_16x16x32_bf16 v[64:67], a[136:139], v[184:187], v[64:67]
    s_add_u32 m0, s55, s3
    s_add_u32 s3, s3, 16384
    v_mfma_f32_16x16x32_bf16 v[64:67], a[140:143], v[188:191], v[64:67]
    v_exp_f32 v34, v34
    v_mfma_f32_16x16x32_bf16 v[72:75], a[128:131], v[192:195], v[132:135]
    v_xor_b32 v13, 32, v12
    ds_read_b128 a[208:211], v6 offset:8192
    v_mfma_f32_16x16x32_bf16 v[72:75], a[132:135], v[196:199], v[72:75]
    buffer_load_dwordx4 v2, s[32:35], s101 offen offset:0 sc1 lds
    v_mfma_f32_16x16x32_bf16 v[72:75], a[136:139], v[200:203], v[72:75]
    v_exp_f32 v35, v35
    v_mfma_f32_16x16x32_bf16 v[72:75], a[140:143], v[204:207], v[72:75]
    v_xor_b32 v14, 64, v12
    ds_read_b128 a[212:215], v6 offset:9216
    v_mfma_f32_16x16x32_bf16 v[68:71], a[144:147], v[176:179], v[136:139]
    v_exp_f32 v36, v36
    v_mfma_f32_16x16x32_bf16 v[68:71], a[148:151], v[180:183], v[68:71]
    v_xor_b32 v15, 96, v12
    ds_read_b64_tr_b16 a[240:241], v12 offset:0
    v_mfma_f32_16x16x32_bf16 v[68:71], a[152:155], v[184:187], v[68:71]
    v_exp_f32 v37, v37
    v_mfma_f32_16x16x32_bf16 v[68:71], a[156:159], v[188:191], v[68:71]
    ds_read_b128 a[216:219], v6 offset:10240
    ds_read_b64_tr_b16 a[242:243], v12 offset:2048
    v_mfma_f32_16x16x32_bf16 v[76:79], a[144:147], v[192:195], v[140:143]
    v_exp_f32 v38, v38
    v_mfma_f32_16x16x32_bf16 v[76:79], a[148:151], v[196:199], v[76:79]
    buffer_load_dwordx4 v2, s[32:35], s101 offen offset:1024 sc1 lds
    v_mfma_f32_16x16x32_bf16 v[76:79], a[152:155], v[200:203], v[76:79]
    ds_read_b128 a[220:223], v6 offset:11264
    ds_read_b64_tr_b16 a[244:245], v13 offset:0
    v_mfma_f32_16x16x32_bf16 v[76:79], a[156:159], v[204:207], v[76:79]
    v_exp_f32 v39, v39
    v_mfma_f32_16x16x32_bf16 v[80:83], a[160:163], v[176:179], v[144:147]
    ds_read_b128 a[224:227], v6 offset:12288
    ds_read_b64_tr_b16 a[246:247], v13 offset:2048
    v_mfma_f32_16x16x32_bf16 v[80:83], a[164:167], v[180:183], v[80:83]
    v_exp_f32 v40, v40
    v_mfma_f32_16x16x32_bf16 v[80:83], a[168:171], v[184:187], v[80:83]
    ds_read_b128 a[228:231], v6 offset:13312
    ds_read_b64_tr_b16 a[248:249], v14 offset:0
    v_mfma_f32_16x16x32_bf16 v[80:83], a[172:175], v[188:191], v[80:83]
    v_exp_f32 v41, v41
    v_mfma_f32_16x16x32_bf16 v[88:91], a[160:163], v[192:195], v[148:151]
    ds_read_b64_tr_b16 a[250:251], v14 offset:2048
    ds_read_b128 a[232:235], v6 offset:14336
    v_mfma_f32_16x16x32_bf16 v[88:91], a[164:167], v[196:199], v[88:91]
    buffer_load_dwordx4 v2, s[32:35], s101 offen offset:2048 sc1 lds
    v_mfma_f32_16x16x32_bf16 v[88:91], a[168:171], v[200:203], v[88:91]
    v_exp_f32 v42, v42
    v_mfma_f32_16x16x32_bf16 v[88:91], a[172:175], v[204:207], v[88:91]
    ds_read_b64_tr_b16 a[252:253], v15 offset:0
    ds_read_b64_tr_b16 a[254:255], v15 offset:2048
    v_mfma_f32_16x16x32_bf16 v[84:87], a[176:179], v[176:179], v[152:155]
    v_exp_f32 v43, v43
    v_mfma_f32_16x16x32_bf16 v[84:87], a[180:183], v[180:183], v[84:87]
    ds_read_b128 a[236:239], v6 offset:15360
    v_cvt_pk_bf16_f32 v96, v32, v33
    v_mfma_f32_16x16x32_bf16 v[84:87], a[184:187], v[184:187], v[84:87]
    v_exp_f32 v44, v44
    v_mfma_f32_16x16x32_bf16 v[84:87], a[188:191], v[188:191], v[84:87]
    s_add_u32 s51, s96, 98304
    v_cvt_pk_bf16_f32 v97, v34, v35
    v_mfma_f32_16x16x32_bf16 v[92:95], a[176:179], v[192:195], v[156:159]
    v_exp_f32 v45, v45
    v_mfma_f32_16x16x32_bf16 v[92:95], a[180:183], v[196:199], v[92:95]
    buffer_load_dwordx4 v2, s[32:35], s101 offen offset:3072 sc1 lds
    v_mfma_f32_16x16x32_bf16 v[92:95], a[184:187], v[200:203], v[92:95]
    s_add_u32 s101, s101, 16384
    s_and_b32 s3, s3, 0xffff
    v_mfma_f32_16x16x32_bf16 v[92:95], a[188:191], v[204:207], v[92:95]
    v_exp_f32 v46, v46
    s_waitcnt lgkmcnt(0)
    v_mfma_f32_16x16x32_bf16 a[0:3], a[208:211], v[112:115], a[0:3]
    ds_read_b128 a[128:131], v5 offset:0
    ds_read_b128 a[132:135], v5 offset:1024
    v_mfma_f32_16x16x32_bf16 a[32:35], a[208:211], v[116:119], a[32:35]
    v_exp_f32 v47, v47
    v_mfma_f32_16x16x32_bf16 a[64:67], a[208:211], v[120:123], a[64:67]
    s_add_u32 s64, s26, 54525952
    s_addc_u32 s65, s27, 0
    v_mfma_f32_16x16x32_bf16 a[96:99], a[208:211], v[124:127], a[96:99]
    v_exp_f32 v48, v48
    v_mfma_f32_16x16x32_bf16 a[100:103], a[212:215], v[124:127], a[100:103]
    ds_read_b128 a[136:139], v5 offset:2048
    v_add_u32 v6, s97, v2
    v_mfma_f32_16x16x32_bf16 a[68:71], a[212:215], v[120:123], a[68:71]
    v_exp_f32 v49, v49
    v_mfma_f32_16x16x32_bf16 a[36:39], a[212:215], v[116:119], a[36:39]
    ds_read_b128 a[140:143], v5 offset:3072
    s_mov_b32 s66, 4718592
    v_mfma_f32_16x16x32_bf16 a[4:7], a[212:215], v[112:115], a[4:7]
    v_exp_f32 v50, v50
    v_mfma_f32_16x16x32_bf16 a[192:195], v[28:31], v[112:115], a[192:195]
    ds_read_b128 a[144:147], v5 offset:4096
    ds_read_b128 a[148:151], v5 offset:5120
    v_mfma_f32_16x16x32_bf16 a[8:11], a[216:219], v[112:115], a[8:11]
    v_exp_f32 v51, v51
    v_mfma_f32_16x16x32_bf16 a[40:43], a[216:219], v[116:119], a[40:43]
    s_mov_b32 s67, 0x20000
    ds_read_b128 a[152:155], v5 offset:6144
    v_mfma_f32_16x16x32_bf16 a[72:75], a[216:219], v[120:123], a[72:75]
    v_exp_f32 v52, v52
    v_mfma_f32_16x16x32_bf16 a[104:107], a[216:219], v[124:127], a[104:107]
    ds_read_b128 a[156:159], v5 offset:7168
    s_add_u32 s52, s75, 65536
    v_mfma_f32_16x16x32_bf16 a[108:111], a[220:223], v[124:127], a[108:111]
    v_exp_f32 v53, v53
    v_mfma_f32_16x16x32_bf16 a[76:79], a[220:223], v[120:123], a[76:79]
    ds_read_b128 a[160:163], v5 offset:8192
    s_add_u32 s97, s97, 16384
    v_mfma_f32_16x16x32_bf16 a[44:47], a[220:223], v[116:119], a[44:47]
    v_exp_f32 v54, v54
    v_mfma_f32_16x16x32_bf16 a[12:15], a[220:223], v[112:115], a[12:15]
    s_add_u32 s96, s96, 16384
    ds_read_b128 a[164:167], v5 offset:9216
    v_mfma_f32_16x16x32_bf16 a[196:199], v[28:31], v[116:119], a[196:199]
    v_exp_f32 v55, v55
    v_mfma_f32_16x16x32_bf16 a[16:19], a[224:227], v[112:115], a[16:19]
    ds_read_b128 a[168:171], v5 offset:10240
    ds_read_b128 a[172:175], v5 offset:11264
    v_mfma_f32_16x16x32_bf16 a[48:51], a[224:227], v[116:119], a[48:51]
    buffer_store_dwordx4 a[240:243], v2, s[64:67], s52 offen offset:0 sc1
    v_mfma_f32_16x16x32_bf16 a[80:83], a[224:227], v[120:123], a[80:83]
    v_exp_f32 v56, v56
    v_mfma_f32_16x16x32_bf16 a[112:115], a[224:227], v[124:127], a[112:115]
    ds_read_b128 a[176:179], v5 offset:12288
    ds_read_b128 a[180:183], v5 offset:13312
    v_mfma_f32_16x16x32_bf16 a[116:119], a[228:231], v[124:127], a[116:119]
    v_exp_f32 v57, v57
    v_mfma_f32_16x16x32_bf16 a[84:87], a[228:231], v[120:123], a[84:87]
    buffer_store_dwordx4 a[244:247], v2, s[64:67], s52 offen offset:1024 sc1
    v_mfma_f32_16x16x32_bf16 a[52:55], a[228:231], v[116:119], a[52:55]
    ds_read_b128 a[184:187], v5 offset:14336
    s_and_b32 s97, s97, 0xffff
    v_mfma_f32_16x16x32_bf16 a[20:23], a[228:231], v[112:115], a[20:23]
    v_exp_f32 v58, v58
    v_mfma_f32_16x16x32_bf16 a[200:203], v[28:31], v[120:123], a[200:203]
    s_and_b32 s96, s96, 0xffff
    ds_read_b128 a[188:191], v5 offset:15360
    v_mfma_f32_16x16x32_bf16 a[24:27], a[232:235], v[112:115], a[24:27]
    buffer_store_dwordx4 a[248:251], v2, s[64:67], s52 offen offset:2048 sc1
    v_mfma_f32_16x16x32_bf16 a[56:59], a[232:235], v[116:119], a[56:59]
    v_exp_f32 v59, v59
    v_mfma_f32_16x16x32_bf16 a[88:91], a[232:235], v[120:123], a[88:91]
    v_exp_f32 v60, v60
    v_mfma_f32_16x16x32_bf16 a[120:123], a[232:235], v[124:127], a[120:123]
    v_exp_f32 v61, v61
    v_mfma_f32_16x16x32_bf16 a[124:127], a[236:239], v[124:127], a[124:127]
    buffer_store_dwordx4 a[252:255], v2, s[64:67], s52 offen offset:3072 sc1
    v_mfma_f32_16x16x32_bf16 a[92:95], a[236:239], v[120:123], a[92:95]
    v_exp_f32 v62, v62
    v_mfma_f32_16x16x32_bf16 a[60:63], a[236:239], v[116:119], a[60:63]
    v_exp_f32 v63, v63
    v_mfma_f32_16x16x32_bf16 a[28:31], a[236:239], v[112:115], a[28:31]
    v_add_u32 v5, s51, v2
    v_cvt_pk_bf16_f32 v98, v36, v37
    v_mfma_f32_16x16x32_bf16 a[204:207], v[28:31], v[124:127], a[204:207]
    v_cvt_pk_bf16_f32 v99, v38, v39
    v_cvt_pk_bf16_f32 v100, v40, v41
    v_cvt_pk_bf16_f32 v101, v42, v43
    v_cvt_pk_bf16_f32 v102, v44, v45
    v_cvt_pk_bf16_f32 v103, v46, v47
    v_cvt_pk_bf16_f32 v104, v48, v49
    v_cvt_pk_bf16_f32 v105, v50, v51
    v_cvt_pk_bf16_f32 v106, v52, v53
    v_cvt_pk_bf16_f32 v107, v54, v55
    v_cvt_pk_bf16_f32 v108, v56, v57
    v_cvt_pk_bf16_f32 v109, v58, v59
    v_cvt_pk_bf16_f32 v110, v60, v61
    v_cvt_pk_bf16_f32 v111, v62, v63
    s_cmp_eq_u32 s50, 7
    s_cbranch_scc0 L_nopa2
    ds_read_b64_tr_b16 v[240:241], v12 offset:4096
    ds_read_b64_tr_b16 v[242:243], v12 offset:6144
    ds_read_b64_tr_b16 v[244:245], v13 offset:4096
    ds_read_b64_tr_b16 v[246:247], v13 offset:6144
    ds_read_b64_tr_b16 v[248:249], v14 offset:4096
    ds_read_b64_tr_b16 v[250:251], v14 offset:6144
    ds_read_b64_tr_b16 v[252:253], v15 offset:4096
    ds_read_b64_tr_b16 v[254:255], v15 offset:6144
    s_waitcnt lgkmcnt(0)
    s_add_u32 s52, s75, 4294508544
    buffer_store_dwordx4 v[240:243], v2, s[64:67], s52 offen offset:0 sc1
    buffer_store_dwordx4 v[244:247], v2, s[64:67], s52 offen offset:1024 sc1
    buffer_store_dwordx4 v[248:251], v2, s[64:67], s52 offen offset:2048 sc1
    buffer_store_dwordx4 v[252:255], v2, s[64:67], s52 offen offset:3072 sc1
L_nopa2:
    s_lshl_b32 s51, s48, 18
    s_lshl_b32 s52, s49, 12
    s_add_u32 s51, s51, s52
    s_lshl_b32 s52, s50, 20
    s_add_u32 s51, s51, s52
    s_nop 2
    v_accvgpr_read_b32 v172, a200
    v_accvgpr_read_b32 v173, a204
    v_rcp_f32 v172, v172
    v_rcp_f32 v173, v173
    v_accvgpr_read_b32 v160, a64
    v_accvgpr_read_b32 v161, a65
    v_accvgpr_read_b32 v162, a66
    v_accvgpr_read_b32 v163, a67
    v_accvgpr_read_b32 v164, a68
    v_accvgpr_read_b32 v165, a69
    v_accvgpr_read_b32 v166, a70
    v_accvgpr_read_b32 v167, a71
    v_mul_f32 v160, v172, v160
    v_mul_f32 v161, v172, v161
    v_mul_f32 v162, v172, v162
    v_mul_f32 v163, v172, v163
    v_mul_f32 v164, v172, v164
    v_mul_f32 v165, v172, v165
    v_mul_f32 v166, v172, v166
    v_mul_f32 v167, v172, v167
    v_cvt_pk_bf16_f32 v168, v160, v161
    v_cvt_pk_bf16_f32 v169, v162, v163
    v_cvt_pk_bf16_f32 v170, v164, v165
    v_cvt_pk_bf16_f32 v171, v166, v167
    buffer_store_dwordx4 v[168:171], v2, s[36:39], s51 offen offset:0 sc1
    v_accvgpr_read_b32 v16, a72
    v_accvgpr_read_b32 v17, a73
    v_accvgpr_read_b32 v18, a74
    v_accvgpr_read_b32 v19, a75
    v_accvgpr_read_b32 v20, a76
    v_accvgpr_read_b32 v21, a77
    v_accvgpr_read_b32 v22, a78
    v_accvgpr_read_b32 v23, a79
    v_mul_f32 v16, v172, v16
    v_mul_f32 v17, v172, v17
    v_mul_f32 v18, v172, v18
    v_mul_f32 v19, v172, v19
    v_mul_f32 v20, v172, v20
    v_mul_f32 v21, v172, v21
    v_mul_f32 v22, v172, v22
    v_mul_f32 v23, v172, v23
    v_cvt_pk_bf16_f32 v24, v16, v17
    v_cvt_pk_bf16_f32 v25, v18, v19
    v_cvt_pk_bf16_f32 v26, v20, v21
    v_cvt_pk_bf16_f32 v27, v22, v23
    buffer_store_dwordx4 v[24:27], v2, s[36:39], s51 offen offset:1024 sc1
    v_accvgpr_read_b32 v160, a80
    v_accvgpr_read_b32 v161, a81
    v_accvgpr_read_b32 v162, a82
    v_accvgpr_read_b32 v163, a83
    v_accvgpr_read_b32 v164, a84
    v_accvgpr_read_b32 v165, a85
    v_accvgpr_read_b32 v166, a86
    v_accvgpr_read_b32 v167, a87
    v_mul_f32 v160, v172, v160
    v_mul_f32 v161, v172, v161
    v_mul_f32 v162, v172, v162
    v_mul_f32 v163, v172, v163
    v_mul_f32 v164, v172, v164
    v_mul_f32 v165, v172, v165
    v_mul_f32 v166, v172, v166
    v_mul_f32 v167, v172, v167
    v_cvt_pk_bf16_f32 v168, v160, v161
    v_cvt_pk_bf16_f32 v169, v162, v163
    v_cvt_pk_bf16_f32 v170, v164, v165
    v_cvt_pk_bf16_f32 v171, v166, v167
    buffer_store_dwordx4 v[168:171], v2, s[36:39], s51 offen offset:2048 sc1
    v_accvgpr_read_b32 v16, a88
    v_accvgpr_read_b32 v17, a89
    v_accvgpr_read_b32 v18, a90
    v_accvgpr_read_b32 v19, a91
    v_accvgpr_read_b32 v20, a92
    v_accvgpr_read_b32 v21, a93
    v_accvgpr_read_b32 v22, a94
    v_accvgpr_read_b32 v23, a95
    v_mul_f32 v16, v172, v16
    v_mul_f32 v17, v172, v17
    v_mul_f32 v18, v172, v18
    v_mul_f32 v19, v172, v19
    v_mul_f32 v20, v172, v20
    v_mul_f32 v21, v172, v21
    v_mul_f32 v22, v172, v22
    v_mul_f32 v23, v172, v23
    v_cvt_pk_bf16_f32 v24, v16, v17
    v_cvt_pk_bf16_f32 v25, v18, v19
    v_cvt_pk_bf16_f32 v26, v20, v21
    v_cvt_pk_bf16_f32 v27, v22, v23
    buffer_store_dwordx4 v[24:27], v2, s[36:39], s51 offen offset:3072 sc1
    s_add_u32 s51, s51, 131072
    v_accvgpr_read_b32 v160, a96
    v_accvgpr_read_b32 v161, a97
    v_accvgpr_read_b32 v162, a98
    v_accvgpr_read_b32 v163, a99
    v_accvgpr_read_b32 v164, a100
    v_accvgpr_read_b32 v165, a101
    v_accvgpr_read_b32 v166, a102
    v_accvgpr_read_b32 v167, a103
    v_mul_f32 v160, v173, v160
    v_mul_f32 v161, v173, v161
    v_mul_f32 v162, v173, v162
    v_mul_f32 v163, v173, v163
    v_mul_f32 v164, v173, v164
    v_mul_f32 v165, v173, v165
    v_mul_f32 v166, v173, v166
    v_mul_f32 v167, v173, v167
    v_cvt_pk_bf16_f32 v168, v160, v161
    v_cvt_pk_bf16_f32 v169, v162, v163
    v_cvt_pk_bf16_f32 v170, v164, v165
    v_cvt_pk_bf16_f32 v171, v166, v167
    buffer_store_dwordx4 v[168:171], v2, s[36:39], s51 offen offset:0 sc1
    v_accvgpr_read_b32 v16, a104
    v_accvgpr_read_b32 v17, a105
    v_accvgpr_read_b32 v18, a106
    v_accvgpr_read_b32 v19, a107
    v_accvgpr_read_b32 v20, a108
    v_accvgpr_read_b32 v21, a109
    v_accvgpr_read_b32 v22, a110
    v_accvgpr_read_b32 v23, a111
    v_mul_f32 v16, v173, v16
    v_mul_f32 v17, v173, v17
    v_mul_f32 v18, v173, v18
    v_mul_f32 v19, v173, v19
    v_mul_f32 v20, v173, v20
    v_mul_f32 v21, v173, v21
    v_mul_f32 v22, v173, v22
    v_mul_f32 v23, v173, v23
    v_cvt_pk_bf16_f32 v24, v16, v17
    v_cvt_pk_bf16_f32 v25, v18, v19
    v_cvt_pk_bf16_f32 v26, v20, v21
    v_cvt_pk_bf16_f32 v27, v22, v23
    buffer_store_dwordx4 v[24:27], v2, s[36:39], s51 offen offset:1024 sc1
    v_accvgpr_read_b32 v160, a112
    v_accvgpr_read_b32 v161, a113
    v_accvgpr_read_b32 v162, a114
    v_accvgpr_read_b32 v163, a115
    v_accvgpr_read_b32 v164, a116
    v_accvgpr_read_b32 v165, a117
    v_accvgpr_read_b32 v166, a118
    v_accvgpr_read_b32 v167, a119
    v_mul_f32 v160, v173, v160
    v_mul_f32 v161, v173, v161
    v_mul_f32 v162, v173, v162
    v_mul_f32 v163, v173, v163
    v_mul_f32 v164, v173, v164
    v_mul_f32 v165, v173, v165
    v_mul_f32 v166, v173, v166
    v_mul_f32 v167, v173, v167
    v_cvt_pk_bf16_f32 v168, v160, v161
    v_cvt_pk_bf16_f32 v169, v162, v163
    v_cvt_pk_bf16_f32 v170, v164, v165
    v_cvt_pk_bf16_f32 v171, v166, v167
    buffer_store_dwordx4 v[168:171], v2, s[36:39], s51 offen offset:2048 sc1
    v_accvgpr_read_b32 v16, a120
    v_accvgpr_read_b32 v17, a121
    v_accvgpr_read_b32 v18, a122
    v_accvgpr_read_b32 v19, a123
    v_accvgpr_read_b32 v20, a124
    v_accvgpr_read_b32 v21, a125
    v_accvgpr_read_b32 v22, a126
    v_accvgpr_read_b32 v23, a127
    v_mul_f32 v16, v173, v16
    v_mul_f32 v17, v173, v17
    v_mul_f32 v18, v173, v18
    v_mul_f32 v19, v173, v19
    v_mul_f32 v20, v173, v20
    v_mul_f32 v21, v173, v21
    v_mul_f32 v22, v173, v22
    v_mul_f32 v23, v173, v23
    v_cvt_pk_bf16_f32 v24, v16, v17
    v_cvt_pk_bf16_f32 v25, v18, v19
    v_cvt_pk_bf16_f32 v26, v20, v21
    v_cvt_pk_bf16_f32 v27, v22, v23
    buffer_store_dwordx4 v[24:27], v2, s[36:39], s51 offen offset:3072 sc1
    s_nop 0
    s_lshl_b32 s51, s50, 7
    s_sub_u32 s52, 1572864, s51
    s_add_u32 s44, s6, s51
    s_addc_u32 s45, s7, 0
    s_mov_b32 s46, s52
    s_mov_b32 s47, 0x20000
    s_mov_b32 s40, s4
    s_mov_b32 s41, s5
    s_mov_b32 s42, 2097152
    s_mov_b32 s43, 0x20000
    s_lshl_b32 s51, s49, 16
    s_lshl_b32 s52, s48, 14
    s_add_u32 s72, s51, s52
    s_sub_u32 s73, s51, 16384
    s_max_i32 s73, s73, 0
    s_and_b32 s52, s48, 1
    s_lshl_b32 s52, s52, 13
    s_add_u32 s73, s73, s52
    s_mul_i32 s74, s48, 49152
    s_lshl_b32 s75, s48, 11
    v_lshrrev_b32 v24, 3, v1
    v_and_b32 v25, 7, v1
    v_xor_b32 v25, v25, v24
    v_lshlrev_b32 v25, 4, v25
    v_lshl_add_u32 v12, v24, 10, v25
    v_add_u32 v13, 7168, v12
    v_mul_u32_u24 v24, 3072, v24
    v_bfe_u32 v25, v1, 1, 2
    v_and_b32 v26, 1, v3
    v_xor_b32 v25, v25, v26
    v_and_b32 v26, 1, v1
    v_lshl_add_u32 v25, v25, 1, v26
    v_lshl_add_u32 v14, v25, 4, v24
    v_xor_b32 v25, 4, v25
    v_lshl_add_u32 v15, v25, 4, v24
    v_add_u32 v15, 23552, v15
    v_and_b32 v24, 7, v1
    v_xor_b32 v24, v24, v3
    v_lshlrev_b32 v24, 4, v24
    v_lshl_add_u32 v18, v4, 7, v24
    v_xor_b32 v19, 64, v18
    v_add_u32 v20, 69632, v18
    v_add_u32 v21, 69632, v19
    v_lshrrev_b32 v24, 2, v4
    v_lshl_add_u32 v24, v3, 3, v24
    v_lshlrev_b32 v24, 7, v24
    v_and_b32 v25, 1, v3
    v_lshrrev_b32 v26, 3, v4
    v_lshl_add_u32 v25, v25, 1, v26
    v_xor_b32 v25, s48, v25
    v_lshl_add_u32 v24, v25, 5, v24
    v_and_b32 v25, 3, v4
    v_lshl_add_u32 v24, v25, 3, v24
    v_add_u32 v22, 10240, v24
    v_add_u32 v23, 79872, v24
    s_sub_u32 s53, 7, s50
    s_cmp_eq_u32 s53, 0
    s_cbranch_scc1 L_tail
    s_and_b32 s51, s50, 1
    s_xor_b32 s51, s51, 1
    s_lshl_b32 s51, s51, 15
    s_xor_b32 s52, s51, 0x8000
    s_add_u32 s100, s54, s51
    s_add_u32 s96, s54, s52
    s_add_u32 s3, s55, s51
    s_add_u32 s92, s55, s52
    v_add_u32 v162, s51, v2
    v_add_u32 v163, s52, v2
    v_add_u32 v160, 98304, v162
    v_add_u32 v161, 98304, v163
    s_lshl_b32 s51, s48, 2
    s_add_u32 s51, s51, 94208
    v_mov_b32 v166, s51
    v_and_b32 v167, 3, v1
    v_lshlrev_b32 v167, 2, v167
    v_add_u32 v167, 94208, v167
    v_mov_b32 v164, 0
    v_mov_b32 v165, 0
    ds_write_b32 v166, v164
    s_waitcnt vmcnt(8) lgkmcnt(0)
    s_barrier
    s_and_b32 s51, s48, 1
    s_cmp_eq_u32 s51, 1
    s_cbranch_scc1 L_loopE1
.p2align 5
L_loopE:
    s_waitcnt vmcnt(8) lgkmcnt(0)
    v_mfma_f32_16x16x32_bf16 v[32:35], a[128:131], v[176:179], v[128:131]
    v_add_u32 v164, 1, v164
    ds_write_b32 v166, v164
    v_mfma_f32_16x16x32_bf16 v[32:35], a[132:135], v[180:183], v[32:35]
    s_add_u32 m0, s100, 16384
    ds_read_b128 a[208:211], v162 offset:0
    v_mfma_f32_16x16x32_bf16 v[32:35], a[136:139], v[184:187], v[32:35]
    buffer_load_dwordx4 v2, s[28:31], s99 offen offset:0 sc1 lds
    v_mfma_f32_16x16x32_bf16 v[32:35], a[140:143], v[188:191], v[32:35]
    v_exp_f32 v64, v64
    v_mfma_f32_16x16x32_bf16 v[40:43], a[128:131], v[192:195], v[132:135]
    v_exp_f32 v65, v65
    v_mfma_f32_16x16x32_bf16 v[40:43], a[132:135], v[196:199], v[40:43]
    v_exp_f32 v66, v66
    v_mfma_f32_16x16x32_bf16 v[40:43], a[136:139], v[200:203], v[40:43]
    ds_read_b128 a[212:215], v162 offset:1024
    ds_read_b128 a[216:219], v162 offset:2048
    v_mfma_f32_16x16x32_bf16 v[40:43], a[140:143], v[204:207], v[40:43]
    v_exp_f32 v67, v67
    v_mfma_f32_16x16x32_bf16 v[36:39], a[144:147], v[176:179], v[136:139]
    v_exp_f32 v68, v68
    v_mfma_f32_16x16x32_bf16 v[36:39], a[148:151], v[180:183], v[36:39]
    ds_read_b128 a[220:223], v162 offset:3072
    ds_read_b128 a[224:227], v162 offset:4096
    v_mfma_f32_16x16x32_bf16 v[36:39], a[152:155], v[184:187], v[36:39]
    buffer_load_dwordx4 v2, s[28:31], s99 offen offset:1024 sc1 lds
    v_mfma_f32_16x16x32_bf16 v[36:39], a[156:159], v[188:191], v[36:39]
    v_exp_f32 v69, v69
    v_mfma_f32_16x16x32_bf16 v[44:47], a[144:147], v[192:195], v[140:143]
    ds_read_b128 a[228:231], v162 offset:5120
    ds_read_b128 a[232:235], v162 offset:6144
    v_mfma_f32_16x16x32_bf16 v[44:47], a[148:151], v[196:199], v[44:47]
    v_exp_f32 v70, v70
    v_mfma_f32_16x16x32_bf16 v[44:47], a[152:155], v[200:203], v[44:47]
    v_exp_f32 v71, v71
    v_mfma_f32_16x16x32_bf16 v[44:47], a[156:159], v[204:207], v[44:47]
    ds_read_b128 a[236:239], v162 offset:7168
    ds_read_b128 a[240:243], v162 offset:8192
    v_mfma_f32_16x16x32_bf16 v[48:51], a[160:163], v[176:179], v[144:147]
    v_exp_f32 v72, v72
    v_mfma_f32_16x16x32_bf16 v[48:51], a[164:167], v[180:183], v[48:51]
    ds_read_b128 a[244:247], v162 offset:9216
    ds_read_b128 a[248:251], v162 offset:10240
    v_mfma_f32_16x16x32_bf16 v[48:51], a[168:171], v[184:187], v[48:51]
    buffer_load_dwordx4 v2, s[28:31], s99 offen offset:2048 sc1 lds
    v_mfma_f32_16x16x32_bf16 v[48:51], a[172:175], v[188:191], v[48:51]
    v_exp_f32 v73, v73
    v_mfma_f32_16x16x32_bf16 v[56:59], a[160:163], v[192:195], v[148:151]
    v_exp_f32 v74, v74
    v_mfma_f32_16x16x32_bf16 v[56:59], a[164:167], v[196:199], v[56:59]
    ds_read_b128 a[252:255], v162 offset:11264
    ds_read_b128 v[240:243], v162 offset:12288
    v_mfma_f32_16x16x32_bf16 v[56:59], a[168:171], v[200:203], v[56:59]
    v_exp_f32 v75, v75
    v_mfma_f32_16x16x32_bf16 v[56:59], a[172:175], v[204:207], v[56:59]
    v_exp_f32 v76, v76
    v_mfma_f32_16x16x32_bf16 v[52:55], a[176:179], v[176:179], v[152:155]
    ds_read_b128 v[244:247], v162 offset:13312
    ds_read_b128 v[248:251], v162 offset:14336
    v_mfma_f32_16x16x32_bf16 v[52:55], a[180:183], v[180:183], v[52:55]
    v_exp_f32 v77, v77
    v_mfma_f32_16x16x32_bf16 v[52:55], a[184:187], v[184:187], v[52:55]
    buffer_load_dwordx4 v2, s[28:31], s99 offen offset:3072 sc1 lds
    v_mfma_f32_16x16x32_bf16 v[52:55], a[188:191], v[188:191], v[52:55]
    ds_read_b128 v[252:255], v162 offset:15360
    ds_read_b32 v165, v167
    v_mfma_f32_16x16x32_bf16 v[60:63], a[176:179], v[192:195], v[156:159]
    v_exp_f32 v78, v78
    v_mfma_f32_16x16x32_bf16 v[60:63], a[180:183], v[196:199], v[60:63]
    v_exp_f32 v79, v79
    v_mfma_f32_16x16x32_bf16 v[60:63], a[184:187], v[200:203], v[60:63]
    v_exp_f32 v80, v80
    v_mfma_f32_16x16x32_bf16 v[60:63], a[188:191], v[204:207], v[60:63]
    s_add_u32 s99, s99, 16384
    s_add_u32 m0, s92, 16384
    s_waitcnt lgkmcnt(0)
    v_mfma_f32_16x16x32_bf16 a[0:3], a[208:211], v[96:99], a[0:3]
    v_cmp_lt_u32 vcc, v165, v164
    v_mfma_f32_16x16x32_bf16 a[0:3], a[240:243], v[104:107], a[0:3]
    s_cbranch_vccnz L_sb17_s
L_sb17:
    v_mfma_f32_16x16x32_bf16 a[32:35], a[240:243], v[108:111], a[32:35]
    v_exp_f32 v81, v81
    v_mfma_f32_16x16x32_bf16 a[32:35], a[208:211], v[100:103], a[32:35]
    buffer_load_dwordx4 v2, s[32:35], s101 offen offset:0 sc1 lds
    v_mfma_f32_16x16x32_bf16 a[4:7], a[212:215], v[96:99], a[4:7]
    ds_read_b128 a[128:131], v161 offset:16384
    ds_read_b128 a[132:135], v161 offset:17408
    v_mfma_f32_16x16x32_bf16 a[4:7], a[244:247], v[104:107], a[4:7]
    v_exp_f32 v82, v82
    v_mfma_f32_16x16x32_bf16 a[36:39], a[244:247], v[108:111], a[36:39]
    v_exp_f32 v83, v83
    v_mfma_f32_16x16x32_bf16 a[36:39], a[212:215], v[100:103], a[36:39]
    ds_read_b128 a[136:139], v161 offset:18432
    ds_read_b128 a[140:143], v161 offset:19456
    v_mfma_f32_16x16x32_bf16 a[8:11], a[216:219], v[96:99], a[8:11]
    v_exp_f32 v84, v84
    v_mfma_f32_16x16x32_bf16 a[8:11], a[248:251], v[104:107], a[8:11]
    buffer_load_dwordx4 v2, s[32:35], s101 offen offset:1024 sc1 lds
    v_mfma_f32_16x16x32_bf16 a[40:43], a[248:251], v[108:111], a[40:43]
    ds_read_b128 a[144:147], v161 offset:20480
    ds_read_b128 a[148:151], v161 offset:21504
    v_mfma_f32_16x16x32_bf16 a[40:43], a[216:219], v[100:103], a[40:43]
    v_exp_f32 v85, v85
    v_mfma_f32_16x16x32_bf16 a[12:15], a[220:223], v[96:99], a[12:15]
    ds_read_b128 a[152:155], v161 offset:22528
    ds_read_b128 a[156:159], v161 offset:23552
    v_mfma_f32_16x16x32_bf16 a[12:15], a[252:255], v[104:107], a[12:15]
    v_exp_f32 v86, v86
    v_mfma_f32_16x16x32_bf16 a[44:47], a[252:255], v[108:111], a[44:47]
    ds_read_b128 a[160:163], v161 offset:24576
    ds_read_b128 a[164:167], v161 offset:25600
    v_mfma_f32_16x16x32_bf16 a[44:47], a[220:223], v[100:103], a[44:47]
    buffer_load_dwordx4 v2, s[32:35], s101 offen offset:2048 sc1 lds
    v_mfma_f32_16x16x32_bf16 a[192:195], v[28:31], v[96:99], a[192:195]
    v_exp_f32 v87, v87
    v_mfma_f32_16x16x32_bf16 a[192:195], v[28:31], v[104:107], a[192:195]
    ds_read_b128 a[168:171], v161 offset:26624
    ds_read_b128 a[172:175], v161 offset:27648
    v_mfma_f32_16x16x32_bf16 a[16:19], a[224:227], v[96:99], a[16:19]
    v_exp_f32 v88, v88
    v_mfma_f32_16x16x32_bf16 a[16:19], v[240:243], v[104:107], a[16:19]
    ds_read_b128 a[176:179], v161 offset:28672
    ds_read_b128 a[180:183], v161 offset:29696
    v_mfma_f32_16x16x32_bf16 a[48:51], v[240:243], v[108:111], a[48:51]
    v_exp_f32 v89, v89
    v_mfma_f32_16x16x32_bf16 a[48:51], a[224:227], v[100:103], a[48:51]
    buffer_load_dwordx4 v2, s[32:35], s101 offen offset:3072 sc1 lds
    v_mfma_f32_16x16x32_bf16 a[20:23], a[228:231], v[96:99], a[20:23]
    s_add_u32 s101, s101, 16384
    ds_read_b128 a[184:187], v161 offset:30720
    v_mfma_f32_16x16x32_bf16 a[20:23], v[244:247], v[104:107], a[20:23]
    v_exp_f32 v90, v90
    v_mfma_f32_16x16x32_bf16 a[52:55], v[244:247], v[108:111], a[52:55]
    ds_read_b128 a[188:191], v161 offset:31744
    v_cvt_pk_bf16_f32 v112, v64, v65
    v_mfma_f32_16x16x32_bf16 a[52:55], a[228:231], v[100:103], a[52:55]
    v_exp_f32 v91, v91
    v_mfma_f32_16x16x32_bf16 a[24:27], a[232:235], v[96:99], a[24:27]
    v_cvt_pk_bf16_f32 v113, v66, v67
    v_cvt_pk_bf16_f32 v114, v68, v69
    v_mfma_f32_16x16x32_bf16 a[24:27], v[248:251], v[104:107], a[24:27]
    v_exp_f32 v92, v92
    v_mfma_f32_16x16x32_bf16 a[56:59], v[248:251], v[108:111], a[56:59]
    v_cvt_pk_bf16_f32 v115, v70, v71
    v_cvt_pk_bf16_f32 v116, v72, v73
    v_mfma_f32_16x16x32_bf16 a[56:59], a[232:235], v[100:103], a[56:59]
    v_exp_f32 v93, v93
    v_mfma_f32_16x16x32_bf16 a[28:31], a[236:239], v[96:99], a[28:31]
    v_cvt_pk_bf16_f32 v117, v74, v75
    v_cvt_pk_bf16_f32 v118, v76, v77
    v_mfma_f32_16x16x32_bf16 a[28:31], v[252:255], v[104:107], a[28:31]
    v_exp_f32 v94, v94
    v_mfma_f32_16x16x32_bf16 a[60:63], v[252:255], v[108:111], a[60:63]
    v_cvt_pk_bf16_f32 v119, v78, v79
    v_cvt_pk_bf16_f32 v120, v80, v81
    v_mfma_f32_16x16x32_bf16 a[60:63], a[236:239], v[100:103], a[60:63]
    v_exp_f32 v95, v95
    v_mfma_f32_16x16x32_bf16 a[196:199], v[28:31], v[100:103], a[196:199]
    v_cvt_pk_bf16_f32 v121, v82, v83
    v_cvt_pk_bf16_f32 v122, v84, v85
    v_mfma_f32_16x16x32_bf16 a[196:199], v[28:31], v[108:111], a[196:199]
    v_cvt_pk_bf16_f32 v123, v86, v87
    v_cvt_pk_bf16_f32 v124, v88, v89
    v_cvt_pk_bf16_f32 v125, v90, v91
    v_cvt_pk_bf16_f32 v126, v92, v93
    v_cvt_pk_bf16_f32 v127, v94, v95
    s_waitcnt vmcnt(8) lgkmcnt(0)
    v_mfma_f32_16x16x32_bf16 v[64:67], a[128:131], v[176:179], v[128:131]
    v_add_u32 v164, 1, v164
    ds_write_b32 v166, v164
    v_mfma_f32_16x16x32_bf16 v[64:67], a[132:135], v[180:183], v[64:67]
    s_add_u32 m0, s96, 0
    ds_read_b128 a[208:211], v162 offset:16384
    v_mfma_f32_16x16x32_bf16 v[64:67], a[136:139], v[184:187], v[64:67]
    buffer_load_dwordx4 v2, s[28:31], s99 offen offset:0 sc1 lds
    v_mfma_f32_16x16x32_bf16 v[64:67], a[140:143], v[188:191], v[64:67]
    v_exp_f32 v32, v32
    v_mfma_f32_16x16x32_bf16 v[72:75], a[128:131], v[192:195], v[132:135]
    v_exp_f32 v33, v33
    v_mfma_f32_16x16x32_bf16 v[72:75], a[132:135], v[196:199], v[72:75]
    v_exp_f32 v34, v34
    v_mfma_f32_16x16x32_bf16 v[72:75], a[136:139], v[200:203], v[72:75]
    ds_read_b128 a[212:215], v162 offset:17408
    ds_read_b128 a[216:219], v162 offset:18432
    v_mfma_f32_16x16x32_bf16 v[72:75], a[140:143], v[204:207], v[72:75]
    v_exp_f32 v35, v35
    v_mfma_f32_16x16x32_bf16 v[68:71], a[144:147], v[176:179], v[136:139]
    v_exp_f32 v36, v36
    v_mfma_f32_16x16x32_bf16 v[68:71], a[148:151], v[180:183], v[68:71]
    ds_read_b128 a[220:223], v162 offset:19456
    ds_read_b128 a[224:227], v162 offset:20480
    v_mfma_f32_16x16x32_bf16 v[68:71], a[152:155], v[184:187], v[68:71]
    buffer_load_dwordx4 v2, s[28:31], s99 offen offset:1024 sc1 lds
    v_mfma_f32_16x16x32_bf16 v[68:71], a[156:159], v[188:191], v[68:71]
    v_exp_f32 v37, v37
    v_mfma_f32_16x16x32_bf16 v[76:79], a[144:147], v[192:195], v[140:143]
    ds_read_b128 a[228:231], v162 offset:21504
    ds_read_b128 a[232:235], v162 offset:22528
    v_mfma_f32_16x16x32_bf16 v[76:79], a[148:151], v[196:199], v[76:79]
    v_exp_f32 v38, v38
    v_mfma_f32_16x16x32_bf16 v[76:79], a[152:155], v[200:203], v[76:79]
    v_exp_f32 v39, v39
    v_mfma_f32_16x16x32_bf16 v[76:79], a[156:159], v[204:207], v[76:79]
    ds_read_b128 a[236:239], v162 offset:23552
    ds_read_b128 a[240:243], v162 offset:24576
    v_mfma_f32_16x16x32_bf16 v[80:83], a[160:163], v[176:179], v[144:147]
    v_exp_f32 v40, v40
    v_mfma_f32_16x16x32_bf16 v[80:83], a[164:167], v[180:183], v[80:83]
    ds_read_b128 a[244:247], v162 offset:25600
    ds_read_b128 a[248:251], v162 offset:26624
    v_mfma_f32_16x16x32_bf16 v[80:83], a[168:171], v[184:187], v[80:83]
    buffer_load_dwordx4 v2, s[28:31], s99 offen offset:2048 sc1 lds
    v_mfma_f32_16x16x32_bf16 v[80:83], a[172:175], v[188:191], v[80:83]
    v_exp_f32 v41, v41
    v_mfma_f32_16x16x32_bf16 v[88:91], a[160:163], v[192:195], v[148:151]
    v_exp_f32 v42, v42
    v_mfma_f32_16x16x32_bf16 v[88:91], a[164:167], v[196:199], v[88:91]
    ds_read_b128 a[252:255], v162 offset:27648
    ds_read_b128 v[240:243], v162 offset:28672
    v_mfma_f32_16x16x32_bf16 v[88:91], a[168:171], v[200:203], v[88:91]
    v_exp_f32 v43, v43
    v_mfma_f32_16x16x32_bf16 v[88:91], a[172:175], v[204:207], v[88:91]
    v_exp_f32 v44, v44
    v_mfma_f32_16x16x32_bf16 v[84:87], a[176:179], v[176:179], v[152:155]
    ds_read_b128 v[244:247], v162 offset:29696
    ds_read_b128 v[248:251], v162 offset:30720
    v_mfma_f32_16x16x32_bf16 v[84:87], a[180:183], v[180:183], v[84:87]
    v_exp_f32 v45, v45
    v_mfma_f32_16x16x32_bf16 v[84:87], a[184:187], v[184:187], v[84:87]
    buffer_load_dwordx4 v2, s[28:31], s99 offen offset:3072 sc1 lds
    v_mfma_f32_16x16x32_bf16 v[84:87], a[188:191], v[188:191], v[84:87]
    ds_read_b128 v[252:255], v162 offset:31744
    ds_read_b32 v165, v167
    v_mfma_f32_16x16x32_bf16 v[92:95], a[176:179], v[192:195], v[156:159]
    v_exp_f32 v46, v46
    v_mfma_f32_16x16x32_bf16 v[92:95], a[180:183], v[196:199], v[92:95]
    v_exp_f32 v47, v47
    v_mfma_f32_16x16x32_bf16 v[92:95], a[184:187], v[200:203], v[92:95]
    v_exp_f32 v48, v48
    v_mfma_f32_16x16x32_bf16 v[92:95], a[188:191], v[204:207], v[92:95]
    s_add_u32 s99, s99, 16384
    s_add_u32 m0, s3, 0
    s_waitcnt lgkmcnt(0)
    v_mfma_f32_16x16x32_bf16 a[0:3], a[208:211], v[112:115], a[0:3]
    v_cmp_lt_u32 vcc, v165, v164
    v_mfma_f32_16x16x32_bf16 a[0:3], a[240:243], v[120:123], a[0:3]
    s_cbranch_vccnz L_sb19_s
L_sb19:
    v_mfma_f32_16x16x32_bf16 a[32:35], a[240:243], v[124:127], a[32:35]
    v_exp_f32 v49, v49
    v_mfma_f32_16x16x32_bf16 a[32:35], a[208:211], v[116:119], a[32:35]
    buffer_load_dwordx4 v2, s[32:35], s101 offen offset:0 sc1 lds
    v_mfma_f32_16x16x32_bf16 a[4:7], a[212:215], v[112:115], a[4:7]
    ds_read_b128 a[128:131], v160 offset:0
    ds_read_b128 a[132:135], v160 offset:1024
    v_mfma_f32_16x16x32_bf16 a[4:7], a[244:247], v[120:123], a[4:7]
    v_exp_f32 v50, v50
    v_mfma_f32_16x16x32_bf16 a[36:39], a[244:247], v[124:127], a[36:39]
    v_exp_f32 v51, v51
    v_mfma_f32_16x16x32_bf16 a[36:39], a[212:215], v[116:119], a[36:39]
    ds_read_b128 a[136:139], v160 offset:2048
    ds_read_b128 a[140:143], v160 offset:3072
    v_mfma_f32_16x16x32_bf16 a[8:11], a[216:219], v[112:115], a[8:11]
    v_exp_f32 v52, v52
    v_mfma_f32_16x16x32_bf16 a[8:11], a[248:251], v[120:123], a[8:11]
    buffer_load_dwordx4 v2, s[32:35], s101 offen offset:1024 sc1 lds
    v_mfma_f32_16x16x32_bf16 a[40:43], a[248:251], v[124:127], a[40:43]
    ds_read_b128 a[144:147], v160 offset:4096
    ds_read_b128 a[148:151], v160 offset:5120
    v_mfma_f32_16x16x32_bf16 a[40:43], a[216:219], v[116:119], a[40:43]
    v_exp_f32 v53, v53
    v_mfma_f32_16x16x32_bf16 a[12:15], a[220:223], v[112:115], a[12:15]
    ds_read_b128 a[152:155], v160 offset:6144
    ds_read_b128 a[156:159], v160 offset:7168
    v_mfma_f32_16x16x32_bf16 a[12:15], a[252:255], v[120:123], a[12:15]
    v_exp_f32 v54, v54
    v_mfma_f32_16x16x32_bf16 a[44:47], a[252:255], v[124:127], a[44:47]
    ds_read_b128 a[160:163], v160 offset:8192
    ds_read_b128 a[164:167], v160 offset:9216
    v_mfma_f32_16x16x32_bf16 a[44:47], a[220:223], v[116:119], a[44:47]
    buffer_load_dwordx4 v2, s[32:35], s101 offen offset:2048 sc1 lds
    v_mfma_f32_16x16x32_bf16 a[192:195], v[28:31], v[112:115], a[192:195]
    v_exp_f32 v55, v55
    v_mfma_f32_16x16x32_bf16 a[192:195], v[28:31], v[120:123], a[192:195]
    ds_read_b128 a[168:171], v160 offset:10240
    ds_read_b128 a[172:175], v160 offset:11264
    v_mfma_f32_16x16x32_bf16 a[16:19], a[224:227], v[112:115], a[16:19]
    v_exp_f32 v56, v56
    v_mfma_f32_16x16x32_bf16 a[16:19], v[240:243], v[120:123], a[16:19]
    ds_read_b128 a[176:179], v160 offset:12288
    ds_read_b128 a[180:183], v160 offset:13312
    v_mfma_f32_16x16x32_bf16 a[48:51], v[240:243], v[124:127], a[48:51]
    v_exp_f32 v57, v57
    v_mfma_f32_16x16x32_bf16 a[48:51], a[224:227], v[116:119], a[48:51]
    buffer_load_dwordx4 v2, s[32:35], s101 offen offset:3072 sc1 lds
    v_mfma_f32_16x16x32_bf16 a[20:23], a[228:231], v[112:115], a[20:23]
    s_add_u32 s101, s101, 16384
    ds_read_b128 a[184:187], v160 offset:14336
    v_mfma_f32_16x16x32_bf16 a[20:23], v[244:247], v[120:123], a[20:23]
    v_exp_f32 v58, v58
    v_mfma_f32_16x16x32_bf16 a[52:55], v[244:247], v[124:127], a[52:55]
    ds_read_b128 a[188:191], v160 offset:15360
    v_cvt_pk_bf16_f32 v96, v32, v33
    v_mfma_f32_16x16x32_bf16 a[52:55], a[228:231], v[116:119], a[52:55]
    v_exp_f32 v59, v59
    v_mfma_f32_16x16x32_bf16 a[24:27], a[232:235], v[112:115], a[24:27]
    v_cvt_pk_bf16_f32 v97, v34, v35
    v_cvt_pk_bf16_f32 v98, v36, v37
    v_mfma_f32_16x16x32_bf16 a[24:27], v[248:251], v[120:123], a[24:27]
    v_exp_f32 v60, v60
    v_mfma_f32_16x16x32_bf16 a[56:59], v[248:251], v[124:127], a[56:59]
    v_cvt_pk_bf16_f32 v99, v38, v39
    v_cvt_pk_bf16_f32 v100, v40, v41
    v_mfma_f32_16x16x32_bf16 a[56:59], a[232:235], v[116:119], a[56:59]
    v_exp_f32 v61, v61
    v_mfma_f32_16x16x32_bf16 a[28:31], a[236:239], v[112:115], a[28:31]
    v_cvt_pk_bf16_f32 v101, v42, v43
    v_cvt_pk_bf16_f32 v102, v44, v45
    v_mfma_f32_16x16x32_bf16 a[28:31], v[252:255], v[120:123], a[28:31]
    v_exp_f32 v62, v62
    v_mfma_f32_16x16x32_bf16 a[60:63], v[252:255], v[124:127], a[60:63]
    v_cvt_pk_bf16_f32 v103, v46, v47
    v_cvt_pk_bf16_f32 v104, v48, v49
    v_mfma_f32_16x16x32_bf16 a[60:63], a[236:239], v[116:119], a[60:63]
    v_exp_f32 v63, v63
    v_mfma_f32_16x16x32_bf16 a[196:199], v[28:31], v[116:119], a[196:199]
    v_cvt_pk_bf16_f32 v105, v50, v51
    v_cvt_pk_bf16_f32 v106, v52, v53
    v_mfma_f32_16x16x32_bf16 a[196:199], v[28:31], v[124:127], a[196:199]
    v_cvt_pk_bf16_f32 v107, v54, v55
    v_cvt_pk_bf16_f32 v108, v56, v57
    v_cvt_pk_bf16_f32 v109, v58, v59
    v_cvt_pk_bf16_f32 v110, v60, v61
    v_cvt_pk_bf16_f32 v111, v62, v63
    s_cmp_eq_u32 s53, 1
    s_waitcnt vmcnt(8) lgkmcnt(0)
    s_cbranch_scc1 L_ev20_h
L_ev20:
    v_mfma_f32_16x16x32_bf16 v[32:35], a[128:131], v[176:179], v[128:131]
    v_add_u32 v164, 1, v164
    ds_write_b32 v166, v164
    v_mfma_f32_16x16x32_bf16 v[32:35], a[132:135], v[180:183], v[32:35]
    s_add_u32 m0, s96, 16384
    ds_read_b128 a[208:211], v163 offset:0
    v_mfma_f32_16x16x32_bf16 v[32:35], a[136:139], v[184:187], v[32:35]
    buffer_load_dwordx4 v2, s[28:31], s99 offen offset:0 sc1 lds
    v_mfma_f32_16x16x32_bf16 v[32:35], a[140:143], v[188:191], v[32:35]
    v_exp_f32 v64, v64
    v_mfma_f32_16x16x32_bf16 v[40:43], a[128:131], v[192:195], v[132:135]
    v_exp_f32 v65, v65
    v_mfma_f32_16x16x32_bf16 v[40:43], a[132:135], v[196:199], v[40:43]
    v_exp_f32 v66, v66
    v_mfma_f32_16x16x32_bf16 v[40:43], a[136:139], v[200:203], v[40:43]
    ds_read_b128 a[212:215], v163 offset:1024
    ds_read_b128 a[216:219], v163 offset:2048
    v_mfma_f32_16x16x32_bf16 v[40:43], a[140:143], v[204:207], v[40:43]
    v_exp_f32 v67, v67
    v_mfma_f32_16x16x32_bf16 v[36:39], a[144:147], v[176:179], v[136:139]
    v_exp_f32 v68, v68
    v_mfma_f32_16x16x32_bf16 v[36:39], a[148:151], v[180:183], v[36:39]
    ds_read_b128 a[220:223], v163 offset:3072
    ds_read_b128 a[224:227], v163 offset:4096
    v_mfma_f32_16x16x32_bf16 v[36:39], a[152:155], v[184:187], v[36:39]
    buffer_load_dwordx4 v2, s[28:31], s99 offen offset:1024 sc1 lds
    v_mfma_f32_16x16x32_bf16 v[36:39], a[156:159], v[188:191], v[36:39]
    v_exp_f32 v69, v69
    v_mfma_f32_16x16x32_bf16 v[44:47], a[144:147], v[192:195], v[140:143]
    ds_read_b128 a[228:231], v163 offset:5120
    ds_read_b128 a[232:235], v163 offset:6144
    v_mfma_f32_16x16x32_bf16 v[44:47], a[148:151], v[196:199], v[44:47]
    v_exp_f32 v70, v70
    v_mfma_f32_16x16x32_bf16 v[44:47], a[152:155], v[200:203], v[44:47]
    v_exp_f32 v71, v71
    v_mfma_f32_16x16x32_bf16 v[44:47], a[156:159], v[204:207], v[44:47]
    ds_read_b128 a[236:239], v163 offset:7168
    ds_read_b128 a[240:243], v163 offset:8192
    v_mfma_f32_16x16x32_bf16 v[48:51], a[160:163], v[176:179], v[144:147]
    v_exp_f32 v72, v72
    v_mfma_f32_16x16x32_bf16 v[48:51], a[164:167], v[180:183], v[48:51]
    ds_read_b128 a[244:247], v163 offset:9216
    ds_read_b128 a[248:251], v163 offset:10240
    v_mfma_f32_16x16x32_bf16 v[48:51], a[168:171], v[184:187], v[48:51]
    buffer_load_dwordx4 v2, s[28:31], s99 offen offset:2048 sc1 lds
    v_mfma_f32_16x16x32_bf16 v[48:51], a[172:175], v[188:191], v[48:51]
    v_exp_f32 v73, v73
    v_mfma_f32_16x16x32_bf16 v[56:59], a[160:163], v[192:195], v[148:151]
    v_exp_f32 v74, v74
    v_mfma_f32_16x16x32_bf16 v[56:59], a[164:167], v[196:199], v[56:59]
    ds_read_b128 a[252:255], v163 offset:11264
    ds_read_b128 v[240:243], v163 offset:12288
    v_mfma_f32_16x16x32_bf16 v[56:59], a[168:171], v[200:203], v[56:59]
    v_exp_f32 v75, v75
    v_mfma_f32_16x16x32_bf16 v[56:59], a[172:175], v[204:207], v[56:59]
    v_exp_f32 v76, v76
    v_mfma_f32_16x16x32_bf16 v[52:55], a[176:179], v[176:179], v[152:155]
    ds_read_b128 v[244:247], v163 offset:13312
    ds_read_b128 v[248:251], v163 offset:14336
    v_mfma_f32_16x16x32_bf16 v[52:55], a[180:183], v[180:183], v[52:55]
    v_exp_f32 v77, v77
    v_mfma_f32_16x16x32_bf16 v[52:55], a[184:187], v[184:187], v[52:55]
    buffer_load_dwordx4 v2, s[28:31], s99 offen offset:3072 sc1 lds
    v_mfma_f32_16x16x32_bf16 v[52:55], a[188:191], v[188:191], v[52:55]
    ds_read_b128 v[252:255], v163 offset:15360
    ds_read_b32 v165, v167
    v_mfma_f32_16x16x32_bf16 v[60:63], a[176:179], v[192:195], v[156:159]
    v_exp_f32 v78, v78
    v_mfma_f32_16x16x32_bf16 v[60:63], a[180:183], v[196:199], v[60:63]
    v_exp_f32 v79, v79
    v_mfma_f32_16x16x32_bf16 v[60:63], a[184:187], v[200:203], v[60:63]
    v_exp_f32 v80, v80
    v_mfma_f32_16x16x32_bf16 v[60:63], a[188:191], v[204:207], v[60:63]
    s_add_u32 s99, s99, 16384
    s_add_u32 m0, s3, 16384
    s_waitcnt lgkmcnt(0)
    v_mfma_f32_16x16x32_bf16 a[0:3], a[208:211], v[96:99], a[0:3]
    v_cmp_lt_u32 vcc, v165, v164
    v_mfma_f32_16x16x32_bf16 a[0:3], a[240:243], v[104:107], a[0:3]
    s_cbranch_vccnz L_sb21_s
L_sb21:
    v_mfma_f32_16x16x32_bf16 a[32:35], a[240:243], v[108:111], a[32:35]
    v_exp_f32 v81, v81
    v_mfma_f32_16x16x32_bf16 a[32:35], a[208:211], v[100:103], a[32:35]
    buffer_load_dwordx4 v2, s[32:35], s101 offen offset:0 sc1 lds
    v_mfma_f32_16x16x32_bf16 a[4:7], a[212:215], v[96:99], a[4:7]
    ds_read_b128 a[128:131], v160 offset:16384
    ds_read_b128 a[132:135], v160 offset:17408
    v_mfma_f32_16x16x32_bf16 a[4:7], a[244:247], v[104:107], a[4:7]
    v_exp_f32 v82, v82
    v_mfma_f32_16x16x32_bf16 a[36:39], a[244:247], v[108:111], a[36:39]
    v_exp_f32 v83, v83
    v_mfma_f32_16x16x32_bf16 a[36:39], a[212:215], v[100:103], a[36:39]
    ds_read_b128 a[136:139], v160 offset:18432
    ds_read_b128 a[140:143], v160 offset:19456
    v_mfma_f32_16x16x32_bf16 a[8:11], a[216:219], v[96:99], a[8:11]
    v_exp_f32 v84, v84
    v_mfma_f32_16x16x32_bf16 a[8:11], a[248:251], v[104:107], a[8:11]
    buffer_load_dwordx4 v2, s[32:35], s101 offen offset:1024 sc1 lds
    v_mfma_f32_16x16x32_bf16 a[40:43], a[248:251], v[108:111], a[40:43]
    ds_read_b128 a[144:147], v160 offset:20480
    ds_read_b128 a[148:151], v160 offset:21504
    v_mfma_f32_16x16x32_bf16 a[40:43], a[216:219], v[100:103], a[40:43]
    v_exp_f32 v85, v85
    v_mfma_f32_16x16x32_bf16 a[12:15], a[220:223], v[96:99], a[12:15]
    ds_read_b128 a[152:155], v160 offset:22528
    ds_read_b128 a[156:159], v160 offset:23552
    v_mfma_f32_16x16x32_bf16 a[12:15], a[252:255], v[104:107], a[12:15]
    v_exp_f32 v86, v86
    v_mfma_f32_16x16x32_bf16 a[44:47], a[252:255], v[108:111], a[44:47]
    ds_read_b128 a[160:163], v160 offset:24576
    ds_read_b128 a[164:167], v160 offset:25600
    v_mfma_f32_16x16x32_bf16 a[44:47], a[220:223], v[100:103], a[44:47]
    buffer_load_dwordx4 v2, s[32:35], s101 offen offset:2048 sc1 lds
    v_mfma_f32_16x16x32_bf16 a[192:195], v[28:31], v[96:99], a[192:195]
    v_exp_f32 v87, v87
    v_mfma_f32_16x16x32_bf16 a[192:195], v[28:31], v[104:107], a[192:195]
    ds_read_b128 a[168:171], v160 offset:26624
    ds_read_b128 a[172:175], v160 offset:27648
    v_mfma_f32_16x16x32_bf16 a[16:19], a[224:227], v[96:99], a[16:19]
    v_exp_f32 v88, v88
    v_mfma_f32_16x16x32_bf16 a[16:19], v[240:243], v[104:107], a[16:19]
    ds_read_b128 a[176:179], v160 offset:28672
    ds_read_b128 a[180:183], v160 offset:29696
    v_mfma_f32_16x16x32_bf16 a[48:51], v[240:243], v[108:111], a[48:51]
    v_exp_f32 v89, v89
    v_mfma_f32_16x16x32_bf16 a[48:51], a[224:227], v[100:103], a[48:51]
    buffer_load_dwordx4 v2, s[32:35], s101 offen offset:3072 sc1 lds
    v_mfma_f32_16x16x32_bf16 a[20:23], a[228:231], v[96:99], a[20:23]
    s_add_u32 s101, s101, 16384
    ds_read_b128 a[184:187], v160 offset:30720
    v_mfma_f32_16x16x32_bf16 a[20:23], v[244:247], v[104:107], a[20:23]
    v_exp_f32 v90, v90
    v_mfma_f32_16x16x32_bf16 a[52:55], v[244:247], v[108:111], a[52:55]
    ds_read_b128 a[188:191], v160 offset:31744
    v_cvt_pk_bf16_f32 v112, v64, v65
    v_mfma_f32_16x16x32_bf16 a[52:55], a[228:231], v[100:103], a[52:55]
    v_exp_f32 v91, v91
    v_mfma_f32_16x16x32_bf16 a[24:27], a[232:235], v[96:99], a[24:27]
    v_cvt_pk_bf16_f32 v113, v66, v67
    v_cvt_pk_bf16_f32 v114, v68, v69
    v_mfma_f32_16x16x32_bf16 a[24:27], v[248:251], v[104:107], a[24:27]
    v_exp_f32 v92, v92
    v_mfma_f32_16x16x32_bf16 a[56:59], v[248:251], v[108:111], a[56:59]
    v_cvt_pk_bf16_f32 v115, v70, v71
    v_cvt_pk_bf16_f32 v116, v72, v73
    v_mfma_f32_16x16x32_bf16 a[56:59], a[232:235], v[100:103], a[56:59]
    v_exp_f32 v93, v93
    v_mfma_f32_16x16x32_bf16 a[28:31], a[236:239], v[96:99], a[28:31]
    v_cvt_pk_bf16_f32 v117, v74, v75
    v_cvt_pk_bf16_f32 v118, v76, v77
    v_mfma_f32_16x16x32_bf16 a[28:31], v[252:255], v[104:107], a[28:31]
    v_exp_f32 v94, v94
    v_mfma_f32_16x16x32_bf16 a[60:63], v[252:255], v[108:111], a[60:63]
    v_cvt_pk_bf16_f32 v119, v78, v79
    v_cvt_pk_bf16_f32 v120, v80, v81
    v_mfma_f32_16x16x32_bf16 a[60:63], a[236:239], v[100:103], a[60:63]
    v_exp_f32 v95, v95
    v_mfma_f32_16x16x32_bf16 a[196:199], v[28:31], v[100:103], a[196:199]
    v_cvt_pk_bf16_f32 v121, v82, v83
    v_cvt_pk_bf16_f32 v122, v84, v85
    v_mfma_f32_16x16x32_bf16 a[196:199], v[28:31], v[108:111], a[196:199]
    v_cvt_pk_bf16_f32 v123, v86, v87
    v_cvt_pk_bf16_f32 v124, v88, v89
    v_cvt_pk_bf16_f32 v125, v90, v91
    v_cvt_pk_bf16_f32 v126, v92, v93
    v_cvt_pk_bf16_f32 v127, v94, v95
    s_cmp_eq_u32 s53, 1
    s_waitcnt vmcnt(8) lgkmcnt(0)
    s_cbranch_scc1 L_ev22_h
L_ev22:
    v_mfma_f32_16x16x32_bf16 v[64:67], a[128:131], v[176:179], v[128:131]
    v_add_u32 v164, 1, v164
    ds_write_b32 v166, v164
    v_mfma_f32_16x16x32_bf16 v[64:67], a[132:135], v[180:183], v[64:67]
    s_add_u32 m0, s100, 0
    ds_read_b128 a[208:211], v163 offset:16384
    v_mfma_f32_16x16x32_bf16 v[64:67], a[136:139], v[184:187], v[64:67]
    buffer_load_dwordx4 v2, s[28:31], s99 offen offset:0 sc1 lds
    v_mfma_f32_16x16x32_bf16 v[64:67], a[140:143], v[188:191], v[64:67]
    v_exp_f32 v32, v32
    v_mfma_f32_16x16x32_bf16 v[72:75], a[128:131], v[192:195], v[132:135]
    v_exp_f32 v33, v33
    v_mfma_f32_16x16x32_bf16 v[72:75], a[132:135], v[196:199], v[72:75]
    v_exp_f32 v34, v34
    v_mfma_f32_16x16x32_bf16 v[72:75], a[136:139], v[200:203], v[72:75]
    ds_read_b128 a[212:215], v163 offset:17408
    ds_read_b128 a[216:219], v163 offset:18432
    v_mfma_f32_16x16x32_bf16 v[72:75], a[140:143], v[204:207], v[72:75]
    v_exp_f32 v35, v35
    v_mfma_f32_16x16x32_bf16 v[68:71], a[144:147], v[176:179], v[136:139]
    v_exp_f32 v36, v36
    v_mfma_f32_16x16x32_bf16 v[68:71], a[148:151], v[180:183], v[68:71]
    ds_read_b128 a[220:223], v163 offset:19456
    ds_read_b128 a[224:227], v163 offset:20480
    v_mfma_f32_16x16x32_bf16 v[68:71], a[152:155], v[184:187], v[68:71]
    buffer_load_dwordx4 v2, s[28:31], s99 offen offset:1024 sc1 lds
    v_mfma_f32_16x16x32_bf16 v[68:71], a[156:159], v[188:191], v[68:71]
    v_exp_f32 v37, v37
    v_mfma_f32_16x16x32_bf16 v[76:79], a[144:147], v[192:195], v[140:143]
    ds_read_b128 a[228:231], v163 offset:21504
    ds_read_b128 a[232:235], v163 offset:22528
    v_mfma_f32_16x16x32_bf16 v[76:79], a[148:151], v[196:199], v[76:79]
    v_exp_f32 v38, v38
    v_mfma_f32_16x16x32_bf16 v[76:79], a[152:155], v[200:203], v[76:79]
    v_exp_f32 v39, v39
    v_mfma_f32_16x16x32_bf16 v[76:79], a[156:159], v[204:207], v[76:79]
    ds_read_b128 a[236:239], v163 offset:23552
    ds_read_b128 a[240:243], v163 offset:24576
    v_mfma_f32_16x16x32_bf16 v[80:83], a[160:163], v[176:179], v[144:147]
    v_exp_f32 v40, v40
    v_mfma_f32_16x16x32_bf16 v[80:83], a[164:167], v[180:183], v[80:83]
    ds_read_b128 a[244:247], v163 offset:25600
    ds_read_b128 a[248:251], v163 offset:26624
    v_mfma_f32_16x16x32_bf16 v[80:83], a[168:171], v[184:187], v[80:83]
    buffer_load_dwordx4 v2, s[28:31], s99 offen offset:2048 sc1 lds
    v_mfma_f32_16x16x32_bf16 v[80:83], a[172:175], v[188:191], v[80:83]
    v_exp_f32 v41, v41
    v_mfma_f32_16x16x32_bf16 v[88:91], a[160:163], v[192:195], v[148:151]
    v_exp_f32 v42, v42
    v_mfma_f32_16x16x32_bf16 v[88:91], a[164:167], v[196:199], v[88:91]
    ds_read_b128 a[252:255], v163 offset:27648
    ds_read_b128 v[240:243], v163 offset:28672
    v_mfma_f32_16x16x32_bf16 v[88:91], a[168:171], v[200:203], v[88:91]
    v_exp_f32 v43, v43
    v_mfma_f32_16x16x32_bf16 v[88:91], a[172:175], v[204:207], v[88:91]
    v_exp_f32 v44, v44
    v_mfma_f32_16x16x32_bf16 v[84:87], a[176:179], v[176:179], v[152:155]
    ds_read_b128 v[244:247], v163 offset:29696
    ds_read_b128 v[248:251], v163 offset:30720
    v_mfma_f32_16x16x32_bf16 v[84:87], a[180:183], v[180:183], v[84:87]
    v_exp_f32 v45, v45
    v_mfma_f32_16x16x32_bf16 v[84:87], a[184:187], v[184:187], v[84:87]
    buffer_load_dwordx4 v2, s[28:31], s99 offen offset:3072 sc1 lds
    v_mfma_f32_16x16x32_bf16 v[84:87], a[188:191], v[188:191], v[84:87]
    ds_read_b128 v[252:255], v163 offset:31744
    ds_read_b32 v165, v167
    v_mfma_f32_16x16x32_bf16 v[92:95], a[176:179], v[192:195], v[156:159]
    v_exp_f32 v46, v46
    v_mfma_f32_16x16x32_bf16 v[92:95], a[180:183], v[196:199], v[92:95]
    v_exp_f32 v47, v47
    v_mfma_f32_16x16x32_bf16 v[92:95], a[184:187], v[200:203], v[92:95]
    v_exp_f32 v48, v48
    v_mfma_f32_16x16x32_bf16 v[92:95], a[188:191], v[204:207], v[92:95]
    s_add_u32 s99, s99, 16384
    s_add_u32 m0, s92, 0
    s_waitcnt lgkmcnt(0)
    v_mfma_f32_16x16x32_bf16 a[0:3], a[208:211], v[112:115], a[0:3]
    v_cmp_lt_u32 vcc, v165, v164
    v_mfma_f32_16x16x32_bf16 a[0:3], a[240:243], v[120:123], a[0:3]
    s_cbranch_vccnz L_sb23_s
L_sb23:
    v_mfma_f32_16x16x32_bf16 a[32:35], a[240:243], v[124:127], a[32:35]
    v_exp_f32 v49, v49
    v_mfma_f32_16x16x32_bf16 a[32:35], a[208:211], v[116:119], a[32:35]
    buffer_load_dwordx4 v2, s[32:35], s101 offen offset:0 sc1 lds
    v_mfma_f32_16x16x32_bf16 a[4:7], a[212:215], v[112:115], a[4:7]
    ds_read_b128 a[128:131], v161 offset:0
    ds_read_b128 a[132:135], v161 offset:1024
    v_mfma_f32_16x16x32_bf16 a[4:7], a[244:247], v[120:123], a[4:7]
    v_exp_f32 v50, v50
    v_mfma_f32_16x16x32_bf16 a[36:39], a[244:247], v[124:127], a[36:39]
    v_exp_f32 v51, v51
    v_mfma_f32_16x16x32_bf16 a[36:39], a[212:215], v[116:119], a[36:39]
    ds_read_b128 a[136:139], v161 offset:2048
    ds_read_b128 a[140:143], v161 offset:3072
    v_mfma_f32_16x16x32_bf16 a[8:11], a[216:219], v[112:115], a[8:11]
    v_exp_f32 v52, v52
    v_mfma_f32_16x16x32_bf16 a[8:11], a[248:251], v[120:123], a[8:11]
    buffer_load_dwordx4 v2, s[32:35], s101 offen offset:1024 sc1 lds
    v_mfma_f32_16x16x32_bf16 a[40:43], a[248:251], v[124:127], a[40:43]
    ds_read_b128 a[144:147], v161 offset:4096
    ds_read_b128 a[148:151], v161 offset:5120
    v_mfma_f32_16x16x32_bf16 a[40:43], a[216:219], v[116:119], a[40:43]
    v_exp_f32 v53, v53
    v_mfma_f32_16x16x32_bf16 a[12:15], a[220:223], v[112:115], a[12:15]
    ds_read_b128 a[152:155], v161 offset:6144
    ds_read_b128 a[156:159], v161 offset:7168
    v_mfma_f32_16x16x32_bf16 a[12:15], a[252:255], v[120:123], a[12:15]
    v_exp_f32 v54, v54
    v_mfma_f32_16x16x32_bf16 a[44:47], a[252:255], v[124:127], a[44:47]
    ds_read_b128 a[160:163], v161 offset:8192
    ds_read_b128 a[164:167], v161 offset:9216
    v_mfma_f32_16x16x32_bf16 a[44:47], a[220:223], v[116:119], a[44:47]
    buffer_load_dwordx4 v2, s[32:35], s101 offen offset:2048 sc1 lds
    v_mfma_f32_16x16x32_bf16 a[192:195], v[28:31], v[112:115], a[192:195]
    v_exp_f32 v55, v55
    v_mfma_f32_16x16x32_bf16 a[192:195], v[28:31], v[120:123], a[192:195]
    ds_read_b128 a[168:171], v161 offset:10240
    ds_read_b128 a[172:175], v161 offset:11264
    v_mfma_f32_16x16x32_bf16 a[16:19], a[224:227], v[112:115], a[16:19]
    v_exp_f32 v56, v56
    v_mfma_f32_16x16x32_bf16 a[16:19], v[240:243], v[120:123], a[16:19]
    ds_read_b128 a[176:179], v161 offset:12288
    ds_read_b128 a[180:183], v161 offset:13312
    v_mfma_f32_16x16x32_bf16 a[48:51], v[240:243], v[124:127], a[48:51]
    v_exp_f32 v57, v57
    v_mfma_f32_16x16x32_bf16 a[48:51], a[224:227], v[116:119], a[48:51]
    buffer_load_dwordx4 v2, s[32:35], s101 offen offset:3072 sc1 lds
    v_mfma_f32_16x16x32_bf16 a[20:23], a[228:231], v[112:115], a[20:23]
    s_add_u32 s101, s101, 16384
    ds_read_b128 a[184:187], v161 offset:14336
    v_mfma_f32_16x16x32_bf16 a[20:23], v[244:247], v[120:123], a[20:23]
    v_exp_f32 v58, v58
    v_mfma_f32_16x16x32_bf16 a[52:55], v[244:247], v[124:127], a[52:55]
    ds_read_b128 a[188:191], v161 offset:15360
    v_cvt_pk_bf16_f32 v96, v32, v33
    v_mfma_f32_16x16x32_bf16 a[52:55], a[228:231], v[116:119], a[52:55]
    v_exp_f32 v59, v59
    v_mfma_f32_16x16x32_bf16 a[24:27], a[232:235], v[112:115], a[24:27]
    v_cvt_pk_bf16_f32 v97, v34, v35
    v_cvt_pk_bf16_f32 v98, v36, v37
    v_mfma_f32_16x16x32_bf16 a[24:27], v[248:251], v[120:123], a[24:27]
    v_exp_f32 v60, v60
    v_mfma_f32_16x16x32_bf16 a[56:59], v[248:251], v[124:127], a[56:59]
    v_cvt_pk_bf16_f32 v99, v38, v39
    v_cvt_pk_bf16_f32 v100, v40, v41
    v_mfma_f32_16x16x32_bf16 a[56:59], a[232:235], v[116:119], a[56:59]
    v_exp_f32 v61, v61
    v_mfma_f32_16x16x32_bf16 a[28:31], a[236:239], v[112:115], a[28:31]
    v_cvt_pk_bf16_f32 v101, v42, v43
    v_cvt_pk_bf16_f32 v102, v44, v45
    v_mfma_f32_16x16x32_bf16 a[28:31], v[252:255], v[120:123], a[28:31]
    v_exp_f32 v62, v62
    v_mfma_f32_16x16x32_bf16 a[60:63], v[252:255], v[124:127], a[60:63]
    v_cvt_pk_bf16_f32 v103, v46, v47
    v_cvt_pk_bf16_f32 v104, v48, v49
    v_mfma_f32_16x16x32_bf16 a[60:63], a[236:239], v[116:119], a[60:63]
    v_exp_f32 v63, v63
    v_mfma_f32_16x16x32_bf16 a[196:199], v[28:31], v[116:119], a[196:199]
    v_cvt_pk_bf16_f32 v105, v50, v51
    v_cvt_pk_bf16_f32 v106, v52, v53
    v_mfma_f32_16x16x32_bf16 a[196:199], v[28:31], v[124:127], a[196:199]
    v_cvt_pk_bf16_f32 v107, v54, v55
    v_cvt_pk_bf16_f32 v108, v56, v57
    v_cvt_pk_bf16_f32 v109, v58, v59
    v_cvt_pk_bf16_f32 v110, v60, v61
    v_cvt_pk_bf16_f32 v111, v62, v63
    s_sub_u32 s53, s53, 1
    s_cmp_lg_u32 s53, 0
    s_cbranch_scc1 L_loopE
    s_branch L_tail
.p2align 5
L_loopE1:
    s_waitcnt vmcnt(8) lgkmcnt(0)
    v_mfma_f32_16x16x32_bf16 v[32:35], a[128:131], v[176:179], v[128:131]
    v_add_u32 v164, 1, v164
    ds_write_b32 v166, v164
    v_mfma_f32_16x16x32_bf16 v[32:35], a[132:135], v[180:183], v[32:35]
    v_exp_f32 v64, v64
    v_mfma_f32_16x16x32_bf16 v[32:35], a[136:139], v[184:187], v[32:35]
    v_exp_f32 v65, v65
    v_mfma_f32_16x16x32_bf16 v[32:35], a[140:143], v[188:191], v[32:35]
    v_exp_f32 v66, v66
    v_mfma_f32_16x16x32_bf16 v[40:43], a[128:131], v[192:195], v[132:135]
    ds_read_b128 a[208:211], v162 offset:0
    s_add_u32 m0, s100, 16384
    v_mfma_f32_16x16x32_bf16 v[40:43], a[132:135], v[196:199], v[40:43]
    ds_read_b128 a[212:215], v162 offset:1024
    ds_read_b128 a[216:219], v162 offset:2048
    v_mfma_f32_16x16x32_bf16 v[40:43], a[136:139], v[200:203], v[40:43]
    buffer_load_dwordx4 v2, s[28:31], s99 offen offset:0 sc1 lds
    v_mfma_f32_16x16x32_bf16 v[40:43], a[140:143], v[204:207], v[40:43]
    v_exp_f32 v67, v67
    v_mfma_f32_16x16x32_bf16 v[36:39], a[144:147], v[176:179], v[136:139]
    v_exp_f32 v68, v68
    v_mfma_f32_16x16x32_bf16 v[36:39], a[148:151], v[180:183], v[36:39]
    ds_read_b128 a[220:223], v162 offset:3072
    ds_read_b128 a[224:227], v162 offset:4096
    v_mfma_f32_16x16x32_bf16 v[36:39], a[152:155], v[184:187], v[36:39]
    v_exp_f32 v69, v69
    v_mfma_f32_16x16x32_bf16 v[36:39], a[156:159], v[188:191], v[36:39]
    v_exp_f32 v70, v70
    v_mfma_f32_16x16x32_bf16 v[44:47], a[144:147], v[192:195], v[140:143]
    ds_read_b128 a[228:231], v162 offset:5120
    ds_read_b128 a[232:235], v162 offset:6144
    v_mfma_f32_16x16x32_bf16 v[44:47], a[148:151], v[196:199], v[44:47]
    v_exp_f32 v71, v71
    v_mfma_f32_16x16x32_bf16 v[44:47], a[152:155], v[200:203], v[44:47]
    buffer_load_dwordx4 v2, s[28:31], s99 offen offset:1024 sc1 lds
    v_mfma_f32_16x16x32_bf16 v[44:47], a[156:159], v[204:207], v[44:47]
    ds_read_b128 a[236:239], v162 offset:7168
    ds_read_b128 a[240:243], v162 offset:8192
    v_mfma_f32_16x16x32_bf16 v[48:51], a[160:163], v[176:179], v[144:147]
    v_exp_f32 v72, v72
    v_mfma_f32_16x16x32_bf16 v[48:51], a[164:167], v[180:183], v[48:51]
    v_exp_f32 v73, v73
    v_mfma_f32_16x16x32_bf16 v[48:51], a[168:171], v[184:187], v[48:51]
    ds_read_b128 a[244:247], v162 offset:9216
    ds_read_b128 a[248:251], v162 offset:10240
    v_mfma_f32_16x16x32_bf16 v[48:51], a[172:175], v[188:191], v[48:51]
    v_exp_f32 v74, v74
    v_mfma_f32_16x16x32_bf16 v[56:59], a[160:163], v[192:195], v[148:151]
    v_exp_f32 v75, v75
    v_mfma_f32_16x16x32_bf16 v[56:59], a[164:167], v[196:199], v[56:59]
    ds_read_b128 a[252:255], v162 offset:11264
    ds_read_b128 v[240:243], v162 offset:12288
    v_mfma_f32_16x16x32_bf16 v[56:59], a[168:171], v[200:203], v[56:59]
    buffer_load_dwordx4 v2, s[28:31], s99 offen offset:2048 sc1 lds
    v_mfma_f32_16x16x32_bf16 v[56:59], a[172:175], v[204:207], v[56:59]
    v_exp_f32 v76, v76
    v_mfma_f32_16x16x32_bf16 v[52:55], a[176:179], v[176:179], v[152:155]
    ds_read_b128 v[244:247], v162 offset:13312
    ds_read_b128 v[248:251], v162 offset:14336
    v_mfma_f32_16x16x32_bf16 v[52:55], a[180:183], v[180:183], v[52:55]
    v_exp_f32 v77, v77
    v_mfma_f32_16x16x32_bf16 v[52:55], a[184:187], v[184:187], v[52:55]
    v_exp_f32 v78, v78
    v_mfma_f32_16x16x32_bf16 v[52:55], a[188:191], v[188:191], v[52:55]
    ds_read_b128 v[252:255], v162 offset:15360
    ds_read_b32 v165, v167
    v_mfma_f32_16x16x32_bf16 v[60:63], a[176:179], v[192:195], v[156:159]
    v_exp_f32 v79, v79
    v_mfma_f32_16x16x32_bf16 v[60:63], a[180:183], v[196:199], v[60:63]
    v_exp_f32 v80, v80
    v_mfma_f32_16x16x32_bf16 v[60:63], a[184:187], v[200:203], v[60:63]
    buffer_load_dwordx4 v2, s[28:31], s99 offen offset:3072 sc1 lds
    v_mfma_f32_16x16x32_bf16 v[60:63], a[188:191], v[204:207], v[60:63]
    v_exp_f32 v81, v81
    s_waitcnt lgkmcnt(0)
    v_mfma_f32_16x16x32_bf16 a[0:3], a[208:211], v[96:99], a[0:3]
    v_cmp_lt_u32 vcc, v165, v164
    v_mfma_f32_16x16x32_bf16 a[0:3], a[240:243], v[104:107], a[0:3]
    s_cbranch_vccnz L_sb25_s
L_sb25:
    v_mfma_f32_16x16x32_bf16 a[32:35], a[240:243], v[108:111], a[32:35]
    s_add_u32 s99, s99, 16384
    ds_read_b128 a[128:131], v161 offset:16384
    v_mfma_f32_16x16x32_bf16 a[32:35], a[208:211], v[100:103], a[32:35]
    v_exp_f32 v82, v82
    v_mfma_f32_16x16x32_bf16 a[4:7], a[212:215], v[96:99], a[4:7]
    s_add_u32 m0, s92, 16384
    ds_read_b128 a[132:135], v161 offset:17408
    v_mfma_f32_16x16x32_bf16 a[4:7], a[244:247], v[104:107], a[4:7]
    v_exp_f32 v83, v83
    v_mfma_f32_16x16x32_bf16 a[36:39], a[244:247], v[108:111], a[36:39]
    buffer_load_dwordx4 v2, s[32:35], s101 offen offset:0 sc1 lds
    v_mfma_f32_16x16x32_bf16 a[36:39], a[212:215], v[100:103], a[36:39]
    ds_read_b128 a[136:139], v161 offset:18432
    ds_read_b128 a[140:143], v161 offset:19456
    v_mfma_f32_16x16x32_bf16 a[8:11], a[216:219], v[96:99], a[8:11]
    v_exp_f32 v84, v84
    v_mfma_f32_16x16x32_bf16 a[8:11], a[248:251], v[104:107], a[8:11]
    ds_read_b128 a[144:147], v161 offset:20480
    ds_read_b128 a[148:151], v161 offset:21504
    v_mfma_f32_16x16x32_bf16 a[40:43], a[248:251], v[108:111], a[40:43]
    v_exp_f32 v85, v85
    v_mfma_f32_16x16x32_bf16 a[40:43], a[216:219], v[100:103], a[40:43]
    ds_read_b128 a[152:155], v161 offset:22528
    ds_read_b128 a[156:159], v161 offset:23552
    v_mfma_f32_16x16x32_bf16 a[12:15], a[220:223], v[96:99], a[12:15]
    buffer_load_dwordx4 v2, s[32:35], s101 offen offset:1024 sc1 lds
    v_mfma_f32_16x16x32_bf16 a[12:15], a[252:255], v[104:107], a[12:15]
    v_exp_f32 v86, v86
    v_mfma_f32_16x16x32_bf16 a[44:47], a[252:255], v[108:111], a[44:47]
    ds_read_b128 a[160:163], v161 offset:24576
    ds_read_b128 a[164:167], v161 offset:25600
    v_mfma_f32_16x16x32_bf16 a[44:47], a[220:223], v[100:103], a[44:47]
    v_exp_f32 v87, v87
    v_mfma_f32_16x16x32_bf16 a[192:195], v[28:31], v[96:99], a[192:195]
    ds_read_b128 a[168:171], v161 offset:26624
    ds_read_b128 a[172:175], v161 offset:27648
    v_mfma_f32_16x16x32_bf16 a[192:195], v[28:31], v[104:107], a[192:195]
    v_exp_f32 v88, v88
    v_mfma_f32_16x16x32_bf16 a[16:19], a[224:227], v[96:99], a[16:19]
    buffer_load_dwordx4 v2, s[32:35], s101 offen offset:2048 sc1 lds
    v_mfma_f32_16x16x32_bf16 a[16:19], v[240:243], v[104:107], a[16:19]
    ds_read_b128 a[176:179], v161 offset:28672
    ds_read_b128 a[180:183], v161 offset:29696
    v_mfma_f32_16x16x32_bf16 a[48:51], v[240:243], v[108:111], a[48:51]
    v_exp_f32 v89, v89
    v_mfma_f32_16x16x32_bf16 a[48:51], a[224:227], v[100:103], a[48:51]
    ds_read_b128 a[184:187], v161 offset:30720
    ds_read_b128 a[188:191], v161 offset:31744
    v_mfma_f32_16x16x32_bf16 a[20:23], a[228:231], v[96:99], a[20:23]
    v_exp_f32 v90, v90
    v_mfma_f32_16x16x32_bf16 a[20:23], v[244:247], v[104:107], a[20:23]
    v_cvt_pk_bf16_f32 v112, v64, v65
    v_cvt_pk_bf16_f32 v113, v66, v67
    v_mfma_f32_16x16x32_bf16 a[52:55], v[244:247], v[108:111], a[52:55]
    buffer_load_dwordx4 v2, s[32:35], s101 offen offset:3072 sc1 lds
    v_mfma_f32_16x16x32_bf16 a[52:55], a[228:231], v[100:103], a[52:55]
    v_exp_f32 v91, v91
    v_mfma_f32_16x16x32_bf16 a[24:27], a[232:235], v[96:99], a[24:27]
    s_add_u32 s101, s101, 16384
    v_cvt_pk_bf16_f32 v114, v68, v69
    v_mfma_f32_16x16x32_bf16 a[24:27], v[248:251], v[104:107], a[24:27]
    v_exp_f32 v92, v92
    v_mfma_f32_16x16x32_bf16 a[56:59], v[248:251], v[108:111], a[56:59]
    v_cvt_pk_bf16_f32 v115, v70, v71
    v_cvt_pk_bf16_f32 v116, v72, v73
    v_mfma_f32_16x16x32_bf16 a[56:59], a[232:235], v[100:103], a[56:59]
    v_exp_f32 v93, v93
    v_mfma_f32_16x16x32_bf16 a[28:31], a[236:239], v[96:99], a[28:31]
    v_cvt_pk_bf16_f32 v117, v74, v75
    v_cvt_pk_bf16_f32 v118, v76, v77
    v_mfma_f32_16x16x32_bf16 a[28:31], v[252:255], v[104:107], a[28:31]
    v_exp_f32 v94, v94
    v_mfma_f32_16x16x32_bf16 a[60:63], v[252:255], v[108:111], a[60:63]
    v_cvt_pk_bf16_f32 v119, v78, v79
    v_cvt_pk_bf16_f32 v120, v80, v81
    v_mfma_f32_16x16x32_bf16 a[60:63], a[236:239], v[100:103], a[60:63]
    v_exp_f32 v95, v95
    v_mfma_f32_16x16x32_bf16 a[196:199], v[28:31], v[100:103], a[196:199]
    v_cvt_pk_bf16_f32 v121, v82, v83
    v_cvt_pk_bf16_f32 v122, v84, v85
    v_mfma_f32_16x16x32_bf16 a[196:199], v[28:31], v[108:111], a[196:199]
    v_cvt_pk_bf16_f32 v123, v86, v87
    v_cvt_pk_bf16_f32 v124, v88, v89
    v_cvt_pk_bf16_f32 v125, v90, v91
    v_cvt_pk_bf16_f32 v126, v92, v93
    v_cvt_pk_bf16_f32 v127, v94, v95
    s_waitcnt vmcnt(8) lgkmcnt(0)
    v_mfma_f32_16x16x32_bf16 v[64:67], a[128:131], v[176:179], v[128:131]
    v_add_u32 v164, 1, v164
    ds_write_b32 v166, v164
    v_mfma_f32_16x16x32_bf16 v[64:67], a[132:135], v[180:183], v[64:67]
    v_exp_f32 v32, v32
    v_mfma_f32_16x16x32_bf16 v[64:67], a[136:139], v[184:187], v[64:67]
    v_exp_f32 v33, v33
    v_mfma_f32_16x16x32_bf16 v[64:67], a[140:143], v[188:191], v[64:67]
    v_exp_f32 v34, v34
    v_mfma_f32_16x16x32_bf16 v[72:75], a[128:131], v[192:195], v[132:135]
    ds_read_b128 a[208:211], v162 offset:16384
    s_add_u32 m0, s96, 0
    v_mfma_f32_16x16x32_bf16 v[72:75], a[132:135], v[196:199], v[72:75]
    ds_read_b128 a[212:215], v162 offset:17408
    ds_read_b128 a[216:219], v162 offset:18432
    v_mfma_f32_16x16x32_bf16 v[72:75], a[136:139], v[200:203], v[72:75]
    buffer_load_dwordx4 v2, s[28:31], s99 offen offset:0 sc1 lds
    v_mfma_f32_16x16x32_bf16 v[72:75], a[140:143], v[204:207], v[72:75]
    v_exp_f32 v35, v35
    v_mfma_f32_16x16x32_bf16 v[68:71], a[144:147], v[176:179], v[136:139]
    v_exp_f32 v36, v36
    v_mfma_f32_16x16x32_bf16 v[68:71], a[148:151], v[180:183], v[68:71]
    ds_read_b128 a[220:223], v162 offset:19456
    ds_read_b128 a[224:227], v162 offset:20480
    v_mfma_f32_16x16x32_bf16 v[68:71], a[152:155], v[184:187], v[68:71]
    v_exp_f32 v37, v37
    v_mfma_f32_16x16x32_bf16 v[68:71], a[156:159], v[188:191], v[68:71]
    v_exp_f32 v38, v38
    v_mfma_f32_16x16x32_bf16 v[76:79], a[144:147], v[192:195], v[140:143]
    ds_read_b128 a[228:231], v162 offset:21504
    ds_read_b128 a[232:235], v162 offset:22528
    v_mfma_f32_16x16x32_bf16 v[76:79], a[148:151], v[196:199], v[76:79]
    v_exp_f32 v39, v39
    v_mfma_f32_16x16x32_bf16 v[76:79], a[152:155], v[200:203], v[76:79]
    buffer_load_dwordx4 v2, s[28:31], s99 offen offset:1024 sc1 lds
    v_mfma_f32_16x16x32_bf16 v[76:79], a[156:159], v[204:207], v[76:79]
    ds_read_b128 a[236:239], v162 offset:23552
    ds_read_b128 a[240:243], v162 offset:24576
    v_mfma_f32_16x16x32_bf16 v[80:83], a[160:163], v[176:179], v[144:147]
    v_exp_f32 v40, v40
    v_mfma_f32_16x16x32_bf16 v[80:83], a[164:167], v[180:183], v[80:83]
    v_exp_f32 v41, v41
    v_mfma_f32_16x16x32_bf16 v[80:83], a[168:171], v[184:187], v[80:83]
    ds_read_b128 a[244:247], v162 offset:25600
    ds_read_b128 a[248:251], v162 offset:26624
    v_mfma_f32_16x16x32_bf16 v[80:83], a[172:175], v[188:191], v[80:83]
    v_exp_f32 v42, v42
    v_mfma_f32_16x16x32_bf16 v[88:91], a[160:163], v[192:195], v[148:151]
    v_exp_f32 v43, v43
    v_mfma_f32_16x16x32_bf16 v[88:91], a[164:167], v[196:199], v[88:91]
    ds_read_b128 a[252:255], v162 offset:27648
    ds_read_b128 v[240:243], v162 offset:28672
    v_mfma_f32_16x16x32_bf16 v[88:91], a[168:171], v[200:203], v[88:91]
    buffer_load_dwordx4 v2, s[28:31], s99 offen offset:2048 sc1 lds
    v_mfma_f32_16x16x32_bf16 v[88:91], a[172:175], v[204:207], v[88:91]
    v_exp_f32 v44, v44
    v_mfma_f32_16x16x32_bf16 v[84:87], a[176:179], v[176:179], v[152:155]
    ds_read_b128 v[244:247], v162 offset:29696
    ds_read_b128 v[248:251], v162 offset:30720
    v_mfma_f32_16x16x32_bf16 v[84:87], a[180:183], v[180:183], v[84:87]
    v_exp_f32 v45, v45
    v_mfma_f32_16x16x32_bf16 v[84:87], a[184:187], v[184:187], v[84:87]
    v_exp_f32 v46, v46
    v_mfma_f32_16x16x32_bf16 v[84:87], a[188:191], v[188:191], v[84:87]
    ds_read_b128 v[252:255], v162 offset:31744
    ds_read_b32 v165, v167
    v_mfma_f32_16x16x32_bf16 v[92:95], a[176:179], v[192:195], v[156:159]
    v_exp_f32 v47, v47
    v_mfma_f32_16x16x32_bf16 v[92:95], a[180:183], v[196:199], v[92:95]
    v_exp_f32 v48, v48
    v_mfma_f32_16x16x32_bf16 v[92:95], a[184:187], v[200:203], v[92:95]
    buffer_load_dwordx4 v2, s[28:31], s99 offen offset:3072 sc1 lds
    v_mfma_f32_16x16x32_bf16 v[92:95], a[188:191], v[204:207], v[92:95]
    v_exp_f32 v49, v49
    s_waitcnt lgkmcnt(0)
    v_mfma_f32_16x16x32_bf16 a[0:3], a[208:211], v[112:115], a[0:3]
    v_cmp_lt_u32 vcc, v165, v164
    v_mfma_f32_16x16x32_bf16 a[0:3], a[240:243], v[120:123], a[0:3]
    s_cbranch_vccnz L_sb27_s
L_sb27:
    v_mfma_f32_16x16x32_bf16 a[32:35], a[240:243], v[124:127], a[32:35]
    s_add_u32 s99, s99, 16384
    ds_read_b128 a[128:131], v160 offset:0
    v_mfma_f32_16x16x32_bf16 a[32:35], a[208:211], v[116:119], a[32:35]
    v_exp_f32 v50, v50
    v_mfma_f32_16x16x32_bf16 a[4:7], a[212:215], v[112:115], a[4:7]
    s_add_u32 m0, s3, 0
    ds_read_b128 a[132:135], v160 offset:1024
    v_mfma_f32_16x16x32_bf16 a[4:7], a[244:247], v[120:123], a[4:7]
    v_exp_f32 v51, v51
    v_mfma_f32_16x16x32_bf16 a[36:39], a[244:247], v[124:127], a[36:39]
    buffer_load_dwordx4 v2, s[32:35], s101 offen offset:0 sc1 lds
    v_mfma_f32_16x16x32_bf16 a[36:39], a[212:215], v[116:119], a[36:39]
    ds_read_b128 a[136:139], v160 offset:2048
    ds_read_b128 a[140:143], v160 offset:3072
    v_mfma_f32_16x16x32_bf16 a[8:11], a[216:219], v[112:115], a[8:11]
    v_exp_f32 v52, v52
    v_mfma_f32_16x16x32_bf16 a[8:11], a[248:251], v[120:123], a[8:11]
    ds_read_b128 a[144:147], v160 offset:4096
    ds_read_b128 a[148:151], v160 offset:5120
    v_mfma_f32_16x16x32_bf16 a[40:43], a[248:251], v[124:127], a[40:43]
    v_exp_f32 v53, v53
    v_mfma_f32_16x16x32_bf16 a[40:43], a[216:219], v[116:119], a[40:43]
    ds_read_b128 a[152:155], v160 offset:6144
    ds_read_b128 a[156:159], v160 offset:7168
    v_mfma_f32_16x16x32_bf16 a[12:15], a[220:223], v[112:115], a[12:15]
    buffer_load_dwordx4 v2, s[32:35], s101 offen offset:1024 sc1 lds
    v_mfma_f32_16x16x32_bf16 a[12:15], a[252:255], v[120:123], a[12:15]
    v_exp_f32 v54, v54
    v_mfma_f32_16x16x32_bf16 a[44:47], a[252:255], v[124:127], a[44:47]
    ds_read_b128 a[160:163], v160 offset:8192
    ds_read_b128 a[164:167], v160 offset:9216
    v_mfma_f32_16x16x32_bf16 a[44:47], a[220:223], v[116:119], a[44:47]
    v_exp_f32 v55, v55
    v_mfma_f32_16x16x32_bf16 a[192:195], v[28:31], v[112:115], a[192:195]
    ds_read_b128 a[168:171], v160 offset:10240
    ds_read_b128 a[172:175], v160 offset:11264
    v_mfma_f32_16x16x32_bf16 a[192:195], v[28:31], v[120:123], a[192:195]
    v_exp_f32 v56, v56
    v_mfma_f32_16x16x32_bf16 a[16:19], a[224:227], v[112:115], a[16:19]
    buffer_load_dwordx4 v2, s[32:35], s101 offen offset:2048 sc1 lds
    v_mfma_f32_16x16x32_bf16 a[16:19], v[240:243], v[120:123], a[16:19]
    ds_read_b128 a[176:179], v160 offset:12288
    ds_read_b128 a[180:183], v160 offset:13312
    v_mfma_f32_16x16x32_bf16 a[48:51], v[240:243], v[124:127], a[48:51]
    v_exp_f32 v57, v57
    v_mfma_f32_16x16x32_bf16 a[48:51], a[224:227], v[116:119], a[48:51]
    ds_read_b128 a[184:187], v160 offset:14336
    ds_read_b128 a[188:191], v160 offset:15360
    v_mfma_f32_16x16x32_bf16 a[20:23], a[228:231], v[112:115], a[20:23]
    v_exp_f32 v58, v58
    v_mfma_f32_16x16x32_bf16 a[20:23], v[244:247], v[120:123], a[20:23]
    v_cvt_pk_bf16_f32 v96, v32, v33
    v_cvt_pk_bf16_f32 v97, v34, v35
    v_mfma_f32_16x16x32_bf16 a[52:55], v[244:247], v[124:127], a[52:55]
    buffer_load_dwordx4 v2, s[32:35], s101 offen offset:3072 sc1 lds
    v_mfma_f32_16x16x32_bf16 a[52:55], a[228:231], v[116:119], a[52:55]
    v_exp_f32 v59, v59
    v_mfma_f32_16x16x32_bf16 a[24:27], a[232:235], v[112:115], a[24:27]
    s_add_u32 s101, s101, 16384
    v_cvt_pk_bf16_f32 v98, v36, v37
    v_mfma_f32_16x16x32_bf16 a[24:27], v[248:251], v[120:123], a[24:27]
    v_exp_f32 v60, v60
    v_mfma_f32_16x16x32_bf16 a[56:59], v[248:251], v[124:127], a[56:59]
    v_cvt_pk_bf16_f32 v99, v38, v39
    v_cvt_pk_bf16_f32 v100, v40, v41
    v_mfma_f32_16x16x32_bf16 a[56:59], a[232:235], v[116:119], a[56:59]
    v_exp_f32 v61, v61
    v_mfma_f32_16x16x32_bf16 a[28:31], a[236:239], v[112:115], a[28:31]
    v_cvt_pk_bf16_f32 v101, v42, v43
    v_cvt_pk_bf16_f32 v102, v44, v45
    v_mfma_f32_16x16x32_bf16 a[28:31], v[252:255], v[120:123], a[28:31]
    v_exp_f32 v62, v62
    v_mfma_f32_16x16x32_bf16 a[60:63], v[252:255], v[124:127], a[60:63]
    v_cvt_pk_bf16_f32 v103, v46, v47
    v_cvt_pk_bf16_f32 v104, v48, v49
    v_mfma_f32_16x16x32_bf16 a[60:63], a[236:239], v[116:119], a[60:63]
    v_exp_f32 v63, v63
    v_mfma_f32_16x16x32_bf16 a[196:199], v[28:31], v[116:119], a[196:199]
    v_cvt_pk_bf16_f32 v105, v50, v51
    v_cvt_pk_bf16_f32 v106, v52, v53
    v_mfma_f32_16x16x32_bf16 a[196:199], v[28:31], v[124:127], a[196:199]
    v_cvt_pk_bf16_f32 v107, v54, v55
    v_cvt_pk_bf16_f32 v108, v56, v57
    v_cvt_pk_bf16_f32 v109, v58, v59
    v_cvt_pk_bf16_f32 v110, v60, v61
    v_cvt_pk_bf16_f32 v111, v62, v63
    s_cmp_eq_u32 s53, 1
    s_waitcnt vmcnt(8) lgkmcnt(0)
    s_cbranch_scc1 L_ev28_h
L_ev28:
    v_mfma_f32_16x16x32_bf16 v[32:35], a[128:131], v[176:179], v[128:131]
    v_add_u32 v164, 1, v164
    ds_write_b32 v166, v164
    v_mfma_f32_16x16x32_bf16 v[32:35], a[132:135], v[180:183], v[32:35]
    v_exp_f32 v64, v64
    v_mfma_f32_16x16x32_bf16 v[32:35], a[136:139], v[184:187], v[32:35]
    v_exp_f32 v65, v65
    v_mfma_f32_16x16x32_bf16 v[32:35], a[140:143], v[188:191], v[32:35]
    v_exp_f32 v66, v66
    v_mfma_f32_16x16x32_bf16 v[40:43], a[128:131], v[192:195], v[132:135]
    ds_read_b128 a[208:211], v163 offset:0
    s_add_u32 m0, s96, 16384
    v_mfma_f32_16x16x32_bf16 v[40:43], a[132:135], v[196:199], v[40:43]
    ds_read_b128 a[212:215], v163 offset:1024
    ds_read_b128 a[216:219], v163 offset:2048
    v_mfma_f32_16x16x32_bf16 v[40:43], a[136:139], v[200:203], v[40:43]
    buffer_load_dwordx4 v2, s[28:31], s99 offen offset:0 sc1 lds
    v_mfma_f32_16x16x32_bf16 v[40:43], a[140:143], v[204:207], v[40:43]
    v_exp_f32 v67, v67
    v_mfma_f32_16x16x32_bf16 v[36:39], a[144:147], v[176:179], v[136:139]
    v_exp_f32 v68, v68
    v_mfma_f32_16x16x32_bf16 v[36:39], a[148:151], v[180:183], v[36:39]
    ds_read_b128 a[220:223], v163 offset:3072
    ds_read_b128 a[224:227], v163 offset:4096
    v_mfma_f32_16x16x32_bf16 v[36:39], a[152:155], v[184:187], v[36:39]
    v_exp_f32 v69, v69
    v_mfma_f32_16x16x32_bf16 v[36:39], a[156:159], v[188:191], v[36:39]
    v_exp_f32 v70, v70
    v_mfma_f32_16x16x32_bf16 v[44:47], a[144:147], v[192:195], v[140:143]
    ds_read_b128 a[228:231], v163 offset:5120
    ds_read_b128 a[232:235], v163 offset:6144
    v_mfma_f32_16x16x32_bf16 v[44:47], a[148:151], v[196:199], v[44:47]
    v_exp_f32 v71, v71
    v_mfma_f32_16x16x32_bf16 v[44:47], a[152:155], v[200:203], v[44:47]
    buffer_load_dwordx4 v2, s[28:31], s99 offen offset:1024 sc1 lds
    v_mfma_f32_16x16x32_bf16 v[44:47], a[156:159], v[204:207], v[44:47]
    ds_read_b128 a[236:239], v163 offset:7168
    ds_read_b128 a[240:243], v163 offset:8192
    v_mfma_f32_16x16x32_bf16 v[48:51], a[160:163], v[176:179], v[144:147]
    v_exp_f32 v72, v72
    v_mfma_f32_16x16x32_bf16 v[48:51], a[164:167], v[180:183], v[48:51]
    v_exp_f32 v73, v73
    v_mfma_f32_16x16x32_bf16 v[48:51], a[168:171], v[184:187], v[48:51]
    ds_read_b128 a[244:247], v163 offset:9216
    ds_read_b128 a[248:251], v163 offset:10240
    v_mfma_f32_16x16x32_bf16 v[48:51], a[172:175], v[188:191], v[48:51]
    v_exp_f32 v74, v74
    v_mfma_f32_16x16x32_bf16 v[56:59], a[160:163], v[192:195], v[148:151]
    v_exp_f32 v75, v75
    v_mfma_f32_16x16x32_bf16 v[56:59], a[164:167], v[196:199], v[56:59]
    ds_read_b128 a[252:255], v163 offset:11264
    ds_read_b128 v[240:243], v163 offset:12288
    v_mfma_f32_16x16x32_bf16 v[56:59], a[168:171], v[200:203], v[56:59]
    buffer_load_dwordx4 v2, s[28:31], s99 offen offset:2048 sc1 lds
    v_mfma_f32_16x16x32_bf16 v[56:59], a[172:175], v[204:207], v[56:59]
    v_exp_f32 v76, v76
    v_mfma_f32_16x16x32_bf16 v[52:55], a[176:179], v[176:179], v[152:155]
    ds_read_b128 v[244:247], v163 offset:13312
    ds_read_b128 v[248:251], v163 offset:14336
    v_mfma_f32_16x16x32_bf16 v[52:55], a[180:183], v[180:183], v[52:55]
    v_exp_f32 v77, v77
    v_mfma_f32_16x16x32_bf16 v[52:55], a[184:187], v[184:187], v[52:55]
    v_exp_f32 v78, v78
    v_mfma_f32_16x16x32_bf16 v[52:55], a[188:191], v[188:191], v[52:55]
    ds_read_b128 v[252:255], v163 offset:15360
    ds_read_b32 v165, v167
    v_mfma_f32_16x16x32_bf16 v[60:63], a[176:179], v[192:195], v[156:159]
    v_exp_f32 v79, v79
    v_mfma_f32_16x16x32_bf16 v[60:63], a[180:183], v[196:199], v[60:63]
    v_exp_f32 v80, v80
    v_mfma_f32_16x16x32_bf16 v[60:63], a[184:187], v[200:203], v[60:63]
    buffer_load_dwordx4 v2, s[28:31], s99 offen offset:3072 sc1 lds
    v_mfma_f32_16x16x32_bf16 v[60:63], a[188:191], v[204:207], v[60:63]
    v_exp_f32 v81, v81
    s_waitcnt lgkmcnt(0)
    v_mfma_f32_16x16x32_bf16 a[0:3], a[208:211], v[96:99], a[0:3]
    v_cmp_lt_u32 vcc, v165, v164
    v_mfma_f32_16x16x32_bf16 a[0:3], a[240:243], v[104:107], a[0:3]
    s_cbranch_vccnz L_sb29_s
L_sb29:
    v_mfma_f32_16x16x32_bf16 a[32:35], a[240:243], v[108:111], a[32:35]
    s_add_u32 s99, s99, 16384
    ds_read_b128 a[128:131], v160 offset:16384
    v_mfma_f32_16x16x32_bf16 a[32:35], a[208:211], v[100:103], a[32:35]
    v_exp_f32 v82, v82
    v_mfma_f32_16x16x32_bf16 a[4:7], a[212:215], v[96:99], a[4:7]
    s_add_u32 m0, s3, 16384
    ds_read_b128 a[132:135], v160 offset:17408
    v_mfma_f32_16x16x32_bf16 a[4:7], a[244:247], v[104:107], a[4:7]
    v_exp_f32 v83, v83
    v_mfma_f32_16x16x32_bf16 a[36:39], a[244:247], v[108:111], a[36:39]
    buffer_load_dwordx4 v2, s[32:35], s101 offen offset:0 sc1 lds
    v_mfma_f32_16x16x32_bf16 a[36:39], a[212:215], v[100:103], a[36:39]
    ds_read_b128 a[136:139], v160 offset:18432
    ds_read_b128 a[140:143], v160 offset:19456
    v_mfma_f32_16x16x32_bf16 a[8:11], a[216:219], v[96:99], a[8:11]
    v_exp_f32 v84, v84
    v_mfma_f32_16x16x32_bf16 a[8:11], a[248:251], v[104:107], a[8:11]
    ds_read_b128 a[144:147], v160 offset:20480
    ds_read_b128 a[148:151], v160 offset:21504
    v_mfma_f32_16x16x32_bf16 a[40:43], a[248:251], v[108:111], a[40:43]
    v_exp_f32 v85, v85
    v_mfma_f32_16x16x32_bf16 a[40:43], a[216:219], v[100:103], a[40:43]
    ds_read_b128 a[152:155], v160 offset:22528
    ds_read_b128 a[156:159], v160 offset:23552
    v_mfma_f32_16x16x32_bf16 a[12:15], a[220:223], v[96:99], a[12:15]
    buffer_load_dwordx4 v2, s[32:35], s101 offen offset:1024 sc1 lds
    v_mfma_f32_16x16x32_bf16 a[12:15], a[252:255], v[104:107], a[12:15]
    v_exp_f32 v86, v86
    v_mfma_f32_16x16x32_bf16 a[44:47], a[252:255], v[108:111], a[44:47]
    ds_read_b128 a[160:163], v160 offset:24576
    ds_read_b128 a[164:167], v160 offset:25600
    v_mfma_f32_16x16x32_bf16 a[44:47], a[220:223], v[100:103], a[44:47]
    v_exp_f32 v87, v87
    v_mfma_f32_16x16x32_bf16 a[192:195], v[28:31], v[96:99], a[192:195]
    ds_read_b128 a[168:171], v160 offset:26624
    ds_read_b128 a[172:175], v160 offset:27648
    v_mfma_f32_16x16x32_bf16 a[192:195], v[28:31], v[104:107], a[192:195]
    v_exp_f32 v88, v88
    v_mfma_f32_16x16x32_bf16 a[16:19], a[224:227], v[96:99], a[16:19]
    buffer_load_dwordx4 v2, s[32:35], s101 offen offset:2048 sc1 lds
    v_mfma_f32_16x16x32_bf16 a[16:19], v[240:243], v[104:107], a[16:19]
    ds_read_b128 a[176:179], v160 offset:28672
    ds_read_b128 a[180:183], v160 offset:29696
    v_mfma_f32_16x16x32_bf16 a[48:51], v[240:243], v[108:111], a[48:51]
    v_exp_f32 v89, v89
    v_mfma_f32_16x16x32_bf16 a[48:51], a[224:227], v[100:103], a[48:51]
    ds_read_b128 a[184:187], v160 offset:30720
    ds_read_b128 a[188:191], v160 offset:31744
    v_mfma_f32_16x16x32_bf16 a[20:23], a[228:231], v[96:99], a[20:23]
    v_exp_f32 v90, v90
    v_mfma_f32_16x16x32_bf16 a[20:23], v[244:247], v[104:107], a[20:23]
    v_cvt_pk_bf16_f32 v112, v64, v65
    v_cvt_pk_bf16_f32 v113, v66, v67
    v_mfma_f32_16x16x32_bf16 a[52:55], v[244:247], v[108:111], a[52:55]
    buffer_load_dwordx4 v2, s[32:35], s101 offen offset:3072 sc1 lds
    v_mfma_f32_16x16x32_bf16 a[52:55], a[228:231], v[100:103], a[52:55]
    v_exp_f32 v91, v91
    v_mfma_f32_16x16x32_bf16 a[24:27], a[232:235], v[96:99], a[24:27]
    s_add_u32 s101, s101, 16384
    v_cvt_pk_bf16_f32 v114, v68, v69
    v_mfma_f32_16x16x32_bf16 a[24:27], v[248:251], v[104:107], a[24:27]
    v_exp_f32 v92, v92
    v_mfma_f32_16x16x32_bf16 a[56:59], v[248:251], v[108:111], a[56:59]
    v_cvt_pk_bf16_f32 v115, v70, v71
    v_cvt_pk_bf16_f32 v116, v72, v73
    v_mfma_f32_16x16x32_bf16 a[56:59], a[232:235], v[100:103], a[56:59]
    v_exp_f32 v93, v93
    v_mfma_f32_16x16x32_bf16 a[28:31], a[236:239], v[96:99], a[28:31]
    v_cvt_pk_bf16_f32 v117, v74, v75
    v_cvt_pk_bf16_f32 v118, v76, v77
    v_mfma_f32_16x16x32_bf16 a[28:31], v[252:255], v[104:107], a[28:31]
    v_exp_f32 v94, v94
    v_mfma_f32_16x16x32_bf16 a[60:63], v[252:255], v[108:111], a[60:63]
    v_cvt_pk_bf16_f32 v119, v78, v79
    v_cvt_pk_bf16_f32 v120, v80, v81
    v_mfma_f32_16x16x32_bf16 a[60:63], a[236:239], v[100:103], a[60:63]
    v_exp_f32 v95, v95
    v_mfma_f32_16x16x32_bf16 a[196:199], v[28:31], v[100:103], a[196:199]
    v_cvt_pk_bf16_f32 v121, v82, v83
    v_cvt_pk_bf16_f32 v122, v84, v85
    v_mfma_f32_16x16x32_bf16 a[196:199], v[28:31], v[108:111], a[196:199]
    v_cvt_pk_bf16_f32 v123, v86, v87
    v_cvt_pk_bf16_f32 v124, v88, v89
    v_cvt_pk_bf16_f32 v125, v90, v91
    v_cvt_pk_bf16_f32 v126, v92, v93
    v_cvt_pk_bf16_f32 v127, v94, v95
    s_cmp_eq_u32 s53, 1
    s_waitcnt vmcnt(8) lgkmcnt(0)
    s_cbranch_scc1 L_ev30_h
L_ev30:
    v_mfma_f32_16x16x32_bf16 v[64:67], a[128:131], v[176:179], v[128:131]
    v_add_u32 v164, 1, v164
    ds_write_b32 v166, v164
    v_mfma_f32_16x16x32_bf16 v[64:67], a[132:135], v[180:183], v[64:67]
    v_exp_f32 v32, v32
    v_mfma_f32_16x16x32_bf16 v[64:67], a[136:139], v[184:187], v[64:67]
    v_exp_f32 v33, v33
    v_mfma_f32_16x16x32_bf16 v[64:67], a[140:143], v[188:191], v[64:67]
    v_exp_f32 v34, v34
    v_mfma_f32_16x16x32_bf16 v[72:75], a[128:131], v[192:195], v[132:135]
    ds_read_b128 a[208:211], v163 offset:16384
    s_add_u32 m0, s100, 0
    v_mfma_f32_16x16x32_bf16 v[72:75], a[132:135], v[196:199], v[72:75]
    ds_read_b128 a[212:215], v163 offset:17408
    ds_read_b128 a[216:219], v163 offset:18432
    v_mfma_f32_16x16x32_bf16 v[72:75], a[136:139], v[200:203], v[72:75]
    buffer_load_dwordx4 v2, s[28:31], s99 offen offset:0 sc1 lds
    v_mfma_f32_16x16x32_bf16 v[72:75], a[140:143], v[204:207], v[72:75]
    v_exp_f32 v35, v35
    v_mfma_f32_16x16x32_bf16 v[68:71], a[144:147], v[176:179], v[136:139]
    v_exp_f32 v36, v36
    v_mfma_f32_16x16x32_bf16 v[68:71], a[148:151], v[180:183], v[68:71]
    ds_read_b128 a[220:223], v163 offset:19456
    ds_read_b128 a[224:227], v163 offset:20480
    v_mfma_f32_16x16x32_bf16 v[68:71], a[152:155], v[184:187], v[68:71]
    v_exp_f32 v37, v37
    v_mfma_f32_16x16x32_bf16 v[68:71], a[156:159], v[188:191], v[68:71]
    v_exp_f32 v38, v38
    v_mfma_f32_16x16x32_bf16 v[76:79], a[144:147], v[192:195], v[140:143]
    ds_read_b128 a[228:231], v163 offset:21504
    ds_read_b128 a[232:235], v163 offset:22528
    v_mfma_f32_16x16x32_bf16 v[76:79], a[148:151], v[196:199], v[76:79]
    v_exp_f32 v39, v39
    v_mfma_f32_16x16x32_bf16 v[76:79], a[152:155], v[200:203], v[76:79]
    buffer_load_dwordx4 v2, s[28:31], s99 offen offset:1024 sc1 lds
    v_mfma_f32_16x16x32_bf16 v[76:79], a[156:159], v[204:207], v[76:79]
    ds_read_b128 a[236:239], v163 offset:23552
    ds_read_b128 a[240:243], v163 offset:24576
    v_mfma_f32_16x16x32_bf16 v[80:83], a[160:163], v[176:179], v[144:147]
    v_exp_f32 v40, v40
    v_mfma_f32_16x16x32_bf16 v[80:83], a[164:167], v[180:183], v[80:83]
    v_exp_f32 v41, v41
    v_mfma_f32_16x16x32_bf16 v[80:83], a[168:171], v[184:187], v[80:83]
    ds_read_b128 a[244:247], v163 offset:25600
    ds_read_b128 a[248:251], v163 offset:26624
    v_mfma_f32_16x16x32_bf16 v[80:83], a[172:175], v[188:191], v[80:83]
    v_exp_f32 v42, v42
    v_mfma_f32_16x16x32_bf16 v[88:91], a[160:163], v[192:195], v[148:151]
    v_exp_f32 v43, v43
    v_mfma_f32_16x16x32_bf16 v[88:91], a[164:167], v[196:199], v[88:91]
    ds_read_b128 a[252:255], v163 offset:27648
    ds_read_b128 v[240:243], v163 offset:28672
    v_mfma_f32_16x16x32_bf16 v[88:91], a[168:171], v[200:203], v[88:91]
    buffer_load_dwordx4 v2, s[28:31], s99 offen offset:2048 sc1 lds
    v_mfma_f32_16x16x32_bf16 v[88:91], a[172:175], v[204:207], v[88:91]
    v_exp_f32 v44, v44
    v_mfma_f32_16x16x32_bf16 v[84:87], a[176:179], v[176:179], v[152:155]
    ds_read_b128 v[244:247], v163 offset:29696
    ds_read_b128 v[248:251], v163 offset:30720
    v_mfma_f32_16x16x32_bf16 v[84:87], a[180:183], v[180:183], v[84:87]
    v_exp_f32 v45, v45
    v_mfma_f32_16x16x32_bf16 v[84:87], a[184:187], v[184:187], v[84:87]
    v_exp_f32 v46, v46
    v_mfma_f32_16x16x32_bf16 v[84:87], a[188:191], v[188:191], v[84:87]
    ds_read_b128 v[252:255], v163 offset:31744
    ds_read_b32 v165, v167
    v_mfma_f32_16x16x32_bf16 v[92:95], a[176:179], v[192:195], v[156:159]
    v_exp_f32 v47, v47
    v_mfma_f32_16x16x32_bf16 v[92:95], a[180:183], v[196:199], v[92:95]
    v_exp_f32 v48, v48
    v_mfma_f32_16x16x32_bf16 v[92:95], a[184:187], v[200:203], v[92:95]
    buffer_load_dwordx4 v2, s[28:31], s99 offen offset:3072 sc1 lds
    v_mfma_f32_16x16x32_bf16 v[92:95], a[188:191], v[204:207], v[92:95]
    v_exp_f32 v49, v49
    s_waitcnt lgkmcnt(0)
    v_mfma_f32_16x16x32_bf16 a[0:3], a[208:211], v[112:115], a[0:3]
    v_cmp_lt_u32 vcc, v165, v164
    v_mfma_f32_16x16x32_bf16 a[0:3], a[240:243], v[120:123], a[0:3]
    s_cbranch_vccnz L_sb31_s
L_sb31:
    v_mfma_f32_16x16x32_bf16 a[32:35], a[240:243], v[124:127], a[32:35]
    s_add_u32 s99, s99, 16384
    ds_read_b128 a[128:131], v161 offset:0
    v_mfma_f32_16x16x32_bf16 a[32:35], a[208:211], v[116:119], a[32:35]
    v_exp_f32 v50, v50
    v_mfma_f32_16x16x32_bf16 a[4:7], a[212:215], v[112:115], a[4:7]
    s_add_u32 m0, s92, 0
    ds_read_b128 a[132:135], v161 offset:1024
    v_mfma_f32_16x16x32_bf16 a[4:7], a[244:247], v[120:123], a[4:7]
    v_exp_f32 v51, v51
    v_mfma_f32_16x16x32_bf16 a[36:39], a[244:247], v[124:127], a[36:39]
    buffer_load_dwordx4 v2, s[32:35], s101 offen offset:0 sc1 lds
    v_mfma_f32_16x16x32_bf16 a[36:39], a[212:215], v[116:119], a[36:39]
    ds_read_b128 a[136:139], v161 offset:2048
    ds_read_b128 a[140:143], v161 offset:3072
    v_mfma_f32_16x16x32_bf16 a[8:11], a[216:219], v[112:115], a[8:11]
    v_exp_f32 v52, v52
    v_mfma_f32_16x16x32_bf16 a[8:11], a[248:251], v[120:123], a[8:11]
    ds_read_b128 a[144:147], v161 offset:4096
    ds_read_b128 a[148:151], v161 offset:5120
    v_mfma_f32_16x16x32_bf16 a[40:43], a[248:251], v[124:127], a[40:43]
    v_exp_f32 v53, v53
    v_mfma_f32_16x16x32_bf16 a[40:43], a[216:219], v[116:119], a[40:43]
    ds_read_b128 a[152:155], v161 offset:6144
    ds_read_b128 a[156:159], v161 offset:7168
    v_mfma_f32_16x16x32_bf16 a[12:15], a[220:223], v[112:115], a[12:15]
    buffer_load_dwordx4 v2, s[32:35], s101 offen offset:1024 sc1 lds
    v_mfma_f32_16x16x32_bf16 a[12:15], a[252:255], v[120:123], a[12:15]
    v_exp_f32 v54, v54
    v_mfma_f32_16x16x32_bf16 a[44:47], a[252:255], v[124:127], a[44:47]
    ds_read_b128 a[160:163], v161 offset:8192
    ds_read_b128 a[164:167], v161 offset:9216
    v_mfma_f32_16x16x32_bf16 a[44:47], a[220:223], v[116:119], a[44:47]
    v_exp_f32 v55, v55
    v_mfma_f32_16x16x32_bf16 a[192:195], v[28:31], v[112:115], a[192:195]
    ds_read_b128 a[168:171], v161 offset:10240
    ds_read_b128 a[172:175], v161 offset:11264
    v_mfma_f32_16x16x32_bf16 a[192:195], v[28:31], v[120:123], a[192:195]
    v_exp_f32 v56, v56
    v_mfma_f32_16x16x32_bf16 a[16:19], a[224:227], v[112:115], a[16:19]
    buffer_load_dwordx4 v2, s[32:35], s101 offen offset:2048 sc1 lds
    v_mfma_f32_16x16x32_bf16 a[16:19], v[240:243], v[120:123], a[16:19]
    ds_read_b128 a[176:179], v161 offset:12288
    ds_read_b128 a[180:183], v161 offset:13312
    v_mfma_f32_16x16x32_bf16 a[48:51], v[240:243], v[124:127], a[48:51]
    v_exp_f32 v57, v57
    v_mfma_f32_16x16x32_bf16 a[48:51], a[224:227], v[116:119], a[48:51]
    ds_read_b128 a[184:187], v161 offset:14336
    ds_read_b128 a[188:191], v161 offset:15360
    v_mfma_f32_16x16x32_bf16 a[20:23], a[228:231], v[112:115], a[20:23]
    v_exp_f32 v58, v58
    v_mfma_f32_16x16x32_bf16 a[20:23], v[244:247], v[120:123], a[20:23]
    v_cvt_pk_bf16_f32 v96, v32, v33
    v_cvt_pk_bf16_f32 v97, v34, v35
    v_mfma_f32_16x16x32_bf16 a[52:55], v[244:247], v[124:127], a[52:55]
    buffer_load_dwordx4 v2, s[32:35], s101 offen offset:3072 sc1 lds
    v_mfma_f32_16x16x32_bf16 a[52:55], a[228:231], v[116:119], a[52:55]
    v_exp_f32 v59, v59
    v_mfma_f32_16x16x32_bf16 a[24:27], a[232:235], v[112:115], a[24:27]
    s_add_u32 s101, s101, 16384
    v_cvt_pk_bf16_f32 v98, v36, v37
    v_mfma_f32_16x16x32_bf16 a[24:27], v[248:251], v[120:123], a[24:27]
    v_exp_f32 v60, v60
    v_mfma_f32_16x16x32_bf16 a[56:59], v[248:251], v[124:127], a[56:59]
    v_cvt_pk_bf16_f32 v99, v38, v39
    v_cvt_pk_bf16_f32 v100, v40, v41
    v_mfma_f32_16x16x32_bf16 a[56:59], a[232:235], v[116:119], a[56:59]
    v_exp_f32 v61, v61
    v_mfma_f32_16x16x32_bf16 a[28:31], a[236:239], v[112:115], a[28:31]
    v_cvt_pk_bf16_f32 v101, v42, v43
    v_cvt_pk_bf16_f32 v102, v44, v45
    v_mfma_f32_16x16x32_bf16 a[28:31], v[252:255], v[120:123], a[28:31]
    v_exp_f32 v62, v62
    v_mfma_f32_16x16x32_bf16 a[60:63], v[252:255], v[124:127], a[60:63]
    v_cvt_pk_bf16_f32 v103, v46, v47
    v_cvt_pk_bf16_f32 v104, v48, v49
    v_mfma_f32_16x16x32_bf16 a[60:63], a[236:239], v[116:119], a[60:63]
    v_exp_f32 v63, v63
    v_mfma_f32_16x16x32_bf16 a[196:199], v[28:31], v[116:119], a[196:199]
    v_cvt_pk_bf16_f32 v105, v50, v51
    v_cvt_pk_bf16_f32 v106, v52, v53
    v_mfma_f32_16x16x32_bf16 a[196:199], v[28:31], v[124:127], a[196:199]
    v_cvt_pk_bf16_f32 v107, v54, v55
    v_cvt_pk_bf16_f32 v108, v56, v57
    v_cvt_pk_bf16_f32 v109, v58, v59
    v_cvt_pk_bf16_f32 v110, v60, v61
    v_cvt_pk_bf16_f32 v111, v62, v63
    s_sub_u32 s53, s53, 1
    s_cmp_lg_u32 s53, 0
    s_cbranch_scc1 L_loopE1
L_tail:
    s_waitcnt vmcnt(0) lgkmcnt(0)
    s_barrier
    ds_read_b128 a[208:211], v6 offset:0
    ds_read_b128 a[212:215], v6 offset:1024
    ds_read_b128 a[216:219], v6 offset:2048
    ds_read_b128 a[220:223], v6 offset:3072
    ds_read_b128 a[224:227], v6 offset:4096
    ds_read_b128 a[228:231], v6 offset:5120
    ds_read_b128 a[232:235], v6 offset:6144
    ds_read_b128 a[236:239], v6 offset:7168
    ds_read_b128 a[240:243], v6 offset:8192
    ds_read_b128 a[244:247], v6 offset:9216
    ds_read_b128 a[248:251], v6 offset:10240
    ds_read_b128 a[252:255], v6 offset:11264
    ds_read_b128 v[240:243], v6 offset:12288
    ds_read_b128 v[244:247], v6 offset:13312
    ds_read_b128 v[248:251], v6 offset:14336
    ds_read_b128 v[252:255], v6 offset:15360
    s_cmp_eq_u32 s48, 0
    s_cbranch_scc0 L_w0_s32
    s_mov_b64 exec, 1
    v_mov_b32 v16, s95
    s_lshl_b32 s51, s2, 7
    v_mov_b32 v17, s51
    buffer_store_dword v16, v17, s[76:79], 0 offen offset:12 sc1
    s_mov_b64 exec, -1
L_w0_s32:
    v_add_u32 v6, s97, v2
    v_exp_f32 v64, v64
    v_exp_f32 v65, v65
    v_exp_f32 v66, v66
    v_exp_f32 v67, v67
    v_exp_f32 v68, v68
    v_exp_f32 v69, v69
    v_exp_f32 v70, v70
    v_exp_f32 v71, v71
    s_waitcnt lgkmcnt(0)
    v_mfma_f32_16x16x32_bf16 a[0:3], a[208:211], v[96:99], a[0:3]
    v_exp_f32 v72, v72
    v_cvt_pk_bf16_f32 v112, v64, v65
    ds_read_b128 a[128:131], v6 offset:0
    s_add_u32 m0, s75, 71680
    s_lshr_b32 s52, s75, 1
    v_mfma_f32_16x16x32_bf16 a[0:3], a[240:243], v[104:107], a[0:3]
    v_exp_f32 v73, v73
    v_cvt_pk_bf16_f32 v113, v66, v67
    buffer_load_dwordx4 v12, s[40:43], s72 offen lds
    v_mfma_f32_16x16x32_bf16 a[32:35], a[240:243], v[108:111], a[32:35]
    v_exp_f32 v74, v74
    v_cvt_pk_bf16_f32 v114, v68, v69
    ds_read_b128 a[132:135], v6 offset:1024
    v_mfma_f32_16x16x32_bf16 a[32:35], a[208:211], v[100:103], a[32:35]
    v_exp_f32 v75, v75
    v_cvt_pk_bf16_f32 v115, v70, v71
    v_mfma_f32_16x16x32_bf16 a[4:7], a[212:215], v[96:99], a[4:7]
    v_exp_f32 v76, v76
    v_cvt_pk_bf16_f32 v116, v72, v73
    v_mfma_f32_16x16x32_bf16 a[4:7], a[244:247], v[104:107], a[4:7]
    v_exp_f32 v77, v77
    v_cvt_pk_bf16_f32 v117, v74, v75
    buffer_load_dwordx4 v13, s[40:43], s72 offen offset:1024 lds
    v_mfma_f32_16x16x32_bf16 a[36:39], a[244:247], v[108:111], a[36:39]
    v_exp_f32 v78, v78
    ds_read_b128 a[136:139], v6 offset:2048
    s_and_b32 s52, s52, 1024
    v_mfma_f32_16x16x32_bf16 a[36:39], a[212:215], v[100:103], a[36:39]
    v_exp_f32 v79, v79
    v_cvt_pk_bf16_f32 v118, v76, v77
    v_mfma_f32_16x16x32_bf16 a[8:11], a[216:219], v[96:99], a[8:11]
    v_exp_f32 v80, v80
    ds_read_b128 a[140:143], v6 offset:3072
    s_add_u32 m0, s52, 69632
    s_add_u32 s72, s72, 128
    v_mfma_f32_16x16x32_bf16 a[8:11], a[248:251], v[104:107], a[8:11]
    v_exp_f32 v81, v81
    v_cvt_pk_bf16_f32 v119, v78, v79
    buffer_load_dwordx4 v12, s[40:43], s73 offen lds
    v_mfma_f32_16x16x32_bf16 a[40:43], a[248:251], v[108:111], a[40:43]
    v_exp_f32 v82, v82
    ds_read_b128 a[144:147], v6 offset:4096
    v_mfma_f32_16x16x32_bf16 a[40:43], a[216:219], v[100:103], a[40:43]
    v_exp_f32 v83, v83
    v_cvt_pk_bf16_f32 v120, v80, v81
    s_add_u32 m0, s75, 79872
    s_add_u32 s52, s74, 0
    v_mfma_f32_16x16x32_bf16 a[12:15], a[220:223], v[96:99], a[12:15]
    v_exp_f32 v84, v84
    ds_read_b128 a[148:151], v6 offset:5120
    buffer_load_dwordx4 v14, s[44:47], s52 offen lds
    v_mfma_f32_16x16x32_bf16 a[12:15], a[252:255], v[104:107], a[12:15]
    v_exp_f32 v85, v85
    v_cvt_pk_bf16_f32 v121, v82, v83
    v_mfma_f32_16x16x32_bf16 a[44:47], a[252:255], v[108:111], a[44:47]
    v_exp_f32 v86, v86
    ds_read_b128 a[152:155], v6 offset:6144
    v_mfma_f32_16x16x32_bf16 a[44:47], a[220:223], v[100:103], a[44:47]
    v_exp_f32 v87, v87
    v_cvt_pk_bf16_f32 v122, v84, v85
    v_mfma_f32_16x16x32_bf16 a[192:195], v[28:31], v[96:99], a[192:195]
    v_exp_f32 v88, v88
    ds_read_b128 a[156:159], v6 offset:7168
    buffer_load_dwordx4 v15, s[44:47], s52 offen offset:1024 lds
    v_mfma_f32_16x16x32_bf16 a[192:195], v[28:31], v[104:107], a[192:195]
    v_exp_f32 v89, v89
    v_cvt_pk_bf16_f32 v123, v86, v87
    v_mfma_f32_16x16x32_bf16 a[16:19], a[224:227], v[96:99], a[16:19]
    v_exp_f32 v90, v90
    ds_read_b128 a[160:163], v6 offset:8192
    s_add_u32 m0, s75, 88064
    s_add_u32 s52, s74, 1024
    v_mfma_f32_16x16x32_bf16 a[16:19], v[240:243], v[104:107], a[16:19]
    v_exp_f32 v91, v91
    v_cvt_pk_bf16_f32 v124, v88, v89
    buffer_load_dwordx4 v14, s[44:47], s52 offen lds
    v_mfma_f32_16x16x32_bf16 a[48:51], v[240:243], v[108:111], a[48:51]
    v_exp_f32 v92, v92
    ds_read_b128 a[164:167], v6 offset:9216
    v_mfma_f32_16x16x32_bf16 a[48:51], a[224:227], v[100:103], a[48:51]
    v_exp_f32 v93, v93
    v_cvt_pk_bf16_f32 v125, v90, v91
    v_mfma_f32_16x16x32_bf16 a[20:23], a[228:231], v[96:99], a[20:23]
    v_exp_f32 v94, v94
    ds_read_b128 a[168:171], v6 offset:10240
    v_mfma_f32_16x16x32_bf16 a[20:23], v[244:247], v[104:107], a[20:23]
    v_exp_f32 v95, v95
    v_cvt_pk_bf16_f32 v126, v92, v93
    v_mfma_f32_16x16x32_bf16 a[52:55], v[244:247], v[108:111], a[52:55]
    ds_read_b128 a[172:175], v6 offset:11264
    ds_read_b128 a[176:179], v6 offset:12288
    v_mfma_f32_16x16x32_bf16 a[52:55], a[228:231], v[100:103], a[52:55]
    v_cvt_pk_bf16_f32 v127, v94, v95
    buffer_load_dwordx4 v15, s[44:47], s52 offen offset:1024 lds
    v_mfma_f32_16x16x32_bf16 a[24:27], a[232:235], v[96:99], a[24:27]
    ds_read_b128 a[180:183], v6 offset:13312
    s_add_u32 m0, s75, 96256
    s_add_u32 s52, s74, 2048
    v_mfma_f32_16x16x32_bf16 a[24:27], v[248:251], v[104:107], a[24:27]
    buffer_load_dwordx4 v14, s[44:47], s52 offen lds
    v_mfma_f32_16x16x32_bf16 a[56:59], v[248:251], v[108:111], a[56:59]
    ds_read_b128 a[184:187], v6 offset:14336
    v_mfma_f32_16x16x32_bf16 a[56:59], a[232:235], v[100:103], a[56:59]
    buffer_load_dwordx4 v15, s[44:47], s52 offen offset:1024 lds
    v_mfma_f32_16x16x32_bf16 a[28:31], a[236:239], v[96:99], a[28:31]
    ds_read_b128 a[188:191], v6 offset:15360
    v_mfma_f32_16x16x32_bf16 a[28:31], v[252:255], v[104:107], a[28:31]
    v_mfma_f32_16x16x32_bf16 a[60:63], v[252:255], v[108:111], a[60:63]
    v_mfma_f32_16x16x32_bf16 a[60:63], a[236:239], v[100:103], a[60:63]
    v_mfma_f32_16x16x32_bf16 a[196:199], v[28:31], v[100:103], a[196:199]
    s_add_u32 s73, s73, 128
    s_add_u32 s74, s74, 196608
    v_mfma_f32_16x16x32_bf16 a[196:199], v[28:31], v[108:111], a[196:199]
    s_waitcnt lgkmcnt(0)
    s_nop 0
    v_mfma_f32_16x16x32_bf16 a[0:3], a[128:131], v[112:115], a[0:3]
    s_add_u32 m0, s75, 106496
    s_lshr_b32 s52, s75, 1
    v_mfma_f32_16x16x32_bf16 a[0:3], a[160:163], v[120:123], a[0:3]
    buffer_load_dwordx4 v12, s[40:43], s72 offen lds
    v_mfma_f32_16x16x32_bf16 a[32:35], a[160:163], v[124:127], a[32:35]
    v_mfma_f32_16x16x32_bf16 a[32:35], a[128:131], v[116:119], a[32:35]
    v_mfma_f32_16x16x32_bf16 a[4:7], a[132:135], v[112:115], a[4:7]
    buffer_load_dwordx4 v13, s[40:43], s72 offen offset:1024 lds
    v_mfma_f32_16x16x32_bf16 a[4:7], a[164:167], v[120:123], a[4:7]
    s_and_b32 s52, s52, 1024
    v_mfma_f32_16x16x32_bf16 a[36:39], a[164:167], v[124:127], a[36:39]
    s_add_u32 m0, s52, 104448
    s_add_u32 s72, s72, 128
    v_mfma_f32_16x16x32_bf16 a[36:39], a[132:135], v[116:119], a[36:39]
    buffer_load_dwordx4 v12, s[40:43], s73 offen lds
    v_mfma_f32_16x16x32_bf16 a[8:11], a[136:139], v[112:115], a[8:11]
    v_mfma_f32_16x16x32_bf16 a[8:11], a[168:171], v[120:123], a[8:11]
    s_add_u32 m0, s75, 114688
    s_add_u32 s52, s74, 0
    v_mfma_f32_16x16x32_bf16 a[40:43], a[168:171], v[124:127], a[40:43]
    buffer_load_dwordx4 v14, s[44:47], s52 offen lds
    v_mfma_f32_16x16x32_bf16 a[40:43], a[136:139], v[116:119], a[40:43]
    v_mfma_f32_16x16x32_bf16 a[12:15], a[140:143], v[112:115], a[12:15]
    v_mfma_f32_16x16x32_bf16 a[12:15], a[172:175], v[120:123], a[12:15]
    buffer_load_dwordx4 v15, s[44:47], s52 offen offset:1024 lds
    v_mfma_f32_16x16x32_bf16 a[44:47], a[172:175], v[124:127], a[44:47]
    v_mfma_f32_16x16x32_bf16 a[44:47], a[140:143], v[116:119], a[44:47]
    v_mfma_f32_16x16x32_bf16 a[192:195], v[28:31], v[112:115], a[192:195]
    s_add_u32 m0, s75, 122880
    s_add_u32 s52, s74, 1024
    v_mfma_f32_16x16x32_bf16 a[192:195], v[28:31], v[120:123], a[192:195]
    buffer_load_dwordx4 v14, s[44:47], s52 offen lds
    v_mfma_f32_16x16x32_bf16 a[16:19], a[144:147], v[112:115], a[16:19]
    v_mfma_f32_16x16x32_bf16 a[16:19], a[176:179], v[120:123], a[16:19]
    v_mfma_f32_16x16x32_bf16 a[48:51], a[176:179], v[124:127], a[48:51]
    buffer_load_dwordx4 v15, s[44:47], s52 offen offset:1024 lds
    v_mfma_f32_16x16x32_bf16 a[48:51], a[144:147], v[116:119], a[48:51]
    v_mfma_f32_16x16x32_bf16 a[20:23], a[148:151], v[112:115], a[20:23]
    s_add_u32 m0, s75, 131072
    s_add_u32 s52, s74, 2048
    v_mfma_f32_16x16x32_bf16 a[20:23], a[180:183], v[120:123], a[20:23]
    buffer_load_dwordx4 v14, s[44:47], s52 offen lds
    v_mfma_f32_16x16x32_bf16 a[52:55], a[180:183], v[124:127], a[52:55]
    v_mfma_f32_16x16x32_bf16 a[52:55], a[148:151], v[116:119], a[52:55]
    v_mfma_f32_16x16x32_bf16 a[24:27], a[152:155], v[112:115], a[24:27]
    buffer_load_dwordx4 v15, s[44:47], s52 offen offset:1024 lds
    v_mfma_f32_16x16x32_bf16 a[24:27], a[184:187], v[120:123], a[24:27]
    v_mfma_f32_16x16x32_bf16 a[56:59], a[184:187], v[124:127], a[56:59]
    v_mfma_f32_16x16x32_bf16 a[56:59], a[152:155], v[116:119], a[56:59]
    s_add_u32 s73, s73, 128
    s_add_u32 s74, s74, 196608
    v_mfma_f32_16x16x32_bf16 a[28:31], a[156:159], v[112:115], a[28:31]
    v_mfma_f32_16x16x32_bf16 a[28:31], a[188:191], v[120:123], a[28:31]
    v_mfma_f32_16x16x32_bf16 a[60:63], a[188:191], v[124:127], a[60:63]
    v_mfma_f32_16x16x32_bf16 a[60:63], a[156:159], v[116:119], a[60:63]
    v_mfma_f32_16x16x32_bf16 a[196:199], v[28:31], v[116:119], a[196:199]
    v_mfma_f32_16x16x32_bf16 a[196:199], v[28:31], v[124:127], a[196:199]
    s_mov_b32 s52, 0x5d800000
    s_nop 6
    v_accvgpr_read_b32 v32, a192
    v_accvgpr_read_b32 v33, a196
    v_accvgpr_read_b32 v34, a200
    v_accvgpr_read_b32 v35, a204
    v_add_f32 v36, v32, v33
    v_add_f32 v37, v34, v35
    v_add_f32 v36, v36, v37
    v_cmp_gt_f32 vcc, s52, v36
    v_rcp_f32 v36, v32
    v_rcp_f32 v37, v33
    v_rcp_f32 v38, v34
    v_rcp_f32 v39, v35
    s_cmp_eq_u64 vcc, -1
    s_cbranch_scc0 L_slow
L_fin2:
    s_lshl_b32 s51, s48, 18
    s_lshl_b32 s52, s49, 12
    s_add_u32 s51, s51, s52
    s_lshl_b32 s52, s50, 20
    s_sub_u32 s52, 15728640, s52
    s_add_u32 s51, s51, s52
    v_accvgpr_read_b32 v40, a0
    v_accvgpr_read_b32 v41, a1
    v_accvgpr_read_b32 v42, a2
    v_accvgpr_read_b32 v43, a3
    v_accvgpr_read_b32 v44, a4
    v_accvgpr_read_b32 v45, a5
    v_accvgpr_read_b32 v46, a6
    v_accvgpr_read_b32 v47, a7
    v_mul_f32 v40, v36, v40
    v_mul_f32 v41, v36, v41
    v_mul_f32 v42, v36, v42
    v_mul_f32 v43, v36, v43
    v_mul_f32 v44, v36, v44
    v_mul_f32 v45, v36, v45
    v_mul_f32 v46, v36, v46
    v_mul_f32 v47, v36, v47
    v_cvt_pk_bf16_f32 v48, v40, v41
    v_cvt_pk_bf16_f32 v49, v42, v43
    v_cvt_pk_bf16_f32 v50, v44, v45
    v_cvt_pk_bf16_f32 v51, v46, v47
    buffer_store_dwordx4 v[48:51], v2, s[36:39], s51 offen offset:0 sc1
    v_accvgpr_read_b32 v52, a8
    v_accvgpr_read_b32 v53, a9
    v_accvgpr_read_b32 v54, a10
    v_accvgpr_read_b32 v55, a11
    v_accvgpr_read_b32 v56, a12
    v_accvgpr_read_b32 v57, a13
    v_accvgpr_read_b32 v58, a14
    v_accvgpr_read_b32 v59, a15
    v_mul_f32 v52, v36, v52
    v_mul_f32 v53, v36, v53
    v_mul_f32 v54, v36, v54
    v_mul_f32 v55, v36, v55
    v_mul_f32 v56, v36, v56
    v_mul_f32 v57, v36, v57
    v_mul_f32 v58, v36, v58
    v_mul_f32 v59, v36, v59
    v_cvt_pk_bf16_f32 v60, v52, v53
    v_cvt_pk_bf16_f32 v61, v54, v55
    v_cvt_pk_bf16_f32 v62, v56, v57
    v_cvt_pk_bf16_f32 v63, v58, v59
    buffer_store_dwordx4 v[60:63], v2, s[36:39], s51 offen offset:1024 sc1
    v_accvgpr_read_b32 v40, a16
    v_accvgpr_read_b32 v41, a17
    v_accvgpr_read_b32 v42, a18
    v_accvgpr_read_b32 v43, a19
    v_accvgpr_read_b32 v44, a20
    v_accvgpr_read_b32 v45, a21
    v_accvgpr_read_b32 v46, a22
    v_accvgpr_read_b32 v47, a23
    v_mul_f32 v40, v36, v40
    v_mul_f32 v41, v36, v41
    v_mul_f32 v42, v36, v42
    v_mul_f32 v43, v36, v43
    v_mul_f32 v44, v36, v44
    v_mul_f32 v45, v36, v45
    v_mul_f32 v46, v36, v46
    v_mul_f32 v47, v36, v47
    v_cvt_pk_bf16_f32 v48, v40, v41
    v_cvt_pk_bf16_f32 v49, v42, v43
    v_cvt_pk_bf16_f32 v50, v44, v45
    v_cvt_pk_bf16_f32 v51, v46, v47
    buffer_store_dwordx4 v[48:51], v2, s[36:39], s51 offen offset:2048 sc1
    v_accvgpr_read_b32 v52, a24
    v_accvgpr_read_b32 v53, a25
    v_accvgpr_read_b32 v54, a26
    v_accvgpr_read_b32 v55, a27
    v_accvgpr_read_b32 v56, a28
    v_accvgpr_read_b32 v57, a29
    v_accvgpr_read_b32 v58, a30
    v_accvgpr_read_b32 v59, a31
    v_mul_f32 v52, v36, v52
    v_mul_f32 v53, v36, v53
    v_mul_f32 v54, v36, v54
    v_mul_f32 v55, v36, v55
    v_mul_f32 v56, v36, v56
    v_mul_f32 v57, v36, v57
    v_mul_f32 v58, v36, v58
    v_mul_f32 v59, v36, v59
    v_cvt_pk_bf16_f32 v60, v52, v53
    v_cvt_pk_bf16_f32 v61, v54, v55
    v_cvt_pk_bf16_f32 v62, v56, v57
    v_cvt_pk_bf16_f32 v63, v58, v59
    buffer_store_dwordx4 v[60:63], v2, s[36:39], s51 offen offset:3072 sc1
    s_add_u32 s51, s51, 131072
    v_accvgpr_read_b32 v40, a32
    v_accvgpr_read_b32 v41, a33
    v_accvgpr_read_b32 v42, a34
    v_accvgpr_read_b32 v43, a35
    v_accvgpr_read_b32 v44, a36
    v_accvgpr_read_b32 v45, a37
    v_accvgpr_read_b32 v46, a38
    v_accvgpr_read_b32 v47, a39
    v_mul_f32 v40, v37, v40
    v_mul_f32 v41, v37, v41
    v_mul_f32 v42, v37, v42
    v_mul_f32 v43, v37, v43
    v_mul_f32 v44, v37, v44
    v_mul_f32 v45, v37, v45
    v_mul_f32 v46, v37, v46
    v_mul_f32 v47, v37, v47
    v_cvt_pk_bf16_f32 v48, v40, v41
    v_cvt_pk_bf16_f32 v49, v42, v43
    v_cvt_pk_bf16_f32 v50, v44, v45
    v_cvt_pk_bf16_f32 v51, v46, v47
    buffer_store_dwordx4 v[48:51], v2, s[36:39], s51 offen offset:0 sc1
    v_accvgpr_read_b32 v52, a40
    v_accvgpr_read_b32 v53, a41
    v_accvgpr_read_b32 v54, a42
    v_accvgpr_read_b32 v55, a43
    v_accvgpr_read_b32 v56, a44
    v_accvgpr_read_b32 v57, a45
    v_accvgpr_read_b32 v58, a46
    v_accvgpr_read_b32 v59, a47
    v_mul_f32 v52, v37, v52
    v_mul_f32 v53, v37, v53
    v_mul_f32 v54, v37, v54
    v_mul_f32 v55, v37, v55
    v_mul_f32 v56, v37, v56
    v_mul_f32 v57, v37, v57
    v_mul_f32 v58, v37, v58
    v_mul_f32 v59, v37, v59
    v_cvt_pk_bf16_f32 v60, v52, v53
    v_cvt_pk_bf16_f32 v61, v54, v55
    v_cvt_pk_bf16_f32 v62, v56, v57
    v_cvt_pk_bf16_f32 v63, v58, v59
    buffer_store_dwordx4 v[60:63], v2, s[36:39], s51 offen offset:1024 sc1
    v_accvgpr_read_b32 v40, a48
    v_accvgpr_read_b32 v41, a49
    v_accvgpr_read_b32 v42, a50
    v_accvgpr_read_b32 v43, a51
    v_accvgpr_read_b32 v44, a52
    v_accvgpr_read_b32 v45, a53
    v_accvgpr_read_b32 v46, a54
    v_accvgpr_read_b32 v47, a55
    v_mul_f32 v40, v37, v40
    v_mul_f32 v41, v37, v41
    v_mul_f32 v42, v37, v42
    v_mul_f32 v43, v37, v43
    v_mul_f32 v44, v37, v44
    v_mul_f32 v45, v37, v45
    v_mul_f32 v46, v37, v46
    v_mul_f32 v47, v37, v47
    v_cvt_pk_bf16_f32 v48, v40, v41
    v_cvt_pk_bf16_f32 v49, v42, v43
    v_cvt_pk_bf16_f32 v50, v44, v45
    v_cvt_pk_bf16_f32 v51, v46, v47
    buffer_store_dwordx4 v[48:51], v2, s[36:39], s51 offen offset:2048 sc1
    v_accvgpr_read_b32 v52, a56
    v_accvgpr_read_b32 v53, a57
    v_accvgpr_read_b32 v54, a58
    v_accvgpr_read_b32 v55, a59
    v_accvgpr_read_b32 v56, a60
    v_accvgpr_read_b32 v57, a61
    v_accvgpr_read_b32 v58, a62
    v_accvgpr_read_b32 v59, a63
    v_mul_f32 v52, v37, v52
    v_mul_f32 v53, v37, v53
    v_mul_f32 v54, v37, v54
    v_mul_f32 v55, v37, v55
    v_mul_f32 v56, v37, v56
    v_mul_f32 v57, v37, v57
    v_mul_f32 v58, v37, v58
    v_mul_f32 v59, v37, v59
    v_cvt_pk_bf16_f32 v60, v52, v53
    v_cvt_pk_bf16_f32 v61, v54, v55
    v_cvt_pk_bf16_f32 v62, v56, v57
    v_cvt_pk_bf16_f32 v63, v58, v59
    buffer_store_dwordx4 v[60:63], v2, s[36:39], s51 offen offset:3072 sc1
    s_waitcnt vmcnt(17)
    s_barrier
    ds_read_b64_tr_b16 a[84:85], v23 offset:0
    ds_read_b64_tr_b16 a[86:87], v23 offset:512
    ds_read_b64_tr_b16 a[88:89], v23 offset:8192
    ds_read_b64_tr_b16 a[90:91], v23 offset:8704
    ds_read_b64_tr_b16 a[92:93], v23 offset:16384
    ds_read_b64_tr_b16 a[94:95], v23 offset:16896
    ds_read_b128 a[64:67], v20 offset:0
    ds_read_b128 a[68:71], v20 offset:2048
    ds_read_b128 a[72:75], v20 offset:4096
    ds_read_b128 a[76:79], v20 offset:6144
    ds_read_b128 a[80:83], v20 offset:8192
    s_waitcnt lgkmcnt(0)
    v_mfma_f32_16x16x32_bf16 v[80:83], a[88:91], a[64:67], 0
    ds_read_b64_tr_b16 a[116:117], v23 offset:4096
    s_add_u32 m0, s75, 2048
    s_lshr_b32 s52, s75, 1
    buffer_load_dwordx4 v12, s[40:43], s72 offen lds
    v_mfma_f32_16x16x32_bf16 v[100:103], a[64:67], a[92:95], 0
    ds_read_b64_tr_b16 a[118:119], v23 offset:4608
    ds_read_b64_tr_b16 a[120:121], v23 offset:12288
    v_mfma_f32_16x16x32_bf16 v[64:67], a[84:87], a[68:71], 0
    ds_read_b64_tr_b16 a[122:123], v23 offset:12800
    buffer_load_dwordx4 v13, s[40:43], s72 offen offset:1024 lds
    s_and_b32 s52, s52, 1024
    v_mfma_f32_16x16x32_bf16 v[84:87], a[88:91], a[68:71], 0
    ds_read_b64_tr_b16 a[124:125], v23 offset:20480
    s_add_u32 m0, s52, 0
    s_add_u32 s72, s72, 128
    buffer_load_dwordx4 v12, s[40:43], s73 offen lds
    v_mfma_f32_16x16x32_bf16 v[104:107], a[68:71], a[92:95], 0
    ds_read_b64_tr_b16 a[126:127], v23 offset:20992
    ds_read_b128 a[96:99], v21 offset:0
    v_mfma_f32_16x16x32_bf16 v[68:71], a[84:87], a[72:75], 0
    ds_read_b128 a[100:103], v21 offset:2048
    s_add_u32 m0, s75, 10240
    s_add_u32 s52, s74, 0
    buffer_load_dwordx4 v14, s[44:47], s52 offen lds
    v_mfma_f32_16x16x32_bf16 v[88:91], a[88:91], a[72:75], 0
    ds_read_b128 a[104:107], v21 offset:4096
    ds_read_b128 a[108:111], v21 offset:6144
    buffer_load_dwordx4 v15, s[44:47], s52 offen offset:1024 lds
    v_mfma_f32_16x16x32_bf16 v[108:111], a[72:75], a[92:95], 0
    ds_read_b128 a[112:115], v21 offset:8192
    s_add_u32 m0, s75, 18432
    s_add_u32 s52, s74, 1024
    buffer_load_dwordx4 v14, s[44:47], s52 offen lds
    v_mfma_f32_16x16x32_bf16 v[72:75], a[84:87], a[76:79], 0
    buffer_load_dwordx4 v15, s[44:47], s52 offen offset:1024 lds
    v_mfma_f32_16x16x32_bf16 v[92:95], a[88:91], a[76:79], 0
    s_add_u32 m0, s75, 26624
    s_add_u32 s52, s74, 2048
    buffer_load_dwordx4 v14, s[44:47], s52 offen lds
    v_mfma_f32_16x16x32_bf16 v[112:115], a[76:79], a[92:95], 0
    buffer_load_dwordx4 v15, s[44:47], s52 offen offset:1024 lds
    v_mfma_f32_16x16x32_bf16 v[76:79], a[84:87], a[80:83], 0
    s_add_u32 s73, s73, 128
    s_add_u32 s74, s74, 196608
    v_mfma_f32_16x16x32_bf16 v[96:99], a[88:91], a[80:83], 0
    s_add_u32 m0, s75, 36864
    s_lshr_b32 s52, s75, 1
    buffer_load_dwordx4 v12, s[40:43], s72 offen lds
    v_mfma_f32_16x16x32_bf16 v[116:119], a[80:83], a[92:95], 0
    buffer_load_dwordx4 v13, s[40:43], s72 offen offset:1024 lds
    s_and_b32 s52, s52, 1024
    s_add_u32 m0, s52, 34816
    s_add_u32 s72, s72, 128
    buffer_load_dwordx4 v12, s[40:43], s73 offen lds
    s_waitcnt vmcnt(12) lgkmcnt(0)
    s_barrier
    s_cmp_eq_u32 s48, 0
    s_cbranch_scc0 L_w0_s33
    s_mov_b64 exec, 1
    v_mov_b32 v16, s95
    s_lshl_b32 s51, s2, 7
    v_mov_b32 v17, s51
    buffer_store_dword v16, v17, s[76:79], 0 offen offset:4 sc1
    s_mov_b64 exec, -1
L_w0_s33:
    v_mfma_f32_16x16x32_bf16 v[80:83], a[120:123], a[96:99], v[80:83]
    ds_read_b64_tr_b16 a[84:85], v23 offset:34816
    s_add_u32 m0, s75, 45056
    s_add_u32 s52, s74, 0
    buffer_load_dwordx4 v14, s[44:47], s52 offen lds
    v_mfma_f32_16x16x32_bf16 v[100:103], a[96:99], a[124:127], v[100:103]
    ds_read_b64_tr_b16 a[86:87], v23 offset:35328
    ds_read_b64_tr_b16 a[88:89], v23 offset:43008
    v_mfma_f32_16x16x32_bf16 v[64:67], a[116:119], a[100:103], v[64:67]
    ds_read_b64_tr_b16 a[90:91], v23 offset:43520
    buffer_load_dwordx4 v15, s[44:47], s52 offen offset:1024 lds
    v_mfma_f32_16x16x32_bf16 v[84:87], a[120:123], a[100:103], v[84:87]
    ds_read_b64_tr_b16 a[92:93], v23 offset:51200
    s_add_u32 m0, s75, 53248
    s_add_u32 s52, s74, 1024
    buffer_load_dwordx4 v14, s[44:47], s52 offen lds
    v_mfma_f32_16x16x32_bf16 v[104:107], a[100:103], a[124:127], v[104:107]
    ds_read_b64_tr_b16 a[94:95], v23 offset:51712
    ds_read_b128 a[64:67], v20 offset:34816
    v_mfma_f32_16x16x32_bf16 v[68:71], a[116:119], a[104:107], v[68:71]
    ds_read_b128 a[68:71], v20 offset:36864
    buffer_load_dwordx4 v15, s[44:47], s52 offen offset:1024 lds
    v_mfma_f32_16x16x32_bf16 v[88:91], a[120:123], a[104:107], v[88:91]
    ds_read_b128 a[72:75], v20 offset:38912
    ds_read_b128 a[76:79], v20 offset:40960
    s_add_u32 m0, s75, 61440
    s_add_u32 s52, s74, 2048
    buffer_load_dwordx4 v14, s[44:47], s52 offen lds
    buffer_load_dwordx4 v15, s[44:47], s52 offen offset:1024 lds
    s_add_u32 s73, s73, 128
    s_add_u32 s74, s74, 196608
    v_mfma_f32_16x16x32_bf16 v[108:111], a[104:107], a[124:127], v[108:111]
    ds_read_b128 a[80:83], v20 offset:43008
    v_mfma_f32_16x16x32_bf16 v[72:75], a[116:119], a[108:111], v[72:75]
    s_add_u32 m0, s75, 71680
    s_lshr_b32 s52, s75, 1
    buffer_load_dwordx4 v12, s[40:43], s72 offen lds
    v_mfma_f32_16x16x32_bf16 v[92:95], a[120:123], a[108:111], v[92:95]
    buffer_load_dwordx4 v13, s[40:43], s72 offen offset:1024 lds
    s_and_b32 s52, s52, 1024
    v_mfma_f32_16x16x32_bf16 v[112:115], a[108:111], a[124:127], v[112:115]
    s_add_u32 m0, s52, 69632
    s_add_u32 s72, s72, 128
    buffer_load_dwordx4 v12, s[40:43], s73 offen lds
    v_mfma_f32_16x16x32_bf16 v[76:79], a[116:119], a[112:115], v[76:79]
    s_add_u32 m0, s75, 79872
    s_add_u32 s52, s74, 0
    buffer_load_dwordx4 v14, s[44:47], s52 offen lds
    v_mfma_f32_16x16x32_bf16 v[96:99], a[120:123], a[112:115], v[96:99]
    v_mfma_f32_16x16x32_bf16 v[116:119], a[112:115], a[124:127], v[116:119]
    buffer_load_dwordx4 v15, s[44:47], s52 offen offset:1024 lds
    s_waitcnt lgkmcnt(0)
    v_mfma_f32_16x16x32_bf16 v[80:83], a[88:91], a[64:67], v[80:83]
    ds_read_b64_tr_b16 a[116:117], v23 offset:38912
    s_and_b32 s99, s2, 7
    v_mfma_f32_16x16x32_bf16 v[100:103], a[64:67], a[92:95], v[100:103]
    ds_read_b64_tr_b16 a[118:119], v23 offset:39424
    ds_read_b64_tr_b16 a[120:121], v23 offset:47104
    s_and_b32 s97, s99, 1
    v_mfma_f32_16x16x32_bf16 v[64:67], a[84:87], a[68:71], v[64:67]
    ds_read_b64_tr_b16 a[122:123], v23 offset:47616
    s_add_u32 m0, s75, 88064
    s_add_u32 s52, s74, 1024
    v_mfma_f32_16x16x32_bf16 v[84:87], a[88:91], a[68:71], v[84:87]
    ds_read_b64_tr_b16 a[124:125], v23 offset:55296
    buffer_load_dwordx4 v14, s[44:47], s52 offen lds
    v_mfma_f32_16x16x32_bf16 v[104:107], a[68:71], a[92:95], v[104:107]
    ds_read_b64_tr_b16 a[126:127], v23 offset:55808
    ds_read_b128 a[96:99], v21 offset:34816
    s_lshr_b32 s99, s99, 1
    s_sub_u32 s96, 15, s50
    v_mfma_f32_16x16x32_bf16 v[68:71], a[84:87], a[72:75], v[68:71]
    ds_read_b128 a[100:103], v21 offset:36864
    buffer_load_dwordx4 v15, s[44:47], s52 offen offset:1024 lds
    v_mfma_f32_16x16x32_bf16 v[88:91], a[88:91], a[72:75], v[88:91]
    ds_read_b128 a[104:107], v21 offset:38912
    ds_read_b128 a[108:111], v21 offset:40960
    s_cmp_eq_u32 s97, 0
    s_cselect_b32 s97, s50, s96
    v_mfma_f32_16x16x32_bf16 v[108:111], a[72:75], a[92:95], v[108:111]
    ds_read_b128 a[112:115], v21 offset:43008
    s_lshr_b32 s98, s2, 3
    s_and_b32 s98, s98, 3
    v_mfma_f32_16x16x32_bf16 v[72:75], a[84:87], a[76:79], v[72:75]
    s_add_u32 m0, s75, 96256
    s_add_u32 s52, s74, 2048
    s_lshl_b32 s101, s97, 20
    v_mfma_f32_16x16x32_bf16 v[92:95], a[88:91], a[76:79], v[92:95]
    buffer_load_dwordx4 v14, s[44:47], s52 offen lds
    v_mfma_f32_16x16x32_bf16 v[112:115], a[76:79], a[92:95], v[112:115]
    buffer_load_dwordx4 v15, s[44:47], s52 offen offset:1024 lds
    v_mfma_f32_16x16x32_bf16 v[76:79], a[84:87], a[80:83], v[76:79]
    s_lshl_b32 s54, s48, 18
    s_add_u32 s54, s54, s101
    v_mfma_f32_16x16x32_bf16 v[96:99], a[88:91], a[80:83], v[96:99]
    s_add_u32 s73, s73, 128
    s_add_u32 s74, s74, 196608
    v_mfma_f32_16x16x32_bf16 v[116:119], a[80:83], a[92:95], v[116:119]
    s_lshl_b32 s55, s99, 15
    s_add_u32 s54, s54, s55
    s_lshl_b32 s55, s98, 18
    s_waitcnt vmcnt(18) lgkmcnt(0)
    s_barrier
    v_mfma_f32_16x16x32_bf16 v[80:83], a[120:123], a[96:99], v[80:83]
    ds_read_b64_tr_b16 a[84:85], v22 offset:0
    s_add_u32 s101, s101, s55
    v_mfma_f32_16x16x32_bf16 v[100:103], a[96:99], a[124:127], v[100:103]
    ds_read_b64_tr_b16 a[86:87], v22 offset:512
    ds_read_b64_tr_b16 a[88:89], v22 offset:8192
    s_lshl_b32 s98, s98, 1
    v_mfma_f32_16x16x32_bf16 v[64:67], a[116:119], a[100:103], v[64:67]
    ds_read_b64_tr_b16 a[90:91], v22 offset:8704
    s_add_u32 m0, s75, 106496
    s_lshr_b32 s52, s75, 1
    v_mfma_f32_16x16x32_bf16 v[84:87], a[120:123], a[100:103], v[84:87]
    ds_read_b64_tr_b16 a[92:93], v22 offset:16384
    buffer_load_dwordx4 v12, s[40:43], s72 offen lds
    v_mfma_f32_16x16x32_bf16 v[104:107], a[100:103], a[124:127], v[104:107]
    ds_read_b64_tr_b16 a[94:95], v22 offset:16896
    ds_read_b128 a[64:67], v18 offset:0
    s_lshr_b32 s55, s48, 1
    s_add_u32 s55, s55, s98
    v_mfma_f32_16x16x32_bf16 v[68:71], a[116:119], a[104:107], v[68:71]
    ds_read_b128 a[68:71], v18 offset:2048
    buffer_load_dwordx4 v13, s[40:43], s72 offen offset:1024 lds
    s_mul_i32 s55, s55, 589824
    v_mfma_f32_16x16x32_bf16 v[88:91], a[120:123], a[104:107], v[88:91]
    ds_read_b128 a[72:75], v18 offset:4096
    ds_read_b128 a[76:79], v18 offset:6144
    s_and_b32 s52, s52, 1024
    v_mfma_f32_16x16x32_bf16 v[108:111], a[104:107], a[124:127], v[108:111]
    ds_read_b128 a[80:83], v18 offset:8192
    s_lshl_b32 s96, s99, 5
    s_and_b32 s3, s48, 1
    v_mfma_f32_16x16x32_bf16 v[72:75], a[116:119], a[108:111], v[72:75]
    s_add_u32 m0, s52, 104448
    s_add_u32 s72, s72, 128
    s_add_u32 s96, s96, s3
    v_mfma_f32_16x16x32_bf16 v[92:95], a[120:123], a[108:111], v[92:95]
    buffer_load_dwordx4 v12, s[40:43], s73 offen lds
    s_add_u32 s96, s96, 16
    v_mfma_f32_16x16x32_bf16 v[112:115], a[108:111], a[124:127], v[112:115]
    s_add_u32 m0, s75, 114688
    s_add_u32 s52, s74, 0
    s_lshl_b32 s96, s96, 12
    v_mfma_f32_16x16x32_bf16 v[76:79], a[116:119], a[112:115], v[76:79]
    buffer_load_dwordx4 v14, s[44:47], s52 offen lds
    v_mfma_f32_16x16x32_bf16 v[96:99], a[120:123], a[112:115], v[96:99]
    buffer_load_dwordx4 v15, s[44:47], s52 offen offset:1024 lds
    v_mfma_f32_16x16x32_bf16 v[116:119], a[112:115], a[124:127], v[116:119]
    s_add_u32 s55, s55, s96
    s_lshl_b32 s97, s97, 1
    s_lshr_b32 s96, s99, 1
    s_waitcnt lgkmcnt(0)
    v_mfma_f32_16x16x32_bf16 v[80:83], a[88:91], a[64:67], v[80:83]
    ds_read_b64_tr_b16 a[116:117], v22 offset:4096
    s_add_u32 s97, s97, s96
    v_mfma_f32_16x16x32_bf16 v[100:103], a[64:67], a[92:95], v[100:103]
    ds_read_b64_tr_b16 a[118:119], v22 offset:4608
    ds_read_b64_tr_b16 a[120:121], v22 offset:12288
    s_and_b32 s96, s99, 1
    v_mfma_f32_16x16x32_bf16 v[64:67], a[84:87], a[68:71], v[64:67]
    ds_read_b64_tr_b16 a[122:123], v22 offset:12800
    s_add_u32 m0, s75, 122880
    s_add_u32 s52, s74, 1024
    v_mfma_f32_16x16x32_bf16 v[84:87], a[88:91], a[68:71], v[84:87]
    ds_read_b64_tr_b16 a[124:125], v22 offset:20480
    buffer_load_dwordx4 v14, s[44:47], s52 offen lds
    v_mfma_f32_16x16x32_bf16 v[104:107], a[68:71], a[92:95], v[104:107]
    ds_read_b64_tr_b16 a[126:127], v22 offset:20992
    ds_read_b128 a[96:99], v19 offset:0
    s_add_u32 s98, s98, s96
    s_lshl_b32 s3, s48, 12
    v_mfma_f32_16x16x32_bf16 v[68:71], a[84:87], a[72:75], v[68:71]
    ds_read_b128 a[100:103], v19 offset:2048
    buffer_load_dwordx4 v15, s[44:47], s52 offen offset:1024 lds
    v_mfma_f32_16x16x32_bf16 v[88:91], a[88:91], a[72:75], v[88:91]
    ds_read_b128 a[104:107], v19 offset:4096
    ds_read_b128 a[108:111], v19 offset:6144
    s_lshl_b32 s96, s97, 16
    v_mfma_f32_16x16x32_bf16 v[108:111], a[72:75], a[92:95], v[108:111]
    ds_read_b128 a[112:115], v19 offset:8192
    s_add_u32 s96, s96, s3
    s_mul_i32 s100, s98, 589824
    v_mfma_f32_16x16x32_bf16 v[72:75], a[84:87], a[76:79], v[72:75]
    s_add_u32 m0, s75, 131072
    s_add_u32 s52, s74, 2048
    s_lshl_b32 s51, s48, 14
    v_mfma_f32_16x16x32_bf16 v[92:95], a[88:91], a[76:79], v[92:95]
    buffer_load_dwordx4 v14, s[44:47], s52 offen lds
    v_mfma_f32_16x16x32_bf16 v[112:115], a[76:79], a[92:95], v[112:115]
    buffer_load_dwordx4 v15, s[44:47], s52 offen offset:1024 lds
    v_mfma_f32_16x16x32_bf16 v[76:79], a[84:87], a[80:83], v[76:79]
    s_add_u32 s100, s100, s51
    v_add_u32 v5, 129024, v2
    v_mfma_f32_16x16x32_bf16 v[96:99], a[88:91], a[80:83], v[96:99]
    s_add_u32 s73, s73, 128
    s_add_u32 s74, s74, 196608
    v_mfma_f32_16x16x32_bf16 v[116:119], a[80:83], a[92:95], v[116:119]
    s_lshr_b32 s51, s48, 1
    s_lshl_b32 s51, s51, 13
    s_add_u32 s51, s51, 32768
    s_waitcnt vmcnt(18) lgkmcnt(0)
    s_barrier
    v_mfma_f32_16x16x32_bf16 v[80:83], a[120:123], a[96:99], v[80:83]
    ds_read_b64_tr_b16 a[84:85], v22 offset:34816
    v_add_u32 v6, s51, v2
    v_mfma_f32_16x16x32_bf16 v[100:103], a[96:99], a[124:127], v[100:103]
    ds_read_b64_tr_b16 a[86:87], v22 offset:35328
    ds_read_b64_tr_b16 a[88:89], v22 offset:43008
    v_add_u32 v7, 0x10000, v6
    v_mfma_f32_16x16x32_bf16 v[64:67], a[116:119], a[100:103], v[64:67]
    ds_read_b64_tr_b16 a[90:91], v22 offset:43520
    s_add_u32 m0, s75, 2048
    s_lshr_b32 s52, s75, 1
    v_mfma_f32_16x16x32_bf16 v[84:87], a[120:123], a[100:103], v[84:87]
    ds_read_b64_tr_b16 a[92:93], v22 offset:51200
    buffer_load_dwordx4 v12, s[40:43], s72 offen lds
    v_mfma_f32_16x16x32_bf16 v[104:107], a[100:103], a[124:127], v[104:107]
    ds_read_b64_tr_b16 a[94:95], v22 offset:51712
    ds_read_b128 a[64:67], v18 offset:34816
    s_and_b32 s51, s48, 1
    s_lshl_b32 s51, s51, 13
    v_mfma_f32_16x16x32_bf16 v[68:71], a[116:119], a[104:107], v[68:71]
    ds_read_b128 a[68:71], v18 offset:36864
    buffer_load_dwordx4 v13, s[40:43], s72 offen offset:1024 lds
    v_mfma_f32_16x16x32_bf16 v[88:91], a[120:123], a[104:107], v[88:91]
    ds_read_b128 a[72:75], v18 offset:38912
    ds_read_b128 a[76:79], v18 offset:40960
    s_and_b32 s52, s52, 1024
    v_mfma_f32_16x16x32_bf16 v[108:111], a[104:107], a[124:127], v[108:111]
    ds_read_b128 a[80:83], v18 offset:43008
    s_add_u32 s51, s51, 49152
    v_add_u32 v8, s51, v2
    v_mfma_f32_16x16x32_bf16 v[72:75], a[116:119], a[108:111], v[72:75]
    s_add_u32 m0, s52, 0
    s_add_u32 s72, s72, 128
    v_mfma_f32_16x16x32_bf16 v[92:95], a[120:123], a[108:111], v[92:95]
    buffer_load_dwordx4 v12, s[40:43], s73 offen lds
    v_add_u32 v9, 0x10000, v8
    v_mfma_f32_16x16x32_bf16 v[112:115], a[108:111], a[124:127], v[112:115]
    s_add_u32 m0, s75, 10240
    s_add_u32 s52, s74, 0
    v_add_u32 v10, 16384, v2
    v_mfma_f32_16x16x32_bf16 v[76:79], a[116:119], a[112:115], v[76:79]
    buffer_load_dwordx4 v14, s[44:47], s52 offen lds
    v_mfma_f32_16x16x32_bf16 v[96:99], a[120:123], a[112:115], v[96:99]
    buffer_load_dwordx4 v15, s[44:47], s52 offen offset:1024 lds
    v_mfma_f32_16x16x32_bf16 v[116:119], a[112:115], a[124:127], v[116:119]
    v_add_u32 v11, 32768, v2
    v_add_u32 v27, 49152, v2
    s_waitcnt lgkmcnt(0)
    v_mfma_f32_16x16x32_bf16 v[80:83], a[88:91], a[64:67], v[80:83]
    ds_read_b64_tr_b16 a[116:117], v22 offset:38912
    v_and_b32 v17, 15, v1
    s_lshl_b32 s51, s99, 5
    v_mfma_f32_16x16x32_bf16 v[100:103], a[64:67], a[92:95], v[100:103]
    ds_read_b64_tr_b16 a[118:119], v22 offset:39424
    ds_read_b64_tr_b16 a[120:121], v22 offset:47104
    v_mfma_f32_16x16x32_bf16 v[64:67], a[84:87], a[68:71], v[64:67]
    ds_read_b64_tr_b16 a[122:123], v22 offset:47616
    s_add_u32 m0, s75, 18432
    s_add_u32 s52, s74, 1024
    v_mfma_f32_16x16x32_bf16 v[84:87], a[88:91], a[68:71], v[84:87]
    ds_read_b64_tr_b16 a[124:125], v22 offset:55296
    buffer_load_dwordx4 v14, s[44:47], s52 offen lds
    v_mfma_f32_16x16x32_bf16 v[104:107], a[68:71], a[92:95], v[104:107]
    ds_read_b64_tr_b16 a[126:127], v22 offset:55808
    ds_read_b128 a[96:99], v19 offset:34816
    s_lshl_b32 s53, s48, 4
    s_add_u32 s51, s51, s53
    v_mfma_f32_16x16x32_bf16 v[68:71], a[84:87], a[72:75], v[68:71]
    ds_read_b128 a[100:103], v19 offset:36864
    buffer_load_dwordx4 v15, s[44:47], s52 offen offset:1024 lds
    v_mfma_f32_16x16x32_bf16 v[88:91], a[88:91], a[72:75], v[88:91]
    ds_read_b128 a[104:107], v19 offset:38912
    ds_read_b128 a[108:111], v19 offset:40960
    v_mfma_f32_16x16x32_bf16 v[108:111], a[72:75], a[92:95], v[108:111]
    ds_read_b128 a[112:115], v19 offset:43008
    s_cmp_lt_u32 s48, 2
    s_cselect_b32 s51, s51, 112
    v_mfma_f32_16x16x32_bf16 v[72:75], a[84:87], a[76:79], v[72:75]
    s_add_u32 m0, s75, 26624
    s_add_u32 s52, s74, 2048
    v_add_lshl_u32 v17, v17, s51, 8
    s_lshr_b32 s51, s98, 2
    v_mfma_f32_16x16x32_bf16 v[92:95], a[88:91], a[76:79], v[92:95]
    buffer_load_dwordx4 v14, s[44:47], s52 offen lds
    v_mfma_f32_16x16x32_bf16 v[112:115], a[76:79], a[92:95], v[112:115]
    buffer_load_dwordx4 v15, s[44:47], s52 offen offset:1024 lds
    v_mfma_f32_16x16x32_bf16 v[76:79], a[84:87], a[80:83], v[76:79]
    s_lshl_b32 s51, s51, 7
    v_add_u32 v17, s51, v17
    v_mfma_f32_16x16x32_bf16 v[96:99], a[88:91], a[80:83], v[96:99]
    s_add_u32 s73, s73, 128
    s_add_u32 s74, s74, 196608
    v_mfma_f32_16x16x32_bf16 v[116:119], a[80:83], a[92:95], v[116:119]
    buffer_load_dword v16, v17, s[76:79], 0 offen offset:12 sc1
    s_waitcnt vmcnt(19) lgkmcnt(0)
    s_barrier
    v_mfma_f32_16x16x32_bf16 v[80:83], a[120:123], a[96:99], v[80:83]
    ds_read_b64_tr_b16 a[84:85], v23 offset:0
    s_add_u32 s28, s26, 54525952
    s_addc_u32 s29, s27, 0
    v_mfma_f32_16x16x32_bf16 v[100:103], a[96:99], a[124:127], v[100:103]
    ds_read_b64_tr_b16 a[86:87], v23 offset:512
    ds_read_b64_tr_b16 a[88:89], v23 offset:8192
    v_mfma_f32_16x16x32_bf16 v[64:67], a[116:119], a[100:103], v[64:67]
    ds_read_b64_tr_b16 a[90:91], v23 offset:8704
    s_add_u32 m0, s75, 36864
    s_lshr_b32 s52, s75, 1
    v_mfma_f32_16x16x32_bf16 v[84:87], a[120:123], a[100:103], v[84:87]
    ds_read_b64_tr_b16 a[92:93], v23 offset:16384
    buffer_load_dwordx4 v12, s[40:43], s72 offen lds
    v_mfma_f32_16x16x32_bf16 v[104:107], a[100:103], a[124:127], v[104:107]
    ds_read_b64_tr_b16 a[94:95], v23 offset:16896
    ds_read_b128 a[64:67], v20 offset:0
    s_mov_b32 s30, 4718592
    v_mfma_f32_16x16x32_bf16 v[68:71], a[116:119], a[104:107], v[68:71]
    ds_read_b128 a[68:71], v20 offset:2048
    buffer_load_dwordx4 v13, s[40:43], s72 offen offset:1024 lds
    v_mfma_f32_16x16x32_bf16 v[88:91], a[120:123], a[104:107], v[88:91]
    ds_read_b128 a[72:75], v20 offset:4096
    ds_read_b128 a[76:79], v20 offset:6144
    s_and_b32 s52, s52, 1024
    v_mfma_f32_16x16x32_bf16 v[108:111], a[104:107], a[124:127], v[108:111]
    ds_read_b128 a[80:83], v20 offset:8192
    s_mov_b32 s31, 0x20000
    v_mfma_f32_16x16x32_bf16 v[72:75], a[116:119], a[108:111], v[72:75]
    s_add_u32 m0, s52, 34816
    s_add_u32 s72, s72, 128
    s_add_u32 s32, s26, 50331648
    s_addc_u32 s33, s27, 0
    v_mfma_f32_16x16x32_bf16 v[92:95], a[120:123], a[108:111], v[92:95]
    buffer_load_dwordx4 v12, s[40:43], s73 offen lds
    v_mfma_f32_16x16x32_bf16 v[112:115], a[108:111], a[124:127], v[112:115]
    s_add_u32 m0, s75, 45056
    s_add_u32 s52, s74, 0
    s_mov_b32 s34, 2097152
    v_mfma_f32_16x16x32_bf16 v[76:79], a[116:119], a[112:115], v[76:79]
    buffer_load_dwordx4 v14, s[44:47], s52 offen lds
    v_mfma_f32_16x16x32_bf16 v[96:99], a[120:123], a[112:115], v[96:99]
    buffer_load_dwordx4 v15, s[44:47], s52 offen offset:1024 lds
    v_mfma_f32_16x16x32_bf16 v[116:119], a[112:115], a[124:127], v[116:119]
    s_mov_b32 s35, 0x20000
    s_waitcnt lgkmcnt(0)
    v_mfma_f32_16x16x32_bf16 v[80:83], a[88:91], a[64:67], v[80:83]
    ds_read_b64_tr_b16 a[116:117], v23 offset:4096
    v_lshlrev_b32 v24, 2, v3
    v_sub_u32 v24, v4, v24
    v_mfma_f32_16x16x32_bf16 v[100:103], a[64:67], a[92:95], v[100:103]
    ds_read_b64_tr_b16 a[118:119], v23 offset:4608
    ds_read_b64_tr_b16 a[120:121], v23 offset:12288
    v_subrev_u32 v25, 0, v24
    v_mfma_f32_16x16x32_bf16 v[64:67], a[84:87], a[68:71], v[64:67]
    ds_read_b64_tr_b16 a[122:123], v23 offset:12800
    s_add_u32 m0, s75, 53248
    s_add_u32 s52, s74, 1024
    v_mfma_f32_16x16x32_bf16 v[84:87], a[88:91], a[68:71], v[84:87]
    ds_read_b64_tr_b16 a[124:125], v23 offset:20480
    buffer_load_dwordx4 v14, s[44:47], s52 offen lds
    v_mfma_f32_16x16x32_bf16 v[104:107], a[68:71], a[92:95], v[104:107]
    ds_read_b64_tr_b16 a[126:127], v23 offset:20992
    ds_read_b128 a[96:99], v21 offset:0
    v_and_b32 v26, 0x80000001, v25
    v_cmp_eq_u32 s[56:57], 0, v26
    v_mfma_f32_16x16x32_bf16 v[68:71], a[84:87], a[72:75], v[68:71]
    ds_read_b128 a[100:103], v21 offset:2048
    buffer_load_dwordx4 v15, s[44:47], s52 offen offset:1024 lds
    v_xor_b32 v26, 0x80000000, v26
    v_mfma_f32_16x16x32_bf16 v[88:91], a[88:91], a[72:75], v[88:91]
    ds_read_b128 a[104:107], v21 offset:4096
    ds_read_b128 a[108:111], v21 offset:6144
    v_cmp_eq_u32 s[64:65], 0, v26
    v_subrev_u32 v25, 1, v24
    v_mfma_f32_16x16x32_bf16 v[108:111], a[72:75], a[92:95], v[108:111]
    ds_read_b128 a[112:115], v21 offset:8192
    v_and_b32 v26, 0x80000001, v25
    v_cmp_eq_u32 s[58:59], 0, v26
    v_mfma_f32_16x16x32_bf16 v[72:75], a[84:87], a[76:79], v[72:75]
    s_add_u32 m0, s75, 61440
    s_add_u32 s52, s74, 2048
    v_xor_b32 v26, 0x80000000, v26
    v_mfma_f32_16x16x32_bf16 v[92:95], a[88:91], a[76:79], v[92:95]
    buffer_load_dwordx4 v14, s[44:47], s52 offen lds
    v_cmp_eq_u32 s[66:67], 0, v26
    v_subrev_u32 v25, 2, v24
    v_mfma_f32_16x16x32_bf16 v[112:115], a[76:79], a[92:95], v[112:115]
    buffer_load_dwordx4 v15, s[44:47], s52 offen offset:1024 lds
    v_and_b32 v26, 0x80000001, v25
    v_mfma_f32_16x16x32_bf16 v[76:79], a[84:87], a[80:83], v[76:79]
    v_cmp_eq_u32 s[60:61], 0, v26
    v_xor_b32 v26, 0x80000000, v26
    v_cmp_eq_u32 s[68:69], 0, v26
    v_mfma_f32_16x16x32_bf16 v[96:99], a[88:91], a[80:83], v[96:99]
    s_add_u32 s73, s73, 128
    s_add_u32 s74, s74, 196608
    v_mfma_f32_16x16x32_bf16 v[116:119], a[80:83], a[92:95], v[116:119]
    v_subrev_u32 v25, 3, v24
    v_and_b32 v26, 0x80000001, v25
    v_cmp_eq_u32 s[62:63], 0, v26
    v_xor_b32 v26, 0x80000000, v26
    v_cmp_eq_u32 s[70:71], 0, v26
    s_waitcnt vmcnt(9) lgkmcnt(0)
    s_mov_b32 s52, 0
L_poll2:
    v_cmp_eq_u32 vcc, s95, v16
    s_nop 0
    s_cmp_eq_u64 vcc, -1
    s_cbranch_scc1 L_poll2_ok
    s_add_u32 s52, s52, 1
    s_cmp_gt_u32 s52, 0x40000
    s_cbranch_scc1 L_poll2_ok
    s_sleep 1
    buffer_load_dword v16, v17, s[76:79], 0 offen offset:12 sc1
    s_waitcnt vmcnt(0)
    s_branch L_poll2
L_poll2_ok:
    s_barrier
    v_mfma_f32_16x16x32_bf16 v[80:83], a[120:123], a[96:99], v[80:83]
    ds_read_b64_tr_b16 a[84:85], v23 offset:34816
    v_and_b32 v17, 3, v1
    v_bfe_u32 v16, v1, 2, 1
    v_mfma_f32_16x16x32_bf16 v[100:103], a[96:99], a[124:127], v[100:103]
    ds_read_b64_tr_b16 a[86:87], v23 offset:35328
    ds_read_b64_tr_b16 a[88:89], v23 offset:43008
    v_mfma_f32_16x16x32_bf16 v[64:67], a[116:119], a[100:103], v[64:67]
    ds_read_b64_tr_b16 a[90:91], v23 offset:43520
    v_lshl_add_u32 v17, v17, 3, v16
    s_lshl_b32 s51, s50, 5
    v_mfma_f32_16x16x32_bf16 v[84:87], a[120:123], a[100:103], v[84:87]
    ds_read_b64_tr_b16 a[92:93], v23 offset:51200
    s_lshl_b32 s53, s99, 1
    s_add_u32 s51, s51, s53
    v_mfma_f32_16x16x32_bf16 v[104:107], a[100:103], a[124:127], v[104:107]
    ds_read_b64_tr_b16 a[94:95], v23 offset:51712
    ds_read_b128 a[64:67], v20 offset:34816
    v_mfma_f32_16x16x32_bf16 v[68:71], a[116:119], a[104:107], v[68:71]
    ds_read_b128 a[68:71], v20 offset:36864
    v_add_lshl_u32 v17, v17, s51, 7
    v_mfma_f32_16x16x32_bf16 v[88:91], a[120:123], a[104:107], v[88:91]
    ds_read_b128 a[72:75], v20 offset:38912
    ds_read_b128 a[76:79], v20 offset:40960
    v_mfma_f32_16x16x32_bf16 v[108:111], a[104:107], a[124:127], v[108:111]
    ds_read_b128 a[80:83], v20 offset:43008
    v_mfma_f32_16x16x32_bf16 v[72:75], a[116:119], a[108:111], v[72:75]
    buffer_load_dword v16, v17, s[76:79], 0 offen offset:4 sc1
    v_mfma_f32_16x16x32_bf16 v[92:95], a[120:123], a[108:111], v[92:95]
    v_mfma_f32_16x16x32_bf16 v[112:115], a[108:111], a[124:127], v[112:115]
    v_mfma_f32_16x16x32_bf16 v[76:79], a[116:119], a[112:115], v[76:79]
    v_mfma_f32_16x16x32_bf16 v[96:99], a[120:123], a[112:115], v[96:99]
    v_mfma_f32_16x16x32_bf16 v[116:119], a[112:115], a[124:127], v[116:119]
    s_waitcnt lgkmcnt(0)
    v_mfma_f32_16x16x32_bf16 v[80:83], a[88:91], a[64:67], v[80:83]
    ds_read_b64_tr_b16 a[116:117], v23 offset:38912
    v_mfma_f32_16x16x32_bf16 v[100:103], a[64:67], a[92:95], v[100:103]
    ds_read_b64_tr_b16 a[118:119], v23 offset:39424
    ds_read_b64_tr_b16 a[120:121], v23 offset:47104
    v_mfma_f32_16x16x32_bf16 v[64:67], a[84:87], a[68:71], v[64:67]
    ds_read_b64_tr_b16 a[122:123], v23 offset:47616
    v_mfma_f32_16x16x32_bf16 v[84:87], a[88:91], a[68:71], v[84:87]
    ds_read_b64_tr_b16 a[124:125], v23 offset:55296
    v_mfma_f32_16x16x32_bf16 v[104:107], a[68:71], a[92:95], v[104:107]
    ds_read_b64_tr_b16 a[126:127], v23 offset:55808
    ds_read_b128 a[96:99], v21 offset:34816
    v_mfma_f32_16x16x32_bf16 v[68:71], a[84:87], a[72:75], v[68:71]
    ds_read_b128 a[100:103], v21 offset:36864
    v_mfma_f32_16x16x32_bf16 v[88:91], a[88:91], a[72:75], v[88:91]
    ds_read_b128 a[104:107], v21 offset:38912
    ds_read_b128 a[108:111], v21 offset:40960
    v_mfma_f32_16x16x32_bf16 v[108:111], a[72:75], a[92:95], v[108:111]
    ds_read_b128 a[112:115], v21 offset:43008
    v_mfma_f32_16x16x32_bf16 v[72:75], a[84:87], a[76:79], v[72:75]
    s_cmp_eq_u32 s49, 0
    s_cselect_b64 s[40:41], 0, s[64:65]
    s_cselect_b64 s[42:43], 0, s[66:67]
    s_cselect_b64 s[44:45], 0, s[68:69]
    s_cselect_b64 s[46:47], 0, s[70:71]
    v_mfma_f32_16x16x32_bf16 v[92:95], a[88:91], a[76:79], v[92:95]
    v_mfma_f32_16x16x32_bf16 v[112:115], a[76:79], a[92:95], v[112:115]
    v_mfma_f32_16x16x32_bf16 v[76:79], a[84:87], a[80:83], v[76:79]
    v_mfma_f32_16x16x32_bf16 v[96:99], a[88:91], a[80:83], v[96:99]
    v_mfma_f32_16x16x32_bf16 v[116:119], a[80:83], a[92:95], v[116:119]
    s_waitcnt vmcnt(0) lgkmcnt(0)
    s_mov_b32 s52, 0
L_poll3:
    v_cmp_eq_u32 vcc, s95, v16
    s_nop 0
    s_cmp_eq_u64 vcc, -1
    s_cbranch_scc1 L_poll3_ok
    s_add_u32 s52, s52, 1
    s_cmp_gt_u32 s52, 0x40000
    s_cbranch_scc1 L_poll3_ok
    s_sleep 1
    buffer_load_dword v16, v17, s[76:79], 0 offen offset:4 sc1
    s_waitcnt vmcnt(0)
    s_branch L_poll3
L_poll3_ok:
    s_barrier
    v_mfma_f32_16x16x32_bf16 v[80:83], a[120:123], a[96:99], v[80:83]
    ds_read_b64_tr_b16 a[84:85], v22 offset:0
    v_mfma_f32_16x16x32_bf16 v[100:103], a[96:99], a[124:127], v[100:103]
    ds_read_b64_tr_b16 a[86:87], v22 offset:512
    ds_read_b64_tr_b16 a[88:89], v22 offset:8192
    v_mfma_f32_16x16x32_bf16 v[64:67], a[116:119], a[100:103], v[64:67]
    ds_read_b64_tr_b16 a[90:91], v22 offset:8704
    s_add_u32 m0, s3, 131072
    v_mfma_f32_16x16x32_bf16 v[84:87], a[120:123], a[100:103], v[84:87]
    ds_read_b64_tr_b16 a[92:93], v22 offset:16384
    buffer_load_dwordx4 v2, s[36:39], s54 offen offset:0 sc1 lds
    v_mfma_f32_16x16x32_bf16 v[104:107], a[100:103], a[124:127], v[104:107]
    ds_read_b64_tr_b16 a[94:95], v22 offset:16896
    ds_read_b128 a[64:67], v18 offset:0
    v_mfma_f32_16x16x32_bf16 v[68:71], a[116:119], a[104:107], v[68:71]
    ds_read_b128 a[68:71], v18 offset:2048
    buffer_load_dwordx4 v2, s[36:39], s54 offen offset:1024 sc1 lds
    v_mfma_f32_16x16x32_bf16 v[88:91], a[120:123], a[104:107], v[88:91]
    ds_read_b128 a[72:75], v18 offset:4096
    ds_read_b128 a[76:79], v18 offset:6144
    v_mfma_f32_16x16x32_bf16 v[108:111], a[104:107], a[124:127], v[108:111]
    ds_read_b128 a[80:83], v18 offset:8192
    v_mfma_f32_16x16x32_bf16 v[72:75], a[116:119], a[108:111], v[72:75]
    buffer_load_dwordx4 v5, s[36:39], s54 offen offset:2048 sc1 lds
    v_mfma_f32_16x16x32_bf16 v[92:95], a[120:123], a[108:111], v[92:95]
    v_mfma_f32_16x16x32_bf16 v[112:115], a[108:111], a[124:127], v[112:115]
    v_mfma_f32_16x16x32_bf16 v[76:79], a[116:119], a[112:115], v[76:79]
    v_mfma_f32_16x16x32_bf16 v[96:99], a[120:123], a[112:115], v[96:99]
    buffer_load_dwordx4 v5, s[36:39], s54 offen offset:3072 sc1 lds
    v_mfma_f32_16x16x32_bf16 v[116:119], a[112:115], a[124:127], v[116:119]
    s_add_u32 s54, s54, 2048
    s_waitcnt lgkmcnt(0)
    v_mfma_f32_16x16x32_bf16 v[80:83], a[88:91], a[64:67], v[80:83]
    ds_read_b64_tr_b16 a[116:117], v22 offset:4096
    v_mfma_f32_16x16x32_bf16 v[100:103], a[64:67], a[92:95], v[100:103]
    ds_read_b64_tr_b16 a[118:119], v22 offset:4608
    ds_read_b64_tr_b16 a[120:121], v22 offset:12288
    v_mfma_f32_16x16x32_bf16 v[64:67], a[84:87], a[68:71], v[64:67]
    ds_read_b64_tr_b16 a[122:123], v22 offset:12800
    s_add_u32 m0, s3, 147456
    v_mfma_f32_16x16x32_bf16 v[84:87], a[88:91], a[68:71], v[84:87]
    ds_read_b64_tr_b16 a[124:125], v22 offset:20480
    buffer_load_dwordx4 v2, s[28:31], s55 offen offset:0 sc1 lds
    v_mfma_f32_16x16x32_bf16 v[104:107], a[68:71], a[92:95], v[104:107]
    ds_read_b64_tr_b16 a[126:127], v22 offset:20992
    ds_read_b128 a[96:99], v19 offset:0
    v_mfma_f32_16x16x32_bf16 v[68:71], a[84:87], a[72:75], v[68:71]
    ds_read_b128 a[100:103], v19 offset:2048
    buffer_load_dwordx4 v2, s[28:31], s55 offen offset:1024 sc1 lds
    v_mfma_f32_16x16x32_bf16 v[88:91], a[88:91], a[72:75], v[88:91]
    ds_read_b128 a[104:107], v19 offset:4096
    ds_read_b128 a[108:111], v19 offset:6144
    v_mfma_f32_16x16x32_bf16 v[108:111], a[72:75], a[92:95], v[108:111]
    ds_read_b128 a[112:115], v19 offset:8192
    v_mfma_f32_16x16x32_bf16 v[72:75], a[84:87], a[76:79], v[72:75]
    buffer_load_dwordx4 v2, s[28:31], s55 offen offset:2048 sc1 lds
    v_mfma_f32_16x16x32_bf16 v[92:95], a[88:91], a[76:79], v[92:95]
    v_mfma_f32_16x16x32_bf16 v[112:115], a[76:79], a[92:95], v[112:115]
    v_mfma_f32_16x16x32_bf16 v[76:79], a[84:87], a[80:83], v[76:79]
    v_mfma_f32_16x16x32_bf16 v[96:99], a[88:91], a[80:83], v[96:99]
    buffer_load_dwordx4 v2, s[28:31], s55 offen offset:3072 sc1 lds
    v_mfma_f32_16x16x32_bf16 v[116:119], a[80:83], a[92:95], v[116:119]
    s_add_u32 s55, s55, 8192
    s_waitcnt vmcnt(9) lgkmcnt(0)
    s_barrier
    v_mfma_f32_16x16x32_bf16 v[80:83], a[120:123], a[96:99], v[80:83]
    ds_read_b64_tr_b16 a[84:85], v22 offset:34816
    v_mfma_f32_16x16x32_bf16 v[100:103], a[96:99], a[124:127], v[100:103]
    ds_read_b64_tr_b16 a[86:87], v22 offset:35328
    ds_read_b64_tr_b16 a[88:89], v22 offset:43008
    v_mfma_f32_16x16x32_bf16 v[64:67], a[116:119], a[100:103], v[64:67]
    ds_read_b64_tr_b16 a[90:91], v22 offset:43520
    s_add_u32 m0, s3, 98304
    v_mfma_f32_16x16x32_bf16 v[84:87], a[120:123], a[100:103], v[84:87]
    ds_read_b64_tr_b16 a[92:93], v22 offset:51200
    buffer_load_dwordx4 v2, s[36:39], s54 offen offset:0 sc1 lds
    v_mfma_f32_16x16x32_bf16 v[104:107], a[100:103], a[124:127], v[104:107]
    ds_read_b64_tr_b16 a[94:95], v22 offset:51712
    ds_read_b128 a[64:67], v18 offset:34816
    v_mfma_f32_16x16x32_bf16 v[68:71], a[116:119], a[104:107], v[68:71]
    ds_read_b128 a[68:71], v18 offset:36864
    buffer_load_dwordx4 v2, s[36:39], s54 offen offset:1024 sc1 lds
    v_mfma_f32_16x16x32_bf16 v[88:91], a[120:123], a[104:107], v[88:91]
    ds_read_b128 a[72:75], v18 offset:38912
    ds_read_b128 a[76:79], v18 offset:40960
    v_mfma_f32_16x16x32_bf16 v[108:111], a[104:107], a[124:127], v[108:111]
    ds_read_b128 a[80:83], v18 offset:43008
    v_mfma_f32_16x16x32_bf16 v[72:75], a[116:119], a[108:111], v[72:75]
    buffer_load_dwordx4 v5, s[36:39], s54 offen offset:2048 sc1 lds
    v_mfma_f32_16x16x32_bf16 v[92:95], a[120:123], a[108:111], v[92:95]
    v_mfma_f32_16x16x32_bf16 v[112:115], a[108:111], a[124:127], v[112:115]
    v_mfma_f32_16x16x32_bf16 v[76:79], a[116:119], a[112:115], v[76:79]
    v_mfma_f32_16x16x32_bf16 v[96:99], a[120:123], a[112:115], v[96:99]
    buffer_load_dwordx4 v5, s[36:39], s54 offen offset:3072 sc1 lds
    v_mfma_f32_16x16x32_bf16 v[116:119], a[112:115], a[124:127], v[116:119]
    s_add_u32 s54, s54, 2048
    s_waitcnt lgkmcnt(0)
    v_mfma_f32_16x16x32_bf16 v[80:83], a[88:91], a[64:67], v[80:83]
    ds_read_b64_tr_b16 a[116:117], v22 offset:38912
    v_mfma_f32_16x16x32_bf16 v[100:103], a[64:67], a[92:95], v[100:103]
    ds_read_b64_tr_b16 a[118:119], v22 offset:39424
    ds_read_b64_tr_b16 a[120:121], v22 offset:47104
    v_mfma_f32_16x16x32_bf16 v[64:67], a[84:87], a[68:71], v[64:67]
    ds_read_b64_tr_b16 a[122:123], v22 offset:47616
    s_add_u32 m0, s3, 114688
    v_mfma_f32_16x16x32_bf16 v[84:87], a[88:91], a[68:71], v[84:87]
    ds_read_b64_tr_b16 a[124:125], v22 offset:55296
    buffer_load_dwordx4 v2, s[28:31], s55 offen offset:0 sc1 lds
    v_mfma_f32_16x16x32_bf16 v[104:107], a[68:71], a[92:95], v[104:107]
    ds_read_b64_tr_b16 a[126:127], v22 offset:55808
    ds_read_b128 a[96:99], v19 offset:34816
    v_mfma_f32_16x16x32_bf16 v[68:71], a[84:87], a[72:75], v[68:71]
    ds_read_b128 a[100:103], v19 offset:36864
    buffer_load_dwordx4 v2, s[28:31], s55 offen offset:1024 sc1 lds
    v_mfma_f32_16x16x32_bf16 v[88:91], a[88:91], a[72:75], v[88:91]
    ds_read_b128 a[104:107], v19 offset:38912
    ds_read_b128 a[108:111], v19 offset:40960
    v_mfma_f32_16x16x32_bf16 v[108:111], a[72:75], a[92:95], v[108:111]
    ds_read_b128 a[112:115], v19 offset:43008
    v_mfma_f32_16x16x32_bf16 v[72:75], a[84:87], a[76:79], v[72:75]
    buffer_load_dwordx4 v2, s[28:31], s55 offen offset:2048 sc1 lds
    v_mfma_f32_16x16x32_bf16 v[92:95], a[88:91], a[76:79], v[92:95]
    v_mfma_f32_16x16x32_bf16 v[112:115], a[76:79], a[92:95], v[112:115]
    v_mfma_f32_16x16x32_bf16 v[76:79], a[84:87], a[80:83], v[76:79]
    v_mfma_f32_16x16x32_bf16 v[96:99], a[88:91], a[80:83], v[96:99]
    buffer_load_dwordx4 v2, s[28:31], s55 offen offset:3072 sc1 lds
    v_mfma_f32_16x16x32_bf16 v[116:119], a[80:83], a[92:95], v[116:119]
    s_add_u32 s55, s55, 8192
    s_waitcnt lgkmcnt(0)
    s_barrier
    v_mfma_f32_16x16x32_bf16 v[80:83], a[120:123], a[96:99], v[80:83]
    s_add_u32 m0, s3, 65536
    s_nop 0
    buffer_load_dwordx4 v2, s[36:39], s54 offen offset:0 sc1 lds
    v_mfma_f32_16x16x32_bf16 v[100:103], a[96:99], a[124:127], v[100:103]
    v_mfma_f32_16x16x32_bf16 v[64:67], a[116:119], a[100:103], v[64:67]
    buffer_load_dwordx4 v2, s[36:39], s54 offen offset:1024 sc1 lds
    v_mfma_f32_16x16x32_bf16 v[84:87], a[120:123], a[100:103], v[84:87]
    v_mfma_f32_16x16x32_bf16 v[104:107], a[100:103], a[124:127], v[104:107]
    buffer_load_dwordx4 v5, s[36:39], s54 offen offset:2048 sc1 lds
    v_mfma_f32_16x16x32_bf16 v[68:71], a[116:119], a[104:107], v[68:71]
    v_mfma_f32_16x16x32_bf16 v[88:91], a[120:123], a[104:107], v[88:91]
    buffer_load_dwordx4 v5, s[36:39], s54 offen offset:3072 sc1 lds
    s_add_u32 s54, s54, 2048
    v_mfma_f32_16x16x32_bf16 v[108:111], a[104:107], a[124:127], v[108:111]
    s_add_u32 m0, s3, 81920
    s_nop 0
    buffer_load_dwordx4 v2, s[28:31], s55 offen offset:0 sc1 lds
    v_mfma_f32_16x16x32_bf16 v[72:75], a[116:119], a[108:111], v[72:75]
    v_mfma_f32_16x16x32_bf16 v[92:95], a[120:123], a[108:111], v[92:95]
    buffer_load_dwordx4 v2, s[28:31], s55 offen offset:1024 sc1 lds
    v_mfma_f32_16x16x32_bf16 v[112:115], a[108:111], a[124:127], v[112:115]
    v_mfma_f32_16x16x32_bf16 v[76:79], a[116:119], a[112:115], v[76:79]
    buffer_load_dwordx4 v2, s[28:31], s55 offen offset:2048 sc1 lds
    v_mfma_f32_16x16x32_bf16 v[96:99], a[120:123], a[112:115], v[96:99]
    v_mfma_f32_16x16x32_bf16 v[116:119], a[112:115], a[124:127], v[116:119]
    buffer_load_dwordx4 v2, s[28:31], s55 offen offset:3072 sc1 lds
    s_add_u32 s55, s55, 8192
    s_waitcnt vmcnt(16)
    s_barrier
    ds_read_b128 a[32:35], v9 offset:32768
    ds_read_b128 a[0:3], v7 offset:32768
    ds_read_b128 a[48:51], v9 offset:36864
    ds_read_b128 a[16:19], v7 offset:33792
    ds_read_b128 a[36:39], v9 offset:33792
    ds_read_b128 a[4:7], v7 offset:34816
    ds_read_b128 a[52:55], v9 offset:37888
    ds_read_b128 a[20:23], v7 offset:35840
    ds_read_b128 a[40:43], v9 offset:34816
    ds_read_b128 a[8:11], v7 offset:36864
    ds_read_b128 a[56:59], v9 offset:38912
    ds_read_b128 a[24:27], v7 offset:37888
    ds_read_b128 a[44:47], v9 offset:35840
    ds_read_b128 a[12:15], v7 offset:38912
    ds_read_b128 a[60:63], v9 offset:39936
    ds_read_b128 a[28:31], v7 offset:39936
    v_mov_b32 v24, 0xff800000
    s_mov_b32 s51, 0x3eb8aa3b
    s_mov_b32 s52, 0xffff0000
    v_cvt_pk_bf16_f32 v128, v80, v81
    s_add_u32 m0, s3, 32768
    s_nop 0
    buffer_load_dwordx4 v2, s[36:39], s54 offen offset:0 sc1 lds
    v_cvt_pk_bf16_f32 v129, v82, v83
    v_cvt_pk_bf16_f32 v130, v84, v85
    v_cvt_pk_bf16_f32 v131, v86, v87
    v_cvt_pk_bf16_f32 v120, v64, v65
    v_cvt_pk_bf16_f32 v121, v66, v67
    v_cvt_pk_bf16_f32 v132, v88, v89
    v_cvt_pk_bf16_f32 v133, v90, v91
    v_cvt_pk_bf16_f32 v122, v68, v69
    v_cvt_pk_bf16_f32 v123, v70, v71
    v_cvt_pk_bf16_f32 v134, v92, v93
    v_cvt_pk_bf16_f32 v135, v94, v95
    buffer_load_dwordx4 v2, s[36:39], s54 offen offset:1024 sc1 lds
    v_cvt_pk_bf16_f32 v124, v72, v73
    v_cvt_pk_bf16_f32 v125, v74, v75
    v_cvt_pk_bf16_f32 v136, v96, v97
    v_cvt_pk_bf16_f32 v137, v98, v99
    v_cvt_pk_bf16_f32 v126, v76, v77
    v_cvt_pk_bf16_f32 v127, v78, v79
    s_nop 0
    v_mfma_f32_16x16x16_bf16 v[148:151], v[128:129], v[120:121], 0
    v_mfma_f32_16x16x16_bf16 v[152:155], v[130:131], v[120:121], 0
    v_mfma_f32_16x16x16_bf16 v[156:159], v[130:131], v[122:123], 0
    v_mfma_f32_16x16x16_bf16 v[160:163], v[132:133], v[122:123], 0
    v_mfma_f32_16x16x16_bf16 v[164:167], v[132:133], v[124:125], 0
    buffer_load_dwordx4 v5, s[36:39], s54 offen offset:2048 sc1 lds
    v_mfma_f32_16x16x16_bf16 v[168:171], v[134:135], v[124:125], 0
    v_mfma_f32_16x16x16_bf16 v[172:175], v[134:135], v[126:127], 0
    v_mfma_f32_16x16x16_bf16 v[176:179], v[136:137], v[126:127], 0
    v_cvt_pk_bf16_f32 v138, v100, v101
    v_cvt_pk_bf16_f32 v139, v102, v103
    v_cvt_pk_bf16_f32 v140, v104, v105
    v_cvt_pk_bf16_f32 v141, v106, v107
    v_cvt_pk_bf16_f32 v142, v108, v109
    v_cvt_pk_bf16_f32 v143, v110, v111
    v_cvt_pk_bf16_f32 v144, v112, v113
    v_cvt_pk_bf16_f32 v145, v114, v115
    buffer_load_dwordx4 v5, s[36:39], s54 offen offset:3072 sc1 lds
    s_add_u32 s54, s54, 2048
    v_cvt_pk_bf16_f32 v146, v116, v117
    v_cvt_pk_bf16_f32 v147, v118, v119
    v_cvt_pk_bf16_f32 v149, v148, v149
    v_cvt_pk_bf16_f32 v151, v150, v151
    v_cvt_pk_bf16_f32 v153, v152, v153
    v_cvt_pk_bf16_f32 v155, v154, v155
    v_lshlrev_b32 v148, 16, v149
    v_and_b32 v149, s52, v149
    v_lshlrev_b32 v150, 16, v151
    v_and_b32 v151, s52, v151
    v_lshlrev_b32 v152, 16, v153
    v_and_b32 v153, s52, v153
    s_add_u32 m0, s3, 49152
    s_nop 0
    buffer_load_dwordx4 v2, s[28:31], s55 offen offset:0 sc1 lds
    v_lshlrev_b32 v154, 16, v155
    v_and_b32 v155, s52, v155
    v_cndmask_b32 v148, v24, v148, s[40:41]
    v_cndmask_b32 v149, v24, v149, s[42:43]
    v_cndmask_b32 v150, v24, v150, s[44:45]
    v_cndmask_b32 v151, v24, v151, s[46:47]
    v_cndmask_b32 v152, v24, v152, s[56:57]
    v_cndmask_b32 v153, v24, v153, s[58:59]
    v_cndmask_b32 v154, v24, v154, s[60:61]
    v_cndmask_b32 v155, v24, v155, s[62:63]
    v_cvt_pk_bf16_f32 v157, v156, v157
    buffer_load_dwordx4 v2, s[28:31], s55 offen offset:1024 sc1 lds
    v_cvt_pk_bf16_f32 v159, v158, v159
    v_cvt_pk_bf16_f32 v161, v160, v161
    v_cvt_pk_bf16_f32 v163, v162, v163
    v_lshlrev_b32 v156, 16, v157
    v_and_b32 v157, s52, v157
    v_lshlrev_b32 v158, 16, v159
    v_and_b32 v159, s52, v159
    v_lshlrev_b32 v160, 16, v161
    v_and_b32 v161, s52, v161
    v_lshlrev_b32 v162, 16, v163
    v_and_b32 v163, s52, v163
    v_cndmask_b32 v156, v24, v156, s[64:65]
    buffer_load_dwordx4 v2, s[28:31], s55 offen offset:2048 sc1 lds
    v_cndmask_b32 v157, v24, v157, s[66:67]
    v_cndmask_b32 v158, v24, v158, s[68:69]
    v_cndmask_b32 v159, v24, v159, s[70:71]
    v_cndmask_b32 v160, v24, v160, s[56:57]
    v_cndmask_b32 v161, v24, v161, s[58:59]
    v_cndmask_b32 v162, v24, v162, s[60:61]
    v_cndmask_b32 v163, v24, v163, s[62:63]
    v_cvt_pk_bf16_f32 v165, v164, v165
    v_cvt_pk_bf16_f32 v167, v166, v167
    v_cvt_pk_bf16_f32 v169, v168, v169
    v_cvt_pk_bf16_f32 v171, v170, v171
    buffer_load_dwordx4 v2, s[28:31], s55 offen offset:3072 sc1 lds
    s_add_u32 s55, s55, 8192
    v_lshlrev_b32 v164, 16, v165
    v_and_b32 v165, s52, v165
    v_lshlrev_b32 v166, 16, v167
    v_and_b32 v167, s52, v167
    v_lshlrev_b32 v168, 16, v169
    v_and_b32 v169, s52, v169
    v_lshlrev_b32 v170, 16, v171
    v_and_b32 v171, s52, v171
    v_cndmask_b32 v164, v24, v164, s[64:65]
    v_cndmask_b32 v165, v24, v165, s[66:67]
    v_cndmask_b32 v166, v24, v166, s[68:69]
    v_cndmask_b32 v167, v24, v167, s[70:71]
    v_cndmask_b32 v168, v24, v168, s[56:57]
    v_cndmask_b32 v169, v24, v169, s[58:59]
    v_cndmask_b32 v170, v24, v170, s[60:61]
    v_cndmask_b32 v171, v24, v171, s[62:63]
    s_waitcnt vmcnt(16) lgkmcnt(0)
    s_barrier
    v_mfma_f32_16x16x32_bf16 v[192:195], a[32:35], a[0:3], 0
    s_add_u32 m0, s3, 131072
    ds_read_b128 a[96:99], v9 offset:0
    v_cvt_pk_bf16_f32 v173, v172, v173
    v_mfma_f32_16x16x32_bf16 v[192:195], a[48:51], a[16:19], v[192:195]
    buffer_load_dwordx4 v2, s[36:39], s54 offen offset:0 sc1 lds
    v_cvt_pk_bf16_f32 v175, v174, v175
    v_mfma_f32_16x16x32_bf16 v[196:199], a[36:39], a[0:3], 0
    ds_read_b128 a[64:67], v7 offset:0
    v_cvt_pk_bf16_f32 v177, v176, v177
    v_cvt_pk_bf16_f32 v179, v178, v179
    v_mfma_f32_16x16x32_bf16 v[196:199], a[52:55], a[16:19], v[196:199]
    v_lshlrev_b32 v172, 16, v173
    v_mfma_f32_16x16x32_bf16 v[200:203], a[40:43], a[0:3], 0
    ds_read_b128 a[112:115], v9 offset:4096
    ds_read_b128 a[80:83], v7 offset:1024
    v_and_b32 v173, s52, v173
    v_mfma_f32_16x16x32_bf16 v[200:203], a[56:59], a[16:19], v[200:203]
    buffer_load_dwordx4 v2, s[36:39], s54 offen offset:1024 sc1 lds
    v_lshlrev_b32 v174, 16, v175
    v_mfma_f32_16x16x32_bf16 v[204:207], a[44:47], a[0:3], 0
    v_and_b32 v175, s52, v175
    v_lshlrev_b32 v176, 16, v177
    v_mfma_f32_16x16x32_bf16 v[204:207], a[60:63], a[16:19], v[204:207]
    ds_read_b128 a[100:103], v9 offset:1024
    v_and_b32 v177, s52, v177
    v_mfma_f32_16x16x32_bf16 v[208:211], a[32:35], a[4:7], 0
    ds_read_b128 a[68:71], v7 offset:2048
    v_lshlrev_b32 v178, 16, v179
    v_mfma_f32_16x16x32_bf16 v[208:211], a[48:51], a[20:23], v[208:211]
    buffer_load_dwordx4 v5, s[36:39], s54 offen offset:2048 sc1 lds
    v_and_b32 v179, s52, v179
    v_mfma_f32_16x16x32_bf16 v[212:215], a[36:39], a[4:7], 0
    ds_read_b128 a[116:119], v9 offset:5120
    v_cndmask_b32 v172, v24, v172, s[64:65]
    v_mfma_f32_16x16x32_bf16 v[212:215], a[52:55], a[20:23], v[212:215]
    v_cndmask_b32 v173, v24, v173, s[66:67]
    v_cndmask_b32 v174, v24, v174, s[68:69]
    v_mfma_f32_16x16x32_bf16 v[216:219], a[40:43], a[4:7], 0
    ds_read_b128 a[84:87], v7 offset:3072
    v_cndmask_b32 v175, v24, v175, s[70:71]
    v_mfma_f32_16x16x32_bf16 v[216:219], a[56:59], a[20:23], v[216:219]
    buffer_load_dwordx4 v5, s[36:39], s54 offen offset:3072 sc1 lds
    v_cndmask_b32 v176, v24, v176, s[56:57]
    v_mfma_f32_16x16x32_bf16 v[220:223], a[44:47], a[4:7], 0
    s_add_u32 s54, s54, 2048
    ds_read_b128 a[104:107], v9 offset:2048
    v_cndmask_b32 v177, v24, v177, s[58:59]
    v_mfma_f32_16x16x32_bf16 v[220:223], a[60:63], a[20:23], v[220:223]
    v_cndmask_b32 v178, v24, v178, s[60:61]
    v_mfma_f32_16x16x32_bf16 v[224:227], a[32:35], a[8:11], 0
    s_add_u32 m0, s3, 147456
    ds_read_b128 a[72:75], v7 offset:4096
    v_cndmask_b32 v179, v24, v179, s[62:63]
    v_max3_f32 v96, v148, v149, v150
    v_mfma_f32_16x16x32_bf16 v[224:227], a[48:51], a[24:27], v[224:227]
    buffer_load_dwordx4 v2, s[28:31], s55 offen offset:0 sc1 lds
    v_max3_f32 v100, v151, v152, v153
    v_mfma_f32_16x16x32_bf16 v[228:231], a[36:39], a[8:11], 0
    ds_read_b128 a[120:123], v9 offset:6144
    v_max3_f32 v96, v96, v154, v155
    v_mfma_f32_16x16x32_bf16 v[228:231], a[52:55], a[24:27], v[228:231]
    ds_read_b128 a[88:91], v7 offset:5120
    v_max_f32 v96, v96, v100
    v_mfma_f32_16x16x32_bf16 v[232:235], a[40:43], a[8:11], 0
    ds_read_b128 a[108:111], v9 offset:3072
    v_max3_f32 v97, v156, v157, v158
    v_max3_f32 v101, v159, v160, v161
    v_mfma_f32_16x16x32_bf16 v[232:235], a[56:59], a[24:27], v[232:235]
    buffer_load_dwordx4 v2, s[28:31], s55 offen offset:1024 sc1 lds
    v_max3_f32 v97, v97, v162, v163
    v_mfma_f32_16x16x32_bf16 v[236:239], a[44:47], a[8:11], 0
    ds_read_b128 a[76:79], v7 offset:6144
    v_max_f32 v97, v97, v101
    v_mfma_f32_16x16x32_bf16 v[236:239], a[60:63], a[24:27], v[236:239]
    v_max3_f32 v98, v164, v165, v166
    v_mfma_f32_16x16x32_bf16 v[240:243], a[32:35], a[12:15], 0
    ds_read_b128 a[124:127], v9 offset:7168
    v_max3_f32 v102, v167, v168, v169
    v_mfma_f32_16x16x32_bf16 v[240:243], a[48:51], a[28:31], v[240:243]
    buffer_load_dwordx4 v2, s[28:31], s55 offen offset:2048 sc1 lds
    v_max3_f32 v98, v98, v170, v171
    v_max_f32 v98, v98, v102
    v_mfma_f32_16x16x32_bf16 v[244:247], a[36:39], a[12:15], 0
    ds_read_b128 a[92:95], v7 offset:7168
    v_max3_f32 v99, v172, v173, v174
    v_mfma_f32_16x16x32_bf16 v[244:247], a[52:55], a[28:31], v[244:247]
    v_max3_f32 v103, v175, v176, v177
    v_mfma_f32_16x16x32_bf16 v[248:251], a[40:43], a[12:15], 0
    v_max3_f32 v99, v99, v178, v179
    v_mfma_f32_16x16x32_bf16 v[248:251], a[56:59], a[28:31], v[248:251]
    buffer_load_dwordx4 v2, s[28:31], s55 offen offset:3072 sc1 lds
    v_max_f32 v99, v99, v103
    v_mov_b32 v100, v96
    v_mfma_f32_16x16x32_bf16 v[252:255], a[44:47], a[12:15], 0
    s_add_u32 s55, s55, 8192
    v_mov_b32 v101, v97
    v_mfma_f32_16x16x32_bf16 v[252:255], a[60:63], a[28:31], v[252:255]
    v_mov_b32 v102, v98
    s_waitcnt vmcnt(16) lgkmcnt(0)
    s_barrier
    v_mfma_f32_16x16x32_bf16 v[192:195], a[96:99], a[64:67], v[192:195]
    s_add_u32 m0, s3, 98304
    ds_read_b128 a[32:35], v8 offset:32768
    v_mov_b32 v103, v99
    v_mfma_f32_16x16x32_bf16 v[192:195], a[112:115], a[80:83], v[192:195]
    buffer_load_dwordx4 v2, s[36:39], s54 offen offset:0 sc1 lds
    s_nop 0
    v_mfma_f32_16x16x32_bf16 v[196:199], a[100:103], a[64:67], v[196:199]
    ds_read_b128 a[0:3], v6 offset:32768
    v_permlane16_swap_b32 v96, v100
    v_permlane16_swap_b32 v97, v101
    v_mfma_f32_16x16x32_bf16 v[196:199], a[116:119], a[80:83], v[196:199]
    v_permlane16_swap_b32 v98, v102
    v_mfma_f32_16x16x32_bf16 v[200:203], a[104:107], a[64:67], v[200:203]
    ds_read_b128 a[48:51], v8 offset:36864
    ds_read_b128 a[16:19], v6 offset:33792
    v_permlane16_swap_b32 v99, v103
    v_mfma_f32_16x16x32_bf16 v[200:203], a[120:123], a[80:83], v[200:203]
    buffer_load_dwordx4 v2, s[36:39], s54 offen offset:1024 sc1 lds
    v_max_f32 v96, v96, v100
    v_mfma_f32_16x16x32_bf16 v[204:207], a[108:111], a[64:67], v[204:207]
    v_max_f32 v97, v97, v101
    v_max_f32 v98, v98, v102
    v_mfma_f32_16x16x32_bf16 v[204:207], a[124:127], a[80:83], v[204:207]
    ds_read_b128 a[36:39], v8 offset:33792
    v_max_f32 v99, v99, v103
    v_mfma_f32_16x16x32_bf16 v[208:211], a[96:99], a[68:71], v[208:211]
    ds_read_b128 a[4:7], v6 offset:34816
    v_mov_b32 v100, v96
    v_mfma_f32_16x16x32_bf16 v[208:211], a[112:115], a[84:87], v[208:211]
    buffer_load_dwordx4 v5, s[36:39], s54 offen offset:2048 sc1 lds
    v_mov_b32 v101, v97
    v_mfma_f32_16x16x32_bf16 v[212:215], a[100:103], a[68:71], v[212:215]
    ds_read_b128 a[52:55], v8 offset:37888
    v_mov_b32 v102, v98
    v_mfma_f32_16x16x32_bf16 v[212:215], a[116:119], a[84:87], v[212:215]
    v_mov_b32 v103, v99
    s_nop 0
    v_mfma_f32_16x16x32_bf16 v[216:219], a[104:107], a[68:71], v[216:219]
    ds_read_b128 a[20:23], v6 offset:35840
    v_permlane32_swap_b32 v96, v100
    v_mfma_f32_16x16x32_bf16 v[216:219], a[120:123], a[84:87], v[216:219]
    buffer_load_dwordx4 v5, s[36:39], s54 offen offset:3072 sc1 lds
    v_permlane32_swap_b32 v97, v101
    v_mfma_f32_16x16x32_bf16 v[220:223], a[108:111], a[68:71], v[220:223]
    s_add_u32 s54, s54, 2048
    ds_read_b128 a[40:43], v8 offset:34816
    v_permlane32_swap_b32 v98, v102
    v_mfma_f32_16x16x32_bf16 v[220:223], a[124:127], a[84:87], v[220:223]
    v_permlane32_swap_b32 v99, v103
    v_mfma_f32_16x16x32_bf16 v[224:227], a[96:99], a[72:75], v[224:227]
    s_add_u32 m0, s3, 114688
    ds_read_b128 a[8:11], v6 offset:36864
    v_max_f32 v96, v96, v100
    v_max_f32 v97, v97, v101
    v_mfma_f32_16x16x32_bf16 v[224:227], a[112:115], a[88:91], v[224:227]
    buffer_load_dwordx4 v2, s[28:31], s55 offen offset:0 sc1 lds
    v_max_f32 v98, v98, v102
    v_mfma_f32_16x16x32_bf16 v[228:231], a[100:103], a[72:75], v[228:231]
    ds_read_b128 a[56:59], v8 offset:38912
    v_max_f32 v99, v99, v103
    v_mfma_f32_16x16x32_bf16 v[228:231], a[116:119], a[88:91], v[228:231]
    ds_read_b128 a[24:27], v6 offset:37888
    v_mul_f32 v96, s51, v96
    v_mfma_f32_16x16x32_bf16 v[232:235], a[104:107], a[72:75], v[232:235]
    ds_read_b128 a[44:47], v8 offset:35840
    v_mul_f32 v97, s51, v97
    v_mul_f32 v98, s51, v98
    v_mfma_f32_16x16x32_bf16 v[232:235], a[120:123], a[88:91], v[232:235]
    buffer_load_dwordx4 v2, s[28:31], s55 offen offset:1024 sc1 lds
    v_mul_f32 v99, s51, v99
    v_mfma_f32_16x16x32_bf16 v[236:239], a[108:111], a[72:75], v[236:239]
    ds_read_b128 a[12:15], v6 offset:38912
    v_fma_f32 v148, v148, s51, -v96
    v_mfma_f32_16x16x32_bf16 v[236:239], a[124:127], a[88:91], v[236:239]
    v_fma_f32 v149, v149, s51, -v96
    v_mfma_f32_16x16x32_bf16 v[240:243], a[96:99], a[76:79], v[240:243]
    ds_read_b128 a[60:63], v8 offset:39936
    v_fma_f32 v150, v150, s51, -v96
    v_mfma_f32_16x16x32_bf16 v[240:243], a[112:115], a[92:95], v[240:243]
    buffer_load_dwordx4 v2, s[28:31], s55 offen offset:2048 sc1 lds
    v_fma_f32 v151, v151, s51, -v96
    v_fma_f32 v152, v152, s51, -v96
    v_mfma_f32_16x16x32_bf16 v[244:247], a[100:103], a[76:79], v[244:247]
    ds_read_b128 a[28:31], v6 offset:39936
    v_fma_f32 v153, v153, s51, -v96
    v_mfma_f32_16x16x32_bf16 v[244:247], a[116:119], a[92:95], v[244:247]
    v_fma_f32 v154, v154, s51, -v96
    v_mfma_f32_16x16x32_bf16 v[248:251], a[104:107], a[76:79], v[248:251]
    v_fma_f32 v155, v155, s51, -v96
    v_mfma_f32_16x16x32_bf16 v[248:251], a[120:123], a[92:95], v[248:251]
    buffer_load_dwordx4 v2, s[28:31], s55 offen offset:3072 sc1 lds
    v_fma_f32 v156, v156, s51, -v97
    v_fma_f32 v157, v157, s51, -v97
    v_mfma_f32_16x16x32_bf16 v[252:255], a[108:111], a[76:79], v[252:255]
    s_add_u32 s55, s55, 8192
    v_fma_f32 v158, v158, s51, -v97
    v_mfma_f32_16x16x32_bf16 v[252:255], a[124:127], a[92:95], v[252:255]
    v_fma_f32 v159, v159, s51, -v97
    s_waitcnt vmcnt(16) lgkmcnt(0)
    s_barrier
    v_mfma_f32_16x16x32_bf16 v[192:195], a[32:35], a[0:3], v[192:195]
    s_add_u32 m0, s3, 65536
    ds_read_b128 a[96:99], v8 offset:0
    v_fma_f32 v160, v160, s51, -v97
    v_mfma_f32_16x16x32_bf16 v[192:195], a[48:51], a[16:19], v[192:195]
    buffer_load_dwordx4 v2, s[36:39], s54 offen offset:0 sc1 lds
    v_fma_f32 v161, v161, s51, -v97
    v_mfma_f32_16x16x32_bf16 v[196:199], a[36:39], a[0:3], v[196:199]
    ds_read_b128 a[64:67], v6 offset:0
    v_fma_f32 v162, v162, s51, -v97
    v_fma_f32 v163, v163, s51, -v97
    v_mfma_f32_16x16x32_bf16 v[196:199], a[52:55], a[16:19], v[196:199]
    v_fma_f32 v164, v164, s51, -v98
    v_mfma_f32_16x16x32_bf16 v[200:203], a[40:43], a[0:3], v[200:203]
    ds_read_b128 a[112:115], v8 offset:4096
    ds_read_b128 a[80:83], v6 offset:1024
    v_fma_f32 v165, v165, s51, -v98
    v_mfma_f32_16x16x32_bf16 v[200:203], a[56:59], a[16:19], v[200:203]
    buffer_load_dwordx4 v2, s[36:39], s54 offen offset:1024 sc1 lds
    v_fma_f32 v166, v166, s51, -v98
    v_mfma_f32_16x16x32_bf16 v[204:207], a[44:47], a[0:3], v[204:207]
    v_fma_f32 v167, v167, s51, -v98
    v_fma_f32 v168, v168, s51, -v98
    v_mfma_f32_16x16x32_bf16 v[204:207], a[60:63], a[16:19], v[204:207]
    ds_read_b128 a[100:103], v8 offset:1024
    v_fma_f32 v169, v169, s51, -v98
    v_mfma_f32_16x16x32_bf16 v[208:211], a[32:35], a[4:7], v[208:211]
    ds_read_b128 a[68:71], v6 offset:2048
    v_fma_f32 v170, v170, s51, -v98
    v_mfma_f32_16x16x32_bf16 v[208:211], a[48:51], a[20:23], v[208:211]
    buffer_load_dwordx4 v5, s[36:39], s54 offen offset:2048 sc1 lds
    v_fma_f32 v171, v171, s51, -v98
    v_mfma_f32_16x16x32_bf16 v[212:215], a[36:39], a[4:7], v[212:215]
    ds_read_b128 a[116:119], v8 offset:5120
    v_fma_f32 v172, v172, s51, -v99
    v_mfma_f32_16x16x32_bf16 v[212:215], a[52:55], a[20:23], v[212:215]
    v_fma_f32 v173, v173, s51, -v99
    v_fma_f32 v174, v174, s51, -v99
    v_mfma_f32_16x16x32_bf16 v[216:219], a[40:43], a[4:7], v[216:219]
    ds_read_b128 a[84:87], v6 offset:3072
    v_fma_f32 v175, v175, s51, -v99
    v_mfma_f32_16x16x32_bf16 v[216:219], a[56:59], a[20:23], v[216:219]
    buffer_load_dwordx4 v5, s[36:39], s54 offen offset:3072 sc1 lds
    v_fma_f32 v176, v176, s51, -v99
    v_mfma_f32_16x16x32_bf16 v[220:223], a[44:47], a[4:7], v[220:223]
    s_add_u32 s54, s54, 2048
    ds_read_b128 a[104:107], v8 offset:2048
    v_fma_f32 v177, v177, s51, -v99
    v_mfma_f32_16x16x32_bf16 v[220:223], a[60:63], a[20:23], v[220:223]
    v_fma_f32 v178, v178, s51, -v99
    v_mfma_f32_16x16x32_bf16 v[224:227], a[32:35], a[8:11], v[224:227]
    s_add_u32 m0, s3, 81920
    ds_read_b128 a[72:75], v6 offset:4096
    v_fma_f32 v179, v179, s51, -v99
    v_exp_f32 v148, v148
    v_mfma_f32_16x16x32_bf16 v[224:227], a[48:51], a[24:27], v[224:227]
    buffer_load_dwordx4 v2, s[28:31], s55 offen offset:0 sc1 lds
    v_exp_f32 v149, v149
    v_mfma_f32_16x16x32_bf16 v[228:231], a[36:39], a[8:11], v[228:231]
    ds_read_b128 a[120:123], v8 offset:6144
    v_exp_f32 v150, v150
    v_mfma_f32_16x16x32_bf16 v[228:231], a[52:55], a[24:27], v[228:231]
    ds_read_b128 a[88:91], v6 offset:5120
    v_exp_f32 v151, v151
    v_mfma_f32_16x16x32_bf16 v[232:235], a[40:43], a[8:11], v[232:235]
    ds_read_b128 a[108:111], v8 offset:3072
    v_exp_f32 v152, v152
    v_exp_f32 v153, v153
    v_mfma_f32_16x16x32_bf16 v[232:235], a[56:59], a[24:27], v[232:235]
    buffer_load_dwordx4 v2, s[28:31], s55 offen offset:1024 sc1 lds
    v_exp_f32 v154, v154
    v_mfma_f32_16x16x32_bf16 v[236:239], a[44:47], a[8:11], v[236:239]
    ds_read_b128 a[76:79], v6 offset:6144
    v_exp_f32 v155, v155
    v_mfma_f32_16x16x32_bf16 v[236:239], a[60:63], a[24:27], v[236:239]
    v_exp_f32 v156, v156
    v_mfma_f32_16x16x32_bf16 v[240:243], a[32:35], a[12:15], v[240:243]
    ds_read_b128 a[124:127], v8 offset:7168
    v_exp_f32 v157, v157
    v_mfma_f32_16x16x32_bf16 v[240:243], a[48:51], a[28:31], v[240:243]
    buffer_load_dwordx4 v2, s[28:31], s55 offen offset:2048 sc1 lds
    v_exp_f32 v158, v158
    v_exp_f32 v159, v159
    v_mfma_f32_16x16x32_bf16 v[244:247], a[36:39], a[12:15], v[244:247]
    ds_read_b128 a[92:95], v6 offset:7168
    v_exp_f32 v160, v160
    v_mfma_f32_16x16x32_bf16 v[244:247], a[52:55], a[28:31], v[244:247]
    v_exp_f32 v161, v161
    v_mfma_f32_16x16x32_bf16 v[248:251], a[40:43], a[12:15], v[248:251]
    v_exp_f32 v162, v162
    v_mfma_f32_16x16x32_bf16 v[248:251], a[56:59], a[28:31], v[248:251]
    buffer_load_dwordx4 v2, s[28:31], s55 offen offset:3072 sc1 lds
    v_exp_f32 v163, v163
    v_exp_f32 v164, v164
    v_mfma_f32_16x16x32_bf16 v[252:255], a[44:47], a[12:15], v[252:255]
    s_add_u32 s55, s55, 8192
    v_exp_f32 v165, v165
    v_mfma_f32_16x16x32_bf16 v[252:255], a[60:63], a[28:31], v[252:255]
    v_exp_f32 v166, v166
    s_waitcnt vmcnt(16) lgkmcnt(0)
    s_barrier
    v_mfma_f32_16x16x32_bf16 v[192:195], a[96:99], a[64:67], v[192:195]
    s_add_u32 m0, s3, 32768
    ds_read_b128 a[32:35], v9 offset:32768
    v_exp_f32 v167, v167
    v_mfma_f32_16x16x32_bf16 v[192:195], a[112:115], a[80:83], v[192:195]
    buffer_load_dwordx4 v2, s[36:39], s54 offen offset:0 sc1 lds
    v_exp_f32 v168, v168
    v_mfma_f32_16x16x32_bf16 v[196:199], a[100:103], a[64:67], v[196:199]
    ds_read_b128 a[0:3], v7 offset:32768
    v_exp_f32 v169, v169
    v_exp_f32 v170, v170
    v_mfma_f32_16x16x32_bf16 v[196:199], a[116:119], a[80:83], v[196:199]
    v_exp_f32 v171, v171
    v_mfma_f32_16x16x32_bf16 v[200:203], a[104:107], a[64:67], v[200:203]
    ds_read_b128 a[48:51], v9 offset:36864
    ds_read_b128 a[16:19], v7 offset:33792
    v_exp_f32 v172, v172
    v_mfma_f32_16x16x32_bf16 v[200:203], a[120:123], a[80:83], v[200:203]
    buffer_load_dwordx4 v2, s[36:39], s54 offen offset:1024 sc1 lds
    v_exp_f32 v173, v173
    v_mfma_f32_16x16x32_bf16 v[204:207], a[108:111], a[64:67], v[204:207]
    v_exp_f32 v174, v174
    v_exp_f32 v175, v175
    v_mfma_f32_16x16x32_bf16 v[204:207], a[124:127], a[80:83], v[204:207]
    ds_read_b128 a[36:39], v9 offset:33792
    v_exp_f32 v176, v176
    v_mfma_f32_16x16x32_bf16 v[208:211], a[96:99], a[68:71], v[208:211]
    ds_read_b128 a[4:7], v7 offset:34816
    v_exp_f32 v177, v177
    v_mfma_f32_16x16x32_bf16 v[208:211], a[112:115], a[84:87], v[208:211]
    buffer_load_dwordx4 v5, s[36:39], s54 offen offset:2048 sc1 lds
    v_exp_f32 v178, v178
    v_mfma_f32_16x16x32_bf16 v[212:215], a[100:103], a[68:71], v[212:215]
    ds_read_b128 a[52:55], v9 offset:37888
    v_exp_f32 v179, v179
    v_mfma_f32_16x16x32_bf16 v[212:215], a[116:119], a[84:87], v[212:215]
    v_add_f32 v96, v148, v149
    v_add_f32 v100, v150, v151
    v_mfma_f32_16x16x32_bf16 v[216:219], a[104:107], a[68:71], v[216:219]
    ds_read_b128 a[20:23], v7 offset:35840
    v_add_f32 v104, v152, v153
    v_mfma_f32_16x16x32_bf16 v[216:219], a[120:123], a[84:87], v[216:219]
    buffer_load_dwordx4 v5, s[36:39], s54 offen offset:3072 sc1 lds
    v_add_f32 v108, v154, v155
    v_mfma_f32_16x16x32_bf16 v[220:223], a[108:111], a[68:71], v[220:223]
    s_add_u32 s54, s54, 2048
    ds_read_b128 a[40:43], v9 offset:34816
    v_add_f32 v97, v156, v157
    v_mfma_f32_16x16x32_bf16 v[220:223], a[124:127], a[84:87], v[220:223]
    v_add_f32 v101, v158, v159
    v_mfma_f32_16x16x32_bf16 v[224:227], a[96:99], a[72:75], v[224:227]
    s_add_u32 m0, s3, 49152
    ds_read_b128 a[8:11], v7 offset:36864
    v_add_f32 v105, v160, v161
    v_add_f32 v109, v162, v163
    v_mfma_f32_16x16x32_bf16 v[224:227], a[112:115], a[88:91], v[224:227]
    buffer_load_dwordx4 v2, s[28:31], s55 offen offset:0 sc1 lds
    v_add_f32 v98, v164, v165
    v_mfma_f32_16x16x32_bf16 v[228:231], a[100:103], a[72:75], v[228:231]
    ds_read_b128 a[56:59], v9 offset:38912
    v_add_f32 v102, v166, v167
    v_mfma_f32_16x16x32_bf16 v[228:231], a[116:119], a[88:91], v[228:231]
    ds_read_b128 a[24:27], v7 offset:37888
    v_add_f32 v106, v168, v169
    v_mfma_f32_16x16x32_bf16 v[232:235], a[104:107], a[72:75], v[232:235]
    ds_read_b128 a[44:47], v9 offset:35840
    v_add_f32 v110, v170, v171
    v_add_f32 v99, v172, v173
    v_mfma_f32_16x16x32_bf16 v[232:235], a[120:123], a[88:91], v[232:235]
    buffer_load_dwordx4 v2, s[28:31], s55 offen offset:1024 sc1 lds
    v_add_f32 v103, v174, v175
    v_mfma_f32_16x16x32_bf16 v[236:239], a[108:111], a[72:75], v[236:239]
    ds_read_b128 a[12:15], v7 offset:38912
    v_add_f32 v107, v176, v177
    v_mfma_f32_16x16x32_bf16 v[236:239], a[124:127], a[88:91], v[236:239]
    v_add_f32 v111, v178, v179
    v_mfma_f32_16x16x32_bf16 v[240:243], a[96:99], a[76:79], v[240:243]
    ds_read_b128 a[60:63], v9 offset:39936
    v_add_f32 v96, v96, v100
    v_mfma_f32_16x16x32_bf16 v[240:243], a[112:115], a[92:95], v[240:243]
    buffer_load_dwordx4 v2, s[28:31], s55 offen offset:2048 sc1 lds
    v_add_f32 v104, v104, v108
    v_add_f32 v97, v97, v101
    v_mfma_f32_16x16x32_bf16 v[244:247], a[100:103], a[76:79], v[244:247]
    ds_read_b128 a[28:31], v7 offset:39936
    v_add_f32 v105, v105, v109
    v_mfma_f32_16x16x32_bf16 v[244:247], a[116:119], a[92:95], v[244:247]
    v_add_f32 v98, v98, v102
    v_mfma_f32_16x16x32_bf16 v[248:251], a[104:107], a[76:79], v[248:251]
    v_add_f32 v106, v106, v110
    v_mfma_f32_16x16x32_bf16 v[248:251], a[120:123], a[92:95], v[248:251]
    buffer_load_dwordx4 v2, s[28:31], s55 offen offset:3072 sc1 lds
    v_add_f32 v99, v99, v103
    v_add_f32 v107, v107, v111
    v_mfma_f32_16x16x32_bf16 v[252:255], a[108:111], a[76:79], v[252:255]
    s_add_u32 s55, s55, 8192
    v_add_f32 v96, v96, v104
    v_mfma_f32_16x16x32_bf16 v[252:255], a[124:127], a[92:95], v[252:255]
    v_add_f32 v97, v97, v105
    s_waitcnt vmcnt(16) lgkmcnt(0)
    s_barrier
    v_mfma_f32_16x16x32_bf16 v[192:195], a[32:35], a[0:3], v[192:195]
    s_add_u32 m0, s3, 131072
    ds_read_b128 a[96:99], v9 offset:0
    v_add_f32 v98, v98, v106
    v_mfma_f32_16x16x32_bf16 v[192:195], a[48:51], a[16:19], v[192:195]
    buffer_load_dwordx4 v2, s[36:39], s54 offen offset:0 sc1 lds
    v_add_f32 v99, v99, v107
    v_mfma_f32_16x16x32_bf16 v[196:199], a[36:39], a[0:3], v[196:199]
    ds_read_b128 a[64:67], v7 offset:0
    v_mov_b32 v100, v96
    v_mov_b32 v101, v97
    v_mfma_f32_16x16x32_bf16 v[196:199], a[52:55], a[16:19], v[196:199]
    v_mov_b32 v102, v98
    v_mfma_f32_16x16x32_bf16 v[200:203], a[40:43], a[0:3], v[200:203]
    ds_read_b128 a[112:115], v9 offset:4096
    ds_read_b128 a[80:83], v7 offset:1024
    v_mov_b32 v103, v99
    v_mfma_f32_16x16x32_bf16 v[200:203], a[56:59], a[16:19], v[200:203]
    buffer_load_dwordx4 v2, s[36:39], s54 offen offset:1024 sc1 lds
    s_nop 0
    v_mfma_f32_16x16x32_bf16 v[204:207], a[44:47], a[0:3], v[204:207]
    v_permlane16_swap_b32 v96, v100
    v_permlane16_swap_b32 v97, v101
    v_mfma_f32_16x16x32_bf16 v[204:207], a[60:63], a[16:19], v[204:207]
    ds_read_b128 a[100:103], v9 offset:1024
    v_permlane16_swap_b32 v98, v102
    v_mfma_f32_16x16x32_bf16 v[208:211], a[32:35], a[4:7], v[208:211]
    ds_read_b128 a[68:71], v7 offset:2048
    v_permlane16_swap_b32 v99, v103
    v_mfma_f32_16x16x32_bf16 v[208:211], a[48:51], a[20:23], v[208:211]
    buffer_load_dwordx4 v5, s[36:39], s54 offen offset:2048 sc1 lds
    v_add_f32 v96, v96, v100
    v_mfma_f32_16x16x32_bf16 v[212:215], a[36:39], a[4:7], v[212:215]
    ds_read_b128 a[116:119], v9 offset:5120
    v_add_f32 v97, v97, v101
    v_mfma_f32_16x16x32_bf16 v[212:215], a[52:55], a[20:23], v[212:215]
    v_add_f32 v98, v98, v102
    v_add_f32 v99, v99, v103
    v_mfma_f32_16x16x32_bf16 v[216:219], a[40:43], a[4:7], v[216:219]
    ds_read_b128 a[84:87], v7 offset:3072
    v_mov_b32 v100, v96
    v_mfma_f32_16x16x32_bf16 v[216:219], a[56:59], a[20:23], v[216:219]
    buffer_load_dwordx4 v5, s[36:39], s54 offen offset:3072 sc1 lds
    v_mov_b32 v101, v97
    v_mfma_f32_16x16x32_bf16 v[220:223], a[44:47], a[4:7], v[220:223]
    s_add_u32 s54, s54, 2048
    ds_read_b128 a[104:107], v9 offset:2048
    v_mov_b32 v102, v98
    v_mfma_f32_16x16x32_bf16 v[220:223], a[60:63], a[20:23], v[220:223]
    v_mov_b32 v103, v99
    v_mfma_f32_16x16x32_bf16 v[224:227], a[32:35], a[8:11], v[224:227]
    s_add_u32 m0, s3, 147456
    ds_read_b128 a[72:75], v7 offset:4096
    s_nop 0
    v_permlane32_swap_b32 v96, v100
    v_mfma_f32_16x16x32_bf16 v[224:227], a[48:51], a[24:27], v[224:227]
    buffer_load_dwordx4 v2, s[28:31], s55 offen offset:0 sc1 lds
    v_permlane32_swap_b32 v97, v101
    v_mfma_f32_16x16x32_bf16 v[228:231], a[36:39], a[8:11], v[228:231]
    ds_read_b128 a[120:123], v9 offset:6144
    v_permlane32_swap_b32 v98, v102
    v_mfma_f32_16x16x32_bf16 v[228:231], a[52:55], a[24:27], v[228:231]
    ds_read_b128 a[88:91], v7 offset:5120
    v_permlane32_swap_b32 v99, v103
    v_mfma_f32_16x16x32_bf16 v[232:235], a[40:43], a[8:11], v[232:235]
    ds_read_b128 a[108:111], v9 offset:3072
    v_add_f32 v96, v96, v100
    v_add_f32 v97, v97, v101
    v_mfma_f32_16x16x32_bf16 v[232:235], a[56:59], a[24:27], v[232:235]
    buffer_load_dwordx4 v2, s[28:31], s55 offen offset:1024 sc1 lds
    v_add_f32 v98, v98, v102
    v_mfma_f32_16x16x32_bf16 v[236:239], a[44:47], a[8:11], v[236:239]
    ds_read_b128 a[76:79], v7 offset:6144
    v_add_f32 v99, v99, v103
    v_mfma_f32_16x16x32_bf16 v[236:239], a[60:63], a[24:27], v[236:239]
    v_rcp_f32 v96, v96
    v_mfma_f32_16x16x32_bf16 v[240:243], a[32:35], a[12:15], v[240:243]
    ds_read_b128 a[124:127], v9 offset:7168
    v_rcp_f32 v97, v97
    v_mfma_f32_16x16x32_bf16 v[240:243], a[48:51], a[28:31], v[240:243]
    buffer_load_dwordx4 v2, s[28:31], s55 offen offset:2048 sc1 lds
    v_rcp_f32 v98, v98
    v_rcp_f32 v99, v99
    v_mfma_f32_16x16x32_bf16 v[244:247], a[36:39], a[12:15], v[244:247]
    ds_read_b128 a[92:95], v7 offset:7168
    s_nop 0
    v_mfma_f32_16x16x32_bf16 v[244:247], a[52:55], a[28:31], v[244:247]
    v_mul_f32 v148, v96, v148
    v_mfma_f32_16x16x32_bf16 v[248:251], a[40:43], a[12:15], v[248:251]
    v_mul_f32 v149, v96, v149
    v_mfma_f32_16x16x32_bf16 v[248:251], a[56:59], a[28:31], v[248:251]
    buffer_load_dwordx4 v2, s[28:31], s55 offen offset:3072 sc1 lds
    v_mul_f32 v150, v96, v150
    v_mul_f32 v151, v96, v151
    v_mfma_f32_16x16x32_bf16 v[252:255], a[44:47], a[12:15], v[252:255]
    s_add_u32 s55, s55, 8192
    v_mul_f32 v152, v96, v152
    v_mfma_f32_16x16x32_bf16 v[252:255], a[60:63], a[28:31], v[252:255]
    v_mul_f32 v153, v96, v153
    s_waitcnt vmcnt(16) lgkmcnt(0)
    s_barrier
    v_mfma_f32_16x16x32_bf16 v[192:195], a[96:99], a[64:67], v[192:195]
    s_add_u32 m0, s3, 98304
    ds_read_b128 a[32:35], v8 offset:32768
    v_mul_f32 v154, v96, v154
    v_mfma_f32_16x16x32_bf16 v[192:195], a[112:115], a[80:83], v[192:195]
    buffer_load_dwordx4 v2, s[36:39], s54 offen offset:0 sc1 lds
    v_mul_f32 v155, v96, v155
    v_mfma_f32_16x16x32_bf16 v[196:199], a[100:103], a[64:67], v[196:199]
    ds_read_b128 a[0:3], v6 offset:32768
    v_cvt_pk_bf16_f32 v64, v148, v149
    v_cvt_pk_bf16_f32 v65, v150, v151
    v_mfma_f32_16x16x32_bf16 v[196:199], a[116:119], a[80:83], v[196:199]
    v_cvt_pk_bf16_f32 v66, v152, v153
    v_mfma_f32_16x16x32_bf16 v[200:203], a[104:107], a[64:67], v[200:203]
    ds_read_b128 a[48:51], v8 offset:36864
    ds_read_b128 a[16:19], v6 offset:33792
    v_cvt_pk_bf16_f32 v67, v154, v155
    v_mfma_f32_16x16x32_bf16 v[200:203], a[120:123], a[80:83], v[200:203]
    buffer_load_dwordx4 v2, s[36:39], s54 offen offset:1024 sc1 lds
    v_mul_f32 v156, v97, v156
    v_mfma_f32_16x16x32_bf16 v[204:207], a[108:111], a[64:67], v[204:207]
    v_mul_f32 v157, v97, v157
    v_mul_f32 v158, v97, v158
    v_mfma_f32_16x16x32_bf16 v[204:207], a[124:127], a[80:83], v[204:207]
    ds_read_b128 a[36:39], v8 offset:33792
    v_mul_f32 v159, v97, v159
    v_mfma_f32_16x16x32_bf16 v[208:211], a[96:99], a[68:71], v[208:211]
    ds_read_b128 a[4:7], v6 offset:34816
    v_mul_f32 v160, v97, v160
    v_mfma_f32_16x16x32_bf16 v[208:211], a[112:115], a[84:87], v[208:211]
    buffer_load_dwordx4 v5, s[36:39], s54 offen offset:2048 sc1 lds
    v_mul_f32 v161, v97, v161
    v_mfma_f32_16x16x32_bf16 v[212:215], a[100:103], a[68:71], v[212:215]
    ds_read_b128 a[52:55], v8 offset:37888
    v_mul_f32 v162, v97, v162
    v_mfma_f32_16x16x32_bf16 v[212:215], a[116:119], a[84:87], v[212:215]
    v_mul_f32 v163, v97, v163
    v_cvt_pk_bf16_f32 v68, v156, v157
    v_mfma_f32_16x16x32_bf16 v[216:219], a[104:107], a[68:71], v[216:219]
    ds_read_b128 a[20:23], v6 offset:35840
    v_cvt_pk_bf16_f32 v69, v158, v159
    v_mfma_f32_16x16x32_bf16 v[216:219], a[120:123], a[84:87], v[216:219]
    buffer_load_dwordx4 v5, s[36:39], s54 offen offset:3072 sc1 lds
    v_cvt_pk_bf16_f32 v70, v160, v161
    v_mfma_f32_16x16x32_bf16 v[220:223], a[108:111], a[68:71], v[220:223]
    s_add_u32 s54, s54, 2048
    ds_read_b128 a[40:43], v8 offset:34816
    v_cvt_pk_bf16_f32 v71, v162, v163
    v_mfma_f32_16x16x32_bf16 v[220:223], a[124:127], a[84:87], v[220:223]
    v_mul_f32 v164, v98, v164
    v_mfma_f32_16x16x32_bf16 v[224:227], a[96:99], a[72:75], v[224:227]
    s_add_u32 m0, s3, 114688
    ds_read_b128 a[8:11], v6 offset:36864
    v_mul_f32 v165, v98, v165
    v_mul_f32 v166, v98, v166
    v_mfma_f32_16x16x32_bf16 v[224:227], a[112:115], a[88:91], v[224:227]
    buffer_load_dwordx4 v2, s[28:31], s55 offen offset:0 sc1 lds
    v_mul_f32 v167, v98, v167
    v_mfma_f32_16x16x32_bf16 v[228:231], a[100:103], a[72:75], v[228:231]
    ds_read_b128 a[56:59], v8 offset:38912
    v_mul_f32 v168, v98, v168
    v_mfma_f32_16x16x32_bf16 v[228:231], a[116:119], a[88:91], v[228:231]
    ds_read_b128 a[24:27], v6 offset:37888
    v_mul_f32 v169, v98, v169
    v_mfma_f32_16x16x32_bf16 v[232:235], a[104:107], a[72:75], v[232:235]
    ds_read_b128 a[44:47], v8 offset:35840
    v_mul_f32 v170, v98, v170
    v_mul_f32 v171, v98, v171
    v_mfma_f32_16x16x32_bf16 v[232:235], a[120:123], a[88:91], v[232:235]
    buffer_load_dwordx4 v2, s[28:31], s55 offen offset:1024 sc1 lds
    v_cvt_pk_bf16_f32 v72, v164, v165
    v_mfma_f32_16x16x32_bf16 v[236:239], a[108:111], a[72:75], v[236:239]
    ds_read_b128 a[12:15], v6 offset:38912
    v_cvt_pk_bf16_f32 v73, v166, v167
    v_mfma_f32_16x16x32_bf16 v[236:239], a[124:127], a[88:91], v[236:239]
    v_cvt_pk_bf16_f32 v74, v168, v169
    v_mfma_f32_16x16x32_bf16 v[240:243], a[96:99], a[76:79], v[240:243]
    ds_read_b128 a[60:63], v8 offset:39936
    v_cvt_pk_bf16_f32 v75, v170, v171
    v_mfma_f32_16x16x32_bf16 v[240:243], a[112:115], a[92:95], v[240:243]
    buffer_load_dwordx4 v2, s[28:31], s55 offen offset:2048 sc1 lds
    v_mul_f32 v172, v99, v172
    v_mul_f32 v173, v99, v173
    v_mfma_f32_16x16x32_bf16 v[244:247], a[100:103], a[76:79], v[244:247]
    ds_read_b128 a[28:31], v6 offset:39936
    v_mul_f32 v174, v99, v174
    v_mfma_f32_16x16x32_bf16 v[244:247], a[116:119], a[92:95], v[244:247]
    v_mul_f32 v175, v99, v175
    v_mfma_f32_16x16x32_bf16 v[248:251], a[104:107], a[76:79], v[248:251]
    v_mul_f32 v176, v99, v176
    v_mfma_f32_16x16x32_bf16 v[248:251], a[120:123], a[92:95], v[248:251]
    buffer_load_dwordx4 v2, s[28:31], s55 offen offset:3072 sc1 lds
    v_mul_f32 v177, v99, v177
    v_mul_f32 v178, v99, v178
    v_mfma_f32_16x16x32_bf16 v[252:255], a[108:111], a[76:79], v[252:255]
    s_add_u32 s55, s55, 8192
    v_mul_f32 v179, v99, v179
    v_mfma_f32_16x16x32_bf16 v[252:255], a[124:127], a[92:95], v[252:255]
    v_cvt_pk_bf16_f32 v76, v172, v173
    s_waitcnt vmcnt(16) lgkmcnt(0)
    s_barrier
    v_mfma_f32_16x16x32_bf16 v[192:195], a[32:35], a[0:3], v[192:195]
    s_add_u32 m0, s3, 65536
    ds_read_b128 a[96:99], v8 offset:0
    v_cvt_pk_bf16_f32 v77, v174, v175
    v_mfma_f32_16x16x32_bf16 v[192:195], a[48:51], a[16:19], v[192:195]
    buffer_load_dwordx4 v2, s[36:39], s54 offen offset:0 sc1 lds
    v_cvt_pk_bf16_f32 v78, v176, v177
    v_mfma_f32_16x16x32_bf16 v[196:199], a[36:39], a[0:3], v[196:199]
    ds_read_b128 a[64:67], v6 offset:0
    v_cvt_pk_bf16_f32 v79, v178, v179
    v_mfma_f32_16x16x32_bf16 v[196:199], a[52:55], a[16:19], v[196:199]
    s_nop 1
    v_mfma_f32_16x16x32_bf16 v[80:83], v[138:141], v[64:67], 0
    v_mfma_f32_16x16x32_bf16 v[200:203], a[40:43], a[0:3], v[200:203]
    ds_read_b128 a[112:115], v8 offset:4096
    ds_read_b128 a[80:83], v6 offset:1024
    v_mfma_f32_16x16x32_bf16 v[84:87], v[140:143], v[68:71], 0
    v_mfma_f32_16x16x32_bf16 v[200:203], a[56:59], a[16:19], v[200:203]
    buffer_load_dwordx4 v2, s[36:39], s54 offen offset:1024 sc1 lds
    v_mfma_f32_16x16x32_bf16 v[88:91], v[142:145], v[72:75], 0
    v_mfma_f32_16x16x32_bf16 v[204:207], a[44:47], a[0:3], v[204:207]
    v_mfma_f32_16x16x32_bf16 v[92:95], v[144:147], v[76:79], 0
    v_mfma_f32_16x16x32_bf16 v[204:207], a[60:63], a[16:19], v[204:207]
    ds_read_b128 a[100:103], v8 offset:1024
    s_lshl_b32 s51, s49, 16
    v_mfma_f32_16x16x32_bf16 v[208:211], a[32:35], a[4:7], v[208:211]
    ds_read_b128 a[68:71], v6 offset:2048
    s_lshl_b32 s52, s50, 11
    v_mfma_f32_16x16x32_bf16 v[208:211], a[48:51], a[20:23], v[208:211]
    buffer_load_dwordx4 v5, s[36:39], s54 offen offset:2048 sc1 lds
    s_add_u32 s51, s51, s52
    s_lshr_b32 s52, s48, 1
    v_mfma_f32_16x16x32_bf16 v[212:215], a[36:39], a[4:7], v[212:215]
    ds_read_b128 a[116:119], v8 offset:5120
    s_lshl_b32 s52, s52, 10
    v_mfma_f32_16x16x32_bf16 v[212:215], a[52:55], a[20:23], v[212:215]
    s_add_u32 s51, s51, s52
    v_mfma_f32_16x16x32_bf16 v[216:219], a[40:43], a[4:7], v[216:219]
    ds_read_b128 a[84:87], v6 offset:3072
    s_and_b32 s52, s48, 1
    v_mfma_f32_16x16x32_bf16 v[216:219], a[56:59], a[20:23], v[216:219]
    buffer_load_dwordx4 v5, s[36:39], s54 offen offset:3072 sc1 lds
    s_lshl_b32 s52, s52, 3
    v_mfma_f32_16x16x32_bf16 v[220:223], a[44:47], a[4:7], v[220:223]
    s_add_u32 s54, s54, 2048
    ds_read_b128 a[104:107], v8 offset:2048
    s_add_u32 s51, s51, s52
    v_mfma_f32_16x16x32_bf16 v[220:223], a[60:63], a[20:23], v[220:223]
    s_mov_b32 s40, s22
    v_mfma_f32_16x16x32_bf16 v[224:227], a[32:35], a[8:11], v[224:227]
    s_add_u32 m0, s3, 81920
    ds_read_b128 a[72:75], v6 offset:4096
    s_mov_b32 s41, s23
    s_mov_b32 s42, 4194304
    v_mfma_f32_16x16x32_bf16 v[224:227], a[48:51], a[24:27], v[224:227]
    buffer_load_dwordx4 v2, s[28:31], s55 offen offset:0 sc1 lds
    s_mov_b32 s43, 0x20000
    v_mfma_f32_16x16x32_bf16 v[228:231], a[36:39], a[8:11], v[228:231]
    ds_read_b128 a[120:123], v8 offset:6144
    v_cvt_pk_bf16_f32 v112, v80, v81
    v_mfma_f32_16x16x32_bf16 v[228:231], a[52:55], a[24:27], v[228:231]
    ds_read_b128 a[88:91], v6 offset:5120
    v_cvt_pk_bf16_f32 v113, v82, v83
    v_mfma_f32_16x16x32_bf16 v[232:235], a[40:43], a[8:11], v[232:235]
    ds_read_b128 a[108:111], v8 offset:3072
    buffer_store_dwordx2 v[112:113], v2, s[32:35], s51 offen sc1
    v_mfma_f32_16x16x32_bf16 v[232:235], a[56:59], a[24:27], v[232:235]
    buffer_load_dwordx4 v2, s[28:31], s55 offen offset:1024 sc1 lds
    s_add_u32 s51, s51, 16384
    v_mfma_f32_16x16x32_bf16 v[236:239], a[44:47], a[8:11], v[236:239]
    ds_read_b128 a[76:79], v6 offset:6144
    v_cvt_pk_bf16_f32 v114, v84, v85
    v_cvt_pk_bf16_f32 v115, v86, v87
    v_mfma_f32_16x16x32_bf16 v[236:239], a[60:63], a[24:27], v[236:239]
    buffer_store_dwordx2 v[114:115], v2, s[32:35], s51 offen sc1
    v_mfma_f32_16x16x32_bf16 v[240:243], a[32:35], a[12:15], v[240:243]
    ds_read_b128 a[124:127], v8 offset:7168
    s_add_u32 s51, s51, 16384
    v_mfma_f32_16x16x32_bf16 v[240:243], a[48:51], a[28:31], v[240:243]
    buffer_load_dwordx4 v2, s[28:31], s55 offen offset:2048 sc1 lds
    v_cvt_pk_bf16_f32 v116, v88, v89
    v_mfma_f32_16x16x32_bf16 v[244:247], a[36:39], a[12:15], v[244:247]
    ds_read_b128 a[92:95], v6 offset:7168
    v_cvt_pk_bf16_f32 v117, v90, v91
    v_mfma_f32_16x16x32_bf16 v[244:247], a[52:55], a[28:31], v[244:247]
    buffer_store_dwordx2 v[116:117], v2, s[32:35], s51 offen sc1
    v_mfma_f32_16x16x32_bf16 v[248:251], a[40:43], a[12:15], v[248:251]
    s_add_u32 s51, s51, 16384
    v_cvt_pk_bf16_f32 v118, v92, v93
    v_mfma_f32_16x16x32_bf16 v[248:251], a[56:59], a[28:31], v[248:251]
    buffer_load_dwordx4 v2, s[28:31], s55 offen offset:3072 sc1 lds
    v_cvt_pk_bf16_f32 v119, v94, v95
    v_mfma_f32_16x16x32_bf16 v[252:255], a[44:47], a[12:15], v[252:255]
    s_add_u32 s55, s55, 8192
    buffer_store_dwordx2 v[118:119], v2, s[32:35], s51 offen sc1
    v_mfma_f32_16x16x32_bf16 v[252:255], a[60:63], a[28:31], v[252:255]
    s_add_u32 s51, s51, 16384
    s_waitcnt vmcnt(20) lgkmcnt(0)
    s_barrier
    v_mfma_f32_16x16x32_bf16 v[192:195], a[96:99], a[64:67], v[192:195]
    s_add_u32 m0, s3, 32768
    ds_read_b128 a[32:35], v9 offset:32768
    v_mfma_f32_16x16x32_bf16 v[192:195], a[112:115], a[80:83], v[192:195]
    buffer_load_dwordx4 v2, s[36:39], s54 offen offset:0 sc1 lds
    v_mfma_f32_16x16x32_bf16 v[196:199], a[100:103], a[64:67], v[196:199]
    ds_read_b128 a[0:3], v7 offset:32768
    v_mfma_f32_16x16x32_bf16 v[196:199], a[116:119], a[80:83], v[196:199]
    v_mfma_f32_16x16x32_bf16 v[200:203], a[104:107], a[64:67], v[200:203]
    ds_read_b128 a[48:51], v9 offset:36864
    ds_read_b128 a[16:19], v7 offset:33792
    v_mfma_f32_16x16x32_bf16 v[200:203], a[120:123], a[80:83], v[200:203]
    buffer_load_dwordx4 v2, s[36:39], s54 offen offset:1024 sc1 lds
    v_mfma_f32_16x16x32_bf16 v[204:207], a[108:111], a[64:67], v[204:207]
    v_mfma_f32_16x16x32_bf16 v[204:207], a[124:127], a[80:83], v[204:207]
    ds_read_b128 a[36:39], v9 offset:33792
    v_mfma_f32_16x16x32_bf16 v[208:211], a[96:99], a[68:71], v[208:211]
    ds_read_b128 a[4:7], v7 offset:34816
    v_mfma_f32_16x16x32_bf16 v[208:211], a[112:115], a[84:87], v[208:211]
    buffer_load_dwordx4 v5, s[36:39], s54 offen offset:2048 sc1 lds
    v_mfma_f32_16x16x32_bf16 v[212:215], a[100:103], a[68:71], v[212:215]
    ds_read_b128 a[52:55], v9 offset:37888
    v_mfma_f32_16x16x32_bf16 v[212:215], a[116:119], a[84:87], v[212:215]
    v_mfma_f32_16x16x32_bf16 v[216:219], a[104:107], a[68:71], v[216:219]
    ds_read_b128 a[20:23], v7 offset:35840
    v_mfma_f32_16x16x32_bf16 v[216:219], a[120:123], a[84:87], v[216:219]
    buffer_load_dwordx4 v5, s[36:39], s54 offen offset:3072 sc1 lds
    v_mfma_f32_16x16x32_bf16 v[220:223], a[108:111], a[68:71], v[220:223]
    s_add_u32 s54, s54, 2048
    ds_read_b128 a[40:43], v9 offset:34816
    v_mfma_f32_16x16x32_bf16 v[220:223], a[124:127], a[84:87], v[220:223]
    v_mfma_f32_16x16x32_bf16 v[224:227], a[96:99], a[72:75], v[224:227]
    s_add_u32 m0, s3, 49152
    ds_read_b128 a[8:11], v7 offset:36864
    v_mfma_f32_16x16x32_bf16 v[224:227], a[112:115], a[88:91], v[224:227]
    buffer_load_dwordx4 v2, s[28:31], s55 offen offset:0 sc1 lds
    v_mfma_f32_16x16x32_bf16 v[228:231], a[100:103], a[72:75], v[228:231]
    ds_read_b128 a[56:59], v9 offset:38912
    v_mfma_f32_16x16x32_bf16 v[228:231], a[116:119], a[88:91], v[228:231]
    ds_read_b128 a[24:27], v7 offset:37888
    v_mfma_f32_16x16x32_bf16 v[232:235], a[104:107], a[72:75], v[232:235]
    ds_read_b128 a[44:47], v9 offset:35840
    v_mfma_f32_16x16x32_bf16 v[232:235], a[120:123], a[88:91], v[232:235]
    buffer_load_dwordx4 v2, s[28:31], s55 offen offset:1024 sc1 lds
    v_mfma_f32_16x16x32_bf16 v[236:239], a[108:111], a[72:75], v[236:239]
    ds_read_b128 a[12:15], v7 offset:38912
    v_mfma_f32_16x16x32_bf16 v[236:239], a[124:127], a[88:91], v[236:239]
    v_mfma_f32_16x16x32_bf16 v[240:243], a[96:99], a[76:79], v[240:243]
    ds_read_b128 a[60:63], v9 offset:39936
    v_mfma_f32_16x16x32_bf16 v[240:243], a[112:115], a[92:95], v[240:243]
    buffer_load_dwordx4 v2, s[28:31], s55 offen offset:2048 sc1 lds
    v_mfma_f32_16x16x32_bf16 v[244:247], a[100:103], a[76:79], v[244:247]
    ds_read_b128 a[28:31], v7 offset:39936
    v_mfma_f32_16x16x32_bf16 v[244:247], a[116:119], a[92:95], v[244:247]
    v_mfma_f32_16x16x32_bf16 v[248:251], a[104:107], a[76:79], v[248:251]
    v_mfma_f32_16x16x32_bf16 v[248:251], a[120:123], a[92:95], v[248:251]
    buffer_load_dwordx4 v2, s[28:31], s55 offen offset:3072 sc1 lds
    v_mfma_f32_16x16x32_bf16 v[252:255], a[108:111], a[76:79], v[252:255]
    s_add_u32 s55, s55, 8192
    v_mfma_f32_16x16x32_bf16 v[252:255], a[124:127], a[92:95], v[252:255]
    s_waitcnt vmcnt(20) lgkmcnt(0)
    s_barrier
    v_mfma_f32_16x16x32_bf16 v[192:195], a[32:35], a[0:3], v[192:195]
    s_add_u32 m0, s3, 131072
    ds_read_b128 a[96:99], v9 offset:0
    v_mfma_f32_16x16x32_bf16 v[192:195], a[48:51], a[16:19], v[192:195]
    buffer_load_dwordx4 v2, s[36:39], s54 offen offset:0 sc1 lds
    v_mfma_f32_16x16x32_bf16 v[196:199], a[36:39], a[0:3], v[196:199]
    ds_read_b128 a[64:67], v7 offset:0
    v_mfma_f32_16x16x32_bf16 v[196:199], a[52:55], a[16:19], v[196:199]
    v_mfma_f32_16x16x32_bf16 v[200:203], a[40:43], a[0:3], v[200:203]
    ds_read_b128 a[112:115], v9 offset:4096
    ds_read_b128 a[80:83], v7 offset:1024
    v_mfma_f32_16x16x32_bf16 v[200:203], a[56:59], a[16:19], v[200:203]
    buffer_load_dwordx4 v2, s[36:39], s54 offen offset:1024 sc1 lds
    v_mfma_f32_16x16x32_bf16 v[204:207], a[44:47], a[0:3], v[204:207]
    v_mfma_f32_16x16x32_bf16 v[204:207], a[60:63], a[16:19], v[204:207]
    ds_read_b128 a[100:103], v9 offset:1024
    v_mfma_f32_16x16x32_bf16 v[208:211], a[32:35], a[4:7], v[208:211]
    ds_read_b128 a[68:71], v7 offset:2048
    v_mfma_f32_16x16x32_bf16 v[208:211], a[48:51], a[20:23], v[208:211]
    buffer_load_dwordx4 v5, s[36:39], s54 offen offset:2048 sc1 lds
    v_mfma_f32_16x16x32_bf16 v[212:215], a[36:39], a[4:7], v[212:215]
    ds_read_b128 a[116:119], v9 offset:5120
    v_mfma_f32_16x16x32_bf16 v[212:215], a[52:55], a[20:23], v[212:215]
    v_mfma_f32_16x16x32_bf16 v[216:219], a[40:43], a[4:7], v[216:219]
    ds_read_b128 a[84:87], v7 offset:3072
    v_mfma_f32_16x16x32_bf16 v[216:219], a[56:59], a[20:23], v[216:219]
    buffer_load_dwordx4 v5, s[36:39], s54 offen offset:3072 sc1 lds
    v_mfma_f32_16x16x32_bf16 v[220:223], a[44:47], a[4:7], v[220:223]
    s_add_u32 s54, s54, 2048
    ds_read_b128 a[104:107], v9 offset:2048
    v_mfma_f32_16x16x32_bf16 v[220:223], a[60:63], a[20:23], v[220:223]
    v_mfma_f32_16x16x32_bf16 v[224:227], a[32:35], a[8:11], v[224:227]
    s_add_u32 m0, s3, 147456
    ds_read_b128 a[72:75], v7 offset:4096
    v_mfma_f32_16x16x32_bf16 v[224:227], a[48:51], a[24:27], v[224:227]
    buffer_load_dwordx4 v2, s[28:31], s55 offen offset:0 sc1 lds
    v_mfma_f32_16x16x32_bf16 v[228:231], a[36:39], a[8:11], v[228:231]
    ds_read_b128 a[120:123], v9 offset:6144
    v_mfma_f32_16x16x32_bf16 v[228:231], a[52:55], a[24:27], v[228:231]
    ds_read_b128 a[88:91], v7 offset:5120
    v_mfma_f32_16x16x32_bf16 v[232:235], a[40:43], a[8:11], v[232:235]
    ds_read_b128 a[108:111], v9 offset:3072
    v_mfma_f32_16x16x32_bf16 v[232:235], a[56:59], a[24:27], v[232:235]
    buffer_load_dwordx4 v2, s[28:31], s55 offen offset:1024 sc1 lds
    v_mfma_f32_16x16x32_bf16 v[236:239], a[44:47], a[8:11], v[236:239]
    ds_read_b128 a[76:79], v7 offset:6144
    v_mfma_f32_16x16x32_bf16 v[236:239], a[60:63], a[24:27], v[236:239]
    v_mfma_f32_16x16x32_bf16 v[240:243], a[32:35], a[12:15], v[240:243]
    ds_read_b128 a[124:127], v9 offset:7168
    v_mfma_f32_16x16x32_bf16 v[240:243], a[48:51], a[28:31], v[240:243]
    buffer_load_dwordx4 v2, s[28:31], s55 offen offset:2048 sc1 lds
    v_mfma_f32_16x16x32_bf16 v[244:247], a[36:39], a[12:15], v[244:247]
    ds_read_b128 a[92:95], v7 offset:7168
    v_mfma_f32_16x16x32_bf16 v[244:247], a[52:55], a[28:31], v[244:247]
    v_mfma_f32_16x16x32_bf16 v[248:251], a[40:43], a[12:15], v[248:251]
    v_mfma_f32_16x16x32_bf16 v[248:251], a[56:59], a[28:31], v[248:251]
    buffer_load_dwordx4 v2, s[28:31], s55 offen offset:3072 sc1 lds
    v_mfma_f32_16x16x32_bf16 v[252:255], a[44:47], a[12:15], v[252:255]
    s_add_u32 s55, s55, 8192
    v_mfma_f32_16x16x32_bf16 v[252:255], a[60:63], a[28:31], v[252:255]
    s_waitcnt vmcnt(16) lgkmcnt(0)
    s_barrier
    s_lshl_b32 s51, s2, 5
    s_add_u32 s51, s51, s48
    s_lshl_b32 s51, s51, 2
    s_mov_b64 exec, 1
    v_mov_b32 v16, s95
    v_mov_b32 v17, s51
    buffer_store_dword v16, v17, s[76:79], 0 offen offset:16 sc1
    s_mov_b64 exec, -1
    v_mfma_f32_16x16x32_bf16 v[192:195], a[96:99], a[64:67], v[192:195]
    s_add_u32 m0, s3, 98304
    ds_read_b128 a[32:35], v8 offset:32768
    v_mfma_f32_16x16x32_bf16 v[192:195], a[112:115], a[80:83], v[192:195]
    buffer_load_dwordx4 v2, s[36:39], s54 offen offset:0 sc1 lds
    v_mfma_f32_16x16x32_bf16 v[196:199], a[100:103], a[64:67], v[196:199]
    ds_read_b128 a[0:3], v6 offset:32768
    v_mfma_f32_16x16x32_bf16 v[196:199], a[116:119], a[80:83], v[196:199]
    v_mfma_f32_16x16x32_bf16 v[200:203], a[104:107], a[64:67], v[200:203]
    ds_read_b128 a[48:51], v8 offset:36864
    ds_read_b128 a[16:19], v6 offset:33792
    v_mfma_f32_16x16x32_bf16 v[200:203], a[120:123], a[80:83], v[200:203]
    buffer_load_dwordx4 v2, s[36:39], s54 offen offset:1024 sc1 lds
    v_mfma_f32_16x16x32_bf16 v[204:207], a[108:111], a[64:67], v[204:207]
    v_mfma_f32_16x16x32_bf16 v[204:207], a[124:127], a[80:83], v[204:207]
    ds_read_b128 a[36:39], v8 offset:33792
    v_mfma_f32_16x16x32_bf16 v[208:211], a[96:99], a[68:71], v[208:211]
    ds_read_b128 a[4:7], v6 offset:34816
    v_mfma_f32_16x16x32_bf16 v[208:211], a[112:115], a[84:87], v[208:211]
    buffer_load_dwordx4 v5, s[36:39], s54 offen offset:2048 sc1 lds
    v_mfma_f32_16x16x32_bf16 v[212:215], a[100:103], a[68:71], v[212:215]
    ds_read_b128 a[52:55], v8 offset:37888
    v_mfma_f32_16x16x32_bf16 v[212:215], a[116:119], a[84:87], v[212:215]
    v_mfma_f32_16x16x32_bf16 v[216:219], a[104:107], a[68:71], v[216:219]
    ds_read_b128 a[20:23], v6 offset:35840
    v_mfma_f32_16x16x32_bf16 v[216:219], a[120:123], a[84:87], v[216:219]
    buffer_load_dwordx4 v5, s[36:39], s54 offen offset:3072 sc1 lds
    v_mfma_f32_16x16x32_bf16 v[220:223], a[108:111], a[68:71], v[220:223]
    s_add_u32 s54, s54, 2048
    ds_read_b128 a[40:43], v8 offset:34816
    v_mfma_f32_16x16x32_bf16 v[220:223], a[124:127], a[84:87], v[220:223]
    v_mfma_f32_16x16x32_bf16 v[224:227], a[96:99], a[72:75], v[224:227]
    s_add_u32 m0, s3, 114688
    ds_read_b128 a[8:11], v6 offset:36864
    v_mfma_f32_16x16x32_bf16 v[224:227], a[112:115], a[88:91], v[224:227]
    buffer_load_dwordx4 v2, s[28:31], s55 offen offset:0 sc1 lds
    v_mfma_f32_16x16x32_bf16 v[228:231], a[100:103], a[72:75], v[228:231]
    ds_read_b128 a[56:59], v8 offset:38912
    v_mfma_f32_16x16x32_bf16 v[228:231], a[116:119], a[88:91], v[228:231]
    ds_read_b128 a[24:27], v6 offset:37888
    v_mfma_f32_16x16x32_bf16 v[232:235], a[104:107], a[72:75], v[232:235]
    ds_read_b128 a[44:47], v8 offset:35840
    v_mfma_f32_16x16x32_bf16 v[232:235], a[120:123], a[88:91], v[232:235]
    buffer_load_dwordx4 v2, s[28:31], s55 offen offset:1024 sc1 lds
    v_mfma_f32_16x16x32_bf16 v[236:239], a[108:111], a[72:75], v[236:239]
    ds_read_b128 a[12:15], v6 offset:38912
    v_mfma_f32_16x16x32_bf16 v[236:239], a[124:127], a[88:91], v[236:239]
    v_mfma_f32_16x16x32_bf16 v[240:243], a[96:99], a[76:79], v[240:243]
    ds_read_b128 a[60:63], v8 offset:39936
    v_mfma_f32_16x16x32_bf16 v[240:243], a[112:115], a[92:95], v[240:243]
    buffer_load_dwordx4 v2, s[28:31], s55 offen offset:2048 sc1 lds
    v_mfma_f32_16x16x32_bf16 v[244:247], a[100:103], a[76:79], v[244:247]
    ds_read_b128 a[28:31], v6 offset:39936
    v_mfma_f32_16x16x32_bf16 v[244:247], a[116:119], a[92:95], v[244:247]
    v_mfma_f32_16x16x32_bf16 v[248:251], a[104:107], a[76:79], v[248:251]
    v_mfma_f32_16x16x32_bf16 v[248:251], a[120:123], a[92:95], v[248:251]
    buffer_load_dwordx4 v2, s[28:31], s55 offen offset:3072 sc1 lds
    v_mfma_f32_16x16x32_bf16 v[252:255], a[108:111], a[76:79], v[252:255]
    s_add_u32 s55, s55, 8192
    v_mfma_f32_16x16x32_bf16 v[252:255], a[124:127], a[92:95], v[252:255]
    s_waitcnt vmcnt(17) lgkmcnt(0)
    s_barrier
    s_lshl_b32 s51, s2, 2
    s_add_u32 s51, s51, s48
    s_cmp_eq_u32 s51, 3
    s_cbranch_scc0 L_noep34
    v_lshlrev_b32 v32, 7, v1
    s_mov_b32 s51, 0
    buffer_load_dword v33, v32, s[76:79], s51 offen offset:12 sc1
    s_mov_b32 s51, 8192
    buffer_load_dword v34, v32, s[76:79], s51 offen offset:12 sc1
    s_mov_b32 s51, 16384
    buffer_load_dword v35, v32, s[76:79], s51 offen offset:12 sc1
    s_mov_b32 s51, 24576
    buffer_load_dword v36, v32, s[76:79], s51 offen offset:12 sc1
L_noep34:
    v_mfma_f32_16x16x32_bf16 v[192:195], a[32:35], a[0:3], v[192:195]
    s_add_u32 m0, s3, 65536
    ds_read_b128 a[96:99], v8 offset:0
    v_mfma_f32_16x16x32_bf16 v[192:195], a[48:51], a[16:19], v[192:195]
    buffer_load_dwordx4 v2, s[36:39], s54 offen offset:0 sc1 lds
    v_mfma_f32_16x16x32_bf16 v[196:199], a[36:39], a[0:3], v[196:199]
    ds_read_b128 a[64:67], v6 offset:0
    v_mfma_f32_16x16x32_bf16 v[196:199], a[52:55], a[16:19], v[196:199]
    v_mfma_f32_16x16x32_bf16 v[200:203], a[40:43], a[0:3], v[200:203]
    ds_read_b128 a[112:115], v8 offset:4096
    ds_read_b128 a[80:83], v6 offset:1024
    v_mfma_f32_16x16x32_bf16 v[200:203], a[56:59], a[16:19], v[200:203]
    buffer_load_dwordx4 v2, s[36:39], s54 offen offset:1024 sc1 lds
    v_mfma_f32_16x16x32_bf16 v[204:207], a[44:47], a[0:3], v[204:207]
    v_mfma_f32_16x16x32_bf16 v[204:207], a[60:63], a[16:19], v[204:207]
    ds_read_b128 a[100:103], v8 offset:1024
    v_mfma_f32_16x16x32_bf16 v[208:211], a[32:35], a[4:7], v[208:211]
    ds_read_b128 a[68:71], v6 offset:2048
    v_mfma_f32_16x16x32_bf16 v[208:211], a[48:51], a[20:23], v[208:211]
    buffer_load_dwordx4 v5, s[36:39], s54 offen offset:2048 sc1 lds
    v_mfma_f32_16x16x32_bf16 v[212:215], a[36:39], a[4:7], v[212:215]
    ds_read_b128 a[116:119], v8 offset:5120
    v_mfma_f32_16x16x32_bf16 v[212:215], a[52:55], a[20:23], v[212:215]
    v_mfma_f32_16x16x32_bf16 v[216:219], a[40:43], a[4:7], v[216:219]
    ds_read_b128 a[84:87], v6 offset:3072
    v_mfma_f32_16x16x32_bf16 v[216:219], a[56:59], a[20:23], v[216:219]
    buffer_load_dwordx4 v5, s[36:39], s54 offen offset:3072 sc1 lds
    v_mfma_f32_16x16x32_bf16 v[220:223], a[44:47], a[4:7], v[220:223]
    s_add_u32 s54, s54, 2048
    ds_read_b128 a[104:107], v8 offset:2048
    v_mfma_f32_16x16x32_bf16 v[220:223], a[60:63], a[20:23], v[220:223]
    v_mfma_f32_16x16x32_bf16 v[224:227], a[32:35], a[8:11], v[224:227]
    s_add_u32 m0, s3, 81920
    ds_read_b128 a[72:75], v6 offset:4096
    v_mfma_f32_16x16x32_bf16 v[224:227], a[48:51], a[24:27], v[224:227]
    buffer_load_dwordx4 v2, s[28:31], s55 offen offset:0 sc1 lds
    v_mfma_f32_16x16x32_bf16 v[228:231], a[36:39], a[8:11], v[228:231]
    ds_read_b128 a[120:123], v8 offset:6144
    v_mfma_f32_16x16x32_bf16 v[228:231], a[52:55], a[24:27], v[228:231]
    ds_read_b128 a[88:91], v6 offset:5120
    v_mfma_f32_16x16x32_bf16 v[232:235], a[40:43], a[8:11], v[232:235]
    ds_read_b128 a[108:111], v8 offset:3072
    v_mfma_f32_16x16x32_bf16 v[232:235], a[56:59], a[24:27], v[232:235]
    buffer_load_dwordx4 v2, s[28:31], s55 offen offset:1024 sc1 lds
    v_mfma_f32_16x16x32_bf16 v[236:239], a[44:47], a[8:11], v[236:239]
    ds_read_b128 a[76:79], v6 offset:6144
    v_mfma_f32_16x16x32_bf16 v[236:239], a[60:63], a[24:27], v[236:239]
    v_mfma_f32_16x16x32_bf16 v[240:243], a[32:35], a[12:15], v[240:243]
    ds_read_b128 a[124:127], v8 offset:7168
    v_mfma_f32_16x16x32_bf16 v[240:243], a[48:51], a[28:31], v[240:243]
    buffer_load_dwordx4 v2, s[28:31], s55 offen offset:2048 sc1 lds
    v_mfma_f32_16x16x32_bf16 v[244:247], a[36:39], a[12:15], v[244:247]
    ds_read_b128 a[92:95], v6 offset:7168
    v_mfma_f32_16x16x32_bf16 v[244:247], a[52:55], a[28:31], v[244:247]
    v_mfma_f32_16x16x32_bf16 v[248:251], a[40:43], a[12:15], v[248:251]
    v_mfma_f32_16x16x32_bf16 v[248:251], a[56:59], a[28:31], v[248:251]
    buffer_load_dwordx4 v2, s[28:31], s55 offen offset:3072 sc1 lds
    v_mfma_f32_16x16x32_bf16 v[252:255], a[44:47], a[12:15], v[252:255]
    s_add_u32 s55, s55, 8192
    v_mfma_f32_16x16x32_bf16 v[252:255], a[60:63], a[28:31], v[252:255]
    s_waitcnt vmcnt(17) lgkmcnt(0)
    s_barrier
    v_mfma_f32_16x16x32_bf16 v[192:195], a[96:99], a[64:67], v[192:195]
    s_add_u32 m0, s3, 32768
    ds_read_b128 a[32:35], v9 offset:32768
    v_mfma_f32_16x16x32_bf16 v[192:195], a[112:115], a[80:83], v[192:195]
    buffer_load_dwordx4 v2, s[36:39], s54 offen offset:0 sc1 lds
    v_mfma_f32_16x16x32_bf16 v[196:199], a[100:103], a[64:67], v[196:199]
    ds_read_b128 a[0:3], v7 offset:32768
    s_lshl_b32 s51, s48, 14
    v_mfma_f32_16x16x32_bf16 v[196:199], a[116:119], a[80:83], v[196:199]
    v_add_u32 v20, s51, v2
    s_lshl_b32 s51, s48, 12
    v_mfma_f32_16x16x32_bf16 v[200:203], a[104:107], a[64:67], v[200:203]
    ds_read_b128 a[48:51], v9 offset:36864
    ds_read_b128 a[16:19], v7 offset:33792
    v_mfma_f32_16x16x32_bf16 v[200:203], a[120:123], a[80:83], v[200:203]
    buffer_load_dwordx4 v2, s[36:39], s54 offen offset:1024 sc1 lds
    v_mfma_f32_16x16x32_bf16 v[204:207], a[108:111], a[64:67], v[204:207]
    v_lshlrev_b32 v21, 10, v3
    v_mfma_f32_16x16x32_bf16 v[204:207], a[124:127], a[80:83], v[204:207]
    ds_read_b128 a[36:39], v9 offset:33792
    v_mfma_f32_16x16x32_bf16 v[208:211], a[96:99], a[68:71], v[208:211]
    ds_read_b128 a[4:7], v7 offset:34816
    v_lshl_add_u32 v21, v4, 4, v21
    v_mfma_f32_16x16x32_bf16 v[208:211], a[112:115], a[84:87], v[208:211]
    buffer_load_dwordx4 v5, s[36:39], s54 offen offset:2048 sc1 lds
    v_mfma_f32_16x16x32_bf16 v[212:215], a[100:103], a[68:71], v[212:215]
    ds_read_b128 a[52:55], v9 offset:37888
    v_add_u32 v21, s51, v21
    v_mfma_f32_16x16x32_bf16 v[212:215], a[116:119], a[84:87], v[212:215]
    v_add_u32 v22, 0x10000, v20
    v_mfma_f32_16x16x32_bf16 v[216:219], a[104:107], a[68:71], v[216:219]
    ds_read_b128 a[20:23], v7 offset:35840
    v_add_u32 v24, 0x10000, v21
    v_mfma_f32_16x16x32_bf16 v[216:219], a[120:123], a[84:87], v[216:219]
    buffer_load_dwordx4 v5, s[36:39], s54 offen offset:3072 sc1 lds
    v_mfma_f32_16x16x32_bf16 v[220:223], a[108:111], a[68:71], v[220:223]
    s_add_u32 s54, s54, 2048
    ds_read_b128 a[40:43], v9 offset:34816
    v_mfma_f32_16x16x32_bf16 v[220:223], a[124:127], a[84:87], v[220:223]
    s_lshl_b32 s72, s97, 17
    s_lshl_b32 s52, s48, 15
    v_mfma_f32_16x16x32_bf16 v[224:227], a[96:99], a[72:75], v[224:227]
    s_add_u32 m0, s3, 49152
    ds_read_b128 a[8:11], v7 offset:36864
    v_mfma_f32_16x16x32_bf16 v[224:227], a[112:115], a[88:91], v[224:227]
    buffer_load_dwordx4 v2, s[28:31], s55 offen offset:0 sc1 lds
    v_mfma_f32_16x16x32_bf16 v[228:231], a[100:103], a[72:75], v[228:231]
    ds_read_b128 a[56:59], v9 offset:38912
    s_add_u32 s72, s72, s52
    v_mfma_f32_16x16x32_bf16 v[228:231], a[116:119], a[88:91], v[228:231]
    ds_read_b128 a[24:27], v7 offset:37888
    v_mfma_f32_16x16x32_bf16 v[232:235], a[104:107], a[72:75], v[232:235]
    ds_read_b128 a[44:47], v9 offset:35840
    s_lshl_b32 s52, s98, 7
    v_mfma_f32_16x16x32_bf16 v[232:235], a[120:123], a[88:91], v[232:235]
    buffer_load_dwordx4 v2, s[28:31], s55 offen offset:1024 sc1 lds
    v_mfma_f32_16x16x32_bf16 v[236:239], a[108:111], a[72:75], v[236:239]
    ds_read_b128 a[12:15], v7 offset:38912
    s_add_u32 s72, s72, s52
    v_mfma_f32_16x16x32_bf16 v[236:239], a[124:127], a[88:91], v[236:239]
    v_mfma_f32_16x16x32_bf16 v[240:243], a[96:99], a[76:79], v[240:243]
    ds_read_b128 a[60:63], v9 offset:39936
    v_lshlrev_b32 v23, 11, v4
    v_mfma_f32_16x16x32_bf16 v[240:243], a[112:115], a[92:95], v[240:243]
    buffer_load_dwordx4 v2, s[28:31], s55 offen offset:2048 sc1 lds
    v_mfma_f32_16x16x32_bf16 v[244:247], a[100:103], a[76:79], v[244:247]
    ds_read_b128 a[28:31], v7 offset:39936
    v_lshl_add_u32 v23, v3, 5, v23
    v_mfma_f32_16x16x32_bf16 v[244:247], a[116:119], a[92:95], v[244:247]
    s_add_u32 s44, s26, 75497472
    s_addc_u32 s45, s27, 0
    v_mfma_f32_16x16x32_bf16 v[248:251], a[104:107], a[76:79], v[248:251]
    s_mov_b32 s46, 16777216
    v_mfma_f32_16x16x32_bf16 v[248:251], a[120:123], a[92:95], v[248:251]
    buffer_load_dwordx4 v2, s[28:31], s55 offen offset:3072 sc1 lds
    v_mfma_f32_16x16x32_bf16 v[252:255], a[108:111], a[76:79], v[252:255]
    s_add_u32 s55, s55, 8192
    v_mfma_f32_16x16x32_bf16 v[252:255], a[124:127], a[92:95], v[252:255]
    s_mov_b32 s47, 0x20000
    s_waitcnt vmcnt(16) lgkmcnt(0)
    s_barrier
    v_mfma_f32_16x16x32_bf16 v[192:195], a[32:35], a[0:3], v[192:195]
    ds_read_b128 a[96:99], v9 offset:0
    v_mfma_f32_16x16x32_bf16 v[192:195], a[48:51], a[16:19], v[192:195]
    v_and_b32 v17, 7, v1
    s_and_b32 s51, s97, 3
    v_mfma_f32_16x16x32_bf16 v[196:199], a[36:39], a[0:3], v[196:199]
    ds_read_b128 a[64:67], v7 offset:0
    v_mfma_f32_16x16x32_bf16 v[196:199], a[52:55], a[16:19], v[196:199]
    s_lshl_b32 s51, s51, 3
    s_lshr_b32 s52, s97, 2
    v_mfma_f32_16x16x32_bf16 v[200:203], a[40:43], a[0:3], v[200:203]
    ds_read_b128 a[112:115], v9 offset:4096
    v_mfma_f32_16x16x32_bf16 v[200:203], a[56:59], a[16:19], v[200:203]
    ds_read_b128 a[80:83], v7 offset:1024
    v_mfma_f32_16x16x32_bf16 v[204:207], a[44:47], a[0:3], v[204:207]
    s_add_u32 s51, s51, s52
    s_lshl_b32 s51, s51, 7
    v_mfma_f32_16x16x32_bf16 v[204:207], a[60:63], a[16:19], v[204:207]
    ds_read_b128 a[100:103], v9 offset:1024
    v_mfma_f32_16x16x32_bf16 v[208:211], a[32:35], a[4:7], v[208:211]
    v_lshl_add_u32 v17, v17, 12, s51
    v_bfe_u32 v16, v1, 3, 2
    v_mfma_f32_16x16x32_bf16 v[208:211], a[48:51], a[20:23], v[208:211]
    ds_read_b128 a[68:71], v7 offset:2048
    v_mfma_f32_16x16x32_bf16 v[212:215], a[36:39], a[4:7], v[212:215]
    ds_read_b128 a[116:119], v9 offset:5120
    v_lshl_add_u32 v17, v16, 2, v17
    v_mfma_f32_16x16x32_bf16 v[212:215], a[52:55], a[20:23], v[212:215]
    buffer_load_dword v16, v17, s[76:79], 0 offen offset:16 sc1
    v_mfma_f32_16x16x32_bf16 v[216:219], a[40:43], a[4:7], v[216:219]
    ds_read_b128 a[84:87], v7 offset:3072
    v_mfma_f32_16x16x32_bf16 v[216:219], a[56:59], a[20:23], v[216:219]
    buffer_load_dwordx4 a[144:147], v2, s[28:31], s100 offen offset:0 sc1
    v_mfma_f32_16x16x32_bf16 v[220:223], a[44:47], a[4:7], v[220:223]
    ds_read_b128 a[104:107], v9 offset:2048
    v_mfma_f32_16x16x32_bf16 v[220:223], a[60:63], a[20:23], v[220:223]
    v_mfma_f32_16x16x32_bf16 v[224:227], a[32:35], a[8:11], v[224:227]
    ds_read_b128 a[72:75], v7 offset:4096
    v_mfma_f32_16x16x32_bf16 v[224:227], a[48:51], a[24:27], v[224:227]
    ds_read_b128 a[120:123], v9 offset:6144
    v_mfma_f32_16x16x32_bf16 v[228:231], a[36:39], a[8:11], v[228:231]
    buffer_load_dwordx4 a[148:151], v2, s[28:31], s100 offen offset:1024 sc1
    v_mfma_f32_16x16x32_bf16 v[228:231], a[52:55], a[24:27], v[228:231]
    ds_read_b128 a[88:91], v7 offset:5120
    v_mfma_f32_16x16x32_bf16 v[232:235], a[40:43], a[8:11], v[232:235]
    buffer_load_dwordx4 a[152:155], v2, s[28:31], s100 offen offset:2048 sc1
    v_mfma_f32_16x16x32_bf16 v[232:235], a[56:59], a[24:27], v[232:235]
    ds_read_b128 a[108:111], v9 offset:3072
    v_mfma_f32_16x16x32_bf16 v[236:239], a[44:47], a[8:11], v[236:239]
    ds_read_b128 a[76:79], v7 offset:6144
    v_mfma_f32_16x16x32_bf16 v[236:239], a[60:63], a[24:27], v[236:239]
    buffer_load_dwordx4 a[156:159], v2, s[28:31], s100 offen offset:3072 sc1
    v_mfma_f32_16x16x32_bf16 v[240:243], a[32:35], a[12:15], v[240:243]
    ds_read_b128 a[124:127], v9 offset:7168
    s_add_u32 s100, s100, 4096
    v_mfma_f32_16x16x32_bf16 v[240:243], a[48:51], a[28:31], v[240:243]
    buffer_load_dwordx4 a[176:179], v2, s[28:31], s100 offen offset:0 sc1
    v_mfma_f32_16x16x32_bf16 v[244:247], a[36:39], a[12:15], v[244:247]
    ds_read_b128 a[92:95], v7 offset:7168
    v_mfma_f32_16x16x32_bf16 v[244:247], a[52:55], a[28:31], v[244:247]
    buffer_load_dwordx4 a[180:183], v2, s[28:31], s100 offen offset:1024 sc1
    v_mfma_f32_16x16x32_bf16 v[248:251], a[40:43], a[12:15], v[248:251]
    buffer_load_dwordx4 a[184:187], v2, s[28:31], s100 offen offset:2048 sc1
    v_mfma_f32_16x16x32_bf16 v[248:251], a[56:59], a[28:31], v[248:251]
    v_mfma_f32_16x16x32_bf16 v[252:255], a[44:47], a[12:15], v[252:255]
    buffer_load_dwordx4 a[188:191], v2, s[28:31], s100 offen offset:3072 sc1
    v_mfma_f32_16x16x32_bf16 v[252:255], a[60:63], a[28:31], v[252:255]
    s_add_u32 s100, s100, 4096
    s_waitcnt vmcnt(17) lgkmcnt(0)
    s_barrier
    v_mfma_f32_16x16x32_bf16 v[192:195], a[96:99], a[64:67], v[192:195]
    ds_read_b128 a[32:35], v8 offset:32768
    v_mfma_f32_16x16x32_bf16 v[192:195], a[112:115], a[80:83], v[192:195]
    buffer_load_dwordx4 a[208:211], v2, s[28:31], s100 offen offset:0 sc1
    v_mfma_f32_16x16x32_bf16 v[196:199], a[100:103], a[64:67], v[196:199]
    ds_read_b128 a[0:3], v6 offset:32768
    v_mfma_f32_16x16x32_bf16 v[196:199], a[116:119], a[80:83], v[196:199]
    v_mfma_f32_16x16x32_bf16 v[200:203], a[104:107], a[64:67], v[200:203]
    ds_read_b128 a[48:51], v8 offset:36864
    v_mfma_f32_16x16x32_bf16 v[200:203], a[120:123], a[80:83], v[200:203]
    ds_read_b128 a[16:19], v6 offset:33792
    v_mfma_f32_16x16x32_bf16 v[204:207], a[108:111], a[64:67], v[204:207]
    buffer_load_dwordx4 a[212:215], v2, s[28:31], s100 offen offset:1024 sc1
    v_mfma_f32_16x16x32_bf16 v[204:207], a[124:127], a[80:83], v[204:207]
    ds_read_b128 a[36:39], v8 offset:33792
    v_mfma_f32_16x16x32_bf16 v[208:211], a[96:99], a[68:71], v[208:211]
    v_mfma_f32_16x16x32_bf16 v[208:211], a[112:115], a[84:87], v[208:211]
    ds_read_b128 a[4:7], v6 offset:34816
    v_mfma_f32_16x16x32_bf16 v[212:215], a[100:103], a[68:71], v[212:215]
    ds_read_b128 a[52:55], v8 offset:37888
    v_mfma_f32_16x16x32_bf16 v[212:215], a[116:119], a[84:87], v[212:215]
    buffer_load_dwordx4 a[216:219], v2, s[28:31], s100 offen offset:2048 sc1
    v_mfma_f32_16x16x32_bf16 v[216:219], a[104:107], a[68:71], v[216:219]
    ds_read_b128 a[20:23], v6 offset:35840
    v_mfma_f32_16x16x32_bf16 v[216:219], a[120:123], a[84:87], v[216:219]
    buffer_load_dwordx4 a[220:223], v2, s[28:31], s100 offen offset:3072 sc1
    v_mfma_f32_16x16x32_bf16 v[220:223], a[108:111], a[68:71], v[220:223]
    ds_read_b128 a[40:43], v8 offset:34816
    s_add_u32 s100, s100, 4096
    v_mfma_f32_16x16x32_bf16 v[220:223], a[124:127], a[84:87], v[220:223]
    v_mfma_f32_16x16x32_bf16 v[224:227], a[96:99], a[72:75], v[224:227]
    ds_read_b128 a[8:11], v6 offset:36864
    v_mfma_f32_16x16x32_bf16 v[224:227], a[112:115], a[88:91], v[224:227]
    ds_read_b128 a[56:59], v8 offset:38912
    v_mfma_f32_16x16x32_bf16 v[228:231], a[100:103], a[72:75], v[228:231]
    buffer_load_dwordx4 a[240:243], v2, s[28:31], s100 offen offset:0 sc1
    v_mfma_f32_16x16x32_bf16 v[228:231], a[116:119], a[88:91], v[228:231]
    ds_read_b128 a[24:27], v6 offset:37888
    v_mfma_f32_16x16x32_bf16 v[232:235], a[104:107], a[72:75], v[232:235]
    v_mfma_f32_16x16x32_bf16 v[232:235], a[120:123], a[88:91], v[232:235]
    ds_read_b128 a[44:47], v8 offset:35840
    v_mfma_f32_16x16x32_bf16 v[236:239], a[108:111], a[72:75], v[236:239]
    ds_read_b128 a[12:15], v6 offset:38912
    v_mfma_f32_16x16x32_bf16 v[236:239], a[124:127], a[88:91], v[236:239]
    buffer_load_dwordx4 a[244:247], v2, s[28:31], s100 offen offset:1024 sc1
    v_mfma_f32_16x16x32_bf16 v[240:243], a[96:99], a[76:79], v[240:243]
    ds_read_b128 a[60:63], v8 offset:39936
    v_mfma_f32_16x16x32_bf16 v[240:243], a[112:115], a[92:95], v[240:243]
    buffer_load_dwordx4 a[248:251], v2, s[28:31], s100 offen offset:2048 sc1
    v_mfma_f32_16x16x32_bf16 v[244:247], a[100:103], a[76:79], v[244:247]
    ds_read_b128 a[28:31], v6 offset:39936
    v_mfma_f32_16x16x32_bf16 v[244:247], a[116:119], a[92:95], v[244:247]
    v_mfma_f32_16x16x32_bf16 v[248:251], a[104:107], a[76:79], v[248:251]
    v_mfma_f32_16x16x32_bf16 v[248:251], a[120:123], a[92:95], v[248:251]
    v_mfma_f32_16x16x32_bf16 v[252:255], a[108:111], a[76:79], v[252:255]
    buffer_load_dwordx4 a[252:255], v2, s[28:31], s100 offen offset:3072 sc1
    v_mfma_f32_16x16x32_bf16 v[252:255], a[124:127], a[92:95], v[252:255]
    s_add_u32 s100, s100, 4096
    s_waitcnt vmcnt(16) lgkmcnt(0)
    s_mov_b32 s52, 0
L_poll4c0:
    v_cmp_eq_u32 vcc, s95, v16
    s_nop 0
    s_cmp_eq_u64 vcc, -1
    s_cbranch_scc1 L_poll4c0_ok
    s_add_u32 s52, s52, 1
    s_cmp_gt_u32 s52, 0x40000
    s_cbranch_scc1 L_poll4c0_ok
    s_sleep 1
    buffer_load_dword v16, v17, s[76:79], 0 offen offset:16 sc1
    s_waitcnt vmcnt(0)
    s_branch L_poll4c0
L_poll4c0_ok:
    s_barrier
    v_mfma_f32_16x16x32_bf16 v[192:195], a[32:35], a[0:3], v[192:195]
    ds_read_b128 a[96:99], v8 offset:0
    v_mfma_f32_16x16x32_bf16 v[192:195], a[48:51], a[16:19], v[192:195]
    buffer_load_dwordx4 a[128:131], v2, s[32:35], s96 offen offset:0 sc1
    v_mfma_f32_16x16x32_bf16 v[196:199], a[36:39], a[0:3], v[196:199]
    ds_read_b128 a[64:67], v6 offset:0
    v_mfma_f32_16x16x32_bf16 v[196:199], a[52:55], a[16:19], v[196:199]
    v_mfma_f32_16x16x32_bf16 v[200:203], a[40:43], a[0:3], v[200:203]
    ds_read_b128 a[112:115], v8 offset:4096
    v_mfma_f32_16x16x32_bf16 v[200:203], a[56:59], a[16:19], v[200:203]
    ds_read_b128 a[80:83], v6 offset:1024
    v_mfma_f32_16x16x32_bf16 v[204:207], a[44:47], a[0:3], v[204:207]
    buffer_load_dwordx4 a[132:135], v10, s[32:35], s96 offen offset:0 sc1
    v_mfma_f32_16x16x32_bf16 v[204:207], a[60:63], a[16:19], v[204:207]
    ds_read_b128 a[100:103], v8 offset:1024
    v_mfma_f32_16x16x32_bf16 v[208:211], a[32:35], a[4:7], v[208:211]
    v_mfma_f32_16x16x32_bf16 v[208:211], a[48:51], a[20:23], v[208:211]
    ds_read_b128 a[68:71], v6 offset:2048
    v_mfma_f32_16x16x32_bf16 v[212:215], a[36:39], a[4:7], v[212:215]
    ds_read_b128 a[116:119], v8 offset:5120
    v_mfma_f32_16x16x32_bf16 v[212:215], a[52:55], a[20:23], v[212:215]
    buffer_load_dwordx4 a[136:139], v11, s[32:35], s96 offen offset:0 sc1
    v_mfma_f32_16x16x32_bf16 v[216:219], a[40:43], a[4:7], v[216:219]
    ds_read_b128 a[84:87], v6 offset:3072
    v_mfma_f32_16x16x32_bf16 v[216:219], a[56:59], a[20:23], v[216:219]
    buffer_load_dwordx4 a[140:143], v27, s[32:35], s96 offen offset:0 sc1
    v_mfma_f32_16x16x32_bf16 v[220:223], a[44:47], a[4:7], v[220:223]
    ds_read_b128 a[104:107], v8 offset:2048
    v_mfma_f32_16x16x32_bf16 v[220:223], a[60:63], a[20:23], v[220:223]
    v_mfma_f32_16x16x32_bf16 v[224:227], a[32:35], a[8:11], v[224:227]
    ds_read_b128 a[72:75], v6 offset:4096
    v_mfma_f32_16x16x32_bf16 v[224:227], a[48:51], a[24:27], v[224:227]
    ds_read_b128 a[120:123], v8 offset:6144
    v_mfma_f32_16x16x32_bf16 v[228:231], a[36:39], a[8:11], v[228:231]
    buffer_load_dwordx4 a[160:163], v2, s[32:35], s96 offen offset:1024 sc1
    v_mfma_f32_16x16x32_bf16 v[228:231], a[52:55], a[24:27], v[228:231]
    ds_read_b128 a[88:91], v6 offset:5120
    v_mfma_f32_16x16x32_bf16 v[232:235], a[40:43], a[8:11], v[232:235]
    v_mfma_f32_16x16x32_bf16 v[232:235], a[56:59], a[24:27], v[232:235]
    ds_read_b128 a[108:111], v8 offset:3072
    v_mfma_f32_16x16x32_bf16 v[236:239], a[44:47], a[8:11], v[236:239]
    ds_read_b128 a[76:79], v6 offset:6144
    v_mfma_f32_16x16x32_bf16 v[236:239], a[60:63], a[24:27], v[236:239]
    buffer_load_dwordx4 a[164:167], v10, s[32:35], s96 offen offset:1024 sc1
    v_mfma_f32_16x16x32_bf16 v[240:243], a[32:35], a[12:15], v[240:243]
    ds_read_b128 a[124:127], v8 offset:7168
    v_mfma_f32_16x16x32_bf16 v[240:243], a[48:51], a[28:31], v[240:243]
    buffer_load_dwordx4 a[168:171], v11, s[32:35], s96 offen offset:1024 sc1
    v_mfma_f32_16x16x32_bf16 v[244:247], a[36:39], a[12:15], v[244:247]
    ds_read_b128 a[92:95], v6 offset:7168
    v_mfma_f32_16x16x32_bf16 v[244:247], a[52:55], a[28:31], v[244:247]
    v_mfma_f32_16x16x32_bf16 v[248:251], a[40:43], a[12:15], v[248:251]
    v_mfma_f32_16x16x32_bf16 v[248:251], a[56:59], a[28:31], v[248:251]
    v_mfma_f32_16x16x32_bf16 v[252:255], a[44:47], a[12:15], v[252:255]
    buffer_load_dwordx4 a[172:175], v27, s[32:35], s96 offen offset:1024 sc1
    v_mfma_f32_16x16x32_bf16 v[252:255], a[60:63], a[28:31], v[252:255]
    s_waitcnt lgkmcnt(0)
    s_barrier
    s_lshl_b32 s51, s2, 2
    s_add_u32 s51, s51, s48
    s_cmp_eq_u32 s51, 3
    s_cbranch_scc0 L_noep35
    s_mov_b32 s52, 0
L_noep35_l:
    v_xor_b32 v33, s95, v33
    v_xor_b32 v34, s95, v34
    v_xor_b32 v35, s95, v35
    v_xor_b32 v36, s95, v36
    v_or3_b32 v33, v33, v34, v35
    v_or_b32 v33, v33, v36
    v_cmp_eq_u32 vcc, 0, v33
    s_nop 0
    s_cmp_eq_u64 vcc, -1
    s_cbranch_scc1 L_noep35_k
    s_add_u32 s52, s52, 1
    s_cmp_gt_u32 s52, 0x40000
    s_cbranch_scc1 L_noep35_k
    s_sleep 1
    s_mov_b32 s51, 0
    buffer_load_dword v33, v32, s[76:79], s51 offen offset:12 sc1
    s_mov_b32 s51, 8192
    buffer_load_dword v34, v32, s[76:79], s51 offen offset:12 sc1
    s_mov_b32 s51, 16384
    buffer_load_dword v35, v32, s[76:79], s51 offen offset:12 sc1
    s_mov_b32 s51, 24576
    buffer_load_dword v36, v32, s[76:79], s51 offen offset:12 sc1
    s_waitcnt vmcnt(0)
    s_branch L_noep35_l
L_noep35_k:
    s_mov_b64 exec, 1
    v_mov_b32 v33, s95
    v_mov_b32 v34, 65536
    buffer_store_dword v33, v34, s[76:79], 0 offen sc1
    s_mov_b64 exec, -1
L_noep35:
    v_mfma_f32_16x16x32_bf16 v[192:195], a[96:99], a[64:67], v[192:195]
    v_mfma_f32_16x16x32_bf16 v[192:195], a[112:115], a[80:83], v[192:195]
    buffer_load_dwordx4 a[192:195], v2, s[32:35], s96 offen offset:2048 sc1
    v_mfma_f32_16x16x32_bf16 v[196:199], a[100:103], a[64:67], v[196:199]
    v_mfma_f32_16x16x32_bf16 v[196:199], a[116:119], a[80:83], v[196:199]
    buffer_load_dwordx4 a[196:199], v10, s[32:35], s96 offen offset:2048 sc1
    v_mfma_f32_16x16x32_bf16 v[200:203], a[104:107], a[64:67], v[200:203]
    v_mfma_f32_16x16x32_bf16 v[200:203], a[120:123], a[80:83], v[200:203]
    v_mfma_f32_16x16x32_bf16 v[204:207], a[108:111], a[64:67], v[204:207]
    buffer_load_dwordx4 a[200:203], v11, s[32:35], s96 offen offset:2048 sc1
    v_mfma_f32_16x16x32_bf16 v[204:207], a[124:127], a[80:83], v[204:207]
    v_mfma_f32_16x16x32_bf16 v[208:211], a[96:99], a[68:71], v[208:211]
    v_mfma_f32_16x16x32_bf16 v[208:211], a[112:115], a[84:87], v[208:211]
    buffer_load_dwordx4 a[204:207], v27, s[32:35], s96 offen offset:2048 sc1
    v_mfma_f32_16x16x32_bf16 v[212:215], a[100:103], a[68:71], v[212:215]
    v_mfma_f32_16x16x32_bf16 v[212:215], a[116:119], a[84:87], v[212:215]
    buffer_load_dwordx4 a[224:227], v2, s[32:35], s96 offen offset:3072 sc1
    v_mfma_f32_16x16x32_bf16 v[216:219], a[104:107], a[68:71], v[216:219]
    v_mfma_f32_16x16x32_bf16 v[216:219], a[120:123], a[84:87], v[216:219]
    v_mfma_f32_16x16x32_bf16 v[220:223], a[108:111], a[68:71], v[220:223]
    buffer_load_dwordx4 a[228:231], v10, s[32:35], s96 offen offset:3072 sc1
    v_mfma_f32_16x16x32_bf16 v[220:223], a[124:127], a[84:87], v[220:223]
    v_mfma_f32_16x16x32_bf16 v[224:227], a[96:99], a[72:75], v[224:227]
    v_mfma_f32_16x16x32_bf16 v[224:227], a[112:115], a[88:91], v[224:227]
    buffer_load_dwordx4 a[232:235], v11, s[32:35], s96 offen offset:3072 sc1
    v_mfma_f32_16x16x32_bf16 v[228:231], a[100:103], a[72:75], v[228:231]
    v_mfma_f32_16x16x32_bf16 v[228:231], a[116:119], a[88:91], v[228:231]
    buffer_load_dwordx4 a[236:239], v27, s[32:35], s96 offen offset:3072 sc1
    v_mfma_f32_16x16x32_bf16 v[232:235], a[104:107], a[72:75], v[232:235]
    v_mfma_f32_16x16x32_bf16 v[232:235], a[120:123], a[88:91], v[232:235]
    v_mfma_f32_16x16x32_bf16 v[236:239], a[108:111], a[72:75], v[236:239]
    s_lshl_b32 s51, s48, 16
    s_lshl_b32 s52, s99, 14
    v_mfma_f32_16x16x32_bf16 v[236:239], a[124:127], a[88:91], v[236:239]
    v_mfma_f32_16x16x32_bf16 v[240:243], a[96:99], a[76:79], v[240:243]
    v_mfma_f32_16x16x32_bf16 v[240:243], a[112:115], a[92:95], v[240:243]
    v_mfma_f32_16x16x32_bf16 v[244:247], a[100:103], a[76:79], v[244:247]
    s_add_u32 s51, s51, s52
    s_add_u32 s51, s51, s101
    v_mfma_f32_16x16x32_bf16 v[244:247], a[116:119], a[92:95], v[244:247]
    v_mfma_f32_16x16x32_bf16 v[248:251], a[104:107], a[76:79], v[248:251]
    v_mfma_f32_16x16x32_bf16 v[248:251], a[120:123], a[92:95], v[248:251]
    v_mfma_f32_16x16x32_bf16 v[252:255], a[108:111], a[76:79], v[252:255]
    s_cmp_eq_u32 s48, s99
    s_cselect_b32 s51, 0x7f000000, s51
    v_mfma_f32_16x16x32_bf16 v[252:255], a[124:127], a[92:95], v[252:255]
L_bdone:
    s_nop 5
    v_cvt_pk_bf16_f32 v64, v192, v193
    v_cvt_pk_bf16_f32 v65, v194, v195
    v_cvt_pk_bf16_f32 v66, v196, v197
    v_cvt_pk_bf16_f32 v67, v198, v199
    buffer_store_dwordx4 v[64:67], v2, s[44:47], s51 offen offset:0 sc1
    v_cvt_pk_bf16_f32 v68, v200, v201
    v_cvt_pk_bf16_f32 v69, v202, v203
    v_cvt_pk_bf16_f32 v70, v204, v205
    v_cvt_pk_bf16_f32 v71, v206, v207
    buffer_store_dwordx4 v[68:71], v2, s[44:47], s51 offen offset:1024 sc1
    v_cvt_pk_bf16_f32 v72, v208, v209
    v_cvt_pk_bf16_f32 v73, v210, v211
    v_cvt_pk_bf16_f32 v74, v212, v213
    v_cvt_pk_bf16_f32 v75, v214, v215
    buffer_store_dwordx4 v[72:75], v2, s[44:47], s51 offen offset:2048 sc1
    v_cvt_pk_bf16_f32 v76, v216, v217
    v_cvt_pk_bf16_f32 v77, v218, v219
    v_cvt_pk_bf16_f32 v78, v220, v221
    v_cvt_pk_bf16_f32 v79, v222, v223
    buffer_store_dwordx4 v[76:79], v2, s[44:47], s51 offen offset:3072 sc1
    s_waitcnt vmcnt(4)
    v_mfma_f32_16x16x32_bf16 v[128:131], a[144:147], a[128:131], 0
    s_add_u32 s51, s51, 4096
    v_mfma_f32_16x16x32_bf16 v[132:135], a[148:151], a[128:131], 0
    v_mfma_f32_16x16x32_bf16 v[136:139], a[152:155], a[128:131], 0
    v_cvt_pk_bf16_f32 v80, v224, v225
    ds_write_b128 v20, v[192:195] offset:0
    v_mfma_f32_16x16x32_bf16 v[140:143], a[156:159], a[128:131], 0
    v_cvt_pk_bf16_f32 v81, v226, v227
    v_mfma_f32_16x16x32_bf16 v[144:147], a[144:147], a[132:135], 0
    v_mfma_f32_16x16x32_bf16 v[148:151], a[148:151], a[132:135], 0
    v_cvt_pk_bf16_f32 v82, v228, v229
    v_mfma_f32_16x16x32_bf16 v[152:155], a[152:155], a[132:135], 0
    v_cvt_pk_bf16_f32 v83, v230, v231
    ds_write_b128 v20, v[196:199] offset:1024
    v_mfma_f32_16x16x32_bf16 v[156:159], a[156:159], a[132:135], 0
    v_mfma_f32_16x16x32_bf16 v[160:163], a[144:147], a[136:139], 0
    buffer_store_dwordx4 v[80:83], v2, s[44:47], s51 offen offset:0 sc1
    v_mfma_f32_16x16x32_bf16 v[164:167], a[148:151], a[136:139], 0
    v_cvt_pk_bf16_f32 v84, v232, v233
    v_mfma_f32_16x16x32_bf16 v[168:171], a[152:155], a[136:139], 0
    ds_write_b128 v20, v[200:203] offset:2048
    v_mfma_f32_16x16x32_bf16 v[172:175], a[156:159], a[136:139], 0
    v_cvt_pk_bf16_f32 v85, v234, v235
    v_mfma_f32_16x16x32_bf16 v[176:179], a[144:147], a[140:143], 0
    v_cvt_pk_bf16_f32 v86, v236, v237
    v_mfma_f32_16x16x32_bf16 v[180:183], a[148:151], a[140:143], 0
    v_mfma_f32_16x16x32_bf16 v[184:187], a[152:155], a[140:143], 0
    v_cvt_pk_bf16_f32 v87, v238, v239
    ds_write_b128 v20, v[204:207] offset:3072
    v_mfma_f32_16x16x32_bf16 v[188:191], a[156:159], a[140:143], 0
    buffer_store_dwordx4 v[84:87], v2, s[44:47], s51 offen offset:1024 sc1
    v_mfma_f32_16x16x32_bf16 v[128:131], a[176:179], a[160:163], v[128:131]
    v_cvt_pk_bf16_f32 v88, v240, v241
    v_mfma_f32_16x16x32_bf16 v[132:135], a[180:183], a[160:163], v[132:135]
    v_mfma_f32_16x16x32_bf16 v[136:139], a[184:187], a[160:163], v[136:139]
    v_cvt_pk_bf16_f32 v89, v242, v243
    ds_write_b128 v20, v[208:211] offset:4096
    v_mfma_f32_16x16x32_bf16 v[140:143], a[188:191], a[160:163], v[140:143]
    v_cvt_pk_bf16_f32 v90, v244, v245
    v_mfma_f32_16x16x32_bf16 v[144:147], a[176:179], a[164:167], v[144:147]
    v_mfma_f32_16x16x32_bf16 v[148:151], a[180:183], a[164:167], v[148:151]
    v_cvt_pk_bf16_f32 v91, v246, v247
    ds_write_b128 v20, v[212:215] offset:5120
    v_mfma_f32_16x16x32_bf16 v[152:155], a[184:187], a[164:167], v[152:155]
    buffer_store_dwordx4 v[88:91], v2, s[44:47], s51 offen offset:2048 sc1
    v_mfma_f32_16x16x32_bf16 v[156:159], a[188:191], a[164:167], v[156:159]
    v_mfma_f32_16x16x32_bf16 v[160:163], a[176:179], a[168:171], v[160:163]
    v_cvt_pk_bf16_f32 v92, v248, v249
    v_mfma_f32_16x16x32_bf16 v[164:167], a[180:183], a[168:171], v[164:167]
    v_cvt_pk_bf16_f32 v93, v250, v251
    v_mfma_f32_16x16x32_bf16 v[168:171], a[184:187], a[168:171], v[168:171]
    ds_write_b128 v20, v[216:219] offset:6144
    v_mfma_f32_16x16x32_bf16 v[172:175], a[188:191], a[168:171], v[172:175]
    v_cvt_pk_bf16_f32 v94, v252, v253
    v_mfma_f32_16x16x32_bf16 v[176:179], a[176:179], a[172:175], v[176:179]
    v_cvt_pk_bf16_f32 v95, v254, v255
    v_mfma_f32_16x16x32_bf16 v[180:183], a[180:183], a[172:175], v[180:183]
    ds_write_b128 v20, v[220:223] offset:7168
    v_mfma_f32_16x16x32_bf16 v[184:187], a[184:187], a[172:175], v[184:187]
    buffer_store_dwordx4 v[92:95], v2, s[44:47], s51 offen offset:3072 sc1
    v_mfma_f32_16x16x32_bf16 v[188:191], a[188:191], a[172:175], v[188:191]
    v_mfma_f32_16x16x32_bf16 v[128:131], a[208:211], a[192:195], v[128:131]
    v_mfma_f32_16x16x32_bf16 v[132:135], a[212:215], a[192:195], v[132:135]
    v_mfma_f32_16x16x32_bf16 v[136:139], a[216:219], a[192:195], v[136:139]
    ds_write_b128 v20, v[224:227] offset:8192
    v_mfma_f32_16x16x32_bf16 v[140:143], a[220:223], a[192:195], v[140:143]
    v_mfma_f32_16x16x32_bf16 v[144:147], a[208:211], a[196:199], v[144:147]
    v_mfma_f32_16x16x32_bf16 v[148:151], a[212:215], a[196:199], v[148:151]
    v_mfma_f32_16x16x32_bf16 v[152:155], a[216:219], a[196:199], v[152:155]
    ds_write_b128 v20, v[228:231] offset:9216
    v_mfma_f32_16x16x32_bf16 v[156:159], a[220:223], a[196:199], v[156:159]
    v_mfma_f32_16x16x32_bf16 v[160:163], a[208:211], a[200:203], v[160:163]
    v_mfma_f32_16x16x32_bf16 v[164:167], a[212:215], a[200:203], v[164:167]
    v_mfma_f32_16x16x32_bf16 v[168:171], a[216:219], a[200:203], v[168:171]
    ds_write_b128 v20, v[232:235] offset:10240
    v_mfma_f32_16x16x32_bf16 v[172:175], a[220:223], a[200:203], v[172:175]
    v_mfma_f32_16x16x32_bf16 v[176:179], a[208:211], a[204:207], v[176:179]
    v_mfma_f32_16x16x32_bf16 v[180:183], a[212:215], a[204:207], v[180:183]
    v_mfma_f32_16x16x32_bf16 v[184:187], a[216:219], a[204:207], v[184:187]
    ds_write_b128 v20, v[236:239] offset:11264
    v_mfma_f32_16x16x32_bf16 v[188:191], a[220:223], a[204:207], v[188:191]
    v_mfma_f32_16x16x32_bf16 v[128:131], a[240:243], a[224:227], v[128:131]
    v_mfma_f32_16x16x32_bf16 v[132:135], a[244:247], a[224:227], v[132:135]
    v_mfma_f32_16x16x32_bf16 v[136:139], a[248:251], a[224:227], v[136:139]
    ds_write_b128 v20, v[240:243] offset:12288
    v_mfma_f32_16x16x32_bf16 v[140:143], a[252:255], a[224:227], v[140:143]
    v_mfma_f32_16x16x32_bf16 v[144:147], a[240:243], a[228:231], v[144:147]
    v_mfma_f32_16x16x32_bf16 v[148:151], a[244:247], a[228:231], v[148:151]
    v_mfma_f32_16x16x32_bf16 v[152:155], a[248:251], a[228:231], v[152:155]
    ds_write_b128 v20, v[244:247] offset:13312
    v_mfma_f32_16x16x32_bf16 v[156:159], a[252:255], a[228:231], v[156:159]
    v_mfma_f32_16x16x32_bf16 v[160:163], a[240:243], a[232:235], v[160:163]
    v_mfma_f32_16x16x32_bf16 v[164:167], a[244:247], a[232:235], v[164:167]
    v_mfma_f32_16x16x32_bf16 v[168:171], a[248:251], a[232:235], v[168:171]
    ds_write_b128 v20, v[248:251] offset:14336
    v_mfma_f32_16x16x32_bf16 v[172:175], a[252:255], a[232:235], v[172:175]
    v_mfma_f32_16x16x32_bf16 v[176:179], a[240:243], a[236:239], v[176:179]
    v_mfma_f32_16x16x32_bf16 v[180:183], a[244:247], a[236:239], v[180:183]
    v_mfma_f32_16x16x32_bf16 v[184:187], a[248:251], a[236:239], v[184:187]
    ds_write_b128 v20, v[252:255] offset:15360
    v_mfma_f32_16x16x32_bf16 v[188:191], a[252:255], a[236:239], v[188:191]
    s_waitcnt vmcnt(0)
    s_lshl_b32 s51, s2, 5
    s_add_u32 s51, s51, s48
    s_lshl_b32 s51, s51, 2
    s_mov_b64 exec, 1
    v_mov_b32 v16, s95
    v_mov_b32 v17, s51
    buffer_store_dword v16, v17, s[76:79], 0 offen offset:32 sc1
    s_mov_b64 exec, -1
    v_and_b32 v25, 3, v1
    v_max_u32 v25, 1, v25
    v_add_u32 v25, s99, v25
    v_and_b32 v25, 3, v25
    s_and_b32 s51, s2, 0xf9
    s_lshl_b32 s51, s51, 5
    s_add_u32 s51, s51, s99
    s_lshl_b32 s51, s51, 2
    v_lshl_add_u32 v25, v25, 8, s51
    s_lshl_b32 s51, s99, 14
    v_add_u32 v26, s51, v21
    v_lshrrev_b32 v27, 1, v3
    s_lshl_b32 s51, s48, 11
    v_lshl_add_u32 v27, v27, 10, s51
    v_lshl_add_u32 v27, v4, 4, v27
    v_and_b32 v16, 1, v3
    v_lshl_add_u32 v27, v16, 3, v27
    ds_write_b128 v22, v[128:131] offset:0
    ds_write_b128 v22, v[132:135] offset:1024
    ds_write_b128 v22, v[136:139] offset:2048
    ds_write_b128 v22, v[140:143] offset:3072
    ds_write_b128 v22, v[144:147] offset:4096
    ds_write_b128 v22, v[148:151] offset:5120
    ds_write_b128 v22, v[152:155] offset:6144
    ds_write_b128 v22, v[156:159] offset:7168
    ds_write_b128 v22, v[160:163] offset:8192
    ds_write_b128 v22, v[164:167] offset:9216
    ds_write_b128 v22, v[168:171] offset:10240
    ds_write_b128 v22, v[172:175] offset:11264
    ds_write_b128 v22, v[176:179] offset:12288
    ds_write_b128 v22, v[180:183] offset:13312
    ds_write_b128 v22, v[184:187] offset:14336
    ds_write_b128 v22, v[188:191] offset:15360
    buffer_load_dword v16, v25, s[76:79], 0 offen offset:32 sc1
    s_waitcnt lgkmcnt(0)
    s_barrier
    ds_read_b128 v[128:131], v24 offset:0
    ds_read_b128 v[132:135], v24 offset:256
    ds_read_b128 v[136:139], v24 offset:512
    ds_read_b128 v[140:143], v24 offset:768
    ds_read_b128 v[144:147], v24 offset:16384
    ds_read_b128 v[148:151], v24 offset:16640
    ds_read_b128 v[152:155], v24 offset:16896
    ds_read_b128 v[156:159], v24 offset:17152
    ds_read_b128 v[160:163], v24 offset:32768
    ds_read_b128 v[164:167], v24 offset:33024
    ds_read_b128 v[168:171], v24 offset:33280
    ds_read_b128 v[172:175], v24 offset:33536
    ds_read_b128 v[176:179], v24 offset:49152
    ds_read_b128 v[180:183], v24 offset:49408
    ds_read_b128 v[184:187], v24 offset:49664
    ds_read_b128 v[188:191], v24 offset:49920
    ds_read_b128 v[192:195], v26 offset:0
    ds_read_b128 v[196:199], v26 offset:256
    ds_read_b128 v[200:203], v26 offset:512
    ds_read_b128 v[204:207], v26 offset:768
    s_waitcnt lgkmcnt(12)
    v_add_f32 v128, v128, v144
    v_add_f32 v129, v129, v145
    v_add_f32 v130, v130, v146
    v_add_f32 v131, v131, v147
    v_add_f32 v132, v132, v148
    v_add_f32 v133, v133, v149
    v_add_f32 v134, v134, v150
    v_add_f32 v135, v135, v151
    v_add_f32 v136, v136, v152
    v_add_f32 v137, v137, v153
    v_add_f32 v138, v138, v154
    v_add_f32 v139, v139, v155
    v_add_f32 v140, v140, v156
    v_add_f32 v141, v141, v157
    v_add_f32 v142, v142, v158
    v_add_f32 v143, v143, v159
    s_waitcnt lgkmcnt(4)
    s_waitcnt vmcnt(0)
    s_mov_b32 s52, 0
L_poll5:
    v_cmp_eq_u32 vcc, s95, v16
    s_nop 0
    s_cmp_eq_u64 vcc, -1
    s_cbranch_scc1 L_poll5_ok
    s_add_u32 s52, s52, 1
    s_cmp_gt_u32 s52, 0x40000
    s_cbranch_scc1 L_poll5_ok
    s_sleep 1
    buffer_load_dword v16, v25, s[76:79], 0 offen offset:32 sc1
    s_waitcnt vmcnt(0)
    s_branch L_poll5
L_poll5_ok:
    s_lshl_b32 s53, s99, 16
    s_add_u32 s53, s53, s101
    s_add_u32 s51, s99, 1
    s_and_b32 s51, s51, 3
    s_lshl_b32 s51, s51, 14
    s_add_u32 s51, s51, s53
    buffer_load_dwordx2 v[72:73], v27, s[44:47], s51 offen offset:0 sc1
    buffer_load_dwordx2 v[74:75], v27, s[44:47], s51 offen offset:256 sc1
    buffer_load_dwordx2 v[76:77], v27, s[44:47], s51 offen offset:512 sc1
    buffer_load_dwordx2 v[78:79], v27, s[44:47], s51 offen offset:768 sc1
    s_add_u32 s51, s99, 2
    s_and_b32 s51, s51, 3
    s_lshl_b32 s51, s51, 14
    s_add_u32 s51, s51, s53
    buffer_load_dwordx2 v[80:81], v27, s[44:47], s51 offen offset:0 sc1
    buffer_load_dwordx2 v[82:83], v27, s[44:47], s51 offen offset:256 sc1
    buffer_load_dwordx2 v[84:85], v27, s[44:47], s51 offen offset:512 sc1
    buffer_load_dwordx2 v[86:87], v27, s[44:47], s51 offen offset:768 sc1
    s_add_u32 s51, s99, 3
    s_and_b32 s51, s51, 3
    s_lshl_b32 s51, s51, 14
    s_add_u32 s51, s51, s53
    buffer_load_dwordx2 v[88:89], v27, s[44:47], s51 offen offset:0 sc1
    buffer_load_dwordx2 v[90:91], v27, s[44:47], s51 offen offset:256 sc1
    buffer_load_dwordx2 v[92:93], v27, s[44:47], s51 offen offset:512 sc1
    buffer_load_dwordx2 v[94:95], v27, s[44:47], s51 offen offset:768 sc1
    v_add_f32 v160, v160, v176
    v_add_f32 v161, v161, v177
    v_add_f32 v162, v162, v178
    v_add_f32 v163, v163, v179
    v_add_f32 v164, v164, v180
    v_add_f32 v165, v165, v181
    v_add_f32 v166, v166, v182
    v_add_f32 v167, v167, v183
    v_add_f32 v168, v168, v184
    v_add_f32 v169, v169, v185
    v_add_f32 v170, v170, v186
    v_add_f32 v171, v171, v187
    v_add_f32 v172, v172, v188
    v_add_f32 v173, v173, v189
    v_add_f32 v174, v174, v190
    v_add_f32 v175, v175, v191
    v_add_f32 v128, v128, v160
    v_add_f32 v129, v129, v161
    v_add_f32 v130, v130, v162
    v_add_f32 v131, v131, v163
    v_add_f32 v132, v132, v164
    v_add_f32 v133, v133, v165
    v_add_f32 v134, v134, v166
    v_add_f32 v135, v135, v167
    v_add_f32 v136, v136, v168
    v_add_f32 v137, v137, v169
    v_add_f32 v138, v138, v170
    v_add_f32 v139, v139, v171
    v_add_f32 v140, v140, v172
    v_add_f32 v141, v141, v173
    v_add_f32 v142, v142, v174
    v_add_f32 v143, v143, v175
    v_cvt_pk_bf16_f32 v144, v128, v129
    v_cvt_pk_bf16_f32 v145, v130, v131
    v_cvt_pk_bf16_f32 v146, v132, v133
    v_cvt_pk_bf16_f32 v147, v134, v135
    v_cvt_pk_bf16_f32 v148, v136, v137
    v_cvt_pk_bf16_f32 v149, v138, v139
    v_cvt_pk_bf16_f32 v150, v140, v141
    v_cvt_pk_bf16_f32 v151, v142, v143
    buffer_store_dwordx4 v[144:147], v23, s[40:43], s72 offen offset:0
    buffer_store_dwordx4 v[148:151], v23, s[40:43], s72 offen offset:16
    s_mov_b32 s51, 0xffff0000
    s_waitcnt vmcnt(2) lgkmcnt(0)
    v_lshlrev_b32 v208, 16, v72
    v_and_b32 v209, s51, v72
    v_lshlrev_b32 v210, 16, v73
    v_and_b32 v211, s51, v73
    v_lshlrev_b32 v212, 16, v74
    v_and_b32 v213, s51, v74
    v_lshlrev_b32 v214, 16, v75
    v_and_b32 v215, s51, v75
    v_lshlrev_b32 v216, 16, v76
    v_and_b32 v217, s51, v76
    v_lshlrev_b32 v218, 16, v77
    v_and_b32 v219, s51, v77
    v_lshlrev_b32 v220, 16, v78
    v_and_b32 v221, s51, v78
    v_lshlrev_b32 v222, 16, v79
    v_and_b32 v223, s51, v79
    v_lshlrev_b32 v224, 16, v80
    v_and_b32 v225, s51, v80
    v_lshlrev_b32 v226, 16, v81
    v_and_b32 v227, s51, v81
    v_lshlrev_b32 v228, 16, v82
    v_and_b32 v229, s51, v82
    v_lshlrev_b32 v230, 16, v83
    v_and_b32 v231, s51, v83
    v_lshlrev_b32 v232, 16, v84
    v_and_b32 v233, s51, v84
    v_lshlrev_b32 v234, 16, v85
    v_and_b32 v235, s51, v85
    v_lshlrev_b32 v236, 16, v86
    v_and_b32 v237, s51, v86
    v_lshlrev_b32 v238, 16, v87
    v_and_b32 v239, s51, v87
    v_lshlrev_b32 v240, 16, v88
    v_and_b32 v241, s51, v88
    v_lshlrev_b32 v242, 16, v89
    v_and_b32 v243, s51, v89
    v_lshlrev_b32 v244, 16, v90
    v_and_b32 v245, s51, v90
    v_lshlrev_b32 v246, 16, v91
    v_and_b32 v247, s51, v91
    v_lshlrev_b32 v248, 16, v92
    v_and_b32 v249, s51, v92
    v_lshlrev_b32 v250, 16, v93
    v_and_b32 v251, s51, v93
    v_lshlrev_b32 v252, 16, v94
    v_and_b32 v253, s51, v94
    v_lshlrev_b32 v254, 16, v95
    v_and_b32 v255, s51, v95
    v_add_f32 v192, v192, v208
    v_add_f32 v193, v193, v209
    v_add_f32 v194, v194, v210
    v_add_f32 v195, v195, v211
    v_add_f32 v196, v196, v212
    v_add_f32 v197, v197, v213
    v_add_f32 v198, v198, v214
    v_add_f32 v199, v199, v215
    v_add_f32 v200, v200, v216
    v_add_f32 v201, v201, v217
    v_add_f32 v202, v202, v218
    v_add_f32 v203, v203, v219
    v_add_f32 v204, v204, v220
    v_add_f32 v205, v205, v221
    v_add_f32 v206, v206, v222
    v_add_f32 v207, v207, v223
    v_add_f32 v224, v224, v240
    v_add_f32 v225, v225, v241
    v_add_f32 v226, v226, v242
    v_add_f32 v227, v227, v243
    v_add_f32 v228, v228, v244
    v_add_f32 v229, v229, v245
    v_add_f32 v230, v230, v246
    v_add_f32 v231, v231, v247
    v_add_f32 v232, v232, v248
    v_add_f32 v233, v233, v249
    v_add_f32 v234, v234, v250
    v_add_f32 v235, v235, v251
    v_add_f32 v236, v236, v252
    v_add_f32 v237, v237, v253
    v_add_f32 v238, v238, v254
    v_add_f32 v239, v239, v255
    v_add_f32 v192, v192, v224
    v_add_f32 v193, v193, v225
    v_add_f32 v194, v194, v226
    v_add_f32 v195, v195, v227
    v_add_f32 v196, v196, v228
    v_add_f32 v197, v197, v229
    v_add_f32 v198, v198, v230
    v_add_f32 v199, v199, v231
    v_add_f32 v200, v200, v232
    v_add_f32 v201, v201, v233
    v_add_f32 v202, v202, v234
    v_add_f32 v203, v203, v235
    v_add_f32 v204, v204, v236
    v_add_f32 v205, v205, v237
    v_add_f32 v206, v206, v238
    v_add_f32 v207, v207, v239
    v_cvt_pk_bf16_f32 v208, v192, v193
    v_cvt_pk_bf16_f32 v209, v194, v195
    v_cvt_pk_bf16_f32 v210, v196, v197
    v_cvt_pk_bf16_f32 v211, v198, v199
    v_cvt_pk_bf16_f32 v212, v200, v201
    v_cvt_pk_bf16_f32 v213, v202, v203
    v_cvt_pk_bf16_f32 v214, v204, v205
    v_cvt_pk_bf16_f32 v215, v206, v207
    buffer_store_dwordx4 v[208:211], v23, s[40:43], s72 offen offset:1024
    buffer_store_dwordx4 v[212:215], v23, s[40:43], s72 offen offset:1040
L_end:
    s_endpgm
L_sb7_s:
    ds_read_b32 v21, v23
    s_waitcnt lgkmcnt(0)
    v_cmp_lt_u32 vcc, v21, v20
    s_cbranch_vccnz L_sb7_s
    s_branch L_sb7
L_sb10_s:
    ds_read_b32 v21, v23
    s_waitcnt lgkmcnt(0)
    v_cmp_lt_u32 vcc, v21, v20
    s_cbranch_vccnz L_sb10_s
    s_branch L_sb10
L_sb17_s:
    ds_read_b32 v165, v167
    s_waitcnt lgkmcnt(0)
    v_cmp_lt_u32 vcc, v165, v164
    s_cbranch_vccnz L_sb17_s
    s_branch L_sb17
L_sb19_s:
    ds_read_b32 v165, v167
    s_waitcnt lgkmcnt(0)
    v_cmp_lt_u32 vcc, v165, v164
    s_cbranch_vccnz L_sb19_s
    s_branch L_sb19
L_sb21_s:
    ds_read_b32 v165, v167
    s_waitcnt lgkmcnt(0)
    v_cmp_lt_u32 vcc, v165, v164
    s_cbranch_vccnz L_sb21_s
    s_branch L_sb21
L_sb23_s:
    ds_read_b32 v165, v167
    s_waitcnt lgkmcnt(0)
    v_cmp_lt_u32 vcc, v165, v164
    s_cbranch_vccnz L_sb23_s
    s_branch L_sb23
L_sb25_s:
    ds_read_b32 v165, v167
    s_waitcnt lgkmcnt(0)
    v_cmp_lt_u32 vcc, v165, v164
    s_cbranch_vccnz L_sb25_s
    s_branch L_sb25
L_sb27_s:
    ds_read_b32 v165, v167
    s_waitcnt lgkmcnt(0)
    v_cmp_lt_u32 vcc, v165, v164
    s_cbranch_vccnz L_sb27_s
    s_branch L_sb27
L_sb29_s:
    ds_read_b32 v165, v167
    s_waitcnt lgkmcnt(0)
    v_cmp_lt_u32 vcc, v165, v164
    s_cbranch_vccnz L_sb29_s
    s_branch L_sb29
L_sb31_s:
    ds_read_b32 v165, v167
    s_waitcnt lgkmcnt(0)
    v_cmp_lt_u32 vcc, v165, v164
    s_cbranch_vccnz L_sb31_s
    s_branch L_sb31
L_ev4_h:
    s_sub_u32 s51, s98, s72
    s_add_u32 s51, s51, 1
    s_cmp_lt_u32 s51, 2
    s_cbranch_scc0 L_nsp36
    s_cmp_eq_u32 s51, 0
    s_cselect_b64 s[64:65], s[56:57], 0
    s_cselect_b64 s[66:67], s[58:59], 0
    s_cselect_b64 s[68:69], s[60:61], 0
    s_cselect_b64 s[70:71], s[62:63], 0
    s_cselect_b64 vcc, -1, 0
    v_cndmask_b32 v160, v11, v9, s[64:65]
    v_cndmask_b32 v172, v11, v10, s[64:65]
    v_mov_b32 v168, v11
    v_cndmask_b32 v164, v11, v10, vcc
    v_cndmask_b32 v161, v11, v9, s[66:67]
    v_cndmask_b32 v173, v11, v10, s[66:67]
    v_mov_b32 v169, v11
    v_cndmask_b32 v165, v11, v10, vcc
    v_cndmask_b32 v162, v11, v9, s[68:69]
    v_cndmask_b32 v174, v11, v10, s[68:69]
    v_mov_b32 v170, v11
    v_cndmask_b32 v166, v11, v10, vcc
    v_cndmask_b32 v163, v11, v9, s[70:71]
    v_cndmask_b32 v175, v11, v10, s[70:71]
    v_mov_b32 v171, v11
    v_cndmask_b32 v167, v11, v10, vcc
    s_nop 1
L_nsp36:
    s_mov_b32 s92, 99
    s_cmp_lt_i32 s98, 32
    s_cselect_b32 s92, 32, s92
    s_cmp_lt_i32 s98, 31
    s_cselect_b32 s92, 31, s92
    s_sub_u32 s51, s72, 0
    s_cmp_lt_i32 s98, s51
    s_cselect_b32 s51, s51, 99
    s_min_u32 s92, s92, s51
    s_sub_u32 s51, s72, 1
    s_cmp_lt_i32 s98, s51
    s_cselect_b32 s51, s51, 99
    s_min_u32 s92, s92, s51
    s_branch L_ev4
L_ev5_h:
    s_sub_u32 s51, s98, s72
    s_add_u32 s51, s51, 1
    s_cmp_lt_u32 s51, 2
    s_cbranch_scc0 L_nsp37
    s_cmp_eq_u32 s51, 0
    s_cselect_b64 s[64:65], s[56:57], 0
    s_cselect_b64 s[66:67], s[58:59], 0
    s_cselect_b64 s[68:69], s[60:61], 0
    s_cselect_b64 s[70:71], s[62:63], 0
    s_cselect_b64 vcc, -1, 0
    v_cndmask_b32 v160, v11, v9, s[64:65]
    v_cndmask_b32 v172, v11, v10, s[64:65]
    v_mov_b32 v168, v11
    v_cndmask_b32 v164, v11, v10, vcc
    v_cndmask_b32 v161, v11, v9, s[66:67]
    v_cndmask_b32 v173, v11, v10, s[66:67]
    v_mov_b32 v169, v11
    v_cndmask_b32 v165, v11, v10, vcc
    v_cndmask_b32 v162, v11, v9, s[68:69]
    v_cndmask_b32 v174, v11, v10, s[68:69]
    v_mov_b32 v170, v11
    v_cndmask_b32 v166, v11, v10, vcc
    v_cndmask_b32 v163, v11, v9, s[70:71]
    v_cndmask_b32 v175, v11, v10, s[70:71]
    v_mov_b32 v171, v11
    v_cndmask_b32 v167, v11, v10, vcc
    s_nop 1
L_nsp37:
    s_mov_b32 s92, 99
    s_cmp_lt_i32 s98, 32
    s_cselect_b32 s92, 32, s92
    s_cmp_lt_i32 s98, 31
    s_cselect_b32 s92, 31, s92
    s_sub_u32 s51, s72, 0
    s_cmp_lt_i32 s98, s51
    s_cselect_b32 s51, s51, 99
    s_min_u32 s92, s92, s51
    s_sub_u32 s51, s72, 1
    s_cmp_lt_i32 s98, s51
    s_cselect_b32 s51, s51, 99
    s_min_u32 s92, s92, s51
    s_branch L_ev5
L_ev6_h:
    s_sub_u32 s51, s98, s72
    s_add_u32 s51, s51, 1
    s_cmp_lt_u32 s51, 2
    s_cbranch_scc0 L_nsp38
    s_cmp_eq_u32 s51, 0
    s_cselect_b64 s[64:65], s[56:57], 0
    s_cselect_b64 s[66:67], s[58:59], 0
    s_cselect_b64 s[68:69], s[60:61], 0
    s_cselect_b64 s[70:71], s[62:63], 0
    s_cselect_b64 vcc, -1, 0
    v_cndmask_b32 v160, v11, v9, s[64:65]
    v_cndmask_b32 v172, v11, v10, s[64:65]
    v_mov_b32 v168, v11
    v_cndmask_b32 v164, v11, v10, vcc
    v_cndmask_b32 v161, v11, v9, s[66:67]
    v_cndmask_b32 v173, v11, v10, s[66:67]
    v_mov_b32 v169, v11
    v_cndmask_b32 v165, v11, v10, vcc
    v_cndmask_b32 v162, v11, v9, s[68:69]
    v_cndmask_b32 v174, v11, v10, s[68:69]
    v_mov_b32 v170, v11
    v_cndmask_b32 v166, v11, v10, vcc
    v_cndmask_b32 v163, v11, v9, s[70:71]
    v_cndmask_b32 v175, v11, v10, s[70:71]
    v_mov_b32 v171, v11
    v_cndmask_b32 v167, v11, v10, vcc
    s_nop 1
L_nsp38:
    s_mov_b32 s92, 99
    s_cmp_lt_i32 s98, 32
    s_cselect_b32 s92, 32, s92
    s_cmp_lt_i32 s98, 31
    s_cselect_b32 s92, 31, s92
    s_sub_u32 s51, s72, 0
    s_cmp_lt_i32 s98, s51
    s_cselect_b32 s51, s51, 99
    s_min_u32 s92, s92, s51
    s_sub_u32 s51, s72, 1
    s_cmp_lt_i32 s98, s51
    s_cselect_b32 s51, s51, 99
    s_min_u32 s92, s92, s51
    s_branch L_ev6
L_ev8_h:
    s_sub_u32 s51, s98, s72
    s_add_u32 s51, s51, 1
    s_cmp_lt_u32 s51, 2
    s_cbranch_scc0 L_nsp39
    s_cmp_eq_u32 s51, 0
    s_cselect_b64 s[64:65], s[56:57], 0
    s_cselect_b64 s[66:67], s[58:59], 0
    s_cselect_b64 s[68:69], s[60:61], 0
    s_cselect_b64 s[70:71], s[62:63], 0
    s_cselect_b64 vcc, -1, 0
    v_cndmask_b32 v160, v11, v9, s[64:65]
    v_cndmask_b32 v172, v11, v10, s[64:65]
    v_mov_b32 v168, v11
    v_cndmask_b32 v164, v11, v10, vcc
    v_cndmask_b32 v161, v11, v9, s[66:67]
    v_cndmask_b32 v173, v11, v10, s[66:67]
    v_mov_b32 v169, v11
    v_cndmask_b32 v165, v11, v10, vcc
    v_cndmask_b32 v162, v11, v9, s[68:69]
    v_cndmask_b32 v174, v11, v10, s[68:69]
    v_mov_b32 v170, v11
    v_cndmask_b32 v166, v11, v10, vcc
    v_cndmask_b32 v163, v11, v9, s[70:71]
    v_cndmask_b32 v175, v11, v10, s[70:71]
    v_mov_b32 v171, v11
    v_cndmask_b32 v167, v11, v10, vcc
    s_nop 1
L_nsp39:
    s_mov_b32 s92, 99
    s_cmp_lt_i32 s98, 32
    s_cselect_b32 s92, 32, s92
    s_cmp_lt_i32 s98, 31
    s_cselect_b32 s92, 31, s92
    s_sub_u32 s51, s72, 0
    s_cmp_lt_i32 s98, s51
    s_cselect_b32 s51, s51, 99
    s_min_u32 s92, s92, s51
    s_sub_u32 s51, s72, 1
    s_cmp_lt_i32 s98, s51
    s_cselect_b32 s51, s51, 99
    s_min_u32 s92, s92, s51
    s_branch L_ev8
L_ev9_h:
    s_sub_u32 s51, s98, s72
    s_add_u32 s51, s51, 1
    s_cmp_lt_u32 s51, 2
    s_cbranch_scc0 L_nsp40
    s_cmp_eq_u32 s51, 0
    s_cselect_b64 s[64:65], s[56:57], 0
    s_cselect_b64 s[66:67], s[58:59], 0
    s_cselect_b64 s[68:69], s[60:61], 0
    s_cselect_b64 s[70:71], s[62:63], 0
    s_cselect_b64 vcc, -1, 0
    v_cndmask_b32 v160, v11, v9, s[64:65]
    v_cndmask_b32 v172, v11, v10, s[64:65]
    v_mov_b32 v168, v11
    v_cndmask_b32 v164, v11, v10, vcc
    v_cndmask_b32 v161, v11, v9, s[66:67]
    v_cndmask_b32 v173, v11, v10, s[66:67]
    v_mov_b32 v169, v11
    v_cndmask_b32 v165, v11, v10, vcc
    v_cndmask_b32 v162, v11, v9, s[68:69]
    v_cndmask_b32 v174, v11, v10, s[68:69]
    v_mov_b32 v170, v11
    v_cndmask_b32 v166, v11, v10, vcc
    v_cndmask_b32 v163, v11, v9, s[70:71]
    v_cndmask_b32 v175, v11, v10, s[70:71]
    v_mov_b32 v171, v11
    v_cndmask_b32 v167, v11, v10, vcc
    s_nop 1
L_nsp40:
    s_mov_b32 s92, 99
    s_cmp_lt_i32 s98, 32
    s_cselect_b32 s92, 32, s92
    s_cmp_lt_i32 s98, 31
    s_cselect_b32 s92, 31, s92
    s_sub_u32 s51, s72, 0
    s_cmp_lt_i32 s98, s51
    s_cselect_b32 s51, s51, 99
    s_min_u32 s92, s92, s51
    s_sub_u32 s51, s72, 1
    s_cmp_lt_i32 s98, s51
    s_cselect_b32 s51, s51, 99
    s_min_u32 s92, s92, s51
    s_branch L_ev9
L_ev11_h:
    s_sub_u32 s51, s98, s72
    s_add_u32 s51, s51, 1
    s_cmp_lt_u32 s51, 2
    s_cbranch_scc0 L_nsp41
    s_cmp_eq_u32 s51, 0
    s_cselect_b64 s[64:65], s[56:57], 0
    s_cselect_b64 s[66:67], s[58:59], 0
    s_cselect_b64 s[68:69], s[60:61], 0
    s_cselect_b64 s[70:71], s[62:63], 0
    s_cselect_b64 vcc, -1, 0
    v_cndmask_b32 v160, v11, v9, s[64:65]
    v_cndmask_b32 v172, v11, v10, s[64:65]
    v_mov_b32 v168, v11
    v_cndmask_b32 v164, v11, v10, vcc
    v_cndmask_b32 v161, v11, v9, s[66:67]
    v_cndmask_b32 v173, v11, v10, s[66:67]
    v_mov_b32 v169, v11
    v_cndmask_b32 v165, v11, v10, vcc
    v_cndmask_b32 v162, v11, v9, s[68:69]
    v_cndmask_b32 v174, v11, v10, s[68:69]
    v_mov_b32 v170, v11
    v_cndmask_b32 v166, v11, v10, vcc
    v_cndmask_b32 v163, v11, v9, s[70:71]
    v_cndmask_b32 v175, v11, v10, s[70:71]
    v_mov_b32 v171, v11
    v_cndmask_b32 v167, v11, v10, vcc
    s_nop 1
L_nsp41:
    s_mov_b32 s92, 99
    s_cmp_lt_i32 s98, 32
    s_cselect_b32 s92, 32, s92
    s_cmp_lt_i32 s98, 31
    s_cselect_b32 s92, 31, s92
    s_sub_u32 s51, s72, 0
    s_cmp_lt_i32 s98, s51
    s_cselect_b32 s51, s51, 99
    s_min_u32 s92, s92, s51
    s_sub_u32 s51, s72, 1
    s_cmp_lt_i32 s98, s51
    s_cselect_b32 s51, s51, 99
    s_min_u32 s92, s92, s51
    s_branch L_ev11
L_ev12_h:
    s_sub_u32 s51, s98, s72
    s_add_u32 s51, s51, 1
    s_cmp_lt_u32 s51, 2
    s_cbranch_scc0 L_nsp42
    s_cmp_eq_u32 s51, 0
    s_cselect_b64 s[64:65], s[56:57], 0
    s_cselect_b64 s[66:67], s[58:59], 0
    s_cselect_b64 s[68:69], s[60:61], 0
    s_cselect_b64 s[70:71], s[62:63], 0
    s_cselect_b64 vcc, -1, 0
    v_cndmask_b32 v160, v11, v9, s[64:65]
    v_cndmask_b32 v172, v11, v10, s[64:65]
    v_mov_b32 v168, v11
    v_cndmask_b32 v164, v11, v10, vcc
    v_cndmask_b32 v161, v11, v9, s[66:67]
    v_cndmask_b32 v173, v11, v10, s[66:67]
    v_mov_b32 v169, v11
    v_cndmask_b32 v165, v11, v10, vcc
    v_cndmask_b32 v162, v11, v9, s[68:69]
    v_cndmask_b32 v174, v11, v10, s[68:69]
    v_mov_b32 v170, v11
    v_cndmask_b32 v166, v11, v10, vcc
    v_cndmask_b32 v163, v11, v9, s[70:71]
    v_cndmask_b32 v175, v11, v10, s[70:71]
    v_mov_b32 v171, v11
    v_cndmask_b32 v167, v11, v10, vcc
    s_nop 1
L_nsp42:
    s_mov_b32 s92, 99
    s_cmp_lt_i32 s98, 32
    s_cselect_b32 s92, 32, s92
    s_cmp_lt_i32 s98, 31
    s_cselect_b32 s92, 31, s92
    s_sub_u32 s51, s72, 0
    s_cmp_lt_i32 s98, s51
    s_cselect_b32 s51, s51, 99
    s_min_u32 s92, s92, s51
    s_sub_u32 s51, s72, 1
    s_cmp_lt_i32 s98, s51
    s_cselect_b32 s51, s51, 99
    s_min_u32 s92, s92, s51
    s_branch L_ev12
L_ev14_h:
    s_cmp_eq_u32 s98, 31
    s_cbranch_scc0 L_nbp43
    s_cmp_gt_u32 s48, 0
    s_cselect_b64 vcc, -1, 0
    s_cmp_eq_u32 s48, 0
    s_cselect_b64 s[64:65], s[56:57], vcc
    s_cselect_b64 s[66:67], s[58:59], vcc
    s_cselect_b64 s[68:69], s[60:61], vcc
    s_cselect_b64 s[70:71], s[62:63], vcc
    v_cndmask_b32 v128, v11, v7, s[64:65]
    v_cndmask_b32 v140, v11, v8, s[64:65]
    v_cndmask_b32 v136, v11, v7, vcc
    v_cndmask_b32 v129, v11, v7, s[66:67]
    v_cndmask_b32 v141, v11, v8, s[66:67]
    v_cndmask_b32 v137, v11, v7, vcc
    v_cndmask_b32 v130, v11, v7, s[68:69]
    v_cndmask_b32 v142, v11, v8, s[68:69]
    v_cndmask_b32 v138, v11, v7, vcc
    v_cndmask_b32 v131, v11, v7, s[70:71]
    v_cndmask_b32 v143, v11, v8, s[70:71]
    v_cndmask_b32 v139, v11, v7, vcc
    s_cmp_ge_u32 s48, 0
    s_cselect_b64 vcc, -1, 0
    v_cndmask_b32 v132, v11, v8, vcc
    v_cndmask_b32 v133, v11, v8, vcc
    v_cndmask_b32 v134, v11, v8, vcc
    v_cndmask_b32 v135, v11, v8, vcc
    s_cmp_gt_u32 s48, 1
    s_cselect_b64 vcc, -1, 0
    s_cmp_eq_u32 s48, 1
    s_cselect_b64 s[64:65], s[56:57], vcc
    s_cselect_b64 s[66:67], s[58:59], vcc
    s_cselect_b64 s[68:69], s[60:61], vcc
    s_cselect_b64 s[70:71], s[62:63], vcc
    v_cndmask_b32 v144, v11, v7, s[64:65]
    v_cndmask_b32 v156, v11, v8, s[64:65]
    v_cndmask_b32 v152, v11, v7, vcc
    v_cndmask_b32 v145, v11, v7, s[66:67]
    v_cndmask_b32 v157, v11, v8, s[66:67]
    v_cndmask_b32 v153, v11, v7, vcc
    v_cndmask_b32 v146, v11, v7, s[68:69]
    v_cndmask_b32 v158, v11, v8, s[68:69]
    v_cndmask_b32 v154, v11, v7, vcc
    v_cndmask_b32 v147, v11, v7, s[70:71]
    v_cndmask_b32 v159, v11, v8, s[70:71]
    v_cndmask_b32 v155, v11, v7, vcc
    s_cmp_ge_u32 s48, 1
    s_cselect_b64 vcc, -1, 0
    v_cndmask_b32 v148, v11, v8, vcc
    v_cndmask_b32 v149, v11, v8, vcc
    v_cndmask_b32 v150, v11, v8, vcc
    v_cndmask_b32 v151, v11, v8, vcc
    s_nop 1
L_nbp43:
    s_mov_b32 s92, 99
    s_cmp_lt_i32 s98, 32
    s_cselect_b32 s92, 32, s92
    s_cmp_lt_i32 s98, 31
    s_cselect_b32 s92, 31, s92
    s_sub_u32 s51, s72, 0
    s_cmp_lt_i32 s98, s51
    s_cselect_b32 s51, s51, 99
    s_min_u32 s92, s92, s51
    s_sub_u32 s51, s72, 1
    s_cmp_lt_i32 s98, s51
    s_cselect_b32 s51, s51, 99
    s_min_u32 s92, s92, s51
    s_branch L_ev14
L_ev15_h:
    s_cmp_eq_u32 s98, 32
    s_cbranch_scc0 L_nbp44
    s_cmp_gt_u32 s48, 2
    s_cselect_b64 vcc, -1, 0
    s_cmp_eq_u32 s48, 2
    s_cselect_b64 s[64:65], s[56:57], vcc
    s_cselect_b64 s[66:67], s[58:59], vcc
    s_cselect_b64 s[68:69], s[60:61], vcc
    s_cselect_b64 s[70:71], s[62:63], vcc
    v_cndmask_b32 v128, v11, v7, s[64:65]
    v_cndmask_b32 v140, v11, v8, s[64:65]
    v_cndmask_b32 v136, v11, v7, vcc
    v_cndmask_b32 v129, v11, v7, s[66:67]
    v_cndmask_b32 v141, v11, v8, s[66:67]
    v_cndmask_b32 v137, v11, v7, vcc
    v_cndmask_b32 v130, v11, v7, s[68:69]
    v_cndmask_b32 v142, v11, v8, s[68:69]
    v_cndmask_b32 v138, v11, v7, vcc
    v_cndmask_b32 v131, v11, v7, s[70:71]
    v_cndmask_b32 v143, v11, v8, s[70:71]
    v_cndmask_b32 v139, v11, v7, vcc
    s_cmp_ge_u32 s48, 2
    s_cselect_b64 vcc, -1, 0
    v_cndmask_b32 v132, v11, v8, vcc
    v_cndmask_b32 v133, v11, v8, vcc
    v_cndmask_b32 v134, v11, v8, vcc
    v_cndmask_b32 v135, v11, v8, vcc
    s_cmp_gt_u32 s48, 3
    s_cselect_b64 vcc, -1, 0
    s_cmp_eq_u32 s48, 3
    s_cselect_b64 s[64:65], s[56:57], vcc
    s_cselect_b64 s[66:67], s[58:59], vcc
    s_cselect_b64 s[68:69], s[60:61], vcc
    s_cselect_b64 s[70:71], s[62:63], vcc
    v_cndmask_b32 v144, v11, v7, s[64:65]
    v_cndmask_b32 v156, v11, v8, s[64:65]
    v_cndmask_b32 v152, v11, v7, vcc
    v_cndmask_b32 v145, v11, v7, s[66:67]
    v_cndmask_b32 v157, v11, v8, s[66:67]
    v_cndmask_b32 v153, v11, v7, vcc
    v_cndmask_b32 v146, v11, v7, s[68:69]
    v_cndmask_b32 v158, v11, v8, s[68:69]
    v_cndmask_b32 v154, v11, v7, vcc
    v_cndmask_b32 v147, v11, v7, s[70:71]
    v_cndmask_b32 v159, v11, v8, s[70:71]
    v_cndmask_b32 v155, v11, v7, vcc
    s_cmp_ge_u32 s48, 3
    s_cselect_b64 vcc, -1, 0
    v_cndmask_b32 v148, v11, v8, vcc
    v_cndmask_b32 v149, v11, v8, vcc
    v_cndmask_b32 v150, v11, v8, vcc
    v_cndmask_b32 v151, v11, v8, vcc
    s_nop 1
L_nbp44:
    s_mov_b32 s92, 99
    s_cmp_lt_i32 s98, 32
    s_cselect_b32 s92, 32, s92
    s_cmp_lt_i32 s98, 31
    s_cselect_b32 s92, 31, s92
    s_sub_u32 s51, s72, 0
    s_cmp_lt_i32 s98, s51
    s_cselect_b32 s51, s51, 99
    s_min_u32 s92, s92, s51
    s_sub_u32 s51, s72, 1
    s_cmp_lt_i32 s98, s51
    s_cselect_b32 s51, s51, 99
    s_min_u32 s92, s92, s51
    s_branch L_ev15
L_ev20_h:
    s_mov_b32 s98, 31
    s_cmp_eq_u32 s98, 31
    s_cbranch_scc0 L_nbp45
    s_cmp_gt_u32 s48, 0
    s_cselect_b64 vcc, -1, 0
    s_cmp_eq_u32 s48, 0
    s_cselect_b64 s[64:65], s[56:57], vcc
    s_cselect_b64 s[66:67], s[58:59], vcc
    s_cselect_b64 s[68:69], s[60:61], vcc
    s_cselect_b64 s[70:71], s[62:63], vcc
    v_cndmask_b32 v128, v11, v7, s[64:65]
    v_cndmask_b32 v140, v11, v8, s[64:65]
    v_cndmask_b32 v136, v11, v7, vcc
    v_cndmask_b32 v129, v11, v7, s[66:67]
    v_cndmask_b32 v141, v11, v8, s[66:67]
    v_cndmask_b32 v137, v11, v7, vcc
    v_cndmask_b32 v130, v11, v7, s[68:69]
    v_cndmask_b32 v142, v11, v8, s[68:69]
    v_cndmask_b32 v138, v11, v7, vcc
    v_cndmask_b32 v131, v11, v7, s[70:71]
    v_cndmask_b32 v143, v11, v8, s[70:71]
    v_cndmask_b32 v139, v11, v7, vcc
    s_cmp_ge_u32 s48, 0
    s_cselect_b64 vcc, -1, 0
    v_cndmask_b32 v132, v11, v8, vcc
    v_cndmask_b32 v133, v11, v8, vcc
    v_cndmask_b32 v134, v11, v8, vcc
    v_cndmask_b32 v135, v11, v8, vcc
    s_cmp_gt_u32 s48, 1
    s_cselect_b64 vcc, -1, 0
    s_cmp_eq_u32 s48, 1
    s_cselect_b64 s[64:65], s[56:57], vcc
    s_cselect_b64 s[66:67], s[58:59], vcc
    s_cselect_b64 s[68:69], s[60:61], vcc
    s_cselect_b64 s[70:71], s[62:63], vcc
    v_cndmask_b32 v144, v11, v7, s[64:65]
    v_cndmask_b32 v156, v11, v8, s[64:65]
    v_cndmask_b32 v152, v11, v7, vcc
    v_cndmask_b32 v145, v11, v7, s[66:67]
    v_cndmask_b32 v157, v11, v8, s[66:67]
    v_cndmask_b32 v153, v11, v7, vcc
    v_cndmask_b32 v146, v11, v7, s[68:69]
    v_cndmask_b32 v158, v11, v8, s[68:69]
    v_cndmask_b32 v154, v11, v7, vcc
    v_cndmask_b32 v147, v11, v7, s[70:71]
    v_cndmask_b32 v159, v11, v8, s[70:71]
    v_cndmask_b32 v155, v11, v7, vcc
    s_cmp_ge_u32 s48, 1
    s_cselect_b64 vcc, -1, 0
    v_cndmask_b32 v148, v11, v8, vcc
    v_cndmask_b32 v149, v11, v8, vcc
    v_cndmask_b32 v150, v11, v8, vcc
    v_cndmask_b32 v151, v11, v8, vcc
    s_nop 1
L_nbp45:
    s_branch L_ev20
L_ev22_h:
    s_mov_b32 s98, 32
    s_cmp_eq_u32 s98, 32
    s_cbranch_scc0 L_nbp46
    s_cmp_gt_u32 s48, 2
    s_cselect_b64 vcc, -1, 0
    s_cmp_eq_u32 s48, 2
    s_cselect_b64 s[64:65], s[56:57], vcc
    s_cselect_b64 s[66:67], s[58:59], vcc
    s_cselect_b64 s[68:69], s[60:61], vcc
    s_cselect_b64 s[70:71], s[62:63], vcc
    v_cndmask_b32 v128, v11, v7, s[64:65]
    v_cndmask_b32 v140, v11, v8, s[64:65]
    v_cndmask_b32 v136, v11, v7, vcc
    v_cndmask_b32 v129, v11, v7, s[66:67]
    v_cndmask_b32 v141, v11, v8, s[66:67]
    v_cndmask_b32 v137, v11, v7, vcc
    v_cndmask_b32 v130, v11, v7, s[68:69]
    v_cndmask_b32 v142, v11, v8, s[68:69]
    v_cndmask_b32 v138, v11, v7, vcc
    v_cndmask_b32 v131, v11, v7, s[70:71]
    v_cndmask_b32 v143, v11, v8, s[70:71]
    v_cndmask_b32 v139, v11, v7, vcc
    s_cmp_ge_u32 s48, 2
    s_cselect_b64 vcc, -1, 0
    v_cndmask_b32 v132, v11, v8, vcc
    v_cndmask_b32 v133, v11, v8, vcc
    v_cndmask_b32 v134, v11, v8, vcc
    v_cndmask_b32 v135, v11, v8, vcc
    s_cmp_gt_u32 s48, 3
    s_cselect_b64 vcc, -1, 0
    s_cmp_eq_u32 s48, 3
    s_cselect_b64 s[64:65], s[56:57], vcc
    s_cselect_b64 s[66:67], s[58:59], vcc
    s_cselect_b64 s[68:69], s[60:61], vcc
    s_cselect_b64 s[70:71], s[62:63], vcc
    v_cndmask_b32 v144, v11, v7, s[64:65]
    v_cndmask_b32 v156, v11, v8, s[64:65]
    v_cndmask_b32 v152, v11, v7, vcc
    v_cndmask_b32 v145, v11, v7, s[66:67]
    v_cndmask_b32 v157, v11, v8, s[66:67]
    v_cndmask_b32 v153, v11, v7, vcc
    v_cndmask_b32 v146, v11, v7, s[68:69]
    v_cndmask_b32 v158, v11, v8, s[68:69]
    v_cndmask_b32 v154, v11, v7, vcc
    v_cndmask_b32 v147, v11, v7, s[70:71]
    v_cndmask_b32 v159, v11, v8, s[70:71]
    v_cndmask_b32 v155, v11, v7, vcc
    s_cmp_ge_u32 s48, 3
    s_cselect_b64 vcc, -1, 0
    v_cndmask_b32 v148, v11, v8, vcc
    v_cndmask_b32 v149, v11, v8, vcc
    v_cndmask_b32 v150, v11, v8, vcc
    v_cndmask_b32 v151, v11, v8, vcc
    s_nop 1
L_nbp46:
    s_branch L_ev22
L_ev28_h:
    s_mov_b32 s98, 31
    s_cmp_eq_u32 s98, 31
    s_cbranch_scc0 L_nbp47
    s_cmp_gt_u32 s48, 0
    s_cselect_b64 vcc, -1, 0
    s_cmp_eq_u32 s48, 0
    s_cselect_b64 s[64:65], s[56:57], vcc
    s_cselect_b64 s[66:67], s[58:59], vcc
    s_cselect_b64 s[68:69], s[60:61], vcc
    s_cselect_b64 s[70:71], s[62:63], vcc
    v_cndmask_b32 v128, v11, v7, s[64:65]
    v_cndmask_b32 v140, v11, v8, s[64:65]
    v_cndmask_b32 v136, v11, v7, vcc
    v_cndmask_b32 v129, v11, v7, s[66:67]
    v_cndmask_b32 v141, v11, v8, s[66:67]
    v_cndmask_b32 v137, v11, v7, vcc
    v_cndmask_b32 v130, v11, v7, s[68:69]
    v_cndmask_b32 v142, v11, v8, s[68:69]
    v_cndmask_b32 v138, v11, v7, vcc
    v_cndmask_b32 v131, v11, v7, s[70:71]
    v_cndmask_b32 v143, v11, v8, s[70:71]
    v_cndmask_b32 v139, v11, v7, vcc
    s_cmp_ge_u32 s48, 0
    s_cselect_b64 vcc, -1, 0
    v_cndmask_b32 v132, v11, v8, vcc
    v_cndmask_b32 v133, v11, v8, vcc
    v_cndmask_b32 v134, v11, v8, vcc
    v_cndmask_b32 v135, v11, v8, vcc
    s_cmp_gt_u32 s48, 1
    s_cselect_b64 vcc, -1, 0
    s_cmp_eq_u32 s48, 1
    s_cselect_b64 s[64:65], s[56:57], vcc
    s_cselect_b64 s[66:67], s[58:59], vcc
    s_cselect_b64 s[68:69], s[60:61], vcc
    s_cselect_b64 s[70:71], s[62:63], vcc
    v_cndmask_b32 v144, v11, v7, s[64:65]
    v_cndmask_b32 v156, v11, v8, s[64:65]
    v_cndmask_b32 v152, v11, v7, vcc
    v_cndmask_b32 v145, v11, v7, s[66:67]
    v_cndmask_b32 v157, v11, v8, s[66:67]
    v_cndmask_b32 v153, v11, v7, vcc
    v_cndmask_b32 v146, v11, v7, s[68:69]
    v_cndmask_b32 v158, v11, v8, s[68:69]
    v_cndmask_b32 v154, v11, v7, vcc
    v_cndmask_b32 v147, v11, v7, s[70:71]
    v_cndmask_b32 v159, v11, v8, s[70:71]
    v_cndmask_b32 v155, v11, v7, vcc
    s_cmp_ge_u32 s48, 1
    s_cselect_b64 vcc, -1, 0
    v_cndmask_b32 v148, v11, v8, vcc
    v_cndmask_b32 v149, v11, v8, vcc
    v_cndmask_b32 v150, v11, v8, vcc
    v_cndmask_b32 v151, v11, v8, vcc
    s_nop 1
L_nbp47:
    s_branch L_ev28
L_ev30_h:
    s_mov_b32 s98, 32
    s_cmp_eq_u32 s98, 32
    s_cbranch_scc0 L_nbp48
    s_cmp_gt_u32 s48, 2
    s_cselect_b64 vcc, -1, 0
    s_cmp_eq_u32 s48, 2
    s_cselect_b64 s[64:65], s[56:57], vcc
    s_cselect_b64 s[66:67], s[58:59], vcc
    s_cselect_b64 s[68:69], s[60:61], vcc
    s_cselect_b64 s[70:71], s[62:63], vcc
    v_cndmask_b32 v128, v11, v7, s[64:65]
    v_cndmask_b32 v140, v11, v8, s[64:65]
    v_cndmask_b32 v136, v11, v7, vcc
    v_cndmask_b32 v129, v11, v7, s[66:67]
    v_cndmask_b32 v141, v11, v8, s[66:67]
    v_cndmask_b32 v137, v11, v7, vcc
    v_cndmask_b32 v130, v11, v7, s[68:69]
    v_cndmask_b32 v142, v11, v8, s[68:69]
    v_cndmask_b32 v138, v11, v7, vcc
    v_cndmask_b32 v131, v11, v7, s[70:71]
    v_cndmask_b32 v143, v11, v8, s[70:71]
    v_cndmask_b32 v139, v11, v7, vcc
    s_cmp_ge_u32 s48, 2
    s_cselect_b64 vcc, -1, 0
    v_cndmask_b32 v132, v11, v8, vcc
    v_cndmask_b32 v133, v11, v8, vcc
    v_cndmask_b32 v134, v11, v8, vcc
    v_cndmask_b32 v135, v11, v8, vcc
    s_cmp_gt_u32 s48, 3
    s_cselect_b64 vcc, -1, 0
    s_cmp_eq_u32 s48, 3
    s_cselect_b64 s[64:65], s[56:57], vcc
    s_cselect_b64 s[66:67], s[58:59], vcc
    s_cselect_b64 s[68:69], s[60:61], vcc
    s_cselect_b64 s[70:71], s[62:63], vcc
    v_cndmask_b32 v144, v11, v7, s[64:65]
    v_cndmask_b32 v156, v11, v8, s[64:65]
    v_cndmask_b32 v152, v11, v7, vcc
    v_cndmask_b32 v145, v11, v7, s[66:67]
    v_cndmask_b32 v157, v11, v8, s[66:67]
    v_cndmask_b32 v153, v11, v7, vcc
    v_cndmask_b32 v146, v11, v7, s[68:69]
    v_cndmask_b32 v158, v11, v8, s[68:69]
    v_cndmask_b32 v154, v11, v7, vcc
    v_cndmask_b32 v147, v11, v7, s[70:71]
    v_cndmask_b32 v159, v11, v8, s[70:71]
    v_cndmask_b32 v155, v11, v7, vcc
    s_cmp_ge_u32 s48, 3
    s_cselect_b64 vcc, -1, 0
    v_cndmask_b32 v148, v11, v8, vcc
    v_cndmask_b32 v149, v11, v8, vcc
    v_cndmask_b32 v150, v11, v8, vcc
    v_cndmask_b32 v151, v11, v8, vcc
    s_nop 1
L_nbp48:
    s_branch L_ev30
L_slow:
    s_lshl_b32 s55, s50, 7
    s_lshl_b32 s96, s48, 5
    v_lshlrev_b32 v66, 2, v3
    v_sub_u32 v66, v4, v66
    v_add_u32 v66, s96, v66
    s_sub_u32 s96, 1920, s55
    v_add_u32 v64, s96, v66
    v_add_u32 v66, s55, v66
    v_add_u32 v65, 16, v64
    v_add_u32 v67, 16, v66
    s_lshl_b32 s55, s50, 2
    s_sub_u32 s55, 64, s55
    s_mov_b32 s96, 0
    v_mov_b32 v7, v11
    v_mov_b32 v8, v11
    v_mov_b32 v9, v11
    v_mov_b32 v10, v11
L_slow1:
    buffer_load_dwordx4 a[128:131], v2, s[28:31], s96 offen offset:0 sc1
    buffer_load_dwordx4 a[132:135], v2, s[28:31], s96 offen offset:1024 sc1
    buffer_load_dwordx4 a[136:139], v2, s[28:31], s96 offen offset:2048 sc1
    buffer_load_dwordx4 a[140:143], v2, s[28:31], s96 offen offset:3072 sc1
    s_add_u32 s53, s96, 4096
    buffer_load_dwordx4 a[144:147], v2, s[28:31], s53 offen offset:0 sc1
    buffer_load_dwordx4 a[148:151], v2, s[28:31], s53 offen offset:1024 sc1
    buffer_load_dwordx4 a[152:155], v2, s[28:31], s53 offen offset:2048 sc1
    buffer_load_dwordx4 a[156:159], v2, s[28:31], s53 offen offset:3072 sc1
    s_waitcnt vmcnt(0)
    v_mfma_f32_16x16x32_bf16 v[32:35], a[128:131], v[176:179], 0
    v_mfma_f32_16x16x32_bf16 v[40:43], a[128:131], v[192:195], 0
    v_mfma_f32_16x16x32_bf16 v[48:51], a[128:131], v[208:211], 0
    v_mfma_f32_16x16x32_bf16 v[56:59], a[128:131], v[224:227], 0
    v_mfma_f32_16x16x32_bf16 v[32:35], a[132:135], v[180:183], v[32:35]
    v_mfma_f32_16x16x32_bf16 v[40:43], a[132:135], v[196:199], v[40:43]
    v_mfma_f32_16x16x32_bf16 v[48:51], a[132:135], v[212:215], v[48:51]
    v_mfma_f32_16x16x32_bf16 v[56:59], a[132:135], v[228:231], v[56:59]
    v_mfma_f32_16x16x32_bf16 v[32:35], a[136:139], v[184:187], v[32:35]
    v_mfma_f32_16x16x32_bf16 v[40:43], a[136:139], v[200:203], v[40:43]
    v_mfma_f32_16x16x32_bf16 v[48:51], a[136:139], v[216:219], v[48:51]
    v_mfma_f32_16x16x32_bf16 v[56:59], a[136:139], v[232:235], v[56:59]
    v_mfma_f32_16x16x32_bf16 v[32:35], a[140:143], v[188:191], v[32:35]
    v_mfma_f32_16x16x32_bf16 v[40:43], a[140:143], v[204:207], v[40:43]
    v_mfma_f32_16x16x32_bf16 v[48:51], a[140:143], v[220:223], v[48:51]
    v_mfma_f32_16x16x32_bf16 v[56:59], a[140:143], v[236:239], v[56:59]
    v_mfma_f32_16x16x32_bf16 v[36:39], a[144:147], v[176:179], 0
    v_mfma_f32_16x16x32_bf16 v[44:47], a[144:147], v[192:195], 0
    v_mfma_f32_16x16x32_bf16 v[52:55], a[144:147], v[208:211], 0
    v_mfma_f32_16x16x32_bf16 v[60:63], a[144:147], v[224:227], 0
    v_mfma_f32_16x16x32_bf16 v[36:39], a[148:151], v[180:183], v[36:39]
    v_mfma_f32_16x16x32_bf16 v[44:47], a[148:151], v[196:199], v[44:47]
    v_mfma_f32_16x16x32_bf16 v[52:55], a[148:151], v[212:215], v[52:55]
    v_mfma_f32_16x16x32_bf16 v[60:63], a[148:151], v[228:231], v[60:63]
    v_mfma_f32_16x16x32_bf16 v[36:39], a[152:155], v[184:187], v[36:39]
    v_mfma_f32_16x16x32_bf16 v[44:47], a[152:155], v[200:203], v[44:47]
    v_mfma_f32_16x16x32_bf16 v[52:55], a[152:155], v[216:219], v[52:55]
    v_mfma_f32_16x16x32_bf16 v[60:63], a[152:155], v[232:235], v[60:63]
    v_mfma_f32_16x16x32_bf16 v[36:39], a[156:159], v[188:191], v[36:39]
    v_mfma_f32_16x16x32_bf16 v[44:47], a[156:159], v[204:207], v[44:47]
    v_mfma_f32_16x16x32_bf16 v[52:55], a[156:159], v[220:223], v[52:55]
    v_mfma_f32_16x16x32_bf16 v[60:63], a[156:159], v[236:239], v[60:63]
    s_nop 7
    v_cmp_le_i32 vcc, 0, v64
    s_nop 1
    v_cndmask_b32 v32, v11, v32, vcc
    v_cmp_le_i32 vcc, 1, v64
    s_nop 1
    v_cndmask_b32 v33, v11, v33, vcc
    v_cmp_le_i32 vcc, 2, v64
    s_nop 1
    v_cndmask_b32 v34, v11, v34, vcc
    v_cmp_le_i32 vcc, 3, v64
    s_nop 1
    v_cndmask_b32 v35, v11, v35, vcc
    v_cmp_le_i32 vcc, 16, v64
    s_nop 1
    v_cndmask_b32 v36, v11, v36, vcc
    v_cmp_le_i32 vcc, 17, v64
    s_nop 1
    v_cndmask_b32 v37, v11, v37, vcc
    v_cmp_le_i32 vcc, 18, v64
    s_nop 1
    v_cndmask_b32 v38, v11, v38, vcc
    v_cmp_le_i32 vcc, 19, v64
    s_nop 1
    v_cndmask_b32 v39, v11, v39, vcc
    v_cmp_le_i32 vcc, 0, v65
    s_nop 1
    v_cndmask_b32 v40, v11, v40, vcc
    v_cmp_le_i32 vcc, 1, v65
    s_nop 1
    v_cndmask_b32 v41, v11, v41, vcc
    v_cmp_le_i32 vcc, 2, v65
    s_nop 1
    v_cndmask_b32 v42, v11, v42, vcc
    v_cmp_le_i32 vcc, 3, v65
    s_nop 1
    v_cndmask_b32 v43, v11, v43, vcc
    v_cmp_le_i32 vcc, 16, v65
    s_nop 1
    v_cndmask_b32 v44, v11, v44, vcc
    v_cmp_le_i32 vcc, 17, v65
    s_nop 1
    v_cndmask_b32 v45, v11, v45, vcc
    v_cmp_le_i32 vcc, 18, v65
    s_nop 1
    v_cndmask_b32 v46, v11, v46, vcc
    v_cmp_le_i32 vcc, 19, v65
    s_nop 1
    v_cndmask_b32 v47, v11, v47, vcc
    v_cmp_le_i32 vcc, 0, v66
    s_nop 1
    v_cndmask_b32 v48, v11, v48, vcc
    v_cmp_le_i32 vcc, 1, v66
    s_nop 1
    v_cndmask_b32 v49, v11, v49, vcc
    v_cmp_le_i32 vcc, 2, v66
    s_nop 1
    v_cndmask_b32 v50, v11, v50, vcc
    v_cmp_le_i32 vcc, 3, v66
    s_nop 1
    v_cndmask_b32 v51, v11, v51, vcc
    v_cmp_le_i32 vcc, 16, v66
    s_nop 1
    v_cndmask_b32 v52, v11, v52, vcc
    v_cmp_le_i32 vcc, 17, v66
    s_nop 1
    v_cndmask_b32 v53, v11, v53, vcc
    v_cmp_le_i32 vcc, 18, v66
    s_nop 1
    v_cndmask_b32 v54, v11, v54, vcc
    v_cmp_le_i32 vcc, 19, v66
    s_nop 1
    v_cndmask_b32 v55, v11, v55, vcc
    v_cmp_le_i32 vcc, 0, v67
    s_nop 1
    v_cndmask_b32 v56, v11, v56, vcc
    v_cmp_le_i32 vcc, 1, v67
    s_nop 1
    v_cndmask_b32 v57, v11, v57, vcc
    v_cmp_le_i32 vcc, 2, v67
    s_nop 1
    v_cndmask_b32 v58, v11, v58, vcc
    v_cmp_le_i32 vcc, 3, v67
    s_nop 1
    v_cndmask_b32 v59, v11, v59, vcc
    v_cmp_le_i32 vcc, 16, v67
    s_nop 1
    v_cndmask_b32 v60, v11, v60, vcc
    v_cmp_le_i32 vcc, 17, v67
    s_nop 1
    v_cndmask_b32 v61, v11, v61, vcc
    v_cmp_le_i32 vcc, 18, v67
    s_nop 1
    v_cndmask_b32 v62, v11, v62, vcc
    v_cmp_le_i32 vcc, 19, v67
    s_nop 1
    v_cndmask_b32 v63, v11, v63, vcc
    v_max3_f32 v7, v7, v32, v33
    v_max3_f32 v7, v7, v34, v35
    v_max3_f32 v7, v7, v36, v37
    v_max3_f32 v7, v7, v38, v39
    v_max3_f32 v8, v8, v40, v41
    v_max3_f32 v8, v8, v42, v43
    v_max3_f32 v8, v8, v44, v45
    v_max3_f32 v8, v8, v46, v47
    v_max3_f32 v9, v9, v48, v49
    v_max3_f32 v9, v9, v50, v51
    v_max3_f32 v9, v9, v52, v53
    v_max3_f32 v9, v9, v54, v55
    v_max3_f32 v10, v10, v56, v57
    v_max3_f32 v10, v10, v58, v59
    v_max3_f32 v10, v10, v60, v61
    v_max3_f32 v10, v10, v62, v63
    v_subrev_u32 v64, 32, v64
    v_subrev_u32 v65, 32, v65
    v_subrev_u32 v66, 32, v66
    v_subrev_u32 v67, 32, v67
    s_add_u32 s96, s96, 8192
    s_sub_u32 s55, s55, 1
    s_cmp_lg_u32 s55, 0
    s_cbranch_scc1 L_slow1
    v_mov_b32 v68, v7
    v_mov_b32 v69, v8
    v_mov_b32 v70, v9
    v_mov_b32 v71, v10
    s_nop 0
    v_permlane16_swap_b32 v7, v68
    v_permlane16_swap_b32 v8, v69
    v_permlane16_swap_b32 v9, v70
    v_permlane16_swap_b32 v10, v71
    v_max_f32 v7, v7, v68
    v_max_f32 v8, v8, v69
    v_max_f32 v9, v9, v70
    v_max_f32 v10, v10, v71
    v_mov_b32 v68, v7
    v_mov_b32 v69, v8
    v_mov_b32 v70, v9
    v_mov_b32 v71, v10
    s_nop 0
    v_permlane32_swap_b32 v7, v68
    v_permlane32_swap_b32 v8, v69
    v_permlane32_swap_b32 v9, v70
    v_permlane32_swap_b32 v10, v71
    v_max_f32 v7, v7, v68
    v_max_f32 v8, v8, v69
    v_max_f32 v9, v9, v70
    v_max_f32 v10, v10, v71
    s_lshl_b32 s55, s50, 7
    s_lshl_b32 s96, s48, 5
    v_lshlrev_b32 v66, 2, v3
    v_sub_u32 v66, v4, v66
    v_add_u32 v66, s96, v66
    s_sub_u32 s96, 1920, s55
    v_add_u32 v64, s96, v66
    v_add_u32 v66, s55, v66
    v_add_u32 v65, 16, v64
    v_add_u32 v67, 16, v66
    s_lshl_b32 s55, s50, 2
    s_sub_u32 s55, 64, s55
    s_mov_b32 s96, 0
    v_accvgpr_write_b32 a0, 0
    v_accvgpr_write_b32 a1, 0
    v_accvgpr_write_b32 a2, 0
    v_accvgpr_write_b32 a3, 0
    v_accvgpr_write_b32 a4, 0
    v_accvgpr_write_b32 a5, 0
    v_accvgpr_write_b32 a6, 0
    v_accvgpr_write_b32 a7, 0
    v_accvgpr_write_b32 a8, 0
    v_accvgpr_write_b32 a9, 0
    v_accvgpr_write_b32 a10, 0
    v_accvgpr_write_b32 a11, 0
    v_accvgpr_write_b32 a12, 0
    v_accvgpr_write_b32 a13, 0
    v_accvgpr_write_b32 a14, 0
    v_accvgpr_write_b32 a15, 0
    v_accvgpr_write_b32 a16, 0
    v_accvgpr_write_b32 a17, 0
    v_accvgpr_write_b32 a18, 0
    v_accvgpr_write_b32 a19, 0
    v_accvgpr_write_b32 a20, 0
    v_accvgpr_write_b32 a21, 0
    v_accvgpr_write_b32 a22, 0
    v_accvgpr_write_b32 a23, 0
    v_accvgpr_write_b32 a24, 0
    v_accvgpr_write_b32 a25, 0
    v_accvgpr_write_b32 a26, 0
    v_accvgpr_write_b32 a27, 0
    v_accvgpr_write_b32 a28, 0
    v_accvgpr_write_b32 a29, 0
    v_accvgpr_write_b32 a30, 0
    v_accvgpr_write_b32 a31, 0
    v_accvgpr_write_b32 a32, 0
    v_accvgpr_write_b32 a33, 0
    v_accvgpr_write_b32 a34, 0
    v_accvgpr_write_b32 a35, 0
    v_accvgpr_write_b32 a36, 0
    v_accvgpr_write_b32 a37, 0
    v_accvgpr_write_b32 a38, 0
    v_accvgpr_write_b32 a39, 0
    v_accvgpr_write_b32 a40, 0
    v_accvgpr_write_b32 a41, 0
    v_accvgpr_write_b32 a42, 0
    v_accvgpr_write_b32 a43, 0
    v_accvgpr_write_b32 a44, 0
    v_accvgpr_write_b32 a45, 0
    v_accvgpr_write_b32 a46, 0
    v_accvgpr_write_b32 a47, 0
    v_accvgpr_write_b32 a48, 0
    v_accvgpr_write_b32 a49, 0
    v_accvgpr_write_b32 a50, 0
    v_accvgpr_write_b32 a51, 0
    v_accvgpr_write_b32 a52, 0
    v_accvgpr_write_b32 a53, 0
    v_accvgpr_write_b32 a54, 0
    v_accvgpr_write_b32 a55, 0
    v_accvgpr_write_b32 a56, 0
    v_accvgpr_write_b32 a57, 0
    v_accvgpr_write_b32 a58, 0
    v_accvgpr_write_b32 a59, 0
    v_accvgpr_write_b32 a60, 0
    v_accvgpr_write_b32 a61, 0
    v_accvgpr_write_b32 a62, 0
    v_accvgpr_write_b32 a63, 0
    v_accvgpr_write_b32 a64, 0
    v_accvgpr_write_b32 a65, 0
    v_accvgpr_write_b32 a66, 0
    v_accvgpr_write_b32 a67, 0
    v_accvgpr_write_b32 a68, 0
    v_accvgpr_write_b32 a69, 0
    v_accvgpr_write_b32 a70, 0
    v_accvgpr_write_b32 a71, 0
    v_accvgpr_write_b32 a72, 0
    v_accvgpr_write_b32 a73, 0
    v_accvgpr_write_b32 a74, 0
    v_accvgpr_write_b32 a75, 0
    v_accvgpr_write_b32 a76, 0
    v_accvgpr_write_b32 a77, 0
    v_accvgpr_write_b32 a78, 0
    v_accvgpr_write_b32 a79, 0
    v_accvgpr_write_b32 a80, 0
    v_accvgpr_write_b32 a81, 0
    v_accvgpr_write_b32 a82, 0
    v_accvgpr_write_b32 a83, 0
    v_accvgpr_write_b32 a84, 0
    v_accvgpr_write_b32 a85, 0
    v_accvgpr_write_b32 a86, 0
    v_accvgpr_write_b32 a87, 0
    v_accvgpr_write_b32 a88, 0
    v_accvgpr_write_b32 a89, 0
    v_accvgpr_write_b32 a90, 0
    v_accvgpr_write_b32 a91, 0
    v_accvgpr_write_b32 a92, 0
    v_accvgpr_write_b32 a93, 0
    v_accvgpr_write_b32 a94, 0
    v_accvgpr_write_b32 a95, 0
    v_accvgpr_write_b32 a96, 0
    v_accvgpr_write_b32 a97, 0
    v_accvgpr_write_b32 a98, 0
    v_accvgpr_write_b32 a99, 0
    v_accvgpr_write_b32 a100, 0
    v_accvgpr_write_b32 a101, 0
    v_accvgpr_write_b32 a102, 0
    v_accvgpr_write_b32 a103, 0
    v_accvgpr_write_b32 a104, 0
    v_accvgpr_write_b32 a105, 0
    v_accvgpr_write_b32 a106, 0
    v_accvgpr_write_b32 a107, 0
    v_accvgpr_write_b32 a108, 0
    v_accvgpr_write_b32 a109, 0
    v_accvgpr_write_b32 a110, 0
    v_accvgpr_write_b32 a111, 0
    v_accvgpr_write_b32 a112, 0
    v_accvgpr_write_b32 a113, 0
    v_accvgpr_write_b32 a114, 0
    v_accvgpr_write_b32 a115, 0
    v_accvgpr_write_b32 a116, 0
    v_accvgpr_write_b32 a117, 0
    v_accvgpr_write_b32 a118, 0
    v_accvgpr_write_b32 a119, 0
    v_accvgpr_write_b32 a120, 0
    v_accvgpr_write_b32 a121, 0
    v_accvgpr_write_b32 a122, 0
    v_accvgpr_write_b32 a123, 0
    v_accvgpr_write_b32 a124, 0
    v_accvgpr_write_b32 a125, 0
    v_accvgpr_write_b32 a126, 0
    v_accvgpr_write_b32 a127, 0
    v_accvgpr_write_b32 a192, 0
    v_accvgpr_write_b32 a193, 0
    v_accvgpr_write_b32 a194, 0
    v_accvgpr_write_b32 a195, 0
    v_accvgpr_write_b32 a196, 0
    v_accvgpr_write_b32 a197, 0
    v_accvgpr_write_b32 a198, 0
    v_accvgpr_write_b32 a199, 0
    v_accvgpr_write_b32 a200, 0
    v_accvgpr_write_b32 a201, 0
    v_accvgpr_write_b32 a202, 0
    v_accvgpr_write_b32 a203, 0
    v_accvgpr_write_b32 a204, 0
    v_accvgpr_write_b32 a205, 0
    v_accvgpr_write_b32 a206, 0
    v_accvgpr_write_b32 a207, 0
L_slow2:
    buffer_load_dwordx4 a[128:131], v2, s[28:31], s96 offen offset:0 sc1
    buffer_load_dwordx4 a[208:211], v2, s[32:35], s96 offen offset:0 sc1
    buffer_load_dwordx4 a[132:135], v2, s[28:31], s96 offen offset:1024 sc1
    buffer_load_dwordx4 a[212:215], v2, s[32:35], s96 offen offset:1024 sc1
    buffer_load_dwordx4 a[136:139], v2, s[28:31], s96 offen offset:2048 sc1
    buffer_load_dwordx4 a[216:219], v2, s[32:35], s96 offen offset:2048 sc1
    buffer_load_dwordx4 a[140:143], v2, s[28:31], s96 offen offset:3072 sc1
    buffer_load_dwordx4 a[220:223], v2, s[32:35], s96 offen offset:3072 sc1
    s_add_u32 s53, s96, 4096
    buffer_load_dwordx4 a[144:147], v2, s[28:31], s53 offen offset:0 sc1
    buffer_load_dwordx4 a[224:227], v2, s[32:35], s53 offen offset:0 sc1
    buffer_load_dwordx4 a[148:151], v2, s[28:31], s53 offen offset:1024 sc1
    buffer_load_dwordx4 a[228:231], v2, s[32:35], s53 offen offset:1024 sc1
    buffer_load_dwordx4 a[152:155], v2, s[28:31], s53 offen offset:2048 sc1
    buffer_load_dwordx4 a[232:235], v2, s[32:35], s53 offen offset:2048 sc1
    buffer_load_dwordx4 a[156:159], v2, s[28:31], s53 offen offset:3072 sc1
    buffer_load_dwordx4 a[236:239], v2, s[32:35], s53 offen offset:3072 sc1
    s_waitcnt vmcnt(0)
    v_mfma_f32_16x16x32_bf16 v[32:35], a[128:131], v[176:179], 0
    v_mfma_f32_16x16x32_bf16 v[40:43], a[128:131], v[192:195], 0
    v_mfma_f32_16x16x32_bf16 v[48:51], a[128:131], v[208:211], 0
    v_mfma_f32_16x16x32_bf16 v[56:59], a[128:131], v[224:227], 0
    v_mfma_f32_16x16x32_bf16 v[32:35], a[132:135], v[180:183], v[32:35]
    v_mfma_f32_16x16x32_bf16 v[40:43], a[132:135], v[196:199], v[40:43]
    v_mfma_f32_16x16x32_bf16 v[48:51], a[132:135], v[212:215], v[48:51]
    v_mfma_f32_16x16x32_bf16 v[56:59], a[132:135], v[228:231], v[56:59]
    v_mfma_f32_16x16x32_bf16 v[32:35], a[136:139], v[184:187], v[32:35]
    v_mfma_f32_16x16x32_bf16 v[40:43], a[136:139], v[200:203], v[40:43]
    v_mfma_f32_16x16x32_bf16 v[48:51], a[136:139], v[216:219], v[48:51]
    v_mfma_f32_16x16x32_bf16 v[56:59], a[136:139], v[232:235], v[56:59]
    v_mfma_f32_16x16x32_bf16 v[32:35], a[140:143], v[188:191], v[32:35]
    v_mfma_f32_16x16x32_bf16 v[40:43], a[140:143], v[204:207], v[40:43]
    v_mfma_f32_16x16x32_bf16 v[48:51], a[140:143], v[220:223], v[48:51]
    v_mfma_f32_16x16x32_bf16 v[56:59], a[140:143], v[236:239], v[56:59]
    v_mfma_f32_16x16x32_bf16 v[36:39], a[144:147], v[176:179], 0
    v_mfma_f32_16x16x32_bf16 v[44:47], a[144:147], v[192:195], 0
    v_mfma_f32_16x16x32_bf16 v[52:55], a[144:147], v[208:211], 0
    v_mfma_f32_16x16x32_bf16 v[60:63], a[144:147], v[224:227], 0
    v_mfma_f32_16x16x32_bf16 v[36:39], a[148:151], v[180:183], v[36:39]
    v_mfma_f32_16x16x32_bf16 v[44:47], a[148:151], v[196:199], v[44:47]
    v_mfma_f32_16x16x32_bf16 v[52:55], a[148:151], v[212:215], v[52:55]
    v_mfma_f32_16x16x32_bf16 v[60:63], a[148:151], v[228:231], v[60:63]
    v_mfma_f32_16x16x32_bf16 v[36:39], a[152:155], v[184:187], v[36:39]
    v_mfma_f32_16x16x32_bf16 v[44:47], a[152:155], v[200:203], v[44:47]
    v_mfma_f32_16x16x32_bf16 v[52:55], a[152:155], v[216:219], v[52:55]
    v_mfma_f32_16x16x32_bf16 v[60:63], a[152:155], v[232:235], v[60:63]
    v_mfma_f32_16x16x32_bf16 v[36:39], a[156:159], v[188:191], v[36:39]
    v_mfma_f32_16x16x32_bf16 v[44:47], a[156:159], v[204:207], v[44:47]
    v_mfma_f32_16x16x32_bf16 v[52:55], a[156:159], v[220:223], v[52:55]
    v_mfma_f32_16x16x32_bf16 v[60:63], a[156:159], v[236:239], v[60:63]
    s_nop 7
    v_cmp_le_i32 vcc, 0, v64
    s_nop 1
    v_cndmask_b32 v32, v11, v32, vcc
    v_cmp_le_i32 vcc, 1, v64
    s_nop 1
    v_cndmask_b32 v33, v11, v33, vcc
    v_cmp_le_i32 vcc, 2, v64
    s_nop 1
    v_cndmask_b32 v34, v11, v34, vcc
    v_cmp_le_i32 vcc, 3, v64
    s_nop 1
    v_cndmask_b32 v35, v11, v35, vcc
    v_cmp_le_i32 vcc, 16, v64
    s_nop 1
    v_cndmask_b32 v36, v11, v36, vcc
    v_cmp_le_i32 vcc, 17, v64
    s_nop 1
    v_cndmask_b32 v37, v11, v37, vcc
    v_cmp_le_i32 vcc, 18, v64
    s_nop 1
    v_cndmask_b32 v38, v11, v38, vcc
    v_cmp_le_i32 vcc, 19, v64
    s_nop 1
    v_cndmask_b32 v39, v11, v39, vcc
    v_cmp_le_i32 vcc, 0, v65
    s_nop 1
    v_cndmask_b32 v40, v11, v40, vcc
    v_cmp_le_i32 vcc, 1, v65
    s_nop 1
    v_cndmask_b32 v41, v11, v41, vcc
    v_cmp_le_i32 vcc, 2, v65
    s_nop 1
    v_cndmask_b32 v42, v11, v42, vcc
    v_cmp_le_i32 vcc, 3, v65
    s_nop 1
    v_cndmask_b32 v43, v11, v43, vcc
    v_cmp_le_i32 vcc, 16, v65
    s_nop 1
    v_cndmask_b32 v44, v11, v44, vcc
    v_cmp_le_i32 vcc, 17, v65
    s_nop 1
    v_cndmask_b32 v45, v11, v45, vcc
    v_cmp_le_i32 vcc, 18, v65
    s_nop 1
    v_cndmask_b32 v46, v11, v46, vcc
    v_cmp_le_i32 vcc, 19, v65
    s_nop 1
    v_cndmask_b32 v47, v11, v47, vcc
    v_cmp_le_i32 vcc, 0, v66
    s_nop 1
    v_cndmask_b32 v48, v11, v48, vcc
    v_cmp_le_i32 vcc, 1, v66
    s_nop 1
    v_cndmask_b32 v49, v11, v49, vcc
    v_cmp_le_i32 vcc, 2, v66
    s_nop 1
    v_cndmask_b32 v50, v11, v50, vcc
    v_cmp_le_i32 vcc, 3, v66
    s_nop 1
    v_cndmask_b32 v51, v11, v51, vcc
    v_cmp_le_i32 vcc, 16, v66
    s_nop 1
    v_cndmask_b32 v52, v11, v52, vcc
    v_cmp_le_i32 vcc, 17, v66
    s_nop 1
    v_cndmask_b32 v53, v11, v53, vcc
    v_cmp_le_i32 vcc, 18, v66
    s_nop 1
    v_cndmask_b32 v54, v11, v54, vcc
    v_cmp_le_i32 vcc, 19, v66
    s_nop 1
    v_cndmask_b32 v55, v11, v55, vcc
    v_cmp_le_i32 vcc, 0, v67
    s_nop 1
    v_cndmask_b32 v56, v11, v56, vcc
    v_cmp_le_i32 vcc, 1, v67
    s_nop 1
    v_cndmask_b32 v57, v11, v57, vcc
    v_cmp_le_i32 vcc, 2, v67
    s_nop 1
    v_cndmask_b32 v58, v11, v58, vcc
    v_cmp_le_i32 vcc, 3, v67
    s_nop 1
    v_cndmask_b32 v59, v11, v59, vcc
    v_cmp_le_i32 vcc, 16, v67
    s_nop 1
    v_cndmask_b32 v60, v11, v60, vcc
    v_cmp_le_i32 vcc, 17, v67
    s_nop 1
    v_cndmask_b32 v61, v11, v61, vcc
    v_cmp_le_i32 vcc, 18, v67
    s_nop 1
    v_cndmask_b32 v62, v11, v62, vcc
    v_cmp_le_i32 vcc, 19, v67
    s_nop 1
    v_cndmask_b32 v63, v11, v63, vcc
    v_sub_f32 v32, v32, v7
    v_sub_f32 v33, v33, v7
    v_sub_f32 v34, v34, v7
    v_sub_f32 v35, v35, v7
    v_sub_f32 v36, v36, v7
    v_sub_f32 v37, v37, v7
    v_sub_f32 v38, v38, v7
    v_sub_f32 v39, v39, v7
    v_sub_f32 v40, v40, v8
    v_sub_f32 v41, v41, v8
    v_sub_f32 v42, v42, v8
    v_sub_f32 v43, v43, v8
    v_sub_f32 v44, v44, v8
    v_sub_f32 v45, v45, v8
    v_sub_f32 v46, v46, v8
    v_sub_f32 v47, v47, v8
    v_sub_f32 v48, v48, v9
    v_sub_f32 v49, v49, v9
    v_sub_f32 v50, v50, v9
    v_sub_f32 v51, v51, v9
    v_sub_f32 v52, v52, v9
    v_sub_f32 v53, v53, v9
    v_sub_f32 v54, v54, v9
    v_sub_f32 v55, v55, v9
    v_sub_f32 v56, v56, v10
    v_sub_f32 v57, v57, v10
    v_sub_f32 v58, v58, v10
    v_sub_f32 v59, v59, v10
    v_sub_f32 v60, v60, v10
    v_sub_f32 v61, v61, v10
    v_sub_f32 v62, v62, v10
    v_sub_f32 v63, v63, v10
    v_exp_f32 v32, v32
    v_exp_f32 v33, v33
    v_exp_f32 v34, v34
    v_exp_f32 v35, v35
    v_exp_f32 v36, v36
    v_exp_f32 v37, v37
    v_exp_f32 v38, v38
    v_exp_f32 v39, v39
    v_exp_f32 v40, v40
    v_exp_f32 v41, v41
    v_exp_f32 v42, v42
    v_exp_f32 v43, v43
    v_exp_f32 v44, v44
    v_exp_f32 v45, v45
    v_exp_f32 v46, v46
    v_exp_f32 v47, v47
    v_exp_f32 v48, v48
    v_exp_f32 v49, v49
    v_exp_f32 v50, v50
    v_exp_f32 v51, v51
    v_exp_f32 v52, v52
    v_exp_f32 v53, v53
    v_exp_f32 v54, v54
    v_exp_f32 v55, v55
    v_exp_f32 v56, v56
    v_exp_f32 v57, v57
    v_exp_f32 v58, v58
    v_exp_f32 v59, v59
    v_exp_f32 v60, v60
    v_exp_f32 v61, v61
    v_exp_f32 v62, v62
    v_exp_f32 v63, v63
    s_nop 0
    v_cvt_pk_bf16_f32 v96, v32, v33
    v_cvt_pk_bf16_f32 v97, v34, v35
    v_cvt_pk_bf16_f32 v98, v36, v37
    v_cvt_pk_bf16_f32 v99, v38, v39
    v_cvt_pk_bf16_f32 v100, v40, v41
    v_cvt_pk_bf16_f32 v101, v42, v43
    v_cvt_pk_bf16_f32 v102, v44, v45
    v_cvt_pk_bf16_f32 v103, v46, v47
    v_cvt_pk_bf16_f32 v104, v48, v49
    v_cvt_pk_bf16_f32 v105, v50, v51
    v_cvt_pk_bf16_f32 v106, v52, v53
    v_cvt_pk_bf16_f32 v107, v54, v55
    v_cvt_pk_bf16_f32 v108, v56, v57
    v_cvt_pk_bf16_f32 v109, v58, v59
    v_cvt_pk_bf16_f32 v110, v60, v61
    v_cvt_pk_bf16_f32 v111, v62, v63
    s_nop 1
    v_mfma_f32_16x16x32_bf16 a[0:3], a[208:211], v[96:99], a[0:3]
    v_mfma_f32_16x16x32_bf16 a[32:35], a[208:211], v[100:103], a[32:35]
    v_mfma_f32_16x16x32_bf16 a[64:67], a[208:211], v[104:107], a[64:67]
    v_mfma_f32_16x16x32_bf16 a[96:99], a[208:211], v[108:111], a[96:99]
    v_mfma_f32_16x16x32_bf16 a[100:103], a[212:215], v[108:111], a[100:103]
    v_mfma_f32_16x16x32_bf16 a[68:71], a[212:215], v[104:107], a[68:71]
    v_mfma_f32_16x16x32_bf16 a[36:39], a[212:215], v[100:103], a[36:39]
    v_mfma_f32_16x16x32_bf16 a[4:7], a[212:215], v[96:99], a[4:7]
    v_mfma_f32_16x16x32_bf16 a[192:195], v[28:31], v[96:99], a[192:195]
    v_mfma_f32_16x16x32_bf16 a[8:11], a[216:219], v[96:99], a[8:11]
    v_mfma_f32_16x16x32_bf16 a[40:43], a[216:219], v[100:103], a[40:43]
    v_mfma_f32_16x16x32_bf16 a[72:75], a[216:219], v[104:107], a[72:75]
    v_mfma_f32_16x16x32_bf16 a[104:107], a[216:219], v[108:111], a[104:107]
    v_mfma_f32_16x16x32_bf16 a[108:111], a[220:223], v[108:111], a[108:111]
    v_mfma_f32_16x16x32_bf16 a[76:79], a[220:223], v[104:107], a[76:79]
    v_mfma_f32_16x16x32_bf16 a[44:47], a[220:223], v[100:103], a[44:47]
    v_mfma_f32_16x16x32_bf16 a[12:15], a[220:223], v[96:99], a[12:15]
    v_mfma_f32_16x16x32_bf16 a[196:199], v[28:31], v[100:103], a[196:199]
    v_mfma_f32_16x16x32_bf16 a[16:19], a[224:227], v[96:99], a[16:19]
    v_mfma_f32_16x16x32_bf16 a[48:51], a[224:227], v[100:103], a[48:51]
    v_mfma_f32_16x16x32_bf16 a[80:83], a[224:227], v[104:107], a[80:83]
    v_mfma_f32_16x16x32_bf16 a[112:115], a[224:227], v[108:111], a[112:115]
    v_mfma_f32_16x16x32_bf16 a[116:119], a[228:231], v[108:111], a[116:119]
    v_mfma_f32_16x16x32_bf16 a[84:87], a[228:231], v[104:107], a[84:87]
    v_mfma_f32_16x16x32_bf16 a[52:55], a[228:231], v[100:103], a[52:55]
    v_mfma_f32_16x16x32_bf16 a[20:23], a[228:231], v[96:99], a[20:23]
    v_mfma_f32_16x16x32_bf16 a[200:203], v[28:31], v[104:107], a[200:203]
    v_mfma_f32_16x16x32_bf16 a[24:27], a[232:235], v[96:99], a[24:27]
    v_mfma_f32_16x16x32_bf16 a[56:59], a[232:235], v[100:103], a[56:59]
    v_mfma_f32_16x16x32_bf16 a[88:91], a[232:235], v[104:107], a[88:91]
    v_mfma_f32_16x16x32_bf16 a[120:123], a[232:235], v[108:111], a[120:123]
    v_mfma_f32_16x16x32_bf16 a[124:127], a[236:239], v[108:111], a[124:127]
    v_mfma_f32_16x16x32_bf16 a[92:95], a[236:239], v[104:107], a[92:95]
    v_mfma_f32_16x16x32_bf16 a[60:63], a[236:239], v[100:103], a[60:63]
    v_mfma_f32_16x16x32_bf16 a[28:31], a[236:239], v[96:99], a[28:31]
    v_mfma_f32_16x16x32_bf16 a[204:207], v[28:31], v[108:111], a[204:207]
    s_nop 3
    v_subrev_u32 v64, 32, v64
    v_subrev_u32 v65, 32, v65
    v_subrev_u32 v66, 32, v66
    v_subrev_u32 v67, 32, v67
    s_add_u32 s96, s96, 8192
    s_sub_u32 s55, s55, 1
    s_cmp_lg_u32 s55, 0
    s_cbranch_scc1 L_slow2
    s_nop 7
    v_accvgpr_read_b32 v32, a192
    v_accvgpr_read_b32 v33, a196
    v_accvgpr_read_b32 v34, a200
    v_accvgpr_read_b32 v35, a204
    v_rcp_f32 v36, v32
    v_rcp_f32 v37, v33
    v_rcp_f32 v38, v34
    v_rcp_f32 v39, v35
    s_lshl_b32 s51, s48, 18
    s_lshl_b32 s52, s49, 12
    s_add_u32 s51, s51, s52
    s_lshl_b32 s52, s50, 20
    s_add_u32 s51, s51, s52
    v_accvgpr_read_b32 v40, a64
    v_accvgpr_read_b32 v41, a65
    v_accvgpr_read_b32 v42, a66
    v_accvgpr_read_b32 v43, a67
    v_accvgpr_read_b32 v44, a68
    v_accvgpr_read_b32 v45, a69
    v_accvgpr_read_b32 v46, a70
    v_accvgpr_read_b32 v47, a71
    v_mul_f32 v40, v38, v40
    v_mul_f32 v41, v38, v41
    v_mul_f32 v42, v38, v42
    v_mul_f32 v43, v38, v43
    v_mul_f32 v44, v38, v44
    v_mul_f32 v45, v38, v45
    v_mul_f32 v46, v38, v46
    v_mul_f32 v47, v38, v47
    v_cvt_pk_bf16_f32 v48, v40, v41
    v_cvt_pk_bf16_f32 v49, v42, v43
    v_cvt_pk_bf16_f32 v50, v44, v45
    v_cvt_pk_bf16_f32 v51, v46, v47
    buffer_store_dwordx4 v[48:51], v2, s[36:39], s51 offen offset:0 sc1
    v_accvgpr_read_b32 v52, a72
    v_accvgpr_read_b32 v53, a73
    v_accvgpr_read_b32 v54, a74
    v_accvgpr_read_b32 v55, a75
    v_accvgpr_read_b32 v56, a76
    v_accvgpr_read_b32 v57, a77
    v_accvgpr_read_b32 v58, a78
    v_accvgpr_read_b32 v59, a79
    v_mul_f32 v52, v38, v52
    v_mul_f32 v53, v38, v53
    v_mul_f32 v54, v38, v54
    v_mul_f32 v55, v38, v55
    v_mul_f32 v56, v38, v56
    v_mul_f32 v57, v38, v57
    v_mul_f32 v58, v38, v58
    v_mul_f32 v59, v38, v59
    v_cvt_pk_bf16_f32 v60, v52, v53
    v_cvt_pk_bf16_f32 v61, v54, v55
    v_cvt_pk_bf16_f32 v62, v56, v57
    v_cvt_pk_bf16_f32 v63, v58, v59
    buffer_store_dwordx4 v[60:63], v2, s[36:39], s51 offen offset:1024 sc1
    v_accvgpr_read_b32 v40, a80
    v_accvgpr_read_b32 v41, a81
    v_accvgpr_read_b32 v42, a82
    v_accvgpr_read_b32 v43, a83
    v_accvgpr_read_b32 v44, a84
    v_accvgpr_read_b32 v45, a85
    v_accvgpr_read_b32 v46, a86
    v_accvgpr_read_b32 v47, a87
    v_mul_f32 v40, v38, v40
    v_mul_f32 v41, v38, v41
    v_mul_f32 v42, v38, v42
    v_mul_f32 v43, v38, v43
    v_mul_f32 v44, v38, v44
    v_mul_f32 v45, v38, v45
    v_mul_f32 v46, v38, v46
    v_mul_f32 v47, v38, v47
    v_cvt_pk_bf16_f32 v48, v40, v41
    v_cvt_pk_bf16_f32 v49, v42, v43
    v_cvt_pk_bf16_f32 v50, v44, v45
    v_cvt_pk_bf16_f32 v51, v46, v47
    buffer_store_dwordx4 v[48:51], v2, s[36:39], s51 offen offset:2048 sc1
    v_accvgpr_read_b32 v52, a88
    v_accvgpr_read_b32 v53, a89
    v_accvgpr_read_b32 v54, a90
    v_accvgpr_read_b32 v55, a91
    v_accvgpr_read_b32 v56, a92
    v_accvgpr_read_b32 v57, a93
    v_accvgpr_read_b32 v58, a94
    v_accvgpr_read_b32 v59, a95
    v_mul_f32 v52, v38, v52
    v_mul_f32 v53, v38, v53
    v_mul_f32 v54, v38, v54
    v_mul_f32 v55, v38, v55
    v_mul_f32 v56, v38, v56
    v_mul_f32 v57, v38, v57
    v_mul_f32 v58, v38, v58
    v_mul_f32 v59, v38, v59
    v_cvt_pk_bf16_f32 v60, v52, v53
    v_cvt_pk_bf16_f32 v61, v54, v55
    v_cvt_pk_bf16_f32 v62, v56, v57
    v_cvt_pk_bf16_f32 v63, v58, v59
    buffer_store_dwordx4 v[60:63], v2, s[36:39], s51 offen offset:3072 sc1
    s_add_u32 s51, s51, 131072
    v_accvgpr_read_b32 v40, a96
    v_accvgpr_read_b32 v41, a97
    v_accvgpr_read_b32 v42, a98
    v_accvgpr_read_b32 v43, a99
    v_accvgpr_read_b32 v44, a100
    v_accvgpr_read_b32 v45, a101
    v_accvgpr_read_b32 v46, a102
    v_accvgpr_read_b32 v47, a103
    v_mul_f32 v40, v39, v40
    v_mul_f32 v41, v39, v41
    v_mul_f32 v42, v39, v42
    v_mul_f32 v43, v39, v43
    v_mul_f32 v44, v39, v44
    v_mul_f32 v45, v39, v45
    v_mul_f32 v46, v39, v46
    v_mul_f32 v47, v39, v47
    v_cvt_pk_bf16_f32 v48, v40, v41
    v_cvt_pk_bf16_f32 v49, v42, v43
    v_cvt_pk_bf16_f32 v50, v44, v45
    v_cvt_pk_bf16_f32 v51, v46, v47
    buffer_store_dwordx4 v[48:51], v2, s[36:39], s51 offen offset:0 sc1
    v_accvgpr_read_b32 v52, a104
    v_accvgpr_read_b32 v53, a105
    v_accvgpr_read_b32 v54, a106
    v_accvgpr_read_b32 v55, a107
    v_accvgpr_read_b32 v56, a108
    v_accvgpr_read_b32 v57, a109
    v_accvgpr_read_b32 v58, a110
    v_accvgpr_read_b32 v59, a111
    v_mul_f32 v52, v39, v52
    v_mul_f32 v53, v39, v53
    v_mul_f32 v54, v39, v54
    v_mul_f32 v55, v39, v55
    v_mul_f32 v56, v39, v56
    v_mul_f32 v57, v39, v57
    v_mul_f32 v58, v39, v58
    v_mul_f32 v59, v39, v59
    v_cvt_pk_bf16_f32 v60, v52, v53
    v_cvt_pk_bf16_f32 v61, v54, v55
    v_cvt_pk_bf16_f32 v62, v56, v57
    v_cvt_pk_bf16_f32 v63, v58, v59
    buffer_store_dwordx4 v[60:63], v2, s[36:39], s51 offen offset:1024 sc1
    v_accvgpr_read_b32 v40, a112
    v_accvgpr_read_b32 v41, a113
    v_accvgpr_read_b32 v42, a114
    v_accvgpr_read_b32 v43, a115
    v_accvgpr_read_b32 v44, a116
    v_accvgpr_read_b32 v45, a117
    v_accvgpr_read_b32 v46, a118
    v_accvgpr_read_b32 v47, a119
    v_mul_f32 v40, v39, v40
    v_mul_f32 v41, v39, v41
    v_mul_f32 v42, v39, v42
    v_mul_f32 v43, v39, v43
    v_mul_f32 v44, v39, v44
    v_mul_f32 v45, v39, v45
    v_mul_f32 v46, v39, v46
    v_mul_f32 v47, v39, v47
    v_cvt_pk_bf16_f32 v48, v40, v41
    v_cvt_pk_bf16_f32 v49, v42, v43
    v_cvt_pk_bf16_f32 v50, v44, v45
    v_cvt_pk_bf16_f32 v51, v46, v47
    buffer_store_dwordx4 v[48:51], v2, s[36:39], s51 offen offset:2048 sc1
    v_accvgpr_read_b32 v52, a120
    v_accvgpr_read_b32 v53, a121
    v_accvgpr_read_b32 v54, a122
    v_accvgpr_read_b32 v55, a123
    v_accvgpr_read_b32 v56, a124
    v_accvgpr_read_b32 v57, a125
    v_accvgpr_read_b32 v58, a126
    v_accvgpr_read_b32 v59, a127
    v_mul_f32 v52, v39, v52
    v_mul_f32 v53, v39, v53
    v_mul_f32 v54, v39, v54
    v_mul_f32 v55, v39, v55
    v_mul_f32 v56, v39, v56
    v_mul_f32 v57, v39, v57
    v_mul_f32 v58, v39, v58
    v_mul_f32 v59, v39, v59
    v_cvt_pk_bf16_f32 v60, v52, v53
    v_cvt_pk_bf16_f32 v61, v54, v55
    v_cvt_pk_bf16_f32 v62, v56, v57
    v_cvt_pk_bf16_f32 v63, v58, v59
    buffer_store_dwordx4 v[60:63], v2, s[36:39], s51 offen offset:3072 sc1
    s_branch L_fin2
.section .rodata,"a"
.p2align 6
.amdhsa_kernel concat_heads__sliding_local_dilated__compressed_kv_cla__prompt_kernel
      .amdhsa_next_free_vgpr 512
      .amdhsa_next_free_sgpr 102
      .amdhsa_accum_offset 256
      .amdhsa_group_segment_fixed_size 0
      .amdhsa_kernarg_size 96
      .amdhsa_user_sgpr_count 2
      .amdhsa_user_sgpr_kernarg_segment_ptr 1
      .amdhsa_system_sgpr_workgroup_id_x 1
.end_amdhsa_kernel
```
